```python
import torch

def _softmax(x, axis=-1):
    return torch.softmax(x, dim=axis)
def _gelu(x):
    return torch.nn.functional.gelu(x, approximate="tanh")
def _silu(x):
    return torch.nn.functional.silu(x)
def _sigmoid(x):
    return torch.sigmoid(x)
def _layernorm(x, axis=-1, eps=1e-5):
    m = x.mean(dim=axis, keepdim=True)
    v = x.var(dim=axis, keepdim=True, unbiased=False)
    return (x - m) / torch.sqrt(v + eps)
def _scatter_add(tgt, idx, src, axis=0):
    return tgt.clone().index_add_(axis, idx, src)
def _segment_sum(src, seg, n):
    out = torch.zeros((n,) + src.shape[1:], dtype=src.dtype)
    return out.index_add_(0, seg, src)
def _pad(x, pw):
    flat = tuple(v for pair in reversed(pw) for v in pair)
    return torch.nn.functional.pad(x, flat)

kernel_name = 'parallel_sum__grouped_kv_mqa__geglu_ffn__prompt'

def setup_inputs():

    _w = (lambda a: (lambda t: t.to(torch.bfloat16) if t.is_floating_point() else t)(torch.as_tensor(a)))
    def _A_setup():
        B, S, D, H = 1, 2048, 576, 32
        Dh = D // H
        return {
            "x": _w((lambda *s: torch.randn(*s, dtype=torch.bfloat16) * 0.05)(B, S, D)),
            "wq": _w((lambda *s: torch.randn(*s, dtype=torch.bfloat16) * 0.2)(D, H * Dh)),
            "wk": _w((lambda *s: torch.randn(*s, dtype=torch.bfloat16) * 0.2)(D, Dh)),
            "wv": _w((lambda *s: torch.randn(*s, dtype=torch.bfloat16) * 0.1)(D, Dh)),
            "wo": _w((lambda *s: torch.randn(*s, dtype=torch.bfloat16) * 0.1)(H * Dh, D)),
        }
    _A_in = _A_setup()

    def _B_setup():
        B, S, D, F = 1, 2048, 576, 4608
        return {
            "x": _w((lambda *s: torch.randn(*s, dtype=torch.bfloat16) * 0.05)(B, S, D)),
            "w_gate": _w((lambda *s: torch.randn(*s, dtype=torch.bfloat16) * 0.1)(D, F)),
            "w_up": _w((lambda *s: torch.randn(*s, dtype=torch.bfloat16) * 0.1)(D, F)),
            "w_down": _w((lambda *s: torch.randn(*s, dtype=torch.bfloat16) * 0.1)(F, D)),
        }
    _B_in = _B_setup()

    return {
        "A_x": _A_in["x"],
        "A_wq": _A_in["wq"],
        "A_wk": _A_in["wk"],
        "A_wv": _A_in["wv"],
        "A_wo": _A_in["wo"],
        "B_x": _B_in["x"],
        "B_w_gate": _B_in["w_gate"],
        "B_w_up": _B_in["w_up"],
        "B_w_down": _B_in["w_down"],
    }

def reference(A_x, A_wq, A_wk, A_wv, A_wo, B_x, B_w_gate, B_w_up, B_w_down):
    def _A_ref(x, wq, wk, wv, wo):
        B, S, D = x.shape
        H = 32
        Dh = D // H
        q = (lambda x, *d: x.permute(*d))((x @ wq).reshape(B, S, H, Dh), 0, 2, 1, 3)
        k = x @ wk
        v = x @ wv
        scores = torch.einsum("bhqd,bkd->bhqk", q, k) * (Dh ** -0.5)
        p = _softmax(scores, axis=-1)
        o = torch.einsum("bhqk,bkd->bhqd", p, v)
        return (lambda x, *d: x.permute(*d))(o, 0, 2, 1, 3).reshape(B, S, H * Dh) @ wo

    def _B_ref(x, w_gate, w_up, w_down):
        return (_gelu(x @ w_gate) * (x @ w_up)) @ w_down

    x = A_x
    xn = _layernorm(x, axis=-1)
    return x + _A_ref(xn, A_wq, A_wk, A_wv, A_wo) + _B_ref(xn, B_w_gate, B_w_up, B_w_down)
```

```asm
; @launch grid=(256,1,1) block=(256,1,1) lds=163840
.amdgcn_target "amdgcn-amd-amdhsa--gfx950"
.set L_tab_w, 18432
.text
.globl parallel_sum__grouped_kv_mqa__geglu_ffn__prompt_kernel
.p2align 12
.p2align 8
.type parallel_sum__grouped_kv_mqa__geglu_ffn__prompt_kernel,@function
parallel_sum__grouped_kv_mqa__geglu_ffn__prompt_kernel:
    s_load_dwordx16 s[4:19], s[0:1], 0
    s_load_dwordx8 s[20:27], s[0:1], 64
    s_getpc_b64 s[90:91]
L_pc:
    s_cmpk_ge_u32 s2, 256
    s_cbranch_scc1 L_end
    v_lshlrev_b32 v2, 4, v0
    global_load_dword v20, v2, s[90:91] offset:128
    v_lshrrev_b32 v1, 5, v0
    s_lshl_b32 s58, s2, 3
    v_add_u32 v1, s58, v1
    v_mul_u32_u24 v1, 1152, v1
    v_and_b32 v3, 31, v0
    v_lshl_add_u32 v228, v3, 4, v1
    v_lshl_add_u32 v229, v3, 2, v1
    s_waitcnt lgkmcnt(0)
    global_load_dwordx4 v[128:131], v228, s[4:5]
    global_load_dwordx4 v[132:135], v228, s[4:5] offset:512
    global_load_dword v136, v229, s[4:5] offset:1024
    v_mov_b32 v138, 208896
    global_load_dword v138, v138, s[26:27] sc1
    v_lshrrev_b32 v2, 6, v0
    v_and_b32 v240, 63, v0
    v_readfirstlane_b32 s54, v2
    s_bfe_u32 s52, s2, 0x40002
    s_and_b32 s53, s2, 3
    s_lshr_b32 s59, s2, 6
    s_lshl2_add_u32 s53, s53, s59
    s_mov_b32 s61, s2
    s_mov_b32 s83, 0x3f803f80
    s_mov_b32 s84, 0x3f80
    s_mov_b32 s85, 1.0
    v_mov_b32 v0, 0
    v_mov_b32 v3, 0
    s_and_b32 s59, s53, 12
    s_lshl_b32 s59, s59, 7
    v_min_u32 v7, 11, v240
    v_lshrrev_b32 v1, 2, v7
    v_mul_u32_u24 v1, 68, v1
    v_add_lshl_u32 v7, v7, v1, 7
    s_sub_u32 s34, 5308416, s59
    s_mov_b32 s35, 0x20000
    s_lshr_b32 s58, s61, 3
    s_and_b32 s57, s54, 1
    s_lshl1_add_u32 s58, s58, s57
    s_mul_i32 s87, s58, 27648
    s_add_u32 s88, s87, 1769472
    s_add_u32 s89, s87, 3538944
    s_cmp_ge_u32 s54, 2
    s_cselect_b32 s32, s18, s16
    s_cselect_b32 s33, s19, s17
    s_add_u32 s32, s32, s59
    s_addc_u32 s33, s33, 0
    s_lshr_b32 s58, s61, 3
    s_lshl2_add_u32 s86, s58, s54
    v_lshrrev_b32 v238, 3, v240
    v_lshl_add_u32 v241, s86, 3, v238
    v_add_u32 v241, 32, v241
    v_min_u32 v241, (L_tab_end-L_pc)/128-1, v241
    v_lshlrev_b32 v241, 7, v241
    s_and_b32 s59, s54, 1
    buffer_load_dword v20, v7, s[32:35], s87 offen
    v_and_b32 v239, 7, v240
    v_bfe_u32 v57, v240, 4, 1
    v_lshl_or_b32 v57, s59, 1, v57
    v_lshlrev_b32 v57, 1, v57
    v_xor_b32 v57, v57, v239
    v_lshlrev_b32 v57, 4, v57
    v_lshl_add_u32 v4, s59, 3, v238
    v_mul_u32_u24 v4, 9216, v4
    buffer_load_dword v20, v7, s[32:35], s88 offen
    s_and_b32 s58, s53, 3
    s_lshl_b32 s58, s58, 7
    v_add3_u32 v4, v4, v57, s58
    s_lshl_b32 s55, s54, 12
    s_mov_b32 s64, 0
    s_mov_b32 s65, 146432
    s_mov_b32 s66, 292864
    s_mov_b32 s67, 439296
    global_load_dword v20, v241, s[90:91]
    s_mov_b32 s68, 589824
    s_mov_b32 s69, 736256
    s_mov_b32 s70, 882688
    s_mov_b32 s71, 1029120
    s_mov_b32 s72, 1179648
    s_mov_b32 s73, 1326080
    s_mov_b32 s74, 1472512
    s_mov_b32 s75, 1618944
    s_mov_b32 s40, s26
    s_add_u32 m0, s55, 49152
    s_mov_b32 s41, s27
    s_mov_b32 s42, 268435456
    s_mov_b32 s43, 0x20000
    s_mov_b64 s[28:29], s[4:5]
    v_lshlrev_b32 v22, 4, v240
    v_or_b32 v8, s54, v240
    v_min_u32 v8, 1, v8
    v_lshlrev_b32 v8, 30, v8
    v_lshrrev_b32 v243, 4, v240
    v_or_b32 v243, s54, v243
    v_lshlrev_b32 v243, 28, v243
    buffer_load_dwordx4 v4, s[32:35], s64 offen offset:0 lds
    v_lshl_add_u32 v243, v240, 3, v243
    s_lshl_b32 s51, s61, 7
    s_add_u32 s51, s51, 229376
    v_add_u32 v243, s51, v243
    v_add_u32 v228, 45088768, v228
    v_add_u32 v229, 45088768, v229
    s_and_b32 s61, s61, 7
    s_lshl2_add_u32 s60, s52, s54
    s_lshl_b32 s57, s60, 7
    s_add_u32 s57, s57, 229376
    v_and_b32 v242, 3, v240
    v_lshlrev_b32 v242, 13, v242
    buffer_load_dwordx4 v4, s[32:35], s65 offen offset:1024 lds
    s_mul_i32 s58, s60, 9216
    v_xor_b32 v56, v238, v239
    v_mul_u32_u24 v9, 72, v238
    v_add_lshl_u32 v9, v9, v56, 4
    s_add_u32 s14, s58, 45088768
    s_add_u32 s15, s58, 45677568
    s_add_u32 s24, s58, 46266368
    s_add_u32 s25, s58, 46855168
    v_and_b32 v236, 15, v240
    v_lshrrev_b32 v237, 4, v240
    v_xor_b32 v56, v237, v239
    v_lshlrev_b32 v56, 4, v56
    buffer_load_dwordx4 v4, s[32:35], s66 offen offset:2048 lds
    v_lshl_add_u32 v56, v236, 7, v56
    v_add_u32 v244, s55, v56
    v_xor_b32 v245, 64, v244
    v_xor_b32 v246, 4096, v244
    v_xor_b32 v247, 64, v246
    v_bfe_u32 v56, v240, 4, 1
    v_bfe_u32 v57, v240, 3, 2
    s_lshl_b32 s58, s59, 1
    v_xor_b32 v57, s58, v57
    v_lshlrev_b32 v57, 5, v57
    v_lshl_add_u32 v57, v56, 12, v57
    v_lshrrev_b32 v56, 5, v240
    buffer_load_dwordx4 v4, s[32:35], s67 offen offset:3072 lds
    v_lshl_add_u32 v57, v56, 10, v57
    v_bfe_u32 v56, v240, 2, 2
    v_lshl_add_u32 v57, v56, 7, v57
    v_and_b32 v56, 3, v240
    v_lshl_add_u32 v57, v56, 3, v57
    v_add_u32 v5, 49152, v57
    v_xor_b32 v6, 32, v5
    v_add_u32 v248, 147456, v244
    v_add_u32 v249, 147456, v245
    v_add_u32 v250, 147456, v246
    v_add_u32 v251, 147456, v247
    s_waitcnt vmcnt(10)
    v_dot2c_f32_bf16 v0, s83, v128
    v_dot2c_f32_bf16 v0, s83, v129
    v_dot2c_f32_bf16 v0, s83, v130
    v_dot2c_f32_bf16 v0, s83, v131
    s_waitcnt vmcnt(9)
    v_dot2c_f32_bf16 v0, s83, v132
    v_dot2c_f32_bf16 v0, s83, v133
    v_dot2c_f32_bf16 v0, s83, v134
    v_dot2c_f32_bf16 v0, s83, v135
    s_waitcnt vmcnt(8)
    v_dot2c_f32_bf16 v0, s83, v136
    s_nop 2
    v_add_f32_dpp v0, v0, v0 quad_perm:[1,0,3,2] row_mask:0xf bank_mask:0xf
    s_nop 1
    v_add_f32_dpp v0, v0, v0 quad_perm:[2,3,0,1] row_mask:0xf bank_mask:0xf
    s_nop 1
    v_add_f32_dpp v0, v0, v0 row_half_mirror row_mask:0xf bank_mask:0xf
    s_nop 1
    v_add_f32_dpp v0, v0, v0 row_mirror row_mask:0xf bank_mask:0xf
    v_mov_b32 v1, v0
    s_nop 1
    v_permlane16_swap_b32 v1, v0
    v_add_f32 v0, v0, v1
    v_mul_f32 v0, 0xbae38e39, v0
    v_cvt_pk_bf16_f32 v1, v0, v0
    v_and_b32 v1, 0xffff0000, v1
    v_sub_f32 v2, v0, v1
    v_dot2_f32_bf16 v144, v128, s84, v1
    v_dot2_f32_bf16 v145, v128, s85, v1
    v_dot2_f32_bf16 v146, v129, s84, v1
    v_dot2_f32_bf16 v147, v129, s85, v1
    v_dot2_f32_bf16 v148, v130, s84, v1
    v_dot2_f32_bf16 v149, v130, s85, v1
    v_dot2_f32_bf16 v150, v131, s84, v1
    v_dot2_f32_bf16 v151, v131, s85, v1
    v_dot2_f32_bf16 v152, v132, s84, v1
    v_dot2_f32_bf16 v153, v132, s85, v1
    v_dot2_f32_bf16 v154, v133, s84, v1
    v_dot2_f32_bf16 v155, v133, s85, v1
    v_dot2_f32_bf16 v156, v134, s84, v1
    v_dot2_f32_bf16 v157, v134, s85, v1
    v_dot2_f32_bf16 v158, v135, s84, v1
    v_dot2_f32_bf16 v159, v135, s85, v1
    v_dot2_f32_bf16 v160, v136, s84, v1
    v_dot2_f32_bf16 v161, v136, s85, v1
    v_cvt_pk_bf16_f32 v128, v144, v145
    v_cvt_pk_bf16_f32 v129, v146, v147
    v_cvt_pk_bf16_f32 v130, v148, v149
    v_cvt_pk_bf16_f32 v131, v150, v151
    v_cvt_pk_bf16_f32 v132, v152, v153
    v_cvt_pk_bf16_f32 v133, v154, v155
    v_cvt_pk_bf16_f32 v134, v156, v157
    v_cvt_pk_bf16_f32 v135, v158, v159
    v_cvt_pk_bf16_f32 v136, v160, v161
    v_dot2c_f32_bf16 v3, v128, v128
    v_dot2c_f32_bf16 v3, v129, v129
    v_dot2c_f32_bf16 v3, v130, v130
    v_dot2c_f32_bf16 v3, v131, v131
    v_dot2c_f32_bf16 v3, v132, v132
    v_dot2c_f32_bf16 v3, v133, v133
    v_dot2c_f32_bf16 v3, v134, v134
    v_dot2c_f32_bf16 v3, v135, v135
    v_dot2c_f32_bf16 v3, v136, v136
    v_lshlrev_b32 v144, 16, v128
    v_and_b32 v145, 0xffff0000, v128
    v_lshlrev_b32 v146, 16, v129
    v_add_f32_dpp v3, v3, v3 quad_perm:[1,0,3,2] row_mask:0xf bank_mask:0xf
    v_and_b32 v147, 0xffff0000, v129
    v_lshlrev_b32 v148, 16, v130
    v_add_f32_dpp v3, v3, v3 quad_perm:[2,3,0,1] row_mask:0xf bank_mask:0xf
    v_and_b32 v149, 0xffff0000, v130
    v_lshlrev_b32 v150, 16, v131
    v_add_f32_dpp v3, v3, v3 row_half_mirror row_mask:0xf bank_mask:0xf
    v_and_b32 v151, 0xffff0000, v131
    v_lshlrev_b32 v152, 16, v132
    v_add_f32_dpp v3, v3, v3 row_mirror row_mask:0xf bank_mask:0xf
    v_and_b32 v153, 0xffff0000, v132
    v_mov_b32 v1, v3
    v_lshlrev_b32 v154, 16, v133
    v_and_b32 v155, 0xffff0000, v133
    v_permlane16_swap_b32 v1, v3
    v_lshlrev_b32 v156, 16, v134
    v_and_b32 v157, 0xffff0000, v134
    v_add_f32 v3, v3, v1
    v_lshlrev_b32 v158, 16, v135
    v_mul_f32 v2, v2, v2
    v_mul_f32 v3, 0x3ae38e39, v3
    v_sub_f32 v3, v3, v2
    v_max_f32 v3, 0, v3
    v_cvt_pk_bf16_f32 v3, v3, v3
    v_and_b32 v3, 0xffff0000, v3
    v_add_f32 v3, 0x3727c5ac, v3
    v_cvt_pk_bf16_f32 v3, v3, v3
    v_and_b32 v3, 0xffff0000, v3
    v_sqrt_f32 v3, v3
    v_and_b32 v159, 0xffff0000, v135
    v_cvt_pk_bf16_f32 v3, v3, v3
    v_and_b32 v3, 0xffff0000, v3
    v_rcp_f32 v2, v3
    v_lshlrev_b32 v160, 16, v136
    v_and_b32 v161, 0xffff0000, v136
    v_mul_f32 v2, 0xbeeff558, v2
    v_pk_mul_f32 v[144:145], v[144:145], v[2:3] op_sel_hi:[1,0]
    v_cvt_pk_bf16_f32 v128, v144, v145
    v_pk_mul_f32 v[146:147], v[146:147], v[2:3] op_sel_hi:[1,0]
    v_cvt_pk_bf16_f32 v129, v146, v147
    v_pk_mul_f32 v[148:149], v[148:149], v[2:3] op_sel_hi:[1,0]
    v_cvt_pk_bf16_f32 v130, v148, v149
    v_pk_mul_f32 v[150:151], v[150:151], v[2:3] op_sel_hi:[1,0]
    v_cvt_pk_bf16_f32 v131, v150, v151
    buffer_store_dwordx4 v[128:131], v228, s[40:43], 0 offen offset:0 sc1
    v_pk_mul_f32 v[152:153], v[152:153], v[2:3] op_sel_hi:[1,0]
    v_cvt_pk_bf16_f32 v132, v152, v153
    v_pk_mul_f32 v[154:155], v[154:155], v[2:3] op_sel_hi:[1,0]
    v_cvt_pk_bf16_f32 v133, v154, v155
    v_pk_mul_f32 v[156:157], v[156:157], v[2:3] op_sel_hi:[1,0]
    v_cvt_pk_bf16_f32 v134, v156, v157
    v_pk_mul_f32 v[158:159], v[158:159], v[2:3] op_sel_hi:[1,0]
    v_cvt_pk_bf16_f32 v135, v158, v159
    buffer_store_dwordx4 v[132:135], v228, s[40:43], 0 offen offset:512 sc1
    v_pk_mul_f32 v[160:161], v[160:161], v[2:3] op_sel_hi:[1,0]
    v_cvt_pk_bf16_f32 v136, v160, v161
    buffer_store_dword v136, v229, s[40:43], 0 offen offset:1024 sc1
    s_waitcnt vmcnt(10)
    v_readfirstlane_b32 s48, v138
    s_nop 1
    s_add_u32 s48, s48, 1
    s_not_b32 s49, s48
    v_mov_b32 v2, s48
    v_mov_b32 v3, s49
    s_waitcnt vmcnt(0)
    s_barrier
    buffer_store_dwordx2 v[2:3], v243, s[40:43], 0 offen sc1
    s_add_u32 m0, s55, 65536
    s_nop 0
    buffer_load_dwordx4 v4, s[32:35], s68 offen offset:0 lds
    buffer_load_dwordx4 v4, s[32:35], s69 offen offset:1024 lds
    buffer_load_dwordx4 v4, s[32:35], s70 offen offset:2048 lds
    buffer_load_dwordx4 v4, s[32:35], s71 offen offset:3072 lds
    s_add_u32 m0, s55, 81920
    s_nop 0
    buffer_load_dwordx4 v4, s[32:35], s72 offen offset:0 lds
    buffer_load_dwordx4 v4, s[32:35], s73 offen offset:1024 lds
    buffer_load_dwordx4 v4, s[32:35], s74 offen offset:2048 lds
    buffer_load_dwordx4 v4, s[32:35], s75 offen offset:3072 lds
    s_mov_b64 exec, 0
    s_cmp_lt_u32 s54, 2
    s_cbranch_scc0 L_vb0
    s_cmp_eq_u32 s54, 0
    s_cbranch_scc1 L_pg0_0
    s_branch L_pg0_1
L_vb0:
    s_cmp_eq_u32 s54, 2
    s_cbranch_scc1 L_pg0_2
    s_branch L_pg0_3
L_back0:
    s_mov_b64 exec, -1
    s_add_u32 s94, s26, s57
    s_addc_u32 s95, s27, 0
    s_mov_b32 s58, 0
    s_load_dwordx2 s[76:77], s[94:95], 0 glc
    s_load_dwordx2 s[78:79], s[94:95], 8192 glc
    s_load_dwordx2 s[80:81], s[94:95], 16384 glc
    s_load_dwordx2 s[82:83], s[94:95], 24576 glc
    v_add_u32 v4, 1769472, v4
    s_add_u32 m0, s55, 98304
    s_nop 0
    buffer_load_dwordx4 v4, s[32:35], s64 offen offset:0 lds
    buffer_load_dwordx4 v4, s[32:35], s65 offen offset:1024 lds
    buffer_load_dwordx4 v4, s[32:35], s66 offen offset:2048 lds
    buffer_load_dwordx4 v4, s[32:35], s67 offen offset:3072 lds
    s_add_u32 m0, s55, 114688
    s_nop 0
    buffer_load_dwordx4 v4, s[32:35], s68 offen offset:0 lds
    buffer_load_dwordx4 v4, s[32:35], s69 offen offset:1024 lds
    buffer_load_dwordx4 v4, s[32:35], s70 offen offset:2048 lds
    buffer_load_dwordx4 v4, s[32:35], s71 offen offset:3072 lds
    s_add_u32 m0, s55, 131072
    s_nop 0
    buffer_load_dwordx4 v4, s[32:35], s72 offen offset:0 lds
    buffer_load_dwordx4 v4, s[32:35], s73 offen offset:1024 lds
    buffer_load_dwordx4 v4, s[32:35], s74 offen offset:2048 lds
    buffer_load_dwordx4 v4, s[32:35], s75 offen offset:3072 lds
    s_branch L_px_in
L_px:
    s_load_dwordx2 s[76:77], s[94:95], 0 glc
    s_load_dwordx2 s[78:79], s[94:95], 8192 glc
    s_load_dwordx2 s[80:81], s[94:95], 16384 glc
    s_load_dwordx2 s[82:83], s[94:95], 24576 glc
L_px_in:
    s_add_u32 s58, s58, 1
    s_cmp_ge_u32 s58, 0x20000
    s_cbranch_scc1 L_px_ok
    s_waitcnt lgkmcnt(0)
    s_xor_b64 s[76:77], s[76:77], s[48:49]
    s_xor_b64 s[78:79], s[78:79], s[48:49]
    s_xor_b64 s[80:81], s[80:81], s[48:49]
    s_xor_b64 s[82:83], s[82:83], s[48:49]
    s_or_b64 s[76:77], s[76:77], s[78:79]
    s_or_b64 s[76:77], s[76:77], s[80:81]
    s_or_b64 s[76:77], s[76:77], s[82:83]
    s_cbranch_scc1 L_px
L_px_ok:
    s_add_u32 m0, s55, 0
    s_nop 0
    buffer_load_dwordx4 v9, s[40:43], s14 offen offset:0 sc1 lds
    buffer_load_dwordx4 v9, s[40:43], s15 offen offset:1024 sc1 lds
    buffer_load_dwordx4 v9, s[40:43], s24 offen offset:2048 sc1 lds
    buffer_load_dwordx4 v9, s[40:43], s25 offen offset:3072 sc1 lds
    v_add_u32 v9, 128, v9
    s_add_u32 m0, s55, 16384
    s_nop 0
    buffer_load_dwordx4 v9, s[40:43], s14 offen offset:0 sc1 lds
    buffer_load_dwordx4 v9, s[40:43], s15 offen offset:1024 sc1 lds
    buffer_load_dwordx4 v9, s[40:43], s24 offen offset:2048 sc1 lds
    buffer_load_dwordx4 v9, s[40:43], s25 offen offset:3072 sc1 lds
    v_add_u32 v9, 128, v9
    s_add_u32 m0, s55, 32768
    s_nop 0
    buffer_load_dwordx4 v9, s[40:43], s14 offen offset:0 sc1 lds
    buffer_load_dwordx4 v9, s[40:43], s15 offen offset:1024 sc1 lds
    buffer_load_dwordx4 v9, s[40:43], s24 offen offset:2048 sc1 lds
    buffer_load_dwordx4 v9, s[40:43], s25 offen offset:3072 sc1 lds
    s_mov_b64 exec, 0
    s_cmp_lt_u32 s54, 2
    s_cbranch_scc0 L_vb1
    s_cmp_eq_u32 s54, 0
    s_cbranch_scc1 L_pg1_0
    s_branch L_pg1_1
L_vb1:
    s_cmp_eq_u32 s54, 2
    s_cbranch_scc1 L_pg1_2
    s_branch L_pg1_3
L_back1:
    s_mov_b64 exec, -1
    s_waitcnt lgkmcnt(0)
    s_waitcnt vmcnt(8)
    s_barrier
    ds_read_b64_tr_b16 v[24:25], v5 offset:0
    ds_read_b64_tr_b16 v[26:27], v5 offset:512
    ds_read_b64_tr_b16 v[28:29], v5 offset:2048
    ds_read_b64_tr_b16 v[30:31], v5 offset:2560
    ds_read_b128 a[0:3], v244 offset:0
    ds_read_b128 a[16:19], v245 offset:0
    ds_read_b128 a[4:7], v244 offset:2048
    ds_read_b128 a[20:23], v245 offset:2048
    ds_read_b128 a[8:11], v246 offset:0
    ds_read_b128 a[24:27], v247 offset:0
    ds_read_b128 a[12:15], v246 offset:2048
    ds_read_b128 a[28:31], v247 offset:2048
    ds_read_b64_tr_b16 v[32:33], v5 offset:8192
    ds_read_b64_tr_b16 v[34:35], v5 offset:8704
    ds_read_b64_tr_b16 v[36:37], v5 offset:10240
    ds_read_b64_tr_b16 v[38:39], v5 offset:10752
    s_waitcnt lgkmcnt(11)
    v_mfma_f32_16x16x32_bf16 v[128:131], v[24:27], a[0:3], 0
    s_add_u32 s0, s90, L_tab-L_pc
    ds_read_b64_tr_b16 v[40:41], v6 offset:0
    s_addc_u32 s1, s91, 0
    s_waitcnt lgkmcnt(11)
    v_mfma_f32_16x16x32_bf16 v[128:131], v[28:31], a[16:19], v[128:131]
    ds_read_b64_tr_b16 v[42:43], v6 offset:512
    v_add_u32 v9, 128, v9
    s_waitcnt lgkmcnt(11)
    v_mfma_f32_16x16x32_bf16 v[132:135], v[24:27], a[4:7], 0
    ds_read_b64_tr_b16 v[44:45], v6 offset:2048
    s_waitcnt lgkmcnt(11)
    v_mfma_f32_16x16x32_bf16 v[132:135], v[28:31], a[20:23], v[132:135]
    s_add_u32 m0, s55, 147456
    ds_read_b64_tr_b16 v[46:47], v6 offset:2560
    s_waitcnt lgkmcnt(11)
    v_mfma_f32_16x16x32_bf16 v[136:139], v[24:27], a[8:11], 0
    s_waitcnt lgkmcnt(10)
    v_mfma_f32_16x16x32_bf16 v[136:139], v[28:31], a[24:27], v[136:139]
    s_mul_i32 s56, s54, L_tab_w
    s_waitcnt lgkmcnt(9)
    v_mfma_f32_16x16x32_bf16 v[140:143], v[24:27], a[12:15], 0
    s_add_u32 s0, s0, s56
    s_addc_u32 s1, s1, 0
    s_waitcnt lgkmcnt(8)
    v_mfma_f32_16x16x32_bf16 v[140:143], v[28:31], a[28:31], v[140:143]
    s_waitcnt lgkmcnt(4)
    buffer_load_dwordx4 v9, s[40:43], s14 offen offset:0 sc1 lds
    v_mfma_f32_16x16x32_bf16 v[144:147], v[32:35], a[0:3], 0
    ds_read_b64_tr_b16 v[24:25], v6 offset:8192
    ds_read_b64_tr_b16 v[26:27], v6 offset:8704
    v_mfma_f32_16x16x32_bf16 v[144:147], v[36:39], a[16:19], v[144:147]
    buffer_load_dwordx4 v9, s[40:43], s15 offen offset:1024 sc1 lds
    v_mfma_f32_16x16x32_bf16 v[148:151], v[32:35], a[4:7], 0
    global_load_dwordx4 v[192:195], v22, s[0:1] offset:0
    v_mfma_f32_16x16x32_bf16 v[148:151], v[36:39], a[20:23], v[148:151]
    ds_read_b64_tr_b16 v[28:29], v6 offset:10240
    ds_read_b64_tr_b16 v[30:31], v6 offset:10752
    v_mfma_f32_16x16x32_bf16 v[152:155], v[32:35], a[8:11], 0
    buffer_load_dwordx4 v9, s[40:43], s24 offen offset:2048 sc1 lds
    v_mfma_f32_16x16x32_bf16 v[152:155], v[36:39], a[24:27], v[152:155]
    s_mov_b32 s26, s51
    s_or_b32 s27, s86, s61
    v_mfma_f32_16x16x32_bf16 v[156:159], v[32:35], a[12:15], 0
    s_min_u32 s27, s27, 1
    v_mfma_f32_16x16x32_bf16 v[156:159], v[36:39], a[28:31], v[156:159]
    s_waitcnt vmcnt(8) lgkmcnt(0)
    buffer_load_dwordx4 v9, s[40:43], s25 offen offset:3072 sc1 lds
    v_mfma_f32_16x16x32_bf16 v[160:163], v[40:43], a[0:3], 0
    s_barrier
    ds_read_b128 a[32:35], v244 offset:16384
    v_mfma_f32_16x16x32_bf16 v[160:163], v[44:47], a[16:19], v[160:163]
    ds_read_b64_tr_b16 v[32:33], v5 offset:16384
    ds_read_b128 a[48:51], v245 offset:16384
    v_mfma_f32_16x16x32_bf16 v[164:167], v[40:43], a[4:7], 0
    s_lshl_b32 s27, s27, 30
    ds_read_b64_tr_b16 v[34:35], v5 offset:16896
    ds_read_b64_tr_b16 v[36:37], v5 offset:18432
    v_mfma_f32_16x16x32_bf16 v[164:167], v[44:47], a[20:23], v[164:167]
    ds_read_b128 a[36:39], v244 offset:18432
    buffer_load_dword v20, v7, s[32:35], s89 offen
    v_mfma_f32_16x16x32_bf16 v[168:171], v[40:43], a[8:11], 0
    s_lshl_b32 s51, s54, 10
    ds_read_b64_tr_b16 v[38:39], v5 offset:18944
    v_mfma_f32_16x16x32_bf16 v[168:171], v[44:47], a[24:27], v[168:171]
    ds_read_b128 a[52:55], v245 offset:18432
    s_add_u32 s87, s87, 2048
    v_mfma_f32_16x16x32_bf16 v[172:175], v[40:43], a[12:15], 0
    ds_read_b128 a[40:43], v246 offset:16384
    v_mfma_f32_16x16x32_bf16 v[172:175], v[44:47], a[28:31], v[172:175]
    ds_read_b128 a[56:59], v247 offset:16384
    buffer_load_dword v20, v7, s[32:35], s87 offen
    v_mfma_f32_16x16x32_bf16 v[176:179], v[24:27], a[0:3], 0
    s_add_u32 s51, s51, 196608
    ds_read_b64_tr_b16 v[40:41], v5 offset:24576
    v_mfma_f32_16x16x32_bf16 v[176:179], v[28:31], a[16:19], v[176:179]
    ds_read_b128 a[44:47], v246 offset:18432
    v_add_u32 v9, 128, v9
    v_mfma_f32_16x16x32_bf16 v[180:183], v[24:27], a[4:7], 0
    s_mov_b32 s50, 0x3e60ec05
    ds_read_b64_tr_b16 v[42:43], v5 offset:25088
    v_mfma_f32_16x16x32_bf16 v[180:183], v[28:31], a[20:23], v[180:183]
    ds_read_b128 a[60:63], v247 offset:18432
    v_mfma_f32_16x16x32_bf16 v[184:187], v[24:27], a[8:11], 0
    s_mov_b32 s44, s12
    ds_read_b64_tr_b16 v[44:45], v5 offset:26624
    v_mfma_f32_16x16x32_bf16 v[184:187], v[28:31], a[24:27], v[184:187]
    s_add_u32 m0, s55, 0
    ds_read_b64_tr_b16 v[46:47], v5 offset:27136
    s_mov_b32 s45, s13
    v_mfma_f32_16x16x32_bf16 v[188:191], v[24:27], a[12:15], 0
    s_mov_b32 s46, 663552
    v_mfma_f32_16x16x32_bf16 v[188:191], v[28:31], a[28:31], v[188:191]
    s_waitcnt lgkmcnt(9)
    s_mov_b32 s47, 0x20000
    s_sub_u32 s12, 127, s86
    v_mfma_f32_16x16x32_bf16 v[128:131], v[32:35], a[32:35], v[128:131]
    s_min_u32 s18, s12, 81
    ds_read_b64_tr_b16 v[24:25], v6 offset:16384
    v_mfma_f32_16x16x32_bf16 v[128:131], v[36:39], a[48:51], v[128:131]
    buffer_load_dwordx4 v9, s[40:43], s14 offen offset:0 sc1 lds
    v_mfma_f32_16x16x32_bf16 v[132:135], v[32:35], a[36:39], v[132:135]
    s_mul_i32 s17, s61, 72
    ds_read_b64_tr_b16 v[26:27], v6 offset:16896
    s_waitcnt lgkmcnt(10)
    v_mfma_f32_16x16x32_bf16 v[132:135], v[36:39], a[52:55], v[132:135]
    buffer_load_dwordx4 v9, s[40:43], s15 offen offset:1024 sc1 lds
    s_waitcnt lgkmcnt(9)
    v_mfma_f32_16x16x32_bf16 v[136:139], v[32:35], a[40:43], v[136:139]
    ds_read_b64_tr_b16 v[28:29], v6 offset:18432
    s_waitcnt lgkmcnt(9)
    v_mfma_f32_16x16x32_bf16 v[136:139], v[36:39], a[56:59], v[136:139]
    buffer_load_dwordx4 v9, s[40:43], s24 offen offset:2048 sc1 lds
    s_waitcnt lgkmcnt(7)
    v_mfma_f32_16x16x32_bf16 v[140:143], v[32:35], a[44:47], v[140:143]
    s_add_u32 s17, s17, s18
    ds_read_b64_tr_b16 v[30:31], v6 offset:18944
    s_waitcnt lgkmcnt(6)
    v_mfma_f32_16x16x32_bf16 v[140:143], v[36:39], a[60:63], v[140:143]
    s_waitcnt lgkmcnt(4)
    s_mul_i32 s4, s61, 82944
L_pg0_0:
L_pgx0:
    s_cbranch_execz L_pgx4
    s_lshl_b32 s58, s18, 5
    v_mfma_f32_16x16x32_bf16 v[144:147], v[40:43], a[32:35], v[144:147]
    buffer_load_dwordx4 v9, s[40:43], s25 offen offset:3072 sc1 lds
    v_mfma_f32_16x16x32_bf16 v[144:147], v[44:47], a[48:51], v[144:147]
    ds_read_b64_tr_b16 v[32:33], v6 offset:24576
    ds_read_b64_tr_b16 v[34:35], v6 offset:25088
    v_mfma_f32_16x16x32_bf16 v[148:151], v[40:43], a[36:39], v[148:151]
    s_add_u32 s4, s4, s58
    ds_read_b64_tr_b16 v[36:37], v6 offset:26624
    v_mfma_f32_16x16x32_bf16 v[148:151], v[44:47], a[52:55], v[148:151]
    ds_read_b64_tr_b16 v[38:39], v6 offset:27136
    v_mfma_f32_16x16x32_bf16 v[152:155], v[40:43], a[40:43], v[152:155]
    v_add_u32 v4, 1769472, v4
    v_mfma_f32_16x16x32_bf16 v[152:155], v[44:47], a[56:59], v[152:155]
    s_cmp_ge_u32 s18, 36
    s_cselect_b32 s56, 40320, 0
    s_add_u32 s4, s4, s56
    v_mfma_f32_16x16x32_bf16 v[156:159], v[40:43], a[44:47], v[156:159]
    s_mul_i32 s58, s61, 10
    s_add_u32 s58, s58, s18
    v_mfma_f32_16x16x32_bf16 v[156:159], v[44:47], a[60:63], v[156:159]
    s_waitcnt vmcnt(11) lgkmcnt(0)
    s_add_u32 m0, s55, 49152
    s_add_u32 s58, s58, 504
    v_mfma_f32_16x16x32_bf16 v[160:163], v[24:27], a[32:35], v[160:163]
    s_barrier
    ds_read_b128 a[64:67], v244 offset:32768
    v_mfma_f32_16x16x32_bf16 v[160:163], v[28:31], a[48:51], v[160:163]
    ds_read_b64_tr_b16 v[40:41], v5 offset:32768
    ds_read_b128 a[80:83], v245 offset:32768
    v_mfma_f32_16x16x32_bf16 v[164:167], v[24:27], a[36:39], v[164:167]
    buffer_load_dwordx4 v4, s[32:35], s64 offen offset:0 lds
    v_mfma_f32_16x16x32_bf16 v[164:167], v[28:31], a[52:55], v[164:167]
    ds_read_b64_tr_b16 v[42:43], v5 offset:33280
    ds_read_b128 a[68:71], v244 offset:34816
    v_mfma_f32_16x16x32_bf16 v[168:171], v[24:27], a[40:43], v[168:171]
    s_and_b32 s56, s61, 1
    ds_read_b64_tr_b16 v[44:45], v5 offset:34816
    ds_read_b64_tr_b16 v[46:47], v5 offset:35328
    v_mfma_f32_16x16x32_bf16 v[168:171], v[28:31], a[56:59], v[168:171]
    ds_read_b128 a[84:87], v245 offset:34816
    buffer_load_dwordx4 v4, s[32:35], s65 offen offset:1024 lds
    v_mfma_f32_16x16x32_bf16 v[172:175], v[24:27], a[44:47], v[172:175]
    ds_read_b128 a[72:75], v246 offset:32768
    v_mfma_f32_16x16x32_bf16 v[172:175], v[28:31], a[60:63], v[172:175]
    ds_read_b128 a[88:91], v247 offset:32768
    s_mul_i32 s56, s56, 10
    v_mfma_f32_16x16x32_bf16 v[176:179], v[32:35], a[32:35], v[176:179]
    buffer_load_dwordx4 v4, s[32:35], s66 offen offset:2048 lds
    v_mfma_f32_16x16x32_bf16 v[176:179], v[36:39], a[48:51], v[176:179]
    ds_read_b128 a[76:79], v246 offset:34816
    s_add_u32 s56, s56, s18
    v_mfma_f32_16x16x32_bf16 v[180:183], v[32:35], a[36:39], v[180:183]
    ds_read_b64_tr_b16 v[24:25], v5 offset:40960
    v_mfma_f32_16x16x32_bf16 v[180:183], v[36:39], a[52:55], v[180:183]
    ds_read_b128 a[92:95], v247 offset:34816
    s_sub_u32 s56, s56, 72
    v_mfma_f32_16x16x32_bf16 v[184:187], v[32:35], a[40:43], v[184:187]
    s_mul_i32 s57, s56, 52
    ds_read_b64_tr_b16 v[26:27], v5 offset:41472
    v_mfma_f32_16x16x32_bf16 v[184:187], v[36:39], a[56:59], v[184:187]
    buffer_load_dwordx4 v4, s[32:35], s67 offen offset:3072 lds
    v_mfma_f32_16x16x32_bf16 v[188:191], v[32:35], a[44:47], v[188:191]
    ds_read_b64_tr_b16 v[28:29], v5 offset:43008
    v_mfma_f32_16x16x32_bf16 v[188:191], v[36:39], a[60:63], v[188:191]
    s_waitcnt lgkmcnt(8)
    ds_read_b64_tr_b16 v[30:31], v5 offset:43520
    v_add_u32 v9, 128, v9
    v_mfma_f32_16x16x32_bf16 v[128:131], v[40:43], a[64:67], v[128:131]
    s_lshr_b32 s57, s57, 8
    ds_read_b64_tr_b16 v[32:33], v6 offset:32768
    s_lshl_b32 s56, s56, 6
    v_mfma_f32_16x16x32_bf16 v[128:131], v[44:47], a[80:83], v[128:131]
    s_lshl_b32 s57, s57, 5
    ds_read_b64_tr_b16 v[34:35], v6 offset:33280
    v_mfma_f32_16x16x32_bf16 v[132:135], v[40:43], a[68:71], v[132:135]
    s_sub_u32 s56, s56, s57
    ds_read_b64_tr_b16 v[36:37], v6 offset:34816
    s_waitcnt lgkmcnt(11)
    v_mfma_f32_16x16x32_bf16 v[132:135], v[44:47], a[84:87], v[132:135]
    s_add_u32 m0, s55, 16384
    ds_read_b64_tr_b16 v[38:39], v6 offset:35328
    s_lshr_b32 s59, s61, 1
    s_waitcnt lgkmcnt(11)
    v_mfma_f32_16x16x32_bf16 v[136:139], v[40:43], a[72:75], v[136:139]
    s_mul_i32 s57, s59, 165888
    s_waitcnt lgkmcnt(10)
    v_mfma_f32_16x16x32_bf16 v[136:139], v[44:47], a[88:91], v[136:139]
    buffer_load_dwordx4 v9, s[40:43], s14 offen offset:0 sc1 lds
    s_waitcnt lgkmcnt(9)
    v_mfma_f32_16x16x32_bf16 v[140:143], v[40:43], a[76:79], v[140:143]
    s_add_u32 s56, s56, s57
    s_waitcnt lgkmcnt(7)
    v_mfma_f32_16x16x32_bf16 v[140:143], v[44:47], a[92:95], v[140:143]
    s_waitcnt lgkmcnt(4)
    s_add_u32 s56, s56, 18432
    v_mfma_f32_16x16x32_bf16 v[144:147], v[24:27], a[64:67], v[144:147]
    buffer_load_dwordx4 v9, s[40:43], s15 offen offset:1024 sc1 lds
    v_mfma_f32_16x16x32_bf16 v[144:147], v[28:31], a[80:83], v[144:147]
    ds_read_b64_tr_b16 v[40:41], v6 offset:40960
    ds_read_b64_tr_b16 v[42:43], v6 offset:41472
    v_mfma_f32_16x16x32_bf16 v[148:151], v[24:27], a[68:71], v[148:151]
    ds_read_b64_tr_b16 v[44:45], v6 offset:43008
    v_mfma_f32_16x16x32_bf16 v[148:151], v[28:31], a[84:87], v[148:151]
    ds_read_b64_tr_b16 v[46:47], v6 offset:43520
    v_mfma_f32_16x16x32_bf16 v[152:155], v[24:27], a[72:75], v[152:155]
    buffer_load_dwordx4 v9, s[40:43], s24 offen offset:2048 sc1 lds
    v_mfma_f32_16x16x32_bf16 v[152:155], v[28:31], a[88:91], v[152:155]
    s_cmp_lt_u32 s18, 72
    s_cselect_b32 s4, s4, s56
    s_cselect_b32 s17, s17, s58
    s_cselect_b64 vcc, -1, 0
    v_mfma_f32_16x16x32_bf16 v[156:159], v[24:27], a[76:79], v[156:159]
    buffer_load_dwordx4 v9, s[40:43], s25 offen offset:3072 sc1 lds
    v_mfma_f32_16x16x32_bf16 v[156:159], v[28:31], a[92:95], v[156:159]
    s_waitcnt vmcnt(14) lgkmcnt(0)
    s_lshl_b32 s17, s17, 10
    s_add_u32 s17, s17, 262144
    v_mfma_f32_16x16x32_bf16 v[160:163], v[32:35], a[64:67], v[160:163]
    s_barrier
    ds_read_b128 a[96:99], v248 offset:0
    v_mfma_f32_16x16x32_bf16 v[160:163], v[36:39], a[80:83], v[160:163]
    s_cmp_lt_u32 s12, 82
    v_add_u32 v5, 49152, v5
    s_cselect_b32 s17, s17, 1073741824
    v_mfma_f32_16x16x32_bf16 v[164:167], v[32:35], a[68:71], v[164:167]
    ds_read_b128 a[112:115], v249 offset:0
    v_add_u32 v9, 128, v9
    v_mfma_f32_16x16x32_bf16 v[164:167], v[36:39], a[84:87], v[164:167]
    ds_read_b64_tr_b16 v[24:25], v5 offset:0
    ds_read_b128 a[100:103], v248 offset:2048
    v_mfma_f32_16x16x32_bf16 v[168:171], v[32:35], a[72:75], v[168:171]
    ds_read_b64_tr_b16 v[26:27], v5 offset:512
    ds_read_b64_tr_b16 v[28:29], v5 offset:2048
    v_mfma_f32_16x16x32_bf16 v[168:171], v[36:39], a[88:91], v[168:171]
    ds_read_b128 a[116:119], v249 offset:2048
    s_add_u32 m0, s55, 32768
    v_mfma_f32_16x16x32_bf16 v[172:175], v[32:35], a[76:79], v[172:175]
    ds_read_b64_tr_b16 v[30:31], v5 offset:2560
    ds_read_b128 a[104:107], v250 offset:0
    v_mfma_f32_16x16x32_bf16 v[172:175], v[36:39], a[92:95], v[172:175]
    ds_read_b128 a[120:123], v251 offset:0
    v_mfma_f32_16x16x32_bf16 v[176:179], v[40:43], a[64:67], v[176:179]
    buffer_load_dwordx4 v9, s[40:43], s14 offen offset:0 sc1 lds
    v_mfma_f32_16x16x32_bf16 v[176:179], v[44:47], a[80:83], v[176:179]
    ds_read_b64_tr_b16 v[32:33], v5 offset:8192
    ds_read_b128 a[108:111], v250 offset:2048
    v_mfma_f32_16x16x32_bf16 v[180:183], v[40:43], a[68:71], v[180:183]
    ds_read_b64_tr_b16 v[34:35], v5 offset:8704
    v_cndmask_b32 v10, v193, v192, vcc
    v_mfma_f32_16x16x32_bf16 v[180:183], v[44:47], a[84:87], v[180:183]
    ds_read_b128 a[124:127], v251 offset:2048
    v_add_u32 v10, s4, v10
    v_mfma_f32_16x16x32_bf16 v[184:187], v[40:43], a[72:75], v[184:187]
    s_lshl_b32 s12, s54, 11
    ds_read_b64_tr_b16 v[36:37], v5 offset:10240
    v_mfma_f32_16x16x32_bf16 v[184:187], v[44:47], a[88:91], v[184:187]
    buffer_load_dwordx4 v9, s[40:43], s15 offen offset:1024 sc1 lds
    v_mfma_f32_16x16x32_bf16 v[188:191], v[40:43], a[76:79], v[188:191]
    s_add_u32 s12, s12, 147456
    ds_read_b64_tr_b16 v[38:39], v5 offset:10752
    v_mfma_f32_16x16x32_bf16 v[188:191], v[44:47], a[92:95], v[188:191]
    s_waitcnt lgkmcnt(8)
    buffer_load_dwordx4 v9, s[40:43], s24 offen offset:2048 sc1 lds
    v_mfma_f32_16x16x32_bf16 v[128:131], v[24:27], a[96:99], v[128:131]
    v_add_u32 v6, 49152, v6
    v_mfma_f32_16x16x32_bf16 v[128:131], v[28:31], a[112:115], v[128:131]
    ds_read_b64_tr_b16 v[40:41], v6 offset:0
    v_mov_b32 v11, v194
    v_mfma_f32_16x16x32_bf16 v[132:135], v[24:27], a[100:103], v[132:135]
    buffer_load_dwordx4 v9, s[40:43], s25 offen offset:3072 sc1 lds
    v_mfma_f32_16x16x32_bf16 v[132:135], v[28:31], a[116:119], v[132:135]
    ds_read_b64_tr_b16 v[42:43], v6 offset:512
    v_mov_b32 v21, v195
    s_waitcnt lgkmcnt(9)
    v_mfma_f32_16x16x32_bf16 v[136:139], v[24:27], a[104:107], v[136:139]
    ds_read_b64_tr_b16 v[44:45], v6 offset:2048
    s_waitcnt lgkmcnt(9)
    v_mfma_f32_16x16x32_bf16 v[136:139], v[28:31], a[120:123], v[136:139]
    s_add_u32 m0, s55, 65536
    ds_read_b64_tr_b16 v[46:47], v6 offset:2560
    s_min_u32 s56, s86, 107
    s_waitcnt lgkmcnt(8)
    v_mfma_f32_16x16x32_bf16 v[140:143], v[24:27], a[108:111], v[140:143]
    s_mul_i32 s57, s61, 108
    s_add_u32 s56, s56, s57
    s_waitcnt lgkmcnt(6)
    v_mfma_f32_16x16x32_bf16 v[140:143], v[28:31], a[124:127], v[140:143]
    s_waitcnt lgkmcnt(4)
    s_mul_i32 s58, s56, 1366
    v_mfma_f32_16x16x32_bf16 v[144:147], v[32:35], a[96:99], v[144:147]
    buffer_load_dwordx4 v4, s[32:35], s68 offen offset:0 lds
    v_mfma_f32_16x16x32_bf16 v[144:147], v[36:39], a[112:115], v[144:147]
    s_lshr_b32 s58, s58, 16
    ds_read_b64_tr_b16 v[24:25], v6 offset:8192
    ds_read_b64_tr_b16 v[26:27], v6 offset:8704
    v_mfma_f32_16x16x32_bf16 v[148:151], v[32:35], a[100:103], v[148:151]
    s_mul_i32 s57, s58, 48
    ds_read_b64_tr_b16 v[28:29], v6 offset:10240
    v_mfma_f32_16x16x32_bf16 v[148:151], v[36:39], a[116:119], v[148:151]
    ds_read_b64_tr_b16 v[30:31], v6 offset:10752
    v_mfma_f32_16x16x32_bf16 v[152:155], v[32:35], a[104:107], v[152:155]
    buffer_load_dwordx4 v4, s[32:35], s69 offen offset:1024 lds
    v_mfma_f32_16x16x32_bf16 v[152:155], v[36:39], a[120:123], v[152:155]
    s_sub_u32 s56, s56, s57
    s_mul_i32 s57, s56, 86
    v_mfma_f32_16x16x32_bf16 v[156:159], v[32:35], a[108:111], v[156:159]
    s_lshr_b32 s57, s57, 8
    s_mul_i32 s59, s57, 3
    v_mfma_f32_16x16x32_bf16 v[156:159], v[36:39], a[124:127], v[156:159]
    s_waitcnt vmcnt(14) lgkmcnt(0)
    s_sub_u32 s56, s56, s59
    v_mfma_f32_16x16x32_bf16 v[160:163], v[40:43], a[96:99], v[160:163]
    s_barrier
    ds_read_b128 a[128:131], v244 offset:0
    v_mfma_f32_16x16x32_bf16 v[160:163], v[44:47], a[112:115], v[160:163]
    ds_read_b128 a[144:147], v245 offset:0
    buffer_load_dwordx4 v4, s[32:35], s70 offen offset:2048 lds
    v_mfma_f32_16x16x32_bf16 v[164:167], v[40:43], a[100:103], v[164:167]
    s_mul_i32 s16, s57, 18
    ds_read_b64_tr_b16 v[32:33], v5 offset:16384
    ds_read_b64_tr_b16 v[34:35], v5 offset:16896
    v_mfma_f32_16x16x32_bf16 v[164:167], v[44:47], a[116:119], v[164:167]
    ds_read_b64_tr_b16 v[36:37], v5 offset:18432
    ds_read_b128 a[132:135], v244 offset:2048
    v_mfma_f32_16x16x32_bf16 v[168:171], v[40:43], a[104:107], v[168:171]
    buffer_load_dwordx4 v4, s[32:35], s71 offen offset:3072 lds
    v_mfma_f32_16x16x32_bf16 v[168:171], v[44:47], a[120:123], v[168:171]
    ds_read_b64_tr_b16 v[38:39], v5 offset:18944
    ds_read_b128 a[148:151], v245 offset:2048
    v_mfma_f32_16x16x32_bf16 v[172:175], v[40:43], a[108:111], v[172:175]
    ds_read_b128 a[136:139], v246 offset:0
    s_add_u32 s16, s16, s58
    v_mfma_f32_16x16x32_bf16 v[172:175], v[44:47], a[124:127], v[172:175]
    ds_read_b128 a[152:155], v247 offset:0
    s_mul_i32 s16, s16, 3
    v_mfma_f32_16x16x32_bf16 v[176:179], v[24:27], a[96:99], v[176:179]
    ds_read_b64_tr_b16 v[40:41], v5 offset:24576
    v_add_u32 v9, 128, v9
    v_mfma_f32_16x16x32_bf16 v[176:179], v[28:31], a[112:115], v[176:179]
    ds_read_b128 a[140:143], v246 offset:2048
    s_add_u32 s16, s16, s56
    v_mfma_f32_16x16x32_bf16 v[180:183], v[24:27], a[100:103], v[180:183]
    s_lshl_b32 s16, s16, 10
    ds_read_b64_tr_b16 v[42:43], v5 offset:25088
    v_mfma_f32_16x16x32_bf16 v[180:183], v[28:31], a[116:119], v[180:183]
    ds_read_b128 a[156:159], v247 offset:2048
    v_mfma_f32_16x16x32_bf16 v[184:187], v[24:27], a[104:107], v[184:187]
    s_add_u32 s16, s16, 3538944
    ds_read_b64_tr_b16 v[44:45], v5 offset:26624
    v_mfma_f32_16x16x32_bf16 v[184:187], v[28:31], a[120:123], v[184:187]
    s_add_u32 m0, s55, 147456
    ds_read_b64_tr_b16 v[46:47], v5 offset:27136
    v_mfma_f32_16x16x32_bf16 v[188:191], v[24:27], a[108:111], v[188:191]
    s_cmp_lt_u32 s86, 108
    s_cselect_b32 s16, s16, 1073741824
    v_mfma_f32_16x16x32_bf16 v[188:191], v[28:31], a[124:127], v[188:191]
    s_waitcnt lgkmcnt(9)
    buffer_load_dwordx4 v9, s[40:43], s14 offen offset:0 sc1 lds
    v_mfma_f32_16x16x32_bf16 v[128:131], v[32:35], a[128:131], v[128:131]
    s_lshl_b32 s58, s58, 5
    ds_read_b64_tr_b16 v[24:25], v6 offset:16384
    v_mfma_f32_16x16x32_bf16 v[128:131], v[36:39], a[144:147], v[128:131]
    buffer_load_dwordx4 v9, s[40:43], s15 offen offset:1024 sc1 lds
    v_mfma_f32_16x16x32_bf16 v[132:135], v[32:35], a[132:135], v[132:135]
    ds_read_b64_tr_b16 v[26:27], v6 offset:16896
    v_lshrrev_b32 v0, 1, v240
    s_waitcnt lgkmcnt(10)
    v_mfma_f32_16x16x32_bf16 v[132:135], v[36:39], a[148:151], v[132:135]
    ds_read_b64_tr_b16 v[28:29], v6 offset:18432
    v_add_u32 v0, s58, v0
    s_waitcnt lgkmcnt(10)
    v_mfma_f32_16x16x32_bf16 v[136:139], v[32:35], a[136:139], v[136:139]
    s_lshr_b32 s58, 0x2c, s57
    ds_read_b64_tr_b16 v[30:31], v6 offset:18944
    s_waitcnt lgkmcnt(10)
    v_mfma_f32_16x16x32_bf16 v[136:139], v[36:39], a[152:155], v[136:139]
    buffer_load_dwordx4 v9, s[40:43], s24 offen offset:2048 sc1 lds
    s_waitcnt lgkmcnt(8)
    v_mfma_f32_16x16x32_bf16 v[140:143], v[32:35], a[140:143], v[140:143]
    s_and_b32 s58, s58, 1
    s_cselect_b32 s8, s10, s8
    s_cselect_b32 s9, s11, s9
    s_waitcnt lgkmcnt(6)
    v_mfma_f32_16x16x32_bf16 v[140:143], v[36:39], a[156:159], v[140:143]
    s_waitcnt lgkmcnt(4)
    buffer_load_dwordx4 v9, s[40:43], s25 offen offset:3072 sc1 lds
    v_mfma_f32_16x16x32_bf16 v[144:147], v[40:43], a[128:131], v[144:147]
    ds_read_b64_tr_b16 v[32:33], v6 offset:24576
    v_mfma_f32_16x16x32_bf16 v[144:147], v[44:47], a[144:147], v[144:147]
    ds_read_b64_tr_b16 v[34:35], v6 offset:25088
    v_mfma_f32_16x16x32_bf16 v[148:151], v[40:43], a[132:135], v[148:151]
    ds_read_b64_tr_b16 v[36:37], v6 offset:26624
    v_mfma_f32_16x16x32_bf16 v[148:151], v[44:47], a[148:151], v[148:151]
    ds_read_b64_tr_b16 v[38:39], v6 offset:27136
    v_mfma_f32_16x16x32_bf16 v[152:155], v[40:43], a[136:139], v[152:155]
    s_add_u32 m0, s55, 81920
    s_and_b32 s58, s57, 1
    s_lshl_b32 s58, s58, 4
    v_mfma_f32_16x16x32_bf16 v[152:155], v[44:47], a[152:155], v[152:155]
    s_cmp_ge_u32 s57, 4
    s_cselect_b32 s58, 20, s58
    v_mfma_f32_16x16x32_bf16 v[156:159], v[40:43], a[140:143], v[156:159]
    buffer_load_dwordx4 v4, s[32:35], s72 offen offset:0 lds
    v_mfma_f32_16x16x32_bf16 v[156:159], v[44:47], a[156:159], v[156:159]
    s_waitcnt vmcnt(13) lgkmcnt(0)
    s_mul_i32 s57, s57, 72
    s_mul_i32 s59, s56, 40
    v_mfma_f32_16x16x32_bf16 v[160:163], v[24:27], a[128:131], v[160:163]
    s_barrier
    ds_read_b128 a[160:163], v244 offset:16384
    v_mfma_f32_16x16x32_bf16 v[160:163], v[28:31], a[144:147], v[160:163]
    ds_read_b64_tr_b16 v[40:41], v5 offset:32768
    ds_read_b128 a[176:179], v245 offset:16384
    v_mfma_f32_16x16x32_bf16 v[164:167], v[24:27], a[132:135], v[164:167]
    buffer_load_dwordx4 v4, s[32:35], s73 offen offset:1024 lds
    v_mfma_f32_16x16x32_bf16 v[164:167], v[28:31], a[148:151], v[164:167]
    ds_read_b64_tr_b16 v[42:43], v5 offset:33280
    ds_read_b128 a[164:167], v244 offset:18432
    v_mfma_f32_16x16x32_bf16 v[168:171], v[24:27], a[136:139], v[168:171]
    ds_read_b64_tr_b16 v[44:45], v5 offset:34816
    ds_read_b64_tr_b16 v[46:47], v5 offset:35328
    v_mfma_f32_16x16x32_bf16 v[168:171], v[28:31], a[152:155], v[168:171]
    ds_read_b128 a[180:183], v245 offset:18432
    v_mfma_f32_16x16x32_bf16 v[172:175], v[24:27], a[140:143], v[172:175]
    ds_read_b128 a[168:171], v246 offset:16384
    v_mfma_f32_16x16x32_bf16 v[172:175], v[28:31], a[156:159], v[172:175]
    ds_read_b128 a[184:187], v247 offset:16384
    buffer_load_dwordx4 v4, s[32:35], s74 offen offset:2048 lds
    v_mfma_f32_16x16x32_bf16 v[176:179], v[32:35], a[128:131], v[176:179]
    s_cmp_eq_u32 s56, 2
    s_cselect_b32 s59, 32, s59
    s_cselect_b32 s11, 0, 1
    v_mfma_f32_16x16x32_bf16 v[176:179], v[36:39], a[144:147], v[176:179]
    ds_read_b128 a[172:175], v246 offset:18432
    s_add_u32 s57, s57, s59
    v_mfma_f32_16x16x32_bf16 v[180:183], v[32:35], a[132:135], v[180:183]
    buffer_load_dwordx4 v4, s[32:35], s75 offen offset:3072 lds
    v_mfma_f32_16x16x32_bf16 v[180:183], v[36:39], a[148:151], v[180:183]
    ds_read_b128 a[188:191], v247 offset:18432
    v_and_b32 v1, 1, v240
    v_mfma_f32_16x16x32_bf16 v[184:187], v[32:35], a[136:139], v[184:187]
    ds_read_b64_tr_b16 v[24:25], v5 offset:40960
    v_lshl_add_u32 v2, v1, 4, s57
    v_mfma_f32_16x16x32_bf16 v[184:187], v[36:39], a[152:155], v[184:187]
    ds_read_b64_tr_b16 v[26:27], v5 offset:41472
    v_cmp_lt_u32 vcc, s11, v1
    v_mfma_f32_16x16x32_bf16 v[188:191], v[32:35], a[140:143], v[188:191]
    s_add_u32 s88, s88, 2048
    ds_read_b64_tr_b16 v[28:29], v5 offset:43008
    v_mov_b32 v200, s58
    v_mfma_f32_16x16x32_bf16 v[188:191], v[36:39], a[156:159], v[188:191]
    s_waitcnt lgkmcnt(8)
    ds_read_b64_tr_b16 v[30:31], v5 offset:43520
    v_mov_b32 v201, 1152
    v_mfma_f32_16x16x32_bf16 v[128:131], v[40:43], a[160:163], v[128:131]
    ds_read_b64_tr_b16 v[32:33], v6 offset:32768
    v_mov_b32 v202, s6
    v_mfma_f32_16x16x32_bf16 v[128:131], v[44:47], a[176:179], v[128:131]
    buffer_load_dword v20, v7, s[32:35], s88 offen
    v_mfma_f32_16x16x32_bf16 v[132:135], v[40:43], a[164:167], v[132:135]
    ds_read_b64_tr_b16 v[34:35], v6 offset:33280
    v_mov_b32 v203, s7
    s_waitcnt lgkmcnt(10)
    v_mfma_f32_16x16x32_bf16 v[132:135], v[44:47], a[180:183], v[132:135]
    s_add_u32 s89, s89, 2048
    ds_read_b64_tr_b16 v[36:37], v6 offset:34816
    v_mov_b32 v204, s8
    s_waitcnt lgkmcnt(10)
    v_mfma_f32_16x16x32_bf16 v[136:139], v[40:43], a[168:171], v[136:139]
    ds_read_b64_tr_b16 v[38:39], v6 offset:35328
    v_mov_b32 v205, s9
    s_waitcnt lgkmcnt(10)
    v_mfma_f32_16x16x32_bf16 v[136:139], v[44:47], a[184:187], v[136:139]
    buffer_load_dword v20, v7, s[32:35], s89 offen
    s_waitcnt lgkmcnt(9)
    v_mfma_f32_16x16x32_bf16 v[140:143], v[40:43], a[172:175], v[140:143]
    s_waitcnt lgkmcnt(8)
    v_mfma_f32_16x16x32_bf16 v[140:143], v[44:47], a[188:191], v[140:143]
    s_waitcnt lgkmcnt(4)
    v_add_u32 v9, 128, v9
    v_cndmask_b32 v2, v2, v200, vcc
    v_mfma_f32_16x16x32_bf16 v[144:147], v[24:27], a[160:163], v[144:147]
    ds_read_b64_tr_b16 v[40:41], v6 offset:40960
    v_cndmask_b32 v201, v201, 36, vcc
    v_mfma_f32_16x16x32_bf16 v[144:147], v[28:31], a[176:179], v[144:147]
    s_add_u32 m0, s55, 0
    ds_read_b64_tr_b16 v[42:43], v6 offset:41472
    v_mfma_f32_16x16x32_bf16 v[148:151], v[24:27], a[164:167], v[148:151]
    ds_read_b64_tr_b16 v[44:45], v6 offset:43008
    v_cndmask_b32 v12, v202, v204, vcc
    v_mfma_f32_16x16x32_bf16 v[148:151], v[28:31], a[180:183], v[148:151]
    ds_read_b64_tr_b16 v[46:47], v6 offset:43520
    v_cndmask_b32 v13, v203, v205, vcc
    v_mfma_f32_16x16x32_bf16 v[152:155], v[24:27], a[168:171], v[152:155]
    buffer_load_dwordx4 v9, s[40:43], s14 offen offset:0 sc1 lds
    v_mfma_f32_16x16x32_bf16 v[152:155], v[28:31], a[184:187], v[152:155]
    v_mad_u32_u24 v200, v0, v201, v2
    v_mfma_f32_16x16x32_bf16 v[156:159], v[24:27], a[172:175], v[156:159]
    v_mov_b32 v201, 0
    v_lshl_add_u64 v[12:13], v[200:201], 0, v[12:13]
    v_mfma_f32_16x16x32_bf16 v[156:159], v[28:31], a[188:191], v[156:159]
    s_waitcnt vmcnt(15) lgkmcnt(0)
    buffer_load_dwordx4 v9, s[40:43], s15 offen offset:1024 sc1 lds
    v_mfma_f32_16x16x32_bf16 v[160:163], v[32:35], a[160:163], v[160:163]
    s_barrier
    ds_read_b128 a[192:195], v244 offset:32768
    v_mfma_f32_16x16x32_bf16 v[160:163], v[36:39], a[176:179], v[160:163]
    s_mov_b32 s30, 2359296
    v_add_u32 v5, 4294918144, v5
    v_mfma_f32_16x16x32_bf16 v[164:167], v[32:35], a[164:167], v[164:167]
    ds_read_b128 a[208:211], v245 offset:32768
    buffer_load_dwordx4 v9, s[40:43], s24 offen offset:2048 sc1 lds
    v_mfma_f32_16x16x32_bf16 v[164:167], v[36:39], a[180:183], v[164:167]
    ds_read_b64_tr_b16 v[24:25], v5 offset:0
    ds_read_b128 a[196:199], v244 offset:34816
    v_mfma_f32_16x16x32_bf16 v[168:171], v[32:35], a[168:171], v[168:171]
    s_mov_b32 s31, 0x20000
    ds_read_b64_tr_b16 v[26:27], v5 offset:512
    ds_read_b64_tr_b16 v[28:29], v5 offset:2048
    v_mfma_f32_16x16x32_bf16 v[168:171], v[36:39], a[184:187], v[168:171]
    ds_read_b128 a[212:215], v245 offset:34816
    buffer_load_dwordx4 v9, s[40:43], s25 offen offset:3072 sc1 lds
    v_mfma_f32_16x16x32_bf16 v[172:175], v[32:35], a[172:175], v[172:175]
    ds_read_b64_tr_b16 v[30:31], v5 offset:2560
    ds_read_b128 a[200:203], v246 offset:32768
    v_mfma_f32_16x16x32_bf16 v[172:175], v[36:39], a[188:191], v[172:175]
    ds_read_b128 a[216:219], v247 offset:32768
    v_mfma_f32_16x16x32_bf16 v[176:179], v[40:43], a[160:163], v[176:179]
    s_mul_i32 s57, s53, 73728
    ds_read_b64_tr_b16 v[32:33], v5 offset:8192
    v_mfma_f32_16x16x32_bf16 v[176:179], v[44:47], a[176:179], v[176:179]
    ds_read_b128 a[204:207], v246 offset:34816
    v_add_u32 v4, 4291430400, v4
    v_mfma_f32_16x16x32_bf16 v[180:183], v[40:43], a[164:167], v[180:183]
    s_add_u32 s36, s20, s57
    ds_read_b64_tr_b16 v[34:35], v5 offset:8704
    s_addc_u32 s37, s21, 0
    v_mfma_f32_16x16x32_bf16 v[180:183], v[44:47], a[180:183], v[180:183]
    ds_read_b128 a[220:223], v247 offset:34816
    v_mfma_f32_16x16x32_bf16 v[184:187], v[40:43], a[168:171], v[184:187]
    s_sub_u32 s38, 5308416, s57
    ds_read_b64_tr_b16 v[36:37], v5 offset:10240
    v_mfma_f32_16x16x32_bf16 v[184:187], v[44:47], a[184:187], v[184:187]
    s_add_u32 m0, s55, 98304
    ds_read_b64_tr_b16 v[38:39], v5 offset:10752
    s_mov_b32 s39, 0x20000
    v_mfma_f32_16x16x32_bf16 v[188:191], v[40:43], a[172:175], v[188:191]
    s_lshl_b32 s56, s60, 4
    v_mfma_f32_16x16x32_bf16 v[188:191], v[44:47], a[188:191], v[188:191]
    s_waitcnt lgkmcnt(8)
    buffer_load_dwordx4 v4, s[32:35], s64 offen offset:0 lds
    v_mfma_f32_16x16x32_bf16 v[128:131], v[24:27], a[192:195], v[128:131]
    s_add_u32 s56, s56, s53
    v_add_u32 v6, 4294918144, v6
    v_mfma_f32_16x16x32_bf16 v[128:131], v[28:31], a[208:211], v[128:131]
    s_mul_i32 s56, s56, 2432
    ds_read_b64_tr_b16 v[40:41], v6 offset:0
    v_mfma_f32_16x16x32_bf16 v[132:135], v[24:27], a[196:199], v[132:135]
    buffer_load_dwordx4 v4, s[32:35], s65 offen offset:1024 lds
    v_mfma_f32_16x16x32_bf16 v[132:135], v[28:31], a[212:215], v[132:135]
    s_add_u32 s97, s56, 1048576
    ds_read_b64_tr_b16 v[42:43], v6 offset:512
    s_waitcnt lgkmcnt(9)
    v_mfma_f32_16x16x32_bf16 v[136:139], v[24:27], a[200:203], v[136:139]
    ds_read_b64_tr_b16 v[44:45], v6 offset:2048
    s_waitcnt lgkmcnt(9)
    v_mfma_f32_16x16x32_bf16 v[136:139], v[28:31], a[216:219], v[136:139]
    buffer_load_dwordx4 v4, s[32:35], s66 offen offset:2048 lds
    s_waitcnt lgkmcnt(7)
    v_mfma_f32_16x16x32_bf16 v[140:143], v[24:27], a[204:207], v[140:143]
    s_lshl_b32 s57, s52, 4
    ds_read_b64_tr_b16 v[46:47], v6 offset:2560
    s_waitcnt lgkmcnt(6)
    v_mfma_f32_16x16x32_bf16 v[140:143], v[28:31], a[220:223], v[140:143]
    s_waitcnt lgkmcnt(4)
    s_add_u32 s57, s57, s53
    s_lshl_b32 s57, s57, 4
    v_mfma_f32_16x16x32_bf16 v[144:147], v[32:35], a[192:195], v[144:147]
    buffer_load_dwordx4 v4, s[32:35], s67 offen offset:3072 lds
    v_mfma_f32_16x16x32_bf16 v[144:147], v[36:39], a[208:211], v[144:147]
    s_add_u32 s98, s57, 196608
    ds_read_b64_tr_b16 v[24:25], v6 offset:8192
    ds_read_b64_tr_b16 v[26:27], v6 offset:8704
    v_mfma_f32_16x16x32_bf16 v[148:151], v[32:35], a[196:199], v[148:151]
    ds_read_b64_tr_b16 v[28:29], v6 offset:10240
    v_mfma_f32_16x16x32_bf16 v[148:151], v[36:39], a[212:215], v[148:151]
    s_lshr_b32 s99, s60, 1
    ds_read_b64_tr_b16 v[30:31], v6 offset:10752
    v_mfma_f32_16x16x32_bf16 v[152:155], v[32:35], a[200:203], v[152:155]
    s_add_u32 m0, s55, 114688
    s_mul_i32 s99, s99, 4992
    v_add_u32 v120, s16, v22
    v_mfma_f32_16x16x32_bf16 v[152:155], v[36:39], a[216:219], v[152:155]
    v_add_u32 v121, s17, v22
    v_add_u32 v122, s98, v8
    v_mfma_f32_16x16x32_bf16 v[156:159], v[32:35], a[204:207], v[156:159]
    v_add_u32 v122, 4096, v122
    v_mov_b32 v124, 0
    v_mfma_f32_16x16x32_bf16 v[156:159], v[36:39], a[220:223], v[156:159]
    s_waitcnt vmcnt(14) lgkmcnt(0)
    buffer_load_dwordx4 v4, s[32:35], s68 offen offset:0 lds
    v_mfma_f32_16x16x32_bf16 v[160:163], v[40:43], a[192:195], v[160:163]
    s_barrier
    ds_read_b128 a[224:227], v248 offset:0
    v_mfma_f32_16x16x32_bf16 v[160:163], v[44:47], a[208:211], v[160:163]
    ds_read_b64_tr_b16 v[32:33], v5 offset:16384
    ds_read_b128 a[240:243], v249 offset:0
    v_mfma_f32_16x16x32_bf16 v[164:167], v[40:43], a[196:199], v[164:167]
    ds_read_b64_tr_b16 v[34:35], v5 offset:16896
    ds_read_b64_tr_b16 v[36:37], v5 offset:18432
    v_mfma_f32_16x16x32_bf16 v[164:167], v[44:47], a[212:215], v[164:167]
    ds_read_b128 a[228:231], v248 offset:2048
    buffer_load_dwordx4 v4, s[32:35], s69 offen offset:1024 lds
    v_mfma_f32_16x16x32_bf16 v[168:171], v[40:43], a[200:203], v[168:171]
    ds_read_b64_tr_b16 v[38:39], v5 offset:18944
    v_mov_b32 v125, 0
    v_mfma_f32_16x16x32_bf16 v[168:171], v[44:47], a[216:219], v[168:171]
    ds_read_b128 a[244:247], v249 offset:2048
    v_mov_b32 v126, 0
    v_mfma_f32_16x16x32_bf16 v[172:175], v[40:43], a[204:207], v[172:175]
    ds_read_b128 a[232:235], v250 offset:0
    v_mov_b32 v127, 0
    v_mfma_f32_16x16x32_bf16 v[172:175], v[44:47], a[220:223], v[172:175]
    ds_read_b128 a[248:251], v251 offset:0
    buffer_load_dwordx4 v4, s[32:35], s70 offen offset:2048 lds
    v_mfma_f32_16x16x32_bf16 v[176:179], v[24:27], a[192:195], v[176:179]
    s_and_b32 s6, s86, 31
    ds_read_b64_tr_b16 v[40:41], v5 offset:24576
    v_mfma_f32_16x16x32_bf16 v[176:179], v[28:31], a[208:211], v[176:179]
    ds_read_b128 a[236:239], v250 offset:2048
    v_mfma_f32_16x16x32_bf16 v[180:183], v[24:27], a[196:199], v[180:183]
    s_mul_i32 s6, s6, 2304
    ds_read_b64_tr_b16 v[42:43], v5 offset:25088
    v_mfma_f32_16x16x32_bf16 v[180:183], v[28:31], a[212:215], v[180:183]
    ds_read_b128 a[252:255], v251 offset:2048
    v_min_u32 v14, 272, v22
    v_mfma_f32_16x16x32_bf16 v[184:187], v[24:27], a[200:203], v[184:187]
    ds_read_b64_tr_b16 v[44:45], v5 offset:26624
    v_lshl_add_u32 v14, v14, 3, s6
    v_mfma_f32_16x16x32_bf16 v[184:187], v[28:31], a[216:219], v[184:187]
    buffer_load_dwordx4 v4, s[32:35], s71 offen offset:3072 lds
    v_mfma_f32_16x16x32_bf16 v[188:191], v[24:27], a[204:207], v[188:191]
    s_and_b32 s7, s53, 3
    ds_read_b64_tr_b16 v[46:47], v5 offset:27136
    v_mfma_f32_16x16x32_bf16 v[188:191], v[28:31], a[220:223], v[188:191]
    s_waitcnt lgkmcnt(9)
    s_lshr_b32 s8, s53, 2
    v_mfma_f32_16x16x32_bf16 v[128:131], v[32:35], a[224:227], v[128:131]
    s_lshl2_add_u32 s8, s52, s8
    ds_read_b64_tr_b16 v[24:25], v6 offset:16384
    v_mfma_f32_16x16x32_bf16 v[128:131], v[36:39], a[240:243], v[128:131]
    s_add_u32 m0, s55, 131072
    ds_read_b64_tr_b16 v[26:27], v6 offset:16896
    s_lshl_b32 s9, s54, 6
    v_mfma_f32_16x16x32_bf16 v[132:135], v[32:35], a[228:231], v[132:135]
    s_add_u32 s8, s8, s9
    ds_read_b64_tr_b16 v[28:29], v6 offset:18432
    s_mul_i32 s8, s8, 9216
    s_waitcnt lgkmcnt(11)
    v_mfma_f32_16x16x32_bf16 v[132:135], v[36:39], a[244:247], v[132:135]
    buffer_load_dwordx4 v4, s[32:35], s72 offen offset:0 lds
    s_waitcnt lgkmcnt(10)
    v_mfma_f32_16x16x32_bf16 v[136:139], v[32:35], a[232:235], v[136:139]
    s_mul_i32 s7, s7, 288
    ds_read_b64_tr_b16 v[30:31], v6 offset:18944
    s_waitcnt lgkmcnt(10)
    v_mfma_f32_16x16x32_bf16 v[136:139], v[36:39], a[248:251], v[136:139]
    s_add_u32 s8, s8, s7
    s_waitcnt lgkmcnt(8)
    v_mfma_f32_16x16x32_bf16 v[140:143], v[32:35], a[236:239], v[140:143]
    v_mul_u32_u24 v0, 1152, v238
    s_waitcnt lgkmcnt(6)
    v_mfma_f32_16x16x32_bf16 v[140:143], v[36:39], a[252:255], v[140:143]
    s_waitcnt lgkmcnt(4)
    buffer_load_dwordx4 v4, s[32:35], s73 offen offset:1024 lds
    v_mfma_f32_16x16x32_bf16 v[144:147], v[40:43], a[224:227], v[144:147]
    ds_read_b64_tr_b16 v[32:33], v6 offset:24576
    v_mul_u32_u24 v1, 40, v239
    v_mfma_f32_16x16x32_bf16 v[144:147], v[44:47], a[240:243], v[144:147]
    ds_read_b64_tr_b16 v[34:35], v6 offset:25088
    v_add3_u32 v16, v0, v1, s8
L_pg0_1:
L_pgx1:
    s_cbranch_execz L_pgx5
    v_mfma_f32_16x16x32_bf16 v[148:151], v[40:43], a[228:231], v[148:151]
    ds_read_b64_tr_b16 v[36:37], v6 offset:26624
    v_mfma_f32_16x16x32_bf16 v[148:151], v[44:47], a[244:247], v[148:151]
    s_cmp_eq_u32 s53, 4
    ds_read_b64_tr_b16 v[38:39], v6 offset:27136
    s_cselect_b64 s[100:101], -1, 0
    v_mfma_f32_16x16x32_bf16 v[152:155], v[40:43], a[232:235], v[152:155]
    buffer_load_dwordx4 v4, s[32:35], s74 offen offset:2048 lds
    v_mfma_f32_16x16x32_bf16 v[152:155], v[44:47], a[248:251], v[152:155]
    s_cmp_eq_u32 s53, 5
    s_cselect_b32 s20, 0x01010101, 0
    v_mfma_f32_16x16x32_bf16 v[156:159], v[40:43], a[236:239], v[156:159]
    buffer_load_dwordx4 v4, s[32:35], s75 offen offset:3072 lds
    v_mfma_f32_16x16x32_bf16 v[156:159], v[44:47], a[252:255], v[156:159]
    s_waitcnt vmcnt(12) lgkmcnt(0)
    s_mov_b32 s21, s20
    s_lshr_b32 s59, 0x2c, s53
    v_mfma_f32_16x16x32_bf16 v[160:163], v[24:27], a[224:227], v[160:163]
    s_barrier
    ds_read_b128 v[48:51], v244 offset:0
    v_mfma_f32_16x16x32_bf16 v[160:163], v[28:31], a[240:243], v[160:163]
    ds_read_b64_tr_b16 v[40:41], v5 offset:32768
    ds_read_b128 v[64:67], v245 offset:0
    v_mfma_f32_16x16x32_bf16 v[164:167], v[24:27], a[228:231], v[164:167]
    ds_read_b64_tr_b16 v[42:43], v5 offset:33280
    v_add_u32 v4, 1769472, v4
    v_mfma_f32_16x16x32_bf16 v[164:167], v[28:31], a[244:247], v[164:167]
    ds_read_b64_tr_b16 v[44:45], v5 offset:34816
    ds_read_b128 v[52:55], v244 offset:2048
    v_mfma_f32_16x16x32_bf16 v[168:171], v[24:27], a[232:235], v[168:171]
    s_and_b32 s59, s59, 1
    ds_read_b64_tr_b16 v[46:47], v5 offset:35328
    s_cselect_b64 s[62:63], -1, 0
    v_mfma_f32_16x16x32_bf16 v[168:171], v[28:31], a[248:251], v[168:171]
    ds_read_b128 v[68:71], v245 offset:2048
    s_add_u32 m0, s55, 16384
    v_mfma_f32_16x16x32_bf16 v[172:175], v[24:27], a[236:239], v[172:175]
    ds_read_b128 v[56:59], v246 offset:0
    v_mfma_f32_16x16x32_bf16 v[172:175], v[28:31], a[252:255], v[172:175]
    ds_read_b128 v[72:75], v247 offset:0
    v_mfma_f32_16x16x32_bf16 v[176:179], v[32:35], a[224:227], v[176:179]
    buffer_load_dwordx4 v4, s[32:35], s68 offen offset:0 lds
    v_mfma_f32_16x16x32_bf16 v[176:179], v[36:39], a[240:243], v[176:179]
    ds_read_b64_tr_b16 v[24:25], v5 offset:40960
    ds_read_b128 v[60:63], v246 offset:2048
    v_mfma_f32_16x16x32_bf16 v[180:183], v[32:35], a[228:231], v[180:183]
    s_lshl_b32 s18, s86, 3
    ds_read_b64_tr_b16 v[26:27], v5 offset:41472
    s_and_b32 s56, s54, 1
    v_mfma_f32_16x16x32_bf16 v[180:183], v[36:39], a[244:247], v[180:183]
    ds_read_b128 v[76:79], v247 offset:2048
    v_mfma_f32_16x16x32_bf16 v[184:187], v[32:35], a[232:235], v[184:187]
    s_lshr_b32 s57, s54, 1
    ds_read_b64_tr_b16 v[28:29], v5 offset:43008
    v_mfma_f32_16x16x32_bf16 v[184:187], v[36:39], a[248:251], v[184:187]
    buffer_load_dwordx4 v4, s[32:35], s69 offen offset:1024 lds
    v_mfma_f32_16x16x32_bf16 v[188:191], v[32:35], a[236:239], v[188:191]
    s_mul_i32 s86, s57, 12288
    ds_read_b64_tr_b16 v[30:31], v5 offset:43520
    v_mfma_f32_16x16x32_bf16 v[188:191], v[36:39], a[252:255], v[188:191]
    s_waitcnt lgkmcnt(9)
    buffer_load_dwordx4 v4, s[32:35], s70 offen offset:2048 lds
    v_mfma_f32_16x16x32_bf16 v[128:131], v[40:43], v[48:51], v[128:131]
    s_lshl_b32 s57, s56, 10
    ds_read_b64_tr_b16 v[32:33], v6 offset:32768
    v_mfma_f32_16x16x32_bf16 v[128:131], v[44:47], v[64:67], v[128:131]
    buffer_load_dwordx4 v4, s[32:35], s71 offen offset:3072 lds
    v_mfma_f32_16x16x32_bf16 v[132:135], v[40:43], v[52:55], v[132:135]
    s_add_u32 s86, s86, s57
    ds_read_b64_tr_b16 v[34:35], v6 offset:33280
    s_waitcnt lgkmcnt(10)
    v_mfma_f32_16x16x32_bf16 v[132:135], v[44:47], v[68:71], v[132:135]
    s_lshl_b32 s56, s53, 6
    ds_read_b64_tr_b16 v[36:37], v6 offset:34816
    s_waitcnt lgkmcnt(10)
    v_mfma_f32_16x16x32_bf16 v[136:139], v[40:43], v[56:59], v[136:139]
    s_sub_u32 s19, 8192, s56
    ds_read_b64_tr_b16 v[38:39], v6 offset:35328
    s_waitcnt lgkmcnt(10)
    v_mfma_f32_16x16x32_bf16 v[136:139], v[44:47], v[72:75], v[136:139]
    s_add_u32 m0, s55, 32768
    s_mul_i32 s84, s19, 576
    s_and_b32 s57, s56, 192
    s_waitcnt lgkmcnt(8)
    v_mfma_f32_16x16x32_bf16 v[140:143], v[40:43], v[60:63], v[140:143]
    s_lshl1_add_u32 s19, s57, s19
    s_waitcnt lgkmcnt(6)
    v_mfma_f32_16x16x32_bf16 v[140:143], v[44:47], v[76:79], v[140:143]
    s_waitcnt lgkmcnt(4)
    s_and_b32 s56, s56, 768
    s_min_u32 s57, s56, 512
    v_mfma_f32_16x16x32_bf16 v[144:147], v[24:27], v[48:51], v[144:147]
    buffer_load_dwordx4 v4, s[32:35], s72 offen offset:0 lds
    v_mfma_f32_16x16x32_bf16 v[144:147], v[28:31], v[64:67], v[144:147]
    ds_read_b64_tr_b16 v[40:41], v6 offset:40960
    ds_read_b64_tr_b16 v[42:43], v6 offset:41472
    v_mfma_f32_16x16x32_bf16 v[148:151], v[24:27], v[52:55], v[148:151]
    s_lshl_b32 s56, s56, 1
    ds_read_b64_tr_b16 v[44:45], v6 offset:43008
    v_mfma_f32_16x16x32_bf16 v[148:151], v[28:31], v[68:71], v[148:151]
    s_sub_u32 s57, s57, s56
    ds_read_b64_tr_b16 v[46:47], v6 offset:43520
    v_mfma_f32_16x16x32_bf16 v[152:155], v[24:27], v[56:59], v[152:155]
    buffer_load_dwordx4 v4, s[32:35], s73 offen offset:1024 lds
    v_mfma_f32_16x16x32_bf16 v[152:155], v[28:31], v[72:75], v[152:155]
    s_add_u32 s92, s57, 2048
    s_mul_i32 s85, s54, 9216
    v_mfma_f32_16x16x32_bf16 v[156:159], v[24:27], v[60:63], v[156:159]
    s_mul_i32 s4, s54, 214
    v_mfma_f32_16x16x32_bf16 v[156:159], v[28:31], v[76:79], v[156:159]
    s_waitcnt vmcnt(14) lgkmcnt(0)
    s_lshr_b32 s4, s4, 4
    s_lshl_b32 s4, s4, 10
    v_mfma_f32_16x16x32_bf16 v[160:163], v[32:35], v[48:51], v[160:163]
    s_barrier
    v_mfma_f32_16x16x32_bf16 v[160:163], v[36:39], v[64:67], v[160:163]
    s_mul_i32 s5, s53, 55296
    v_add_u32 v5, 49152, v5
    v_mfma_f32_16x16x32_bf16 v[164:167], v[32:35], v[52:55], v[164:167]
    buffer_load_dwordx4 v4, s[32:35], s74 offen offset:2048 lds
    v_mfma_f32_16x16x32_bf16 v[164:167], v[36:39], v[68:71], v[164:167]
    s_add_u32 s5, s5, s4
    ds_read_b64_tr_b16 v[24:25], v5 offset:0
    v_mfma_f32_16x16x32_bf16 v[168:171], v[32:35], v[56:59], v[168:171]
    s_min_u32 s6, s53, 6
    ds_read_b64_tr_b16 v[26:27], v5 offset:512
    v_mfma_f32_16x16x32_bf16 v[168:171], v[36:39], v[72:75], v[168:171]
    buffer_load_dwordx4 v4, s[32:35], s75 offen offset:3072 lds
    v_mfma_f32_16x16x32_bf16 v[172:175], v[32:35], v[60:63], v[172:175]
    ds_read_b64_tr_b16 v[28:29], v5 offset:2048
    v_mfma_f32_16x16x32_bf16 v[172:175], v[36:39], v[76:79], v[172:175]
    ds_read_b64_tr_b16 v[30:31], v5 offset:2560
    s_lshl_b32 s6, s6, 8
    v_mfma_f32_16x16x32_bf16 v[176:179], v[40:43], v[48:51], v[176:179]
    s_mov_b32 s76, 0
    ds_read_b64_tr_b16 v[32:33], v5 offset:8192
    s_mov_b32 s77, 35840
    v_mfma_f32_16x16x32_bf16 v[176:179], v[44:47], v[64:67], v[176:179]
    s_add_u32 m0, s55, 0
    ds_read_b64_tr_b16 v[34:35], v5 offset:8704
    s_mov_b32 s78, 1177600
    v_mfma_f32_16x16x32_bf16 v[180:183], v[40:43], v[52:55], v[180:183]
    s_mov_b32 s79, 1213440
    ds_read_b64_tr_b16 v[36:37], v5 offset:10240
    s_mov_b32 s80, 2359296
    v_mfma_f32_16x16x32_bf16 v[180:183], v[44:47], v[68:71], v[180:183]
    buffer_load_dwordx4 v4, s[32:35], s64 offen offset:0 lds
    v_mfma_f32_16x16x32_bf16 v[184:187], v[40:43], v[56:59], v[184:187]
    ds_read_b64_tr_b16 v[38:39], v5 offset:10752
    v_mfma_f32_16x16x32_bf16 v[184:187], v[44:47], v[72:75], v[184:187]
    s_mov_b32 s81, 2395136
    s_mov_b32 s82, 3536896
    v_mfma_f32_16x16x32_bf16 v[188:191], v[40:43], v[60:63], v[188:191]
    s_mov_b32 s83, 3572736
    v_mfma_f32_16x16x32_bf16 v[188:191], v[44:47], v[76:79], v[188:191]
    s_waitcnt lgkmcnt(4)
    buffer_load_dwordx4 v4, s[32:35], s65 offen offset:1024 lds
    v_mfma_f32_16x16x32_bf16 v[192:195], v[24:27], a[0:3], 0
    v_add_u32 v6, 49152, v6
    v_mfma_f32_16x16x32_bf16 v[192:195], v[28:31], a[16:19], v[192:195]
    ds_read_b64_tr_b16 v[40:41], v6 offset:0
    v_mfma_f32_16x16x32_bf16 v[196:199], v[24:27], a[4:7], 0
    ds_read_b64_tr_b16 v[42:43], v6 offset:512
    v_mfma_f32_16x16x32_bf16 v[196:199], v[28:31], a[20:23], v[196:199]
    ds_read_b64_tr_b16 v[44:45], v6 offset:2048
    v_mfma_f32_16x16x32_bf16 v[200:203], v[24:27], a[8:11], 0
    ds_read_b64_tr_b16 v[46:47], v6 offset:2560
    v_fmaak_f32 v0, v128, v128, 0x409d30fc
    v_mfma_f32_16x16x32_bf16 v[200:203], v[28:31], a[24:27], v[200:203]
    buffer_load_dwordx4 v4, s[32:35], s66 offen offset:2048 lds
    v_mfma_f32_16x16x32_bf16 v[204:207], v[24:27], a[12:15], 0
    v_fmaak_f32 v1, v129, v129, 0x409d30fc
    v_mul_f32 v0, v0, v128
    v_mfma_f32_16x16x32_bf16 v[204:207], v[28:31], a[28:31], v[204:207]
    s_waitcnt lgkmcnt(4)
    buffer_load_dwordx4 v4, s[32:35], s67 offen offset:3072 lds
    v_mfma_f32_16x16x32_bf16 v[208:211], v[32:35], a[0:3], 0
    ds_read_b64_tr_b16 v[24:25], v6 offset:8192
    ds_read_b64_tr_b16 v[26:27], v6 offset:8704
    v_mfma_f32_16x16x32_bf16 v[208:211], v[36:39], a[16:19], v[208:211]
    ds_read_b64_tr_b16 v[28:29], v6 offset:10240
    v_mul_f32 v1, v1, v129
    v_mfma_f32_16x16x32_bf16 v[212:215], v[32:35], a[4:7], 0
    ds_read_b64_tr_b16 v[30:31], v6 offset:10752
    v_mfma_f32_16x16x32_bf16 v[212:215], v[36:39], a[20:23], v[212:215]
    v_exp_f32 v0, v0
    v_mfma_f32_16x16x32_bf16 v[216:219], v[32:35], a[8:11], 0
    s_add_u32 s87, s87, 2048
    v_exp_f32 v1, v1
    v_mfma_f32_16x16x32_bf16 v[216:219], v[36:39], a[24:27], v[216:219]
    buffer_load_dword v20, v7, s[32:35], s87 offen
    v_mfma_f32_16x16x32_bf16 v[220:223], v[32:35], a[12:15], 0
    v_mul_f32 v144, v128, v144
    v_fma_f32 v0, v0, s50, s50
    v_mfma_f32_16x16x32_bf16 v[220:223], v[36:39], a[28:31], v[220:223]
    s_waitcnt vmcnt(17) lgkmcnt(0)
    v_add_u32 v4, 1769472, v4
    v_fma_f32 v1, v1, s50, s50
    v_mfma_f32_16x16x32_bf16 v[224:227], v[40:43], a[0:3], 0
    s_barrier
    v_mfma_f32_16x16x32_bf16 v[224:227], v[44:47], a[16:19], v[224:227]
    v_rcp_f32 v0, v0
    v_mfma_f32_16x16x32_bf16 v[228:231], v[40:43], a[4:7], 0
    v_rcp_f32 v1, v1
    v_mfma_f32_16x16x32_bf16 v[228:231], v[44:47], a[20:23], v[228:231]
    s_add_u32 m0, s55, 49152
    ds_read_b64_tr_b16 v[32:33], v5 offset:16384
    v_mul_f32 v145, v129, v145
    v_mfma_f32_16x16x32_bf16 v[232:235], v[40:43], a[8:11], 0
    ds_read_b64_tr_b16 v[34:35], v5 offset:16896
    v_mul_f32 v0, v0, v144
    v_mfma_f32_16x16x32_bf16 v[232:235], v[44:47], a[24:27], v[232:235]
    buffer_load_dwordx4 v4, s[32:35], s64 offen offset:0 lds
    v_mfma_f32_16x16x32_bf16 v[236:239], v[40:43], a[12:15], 0
    ds_read_b64_tr_b16 v[36:37], v5 offset:18432
    v_mul_f32 v1, v1, v145
    v_mfma_f32_16x16x32_bf16 v[236:239], v[44:47], a[28:31], v[236:239]
    ds_read_b64_tr_b16 v[38:39], v5 offset:18944
    v_cvt_pk_bf16_f32 v80, v0, v1
    v_mfma_f32_16x16x32_bf16 v[240:243], v[24:27], a[0:3], 0
    ds_read_b64_tr_b16 v[40:41], v5 offset:24576
    v_fmaak_f32 v0, v130, v130, 0x409d30fc
    v_mfma_f32_16x16x32_bf16 v[240:243], v[28:31], a[16:19], v[240:243]
    buffer_load_dwordx4 v4, s[32:35], s65 offen offset:1024 lds
    v_mfma_f32_16x16x32_bf16 v[244:247], v[24:27], a[4:7], 0
    ds_read_b64_tr_b16 v[42:43], v5 offset:25088
    v_fmaak_f32 v1, v131, v131, 0x409d30fc
    v_mfma_f32_16x16x32_bf16 v[244:247], v[28:31], a[20:23], v[244:247]
    buffer_load_dwordx4 v4, s[32:35], s66 offen offset:2048 lds
    v_mfma_f32_16x16x32_bf16 v[248:251], v[24:27], a[8:11], 0
    ds_read_b64_tr_b16 v[44:45], v5 offset:26624
    v_mul_f32 v0, v0, v130
    v_mfma_f32_16x16x32_bf16 v[248:251], v[28:31], a[24:27], v[248:251]
    ds_read_b64_tr_b16 v[46:47], v5 offset:27136
    v_mul_f32 v1, v1, v131
    v_mfma_f32_16x16x32_bf16 v[252:255], v[24:27], a[12:15], 0
    v_exp_f32 v0, v0
    v_mfma_f32_16x16x32_bf16 v[252:255], v[28:31], a[28:31], v[252:255]
    s_waitcnt lgkmcnt(4)
    buffer_load_dwordx4 v4, s[32:35], s67 offen offset:3072 lds
    v_mfma_f32_16x16x32_bf16 v[192:195], v[32:35], a[32:35], v[192:195]
    v_exp_f32 v1, v1
    v_mfma_f32_16x16x32_bf16 v[192:195], v[36:39], a[48:51], v[192:195]
    ds_read_b64_tr_b16 v[24:25], v6 offset:16384
    v_mul_f32 v146, v130, v146
    v_mfma_f32_16x16x32_bf16 v[196:199], v[32:35], a[36:39], v[196:199]
    ds_read_b64_tr_b16 v[26:27], v6 offset:16896
    v_fma_f32 v0, v0, s50, s50
    v_mfma_f32_16x16x32_bf16 v[196:199], v[36:39], a[52:55], v[196:199]
    s_add_u32 m0, s55, 65536
    ds_read_b64_tr_b16 v[28:29], v6 offset:18432
    v_fma_f32 v1, v1, s50, s50
    v_mfma_f32_16x16x32_bf16 v[200:203], v[32:35], a[40:43], v[200:203]
    v_rcp_f32 v0, v0
    v_mfma_f32_16x16x32_bf16 v[200:203], v[36:39], a[56:59], v[200:203]
    buffer_load_dwordx4 v4, s[32:35], s68 offen offset:0 lds
    v_mfma_f32_16x16x32_bf16 v[204:207], v[32:35], a[44:47], v[204:207]
    v_rcp_f32 v1, v1
    v_mfma_f32_16x16x32_bf16 v[204:207], v[36:39], a[60:63], v[204:207]
    s_waitcnt lgkmcnt(3)
    ds_read_b64_tr_b16 v[30:31], v6 offset:18944
    v_mul_f32 v147, v131, v147
    v_mfma_f32_16x16x32_bf16 v[208:211], v[40:43], a[32:35], v[208:211]
    ds_read_b64_tr_b16 v[32:33], v6 offset:24576
    ds_read_b64_tr_b16 v[34:35], v6 offset:25088
    v_mfma_f32_16x16x32_bf16 v[208:211], v[44:47], a[48:51], v[208:211]
    buffer_load_dwordx4 v4, s[32:35], s69 offen offset:1024 lds
    v_mfma_f32_16x16x32_bf16 v[212:215], v[40:43], a[36:39], v[212:215]
    ds_read_b64_tr_b16 v[36:37], v6 offset:26624
    v_mul_f32 v0, v0, v146
    v_mfma_f32_16x16x32_bf16 v[212:215], v[44:47], a[52:55], v[212:215]
    ds_read_b64_tr_b16 v[38:39], v6 offset:27136
    v_mul_f32 v1, v1, v147
    v_mfma_f32_16x16x32_bf16 v[216:219], v[40:43], a[40:43], v[216:219]
    v_cvt_pk_bf16_f32 v81, v0, v1
    v_fmaak_f32 v0, v132, v132, 0x409d30fc
    v_mfma_f32_16x16x32_bf16 v[216:219], v[44:47], a[56:59], v[216:219]
    buffer_load_dwordx4 v4, s[32:35], s70 offen offset:2048 lds
    v_mfma_f32_16x16x32_bf16 v[220:223], v[40:43], a[44:47], v[220:223]
    v_fmaak_f32 v1, v133, v133, 0x409d30fc
    v_mul_f32 v0, v0, v132
    v_mfma_f32_16x16x32_bf16 v[220:223], v[44:47], a[60:63], v[220:223]
    s_waitcnt vmcnt(20) lgkmcnt(0)
    v_mul_f32 v1, v1, v133
    v_mfma_f32_16x16x32_bf16 v[224:227], v[24:27], a[32:35], v[224:227]
    s_barrier
    v_mfma_f32_16x16x32_bf16 v[224:227], v[28:31], a[48:51], v[224:227]
    buffer_load_dwordx4 v4, s[32:35], s71 offen offset:3072 lds
    v_mfma_f32_16x16x32_bf16 v[228:231], v[24:27], a[36:39], v[228:231]
    v_exp_f32 v0, v0
    v_mfma_f32_16x16x32_bf16 v[228:231], v[28:31], a[52:55], v[228:231]
    v_exp_f32 v1, v1
    v_mfma_f32_16x16x32_bf16 v[232:235], v[24:27], a[40:43], v[232:235]
    ds_read_b64_tr_b16 v[40:41], v5 offset:32768
    v_mul_f32 v148, v132, v148
    v_mfma_f32_16x16x32_bf16 v[232:235], v[28:31], a[56:59], v[232:235]
    s_add_u32 m0, s55, 81920
    ds_read_b64_tr_b16 v[42:43], v5 offset:33280
    v_fma_f32 v0, v0, s50, s50
    v_mfma_f32_16x16x32_bf16 v[236:239], v[24:27], a[44:47], v[236:239]
    ds_read_b64_tr_b16 v[44:45], v5 offset:34816
    v_fma_f32 v1, v1, s50, s50
    v_mfma_f32_16x16x32_bf16 v[236:239], v[28:31], a[60:63], v[236:239]
    ds_read_b64_tr_b16 v[46:47], v5 offset:35328
    v_mfma_f32_16x16x32_bf16 v[240:243], v[32:35], a[32:35], v[240:243]
    v_rcp_f32 v0, v0
    v_mfma_f32_16x16x32_bf16 v[240:243], v[36:39], a[48:51], v[240:243]
    buffer_load_dwordx4 v4, s[32:35], s72 offen offset:0 lds
    v_mfma_f32_16x16x32_bf16 v[244:247], v[32:35], a[36:39], v[244:247]
    v_rcp_f32 v1, v1
    v_mfma_f32_16x16x32_bf16 v[244:247], v[36:39], a[52:55], v[244:247]
    ds_read_b64_tr_b16 v[24:25], v5 offset:40960
    v_mul_f32 v149, v133, v149
    v_mfma_f32_16x16x32_bf16 v[248:251], v[32:35], a[40:43], v[248:251]
    ds_read_b64_tr_b16 v[26:27], v5 offset:41472
    v_mul_f32 v0, v0, v148
    v_mfma_f32_16x16x32_bf16 v[248:251], v[36:39], a[56:59], v[248:251]
    buffer_load_dwordx4 v4, s[32:35], s73 offen offset:1024 lds
    v_mfma_f32_16x16x32_bf16 v[252:255], v[32:35], a[44:47], v[252:255]
    ds_read_b64_tr_b16 v[28:29], v5 offset:43008
    v_mul_f32 v1, v1, v149
    v_mfma_f32_16x16x32_bf16 v[252:255], v[36:39], a[60:63], v[252:255]
    s_waitcnt lgkmcnt(3)
    ds_read_b64_tr_b16 v[30:31], v5 offset:43520
    v_cvt_pk_bf16_f32 v84, v0, v1
    v_mfma_f32_16x16x32_bf16 v[192:195], v[40:43], a[64:67], v[192:195]
    ds_read_b64_tr_b16 v[32:33], v6 offset:32768
    v_fmaak_f32 v0, v134, v134, 0x409d30fc
    v_mfma_f32_16x16x32_bf16 v[192:195], v[44:47], a[80:83], v[192:195]
    buffer_load_dwordx4 v4, s[32:35], s74 offen offset:2048 lds
    v_mfma_f32_16x16x32_bf16 v[196:199], v[40:43], a[68:71], v[196:199]
    ds_read_b64_tr_b16 v[34:35], v6 offset:33280
    v_fmaak_f32 v1, v135, v135, 0x409d30fc
    v_mfma_f32_16x16x32_bf16 v[196:199], v[44:47], a[84:87], v[196:199]
    ds_read_b64_tr_b16 v[36:37], v6 offset:34816
    v_mul_f32 v0, v0, v134
    v_mfma_f32_16x16x32_bf16 v[200:203], v[40:43], a[72:75], v[200:203]
    ds_read_b64_tr_b16 v[38:39], v6 offset:35328
    v_mul_f32 v1, v1, v135
    v_mfma_f32_16x16x32_bf16 v[200:203], v[44:47], a[88:91], v[200:203]
    buffer_load_dwordx4 v4, s[32:35], s75 offen offset:3072 lds
    v_mfma_f32_16x16x32_bf16 v[204:207], v[40:43], a[76:79], v[204:207]
    v_exp_f32 v0, v0
    v_mfma_f32_16x16x32_bf16 v[204:207], v[44:47], a[92:95], v[204:207]
    s_waitcnt lgkmcnt(4)
    v_exp_f32 v1, v1
    v_mfma_f32_16x16x32_bf16 v[208:211], v[24:27], a[64:67], v[208:211]
    ds_read_b64_tr_b16 v[40:41], v6 offset:40960
    v_mul_f32 v150, v134, v150
    v_mfma_f32_16x16x32_bf16 v[208:211], v[28:31], a[80:83], v[208:211]
    ds_read_b64_tr_b16 v[42:43], v6 offset:41472
    v_fma_f32 v0, v0, s50, s50
    v_mfma_f32_16x16x32_bf16 v[212:215], v[24:27], a[68:71], v[212:215]
    ds_read_b64_tr_b16 v[44:45], v6 offset:43008
    v_fma_f32 v1, v1, s50, s50
    v_mfma_f32_16x16x32_bf16 v[212:215], v[28:31], a[84:87], v[212:215]
    ds_read_b64_tr_b16 v[46:47], v6 offset:43520
    v_rcp_f32 v0, v0
    v_mfma_f32_16x16x32_bf16 v[216:219], v[24:27], a[72:75], v[216:219]
    v_rcp_f32 v1, v1
    v_mfma_f32_16x16x32_bf16 v[216:219], v[28:31], a[88:91], v[216:219]
    v_mul_f32 v151, v135, v151
    v_mul_f32 v0, v0, v150
    v_mfma_f32_16x16x32_bf16 v[220:223], v[24:27], a[76:79], v[220:223]
    v_mul_f32 v1, v1, v151
    v_cvt_pk_bf16_f32 v85, v0, v1
    v_mfma_f32_16x16x32_bf16 v[220:223], v[28:31], a[92:95], v[220:223]
    s_waitcnt vmcnt(13) lgkmcnt(0)
    v_fmaak_f32 v0, v136, v136, 0x409d30fc
    v_fmaak_f32 v1, v137, v137, 0x409d30fc
    v_mfma_f32_16x16x32_bf16 v[224:227], v[32:35], a[64:67], v[224:227]
    s_barrier
    v_add_u32 v5, 4294868992, v5
    v_mfma_f32_16x16x32_bf16 v[224:227], v[36:39], a[80:83], v[224:227]
    s_add_u32 s88, s88, 2048
    ds_read_b64_tr_b16 v[24:25], v5 offset:0
    v_mul_f32 v0, v0, v136
    v_mfma_f32_16x16x32_bf16 v[228:231], v[32:35], a[68:71], v[228:231]
    buffer_load_dword v20, v7, s[32:35], s88 offen
    v_mfma_f32_16x16x32_bf16 v[228:231], v[36:39], a[84:87], v[228:231]
    ds_read_b64_tr_b16 v[26:27], v5 offset:512
    v_mul_f32 v1, v1, v137
    v_mfma_f32_16x16x32_bf16 v[232:235], v[32:35], a[72:75], v[232:235]
    v_exp_f32 v0, v0
    v_mfma_f32_16x16x32_bf16 v[232:235], v[36:39], a[88:91], v[232:235]
    s_mov_b32 m0, s12
    v_exp_f32 v1, v1
    v_mfma_f32_16x16x32_bf16 v[236:239], v[32:35], a[76:79], v[236:239]
    ds_read_b64_tr_b16 v[28:29], v5 offset:2048
    v_mul_f32 v152, v136, v152
    v_mfma_f32_16x16x32_bf16 v[236:239], v[36:39], a[92:95], v[236:239]
    ds_read_b64_tr_b16 v[30:31], v5 offset:2560
    global_load_lds_dwordx4 v[12:13], off
    v_mfma_f32_16x16x32_bf16 v[240:243], v[40:43], a[64:67], v[240:243]
    ds_read_b64_tr_b16 v[32:33], v5 offset:8192
    v_fma_f32 v0, v0, s50, s50
    v_mfma_f32_16x16x32_bf16 v[240:243], v[44:47], a[80:83], v[240:243]
    s_add_u32 m0, s12, 1024
    ds_read_b64_tr_b16 v[34:35], v5 offset:8704
    v_fma_f32 v1, v1, s50, s50
    v_mfma_f32_16x16x32_bf16 v[244:247], v[40:43], a[68:71], v[244:247]
    v_rcp_f32 v0, v0
    v_mfma_f32_16x16x32_bf16 v[244:247], v[44:47], a[84:87], v[244:247]
    buffer_load_dwordx4 v10, s[44:47], 0 offen lds
    v_mfma_f32_16x16x32_bf16 v[248:251], v[40:43], a[72:75], v[248:251]
    v_rcp_f32 v1, v1
    v_mfma_f32_16x16x32_bf16 v[248:251], v[44:47], a[88:91], v[248:251]
    ds_read_b64_tr_b16 v[36:37], v5 offset:10240
    v_add_u32 v4, 4291430400, v4
    v_mfma_f32_16x16x32_bf16 v[252:255], v[40:43], a[76:79], v[252:255]
    ds_read_b64_tr_b16 v[38:39], v5 offset:10752
    v_mul_f32 v153, v137, v153
    v_mfma_f32_16x16x32_bf16 v[252:255], v[44:47], a[92:95], v[252:255]
    s_waitcnt lgkmcnt(4)
    v_mul_f32 v0, v0, v152
    v_mul_f32 v1, v1, v153
    v_mfma_f32_16x16x32_bf16 v[192:195], v[24:27], a[96:99], v[192:195]
    v_add_u32 v6, 4294868992, v6
    v_cvt_pk_bf16_f32 v88, v0, v1
    v_mfma_f32_16x16x32_bf16 v[192:195], v[28:31], a[112:115], v[192:195]
    ds_read_b64_tr_b16 v[40:41], v6 offset:0
    v_fmaak_f32 v0, v138, v138, 0x409d30fc
    v_mfma_f32_16x16x32_bf16 v[196:199], v[24:27], a[100:103], v[196:199]
    s_add_u32 m0, s55, 98304
    ds_read_b64_tr_b16 v[42:43], v6 offset:512
    v_fmaak_f32 v1, v139, v139, 0x409d30fc
    v_mfma_f32_16x16x32_bf16 v[196:199], v[28:31], a[116:119], v[196:199]
    ds_read_b64_tr_b16 v[44:45], v6 offset:2048
    v_mul_f32 v0, v0, v138
    v_mfma_f32_16x16x32_bf16 v[200:203], v[24:27], a[104:107], v[200:203]
    ds_read_b64_tr_b16 v[46:47], v6 offset:2560
    v_mul_f32 v1, v1, v139
    v_mfma_f32_16x16x32_bf16 v[200:203], v[28:31], a[120:123], v[200:203]
    buffer_load_dwordx4 v4, s[32:35], s64 offen offset:0 lds
    v_mfma_f32_16x16x32_bf16 v[204:207], v[24:27], a[108:111], v[204:207]
    v_exp_f32 v0, v0
    v_mfma_f32_16x16x32_bf16 v[204:207], v[28:31], a[124:127], v[204:207]
    s_waitcnt lgkmcnt(4)
    v_exp_f32 v1, v1
    v_mfma_f32_16x16x32_bf16 v[208:211], v[32:35], a[96:99], v[208:211]
    ds_read_b64_tr_b16 v[24:25], v6 offset:8192
    v_mul_f32 v154, v138, v154
    v_mfma_f32_16x16x32_bf16 v[208:211], v[36:39], a[112:115], v[208:211]
    ds_read_b64_tr_b16 v[26:27], v6 offset:8704
    v_fma_f32 v0, v0, s50, s50
    v_mfma_f32_16x16x32_bf16 v[212:215], v[32:35], a[100:103], v[212:215]
    ds_read_b64_tr_b16 v[28:29], v6 offset:10240
    v_fma_f32 v1, v1, s50, s50
    v_mfma_f32_16x16x32_bf16 v[212:215], v[36:39], a[116:119], v[212:215]
    buffer_load_dwordx4 v4, s[32:35], s65 offen offset:1024 lds
    v_mfma_f32_16x16x32_bf16 v[216:219], v[32:35], a[104:107], v[216:219]
    v_rcp_f32 v0, v0
    v_mfma_f32_16x16x32_bf16 v[216:219], v[36:39], a[120:123], v[216:219]
    v_rcp_f32 v1, v1
    v_mfma_f32_16x16x32_bf16 v[220:223], v[32:35], a[108:111], v[220:223]
    ds_read_b64_tr_b16 v[30:31], v6 offset:10752
    v_mul_f32 v155, v139, v155
    v_mfma_f32_16x16x32_bf16 v[220:223], v[36:39], a[124:127], v[220:223]
    s_waitcnt lgkmcnt(4)
    v_mul_f32 v0, v0, v154
    v_mul_f32 v1, v1, v155
    v_mfma_f32_16x16x32_bf16 v[224:227], v[40:43], a[96:99], v[224:227]
    ds_read_b64_tr_b16 v[32:33], v5 offset:16384
    v_cvt_pk_bf16_f32 v89, v0, v1
    v_mfma_f32_16x16x32_bf16 v[224:227], v[44:47], a[112:115], v[224:227]
    buffer_load_dwordx4 v4, s[32:35], s66 offen offset:2048 lds
    v_mfma_f32_16x16x32_bf16 v[228:231], v[40:43], a[100:103], v[228:231]
    ds_read_b64_tr_b16 v[34:35], v5 offset:16896
    v_fmaak_f32 v0, v140, v140, 0x409d30fc
    v_mfma_f32_16x16x32_bf16 v[228:231], v[44:47], a[116:119], v[228:231]
    ds_read_b64_tr_b16 v[36:37], v5 offset:18432
    v_fmaak_f32 v1, v141, v141, 0x409d30fc
    v_mfma_f32_16x16x32_bf16 v[232:235], v[40:43], a[104:107], v[232:235]
    ds_read_b64_tr_b16 v[38:39], v5 offset:18944
    v_mul_f32 v0, v0, v140
    v_mfma_f32_16x16x32_bf16 v[232:235], v[44:47], a[120:123], v[232:235]
    buffer_load_dwordx4 v4, s[32:35], s67 offen offset:3072 lds
    v_mfma_f32_16x16x32_bf16 v[236:239], v[40:43], a[108:111], v[236:239]
    v_mul_f32 v1, v1, v141
    v_mfma_f32_16x16x32_bf16 v[236:239], v[44:47], a[124:127], v[236:239]
    s_waitcnt lgkmcnt(4)
    v_exp_f32 v0, v0
    v_mfma_f32_16x16x32_bf16 v[240:243], v[24:27], a[96:99], v[240:243]
    v_exp_f32 v1, v1
    v_mfma_f32_16x16x32_bf16 v[240:243], v[28:31], a[112:115], v[240:243]
    s_add_u32 m0, s55, 114688
    ds_read_b64_tr_b16 v[40:41], v5 offset:24576
    v_mul_f32 v156, v140, v156
    v_mfma_f32_16x16x32_bf16 v[244:247], v[24:27], a[100:103], v[244:247]
    ds_read_b64_tr_b16 v[42:43], v5 offset:25088
    v_fma_f32 v0, v0, s50, s50
    v_mfma_f32_16x16x32_bf16 v[244:247], v[28:31], a[116:119], v[244:247]
    ds_read_b64_tr_b16 v[44:45], v5 offset:26624
    v_fma_f32 v1, v1, s50, s50
    v_mfma_f32_16x16x32_bf16 v[248:251], v[24:27], a[104:107], v[248:251]
    v_rcp_f32 v0, v0
    v_mfma_f32_16x16x32_bf16 v[248:251], v[28:31], a[120:123], v[248:251]
    v_rcp_f32 v1, v1
    v_mfma_f32_16x16x32_bf16 v[252:255], v[24:27], a[108:111], v[252:255]
    v_mul_f32 v157, v141, v157
    v_mul_f32 v0, v0, v156
    v_mfma_f32_16x16x32_bf16 v[252:255], v[28:31], a[124:127], v[252:255]
    s_waitcnt lgkmcnt(3)
    ds_read_b64_tr_b16 v[46:47], v5 offset:27136
    buffer_load_dwordx4 v4, s[32:35], s68 offen offset:0 lds
    v_mfma_f32_16x16x32_bf16 v[192:195], v[32:35], a[128:131], v[192:195]
    ds_read_b64_tr_b16 v[24:25], v6 offset:16384
    v_mul_f32 v1, v1, v157
    v_mfma_f32_16x16x32_bf16 v[192:195], v[36:39], a[144:147], v[192:195]
    ds_read_b64_tr_b16 v[26:27], v6 offset:16896
    v_cvt_pk_bf16_f32 v92, v0, v1
    v_mfma_f32_16x16x32_bf16 v[196:199], v[32:35], a[132:135], v[196:199]
    ds_read_b64_tr_b16 v[28:29], v6 offset:18432
    v_fmaak_f32 v0, v142, v142, 0x409d30fc
    v_mfma_f32_16x16x32_bf16 v[196:199], v[36:39], a[148:151], v[196:199]
    buffer_load_dwordx4 v4, s[32:35], s69 offen offset:1024 lds
    v_mfma_f32_16x16x32_bf16 v[200:203], v[32:35], a[136:139], v[200:203]
    ds_read_b64_tr_b16 v[30:31], v6 offset:18944
    v_fmaak_f32 v1, v143, v143, 0x409d30fc
    v_mfma_f32_16x16x32_bf16 v[200:203], v[36:39], a[152:155], v[200:203]
    v_mul_f32 v0, v0, v142
    v_mul_f32 v1, v1, v143
    v_mfma_f32_16x16x32_bf16 v[204:207], v[32:35], a[140:143], v[204:207]
    v_exp_f32 v0, v0
    v_mfma_f32_16x16x32_bf16 v[204:207], v[36:39], a[156:159], v[204:207]
    s_waitcnt lgkmcnt(4)
    v_exp_f32 v1, v1
    v_mfma_f32_16x16x32_bf16 v[208:211], v[40:43], a[128:131], v[208:211]
    ds_read_b64_tr_b16 v[32:33], v6 offset:24576
    v_mul_f32 v158, v142, v158
    v_mfma_f32_16x16x32_bf16 v[208:211], v[44:47], a[144:147], v[208:211]
    buffer_load_dwordx4 v4, s[32:35], s70 offen offset:2048 lds
    v_mfma_f32_16x16x32_bf16 v[212:215], v[40:43], a[132:135], v[212:215]
    ds_read_b64_tr_b16 v[34:35], v6 offset:25088
    v_fma_f32 v0, v0, s50, s50
    v_mfma_f32_16x16x32_bf16 v[212:215], v[44:47], a[148:151], v[212:215]
    ds_read_b64_tr_b16 v[36:37], v6 offset:26624
    v_fma_f32 v1, v1, s50, s50
    v_mfma_f32_16x16x32_bf16 v[216:219], v[40:43], a[136:139], v[216:219]
    v_rcp_f32 v0, v0
    v_mfma_f32_16x16x32_bf16 v[216:219], v[44:47], a[152:155], v[216:219]
    buffer_load_dwordx4 v4, s[32:35], s71 offen offset:3072 lds
    v_mfma_f32_16x16x32_bf16 v[220:223], v[40:43], a[140:143], v[220:223]
    v_rcp_f32 v1, v1
    v_mfma_f32_16x16x32_bf16 v[220:223], v[44:47], a[156:159], v[220:223]
    s_waitcnt lgkmcnt(3)
    ds_read_b64_tr_b16 v[38:39], v6 offset:27136
    v_mul_f32 v159, v143, v159
    v_mfma_f32_16x16x32_bf16 v[224:227], v[24:27], a[128:131], v[224:227]
    ds_read_b64_tr_b16 v[40:41], v5 offset:32768
    v_mul_f32 v0, v0, v158
    v_mfma_f32_16x16x32_bf16 v[224:227], v[28:31], a[144:147], v[224:227]
    ds_read_b64_tr_b16 v[42:43], v5 offset:33280
    v_mul_f32 v1, v1, v159
    v_mfma_f32_16x16x32_bf16 v[228:231], v[24:27], a[132:135], v[228:231]
    ds_read_b64_tr_b16 v[44:45], v5 offset:34816
    v_cvt_pk_bf16_f32 v93, v0, v1
    v_mfma_f32_16x16x32_bf16 v[228:231], v[28:31], a[148:151], v[228:231]
    s_add_u32 m0, s55, 131072
    v_fmaak_f32 v0, v160, v160, 0x409d30fc
    v_fmaak_f32 v1, v161, v161, 0x409d30fc
    v_mfma_f32_16x16x32_bf16 v[232:235], v[24:27], a[136:139], v[232:235]
    v_mul_f32 v0, v0, v160
    v_mul_f32 v1, v1, v161
    v_mfma_f32_16x16x32_bf16 v[232:235], v[28:31], a[152:155], v[232:235]
    v_exp_f32 v0, v0
    v_mfma_f32_16x16x32_bf16 v[236:239], v[24:27], a[140:143], v[236:239]
    v_exp_f32 v1, v1
    v_mfma_f32_16x16x32_bf16 v[236:239], v[28:31], a[156:159], v[236:239]
    s_waitcnt lgkmcnt(3)
    ds_read_b64_tr_b16 v[46:47], v5 offset:35328
    v_mul_f32 v176, v160, v176
    v_mfma_f32_16x16x32_bf16 v[240:243], v[32:35], a[128:131], v[240:243]
    ds_read_b64_tr_b16 v[24:25], v5 offset:40960
    v_fma_f32 v0, v0, s50, s50
    v_mfma_f32_16x16x32_bf16 v[240:243], v[36:39], a[144:147], v[240:243]
    buffer_load_dwordx4 v4, s[32:35], s72 offen offset:0 lds
    v_mfma_f32_16x16x32_bf16 v[244:247], v[32:35], a[132:135], v[244:247]
    ds_read_b64_tr_b16 v[26:27], v5 offset:41472
    v_fma_f32 v1, v1, s50, s50
    v_mfma_f32_16x16x32_bf16 v[244:247], v[36:39], a[148:151], v[244:247]
    v_rcp_f32 v0, v0
L_pg0_2:
L_pgx2:
    s_cbranch_execz L_pgx6
    v_mfma_f32_16x16x32_bf16 v[248:251], v[32:35], a[136:139], v[248:251]
    v_rcp_f32 v1, v1
    v_mfma_f32_16x16x32_bf16 v[248:251], v[36:39], a[152:155], v[248:251]
    buffer_load_dwordx4 v4, s[32:35], s73 offen offset:1024 lds
    v_mfma_f32_16x16x32_bf16 v[252:255], v[32:35], a[140:143], v[252:255]
    ds_read_b64_tr_b16 v[28:29], v5 offset:43008
    v_mul_f32 v177, v161, v177
    v_mfma_f32_16x16x32_bf16 v[252:255], v[36:39], a[156:159], v[252:255]
    s_waitcnt lgkmcnt(3)
    ds_read_b64_tr_b16 v[30:31], v5 offset:43520
    v_mul_f32 v0, v0, v176
    v_mfma_f32_16x16x32_bf16 v[192:195], v[40:43], a[160:163], v[192:195]
    ds_read_b64_tr_b16 v[32:33], v6 offset:32768
    v_mul_f32 v1, v1, v177
    v_mfma_f32_16x16x32_bf16 v[192:195], v[44:47], a[176:179], v[192:195]
    buffer_load_dwordx4 v4, s[32:35], s74 offen offset:2048 lds
    v_mfma_f32_16x16x32_bf16 v[196:199], v[40:43], a[164:167], v[196:199]
    ds_read_b64_tr_b16 v[34:35], v6 offset:33280
    v_cvt_pk_bf16_f32 v82, v0, v1
    v_mfma_f32_16x16x32_bf16 v[196:199], v[44:47], a[180:183], v[196:199]
    ds_read_b64_tr_b16 v[36:37], v6 offset:34816
    v_fmaak_f32 v0, v162, v162, 0x409d30fc
    v_mfma_f32_16x16x32_bf16 v[200:203], v[40:43], a[168:171], v[200:203]
    ds_read_b64_tr_b16 v[38:39], v6 offset:35328
    v_fmaak_f32 v1, v163, v163, 0x409d30fc
    v_mfma_f32_16x16x32_bf16 v[200:203], v[44:47], a[184:187], v[200:203]
    v_mul_f32 v0, v0, v162
    v_mul_f32 v1, v1, v163
    v_mfma_f32_16x16x32_bf16 v[204:207], v[40:43], a[172:175], v[204:207]
    v_exp_f32 v0, v0
    v_mfma_f32_16x16x32_bf16 v[204:207], v[44:47], a[188:191], v[204:207]
    s_waitcnt lgkmcnt(4)
    buffer_load_dwordx4 v4, s[32:35], s75 offen offset:3072 lds
    v_mfma_f32_16x16x32_bf16 v[208:211], v[24:27], a[160:163], v[208:211]
    ds_read_b64_tr_b16 v[40:41], v6 offset:40960
    ds_read_b64_tr_b16 v[42:43], v6 offset:41472
    v_mfma_f32_16x16x32_bf16 v[208:211], v[28:31], a[176:179], v[208:211]
    ds_read_b64_tr_b16 v[44:45], v6 offset:43008
    v_mfma_f32_16x16x32_bf16 v[212:215], v[24:27], a[164:167], v[212:215]
    v_exp_f32 v1, v1
    v_mfma_f32_16x16x32_bf16 v[212:215], v[28:31], a[180:183], v[212:215]
    ds_read_b64_tr_b16 v[46:47], v6 offset:43520
    v_mul_f32 v178, v162, v178
    v_mfma_f32_16x16x32_bf16 v[216:219], v[24:27], a[168:171], v[216:219]
    v_fma_f32 v0, v0, s50, s50
    v_fma_f32 v1, v1, s50, s50
    v_mfma_f32_16x16x32_bf16 v[216:219], v[28:31], a[184:187], v[216:219]
    v_rcp_f32 v0, v0
    v_mfma_f32_16x16x32_bf16 v[220:223], v[24:27], a[172:175], v[220:223]
    v_rcp_f32 v1, v1
    v_mfma_f32_16x16x32_bf16 v[220:223], v[28:31], a[188:191], v[220:223]
    s_waitcnt vmcnt(15) lgkmcnt(0)
    v_mul_f32 v179, v163, v179
    v_mul_f32 v0, v0, v178
    v_mfma_f32_16x16x32_bf16 v[224:227], v[32:35], a[160:163], v[224:227]
    s_barrier
    v_mfma_f32_16x16x32_bf16 v[224:227], v[36:39], a[176:179], v[224:227]
    s_add_u32 s89, s89, 2048
    v_add_u32 v5, 49152, v5
    v_mul_f32 v1, v1, v179
    v_mfma_f32_16x16x32_bf16 v[228:231], v[32:35], a[164:167], v[228:231]
    buffer_load_dword v20, v7, s[32:35], s89 offen
    v_mfma_f32_16x16x32_bf16 v[228:231], v[36:39], a[180:183], v[228:231]
    ds_read_b64_tr_b16 v[24:25], v5 offset:0
    v_cvt_pk_bf16_f32 v83, v0, v1
    v_mfma_f32_16x16x32_bf16 v[232:235], v[32:35], a[168:171], v[232:235]
    ds_read_b64_tr_b16 v[26:27], v5 offset:512
    v_fmaak_f32 v0, v164, v164, 0x409d30fc
    v_mfma_f32_16x16x32_bf16 v[232:235], v[36:39], a[184:187], v[232:235]
    ds_read_b64_tr_b16 v[28:29], v5 offset:2048
    v_add_u32 v4, 1769472, v4
    v_mfma_f32_16x16x32_bf16 v[236:239], v[32:35], a[172:175], v[236:239]
    ds_read_b64_tr_b16 v[30:31], v5 offset:2560
    v_fmaak_f32 v1, v165, v165, 0x409d30fc
    v_mfma_f32_16x16x32_bf16 v[236:239], v[36:39], a[188:191], v[236:239]
    v_mul_f32 v0, v0, v164
    v_mul_f32 v1, v1, v165
    v_mfma_f32_16x16x32_bf16 v[240:243], v[40:43], a[160:163], v[240:243]
    v_exp_f32 v0, v0
    v_mfma_f32_16x16x32_bf16 v[240:243], v[44:47], a[176:179], v[240:243]
    s_add_u32 m0, s55, 0
    ds_read_b64_tr_b16 v[32:33], v5 offset:8192
    buffer_store_dwordx4 v[124:127], v122, s[40:43], 0 offen sc1
    v_mfma_f32_16x16x32_bf16 v[244:247], v[40:43], a[164:167], v[244:247]
    v_exp_f32 v1, v1
    v_mfma_f32_16x16x32_bf16 v[244:247], v[44:47], a[180:183], v[244:247]
    ds_read_b64_tr_b16 v[34:35], v5 offset:8704
    v_mul_f32 v180, v164, v180
    v_mfma_f32_16x16x32_bf16 v[248:251], v[40:43], a[168:171], v[248:251]
    ds_read_b64_tr_b16 v[36:37], v5 offset:10240
    v_fma_f32 v0, v0, s50, s50
    v_mfma_f32_16x16x32_bf16 v[248:251], v[44:47], a[184:187], v[248:251]
    ds_read_b64_tr_b16 v[38:39], v5 offset:10752
    v_fma_f32 v1, v1, s50, s50
    v_mfma_f32_16x16x32_bf16 v[252:255], v[40:43], a[172:175], v[252:255]
    v_rcp_f32 v0, v0
    v_mfma_f32_16x16x32_bf16 v[252:255], v[44:47], a[188:191], v[252:255]
    s_waitcnt lgkmcnt(4)
    buffer_load_dwordx4 v4, s[32:35], s64 offen offset:0 lds
    v_mfma_f32_16x16x32_bf16 v[192:195], v[24:27], a[192:195], v[192:195]
    v_add_u32 v6, 49152, v6
    v_mfma_f32_16x16x32_bf16 v[192:195], v[28:31], a[208:211], v[192:195]
    v_rcp_f32 v1, v1
    v_mfma_f32_16x16x32_bf16 v[196:199], v[24:27], a[196:199], v[196:199]
    ds_read_b64_tr_b16 v[40:41], v6 offset:0
    v_mul_f32 v181, v165, v181
    v_mfma_f32_16x16x32_bf16 v[196:199], v[28:31], a[212:215], v[196:199]
    ds_read_b64_tr_b16 v[42:43], v6 offset:512
    v_mul_f32 v0, v0, v180
    v_mfma_f32_16x16x32_bf16 v[200:203], v[24:27], a[200:203], v[200:203]
    s_waitcnt vmcnt(16)
    ds_read_b64_tr_b16 v[44:45], v6 offset:2048
    v_mul_f32 v1, v1, v181
    v_mfma_f32_16x16x32_bf16 v[200:203], v[28:31], a[216:219], v[200:203]
    buffer_load_dwordx4 v4, s[32:35], s65 offen offset:1024 lds
    v_mfma_f32_16x16x32_bf16 v[204:207], v[24:27], a[204:207], v[204:207]
    ds_read_b64_tr_b16 v[46:47], v6 offset:2560
    v_cvt_pk_bf16_f32 v86, v0, v1
    v_mfma_f32_16x16x32_bf16 v[204:207], v[28:31], a[220:223], v[204:207]
    s_waitcnt lgkmcnt(4)
    ds_read_b64_tr_b16 v[112:113], v11 offset:0
    v_fmaak_f32 v0, v166, v166, 0x409d30fc
    v_mfma_f32_16x16x32_bf16 v[208:211], v[32:35], a[192:195], v[208:211]
    ds_read_b64_tr_b16 v[24:25], v6 offset:8192
    ds_read_b64_tr_b16 v[26:27], v6 offset:8704
    v_mfma_f32_16x16x32_bf16 v[208:211], v[36:39], a[208:211], v[208:211]
    buffer_load_dwordx4 v4, s[32:35], s66 offen offset:2048 lds
    v_mfma_f32_16x16x32_bf16 v[212:215], v[32:35], a[196:199], v[212:215]
    ds_read_b64_tr_b16 v[28:29], v6 offset:10240
    v_fmaak_f32 v1, v167, v167, 0x409d30fc
    v_mfma_f32_16x16x32_bf16 v[212:215], v[36:39], a[212:215], v[212:215]
    ds_read_b64_tr_b16 v[114:115], v11 offset:128
    v_mul_f32 v0, v0, v166
    v_mfma_f32_16x16x32_bf16 v[216:219], v[32:35], a[200:203], v[216:219]
    ds_read_b64_tr_b16 v[30:31], v6 offset:10752
    v_mul_f32 v1, v1, v167
    v_mfma_f32_16x16x32_bf16 v[216:219], v[36:39], a[216:219], v[216:219]
    s_waitcnt vmcnt(17)
    v_exp_f32 v0, v0
    v_mfma_f32_16x16x32_bf16 v[220:223], v[32:35], a[204:207], v[220:223]
    v_exp_f32 v1, v1
    v_mfma_f32_16x16x32_bf16 v[220:223], v[36:39], a[220:223], v[220:223]
    s_waitcnt lgkmcnt(6)
    ds_read_b64_tr_b16 v[116:117], v11 offset:1024
    v_mfma_f32_16x16x32_bf16 v[224:227], v[40:43], a[192:195], v[224:227]
    ds_read_b64_tr_b16 v[32:33], v5 offset:16384
    v_mul_f32 v182, v166, v182
    v_mfma_f32_16x16x32_bf16 v[224:227], v[44:47], a[208:211], v[224:227]
    buffer_load_dwordx4 v4, s[32:35], s67 offen offset:3072 lds
    v_mfma_f32_16x16x32_bf16 v[228:231], v[40:43], a[196:199], v[228:231]
    ds_read_b64_tr_b16 v[34:35], v5 offset:16896
    v_fma_f32 v0, v0, s50, s50
    v_mfma_f32_16x16x32_bf16 v[228:231], v[44:47], a[212:215], v[228:231]
    ds_read_b64_tr_b16 v[118:119], v11 offset:1152
    v_fma_f32 v1, v1, s50, s50
    v_mfma_f32_16x16x32_bf16 v[232:235], v[40:43], a[200:203], v[232:235]
    v_rcp_f32 v0, v0
    v_mfma_f32_16x16x32_bf16 v[232:235], v[44:47], a[216:219], v[232:235]
    s_add_u32 m0, s55, 16384
    v_rcp_f32 v1, v1
    v_mfma_f32_16x16x32_bf16 v[236:239], v[40:43], a[204:207], v[236:239]
    ds_read_b64_tr_b16 v[36:37], v5 offset:18432
    v_mul_f32 v183, v167, v183
    v_mfma_f32_16x16x32_bf16 v[236:239], v[44:47], a[220:223], v[236:239]
    s_waitcnt lgkmcnt(5)
    ds_read_b64_tr_b16 v[38:39], v5 offset:18944
    v_mul_f32 v0, v0, v182
    v_mfma_f32_16x16x32_bf16 v[240:243], v[24:27], a[192:195], v[240:243]
    ds_read_b64_tr_b16 v[40:41], v5 offset:24576
    v_mul_f32 v1, v1, v183
    v_mfma_f32_16x16x32_bf16 v[240:243], v[28:31], a[208:211], v[240:243]
    ds_read_b64_tr_b16 v[42:43], v5 offset:25088
    v_cvt_pk_bf16_f32 v87, v0, v1
    v_mfma_f32_16x16x32_bf16 v[244:247], v[24:27], a[196:199], v[244:247]
    ds_read_b64_tr_b16 v[44:45], v5 offset:26624
    v_fmaak_f32 v0, v168, v168, 0x409d30fc
    v_mfma_f32_16x16x32_bf16 v[244:247], v[28:31], a[212:215], v[244:247]
    buffer_load_dwordx4 v4, s[32:35], s68 offen offset:0 lds
    v_mfma_f32_16x16x32_bf16 v[248:251], v[24:27], a[200:203], v[248:251]
    ds_read_b64_tr_b16 v[46:47], v5 offset:27136
    v_fmaak_f32 v1, v169, v169, 0x409d30fc
    v_mfma_f32_16x16x32_bf16 v[248:251], v[28:31], a[216:219], v[248:251]
    v_mul_f32 v0, v0, v168
    v_mul_f32 v1, v1, v169
    v_mfma_f32_16x16x32_bf16 v[252:255], v[24:27], a[204:207], v[252:255]
    v_exp_f32 v0, v0
    v_mfma_f32_16x16x32_bf16 v[252:255], v[28:31], a[220:223], v[252:255]
    s_waitcnt lgkmcnt(4)
    v_exp_f32 v1, v1
    v_mfma_f32_16x16x32_bf16 v[192:195], v[32:35], a[224:227], v[192:195]
    ds_read_b64_tr_b16 v[24:25], v6 offset:16384
    v_mfma_f32_16x16x32_bf16 v[192:195], v[36:39], a[240:243], v[192:195]
    buffer_load_dwordx4 v4, s[32:35], s69 offen offset:1024 lds
    v_mfma_f32_16x16x32_bf16 v[196:199], v[32:35], a[228:231], v[196:199]
    ds_read_b64_tr_b16 v[26:27], v6 offset:16896
    v_mul_f32 v184, v168, v184
    v_mfma_f32_16x16x32_bf16 v[196:199], v[36:39], a[244:247], v[196:199]
    buffer_store_dwordx4 v[112:115], v120, s[40:43], 0 offen sc1
    v_mfma_f32_16x16x32_bf16 v[200:203], v[32:35], a[232:235], v[200:203]
    ds_read_b64_tr_b16 v[28:29], v6 offset:18432
    v_fma_f32 v0, v0, s50, s50
    v_mfma_f32_16x16x32_bf16 v[200:203], v[36:39], a[248:251], v[200:203]
    buffer_load_dwordx4 v4, s[32:35], s70 offen offset:2048 lds
    v_mfma_f32_16x16x32_bf16 v[204:207], v[32:35], a[236:239], v[204:207]
    ds_read_b64_tr_b16 v[30:31], v6 offset:18944
    v_fma_f32 v1, v1, s50, s50
    v_mfma_f32_16x16x32_bf16 v[204:207], v[36:39], a[252:255], v[204:207]
    s_waitcnt lgkmcnt(4)
    v_rcp_f32 v0, v0
    v_mfma_f32_16x16x32_bf16 v[208:211], v[40:43], a[224:227], v[208:211]
    v_rcp_f32 v1, v1
    v_mfma_f32_16x16x32_bf16 v[208:211], v[44:47], a[240:243], v[208:211]
    ds_read_b64_tr_b16 v[32:33], v6 offset:24576
    v_mul_f32 v185, v169, v185
    v_mfma_f32_16x16x32_bf16 v[212:215], v[40:43], a[228:231], v[212:215]
    ds_read_b64_tr_b16 v[34:35], v6 offset:25088
    v_mul_f32 v0, v0, v184
    v_mfma_f32_16x16x32_bf16 v[212:215], v[44:47], a[244:247], v[212:215]
    buffer_load_dwordx4 v4, s[32:35], s71 offen offset:3072 lds
    v_mfma_f32_16x16x32_bf16 v[216:219], v[40:43], a[232:235], v[216:219]
    ds_read_b64_tr_b16 v[36:37], v6 offset:26624
    v_mul_f32 v1, v1, v185
    v_mfma_f32_16x16x32_bf16 v[216:219], v[44:47], a[248:251], v[216:219]
    ds_read_b64_tr_b16 v[38:39], v6 offset:27136
    v_cvt_pk_bf16_f32 v90, v0, v1
    v_mfma_f32_16x16x32_bf16 v[220:223], v[40:43], a[236:239], v[220:223]
    v_fmaak_f32 v0, v170, v170, 0x409d30fc
    v_fmaak_f32 v1, v171, v171, 0x409d30fc
    v_mfma_f32_16x16x32_bf16 v[220:223], v[44:47], a[252:255], v[220:223]
    s_waitcnt lgkmcnt(4)
    v_mul_f32 v0, v0, v170
    v_mul_f32 v1, v1, v171
    v_mfma_f32_16x16x32_bf16 v[224:227], v[24:27], a[224:227], v[224:227]
    ds_read_b64_tr_b16 v[40:41], v5 offset:32768
    v_mfma_f32_16x16x32_bf16 v[224:227], v[28:31], a[240:243], v[224:227]
    s_add_u32 m0, s55, 32768
    v_exp_f32 v0, v0
    v_mfma_f32_16x16x32_bf16 v[228:231], v[24:27], a[228:231], v[228:231]
    v_exp_f32 v1, v1
    v_mfma_f32_16x16x32_bf16 v[228:231], v[28:31], a[244:247], v[228:231]
    ds_read_b64_tr_b16 v[42:43], v5 offset:33280
    v_mul_f32 v186, v170, v186
    v_mfma_f32_16x16x32_bf16 v[232:235], v[24:27], a[232:235], v[232:235]
    ds_read_b64_tr_b16 v[44:45], v5 offset:34816
    v_fma_f32 v0, v0, s50, s50
    v_mfma_f32_16x16x32_bf16 v[232:235], v[28:31], a[248:251], v[232:235]
    buffer_load_dwordx4 v4, s[32:35], s72 offen offset:0 lds
    v_mfma_f32_16x16x32_bf16 v[236:239], v[24:27], a[236:239], v[236:239]
    ds_read_b64_tr_b16 v[46:47], v5 offset:35328
    v_fma_f32 v1, v1, s50, s50
    v_mfma_f32_16x16x32_bf16 v[236:239], v[28:31], a[252:255], v[236:239]
    s_waitcnt lgkmcnt(4)
    v_rcp_f32 v0, v0
    v_mfma_f32_16x16x32_bf16 v[240:243], v[32:35], a[224:227], v[240:243]
    v_rcp_f32 v1, v1
    v_mfma_f32_16x16x32_bf16 v[240:243], v[36:39], a[240:243], v[240:243]
    ds_read_b64_tr_b16 v[24:25], v5 offset:40960
    v_mul_f32 v187, v171, v187
    v_mfma_f32_16x16x32_bf16 v[244:247], v[32:35], a[228:231], v[244:247]
    ds_read_b64_tr_b16 v[26:27], v5 offset:41472
    v_mul_f32 v0, v0, v186
    v_mfma_f32_16x16x32_bf16 v[244:247], v[36:39], a[244:247], v[244:247]
    buffer_load_dwordx4 v4, s[32:35], s73 offen offset:1024 lds
    v_mfma_f32_16x16x32_bf16 v[248:251], v[32:35], a[232:235], v[248:251]
    ds_read_b64_tr_b16 v[28:29], v5 offset:43008
    v_mul_f32 v1, v1, v187
    v_mfma_f32_16x16x32_bf16 v[248:251], v[36:39], a[248:251], v[248:251]
    buffer_store_dwordx4 v[116:119], v121, s[40:43], 0 offen sc1
    v_mfma_f32_16x16x32_bf16 v[252:255], v[32:35], a[236:239], v[252:255]
    ds_read_b64_tr_b16 v[30:31], v5 offset:43520
    v_cvt_pk_bf16_f32 v91, v0, v1
    v_mfma_f32_16x16x32_bf16 v[252:255], v[36:39], a[252:255], v[252:255]
    s_waitcnt lgkmcnt(4)
    v_fmaak_f32 v0, v172, v172, 0x409d30fc
    v_fmaak_f32 v1, v173, v173, 0x409d30fc
    v_mfma_f32_16x16x32_bf16 v[192:195], v[40:43], v[48:51], v[192:195]
    ds_read_b64_tr_b16 v[32:33], v6 offset:32768
    v_mul_f32 v0, v0, v172
    v_mfma_f32_16x16x32_bf16 v[192:195], v[44:47], v[64:67], v[192:195]
    buffer_load_dwordx4 v4, s[32:35], s74 offen offset:2048 lds
    v_mfma_f32_16x16x32_bf16 v[196:199], v[40:43], v[52:55], v[196:199]
    ds_read_b64_tr_b16 v[34:35], v6 offset:33280
    v_mul_f32 v1, v1, v173
    v_mfma_f32_16x16x32_bf16 v[196:199], v[44:47], v[68:71], v[196:199]
    ds_read_b64_tr_b16 v[36:37], v6 offset:34816
    v_mfma_f32_16x16x32_bf16 v[200:203], v[40:43], v[56:59], v[200:203]
    v_exp_f32 v0, v0
    v_mfma_f32_16x16x32_bf16 v[200:203], v[44:47], v[72:75], v[200:203]
    buffer_load_dwordx4 v4, s[32:35], s75 offen offset:3072 lds
    v_mfma_f32_16x16x32_bf16 v[204:207], v[40:43], v[60:63], v[204:207]
    v_exp_f32 v1, v1
    v_mfma_f32_16x16x32_bf16 v[204:207], v[44:47], v[76:79], v[204:207]
    s_waitcnt lgkmcnt(3)
    ds_read_b64_tr_b16 v[38:39], v6 offset:35328
    v_mul_f32 v188, v172, v188
    v_mfma_f32_16x16x32_bf16 v[208:211], v[24:27], v[48:51], v[208:211]
    ds_read_b64_tr_b16 v[40:41], v6 offset:40960
    ds_read_b64_tr_b16 v[42:43], v6 offset:41472
    v_mfma_f32_16x16x32_bf16 v[208:211], v[28:31], v[64:67], v[208:211]
    ds_read_b64_tr_b16 v[44:45], v6 offset:43008
    v_fma_f32 v0, v0, s50, s50
    v_mfma_f32_16x16x32_bf16 v[212:215], v[24:27], v[52:55], v[212:215]
    ds_read_b64_tr_b16 v[46:47], v6 offset:43520
    v_fma_f32 v1, v1, s50, s50
    v_mfma_f32_16x16x32_bf16 v[212:215], v[28:31], v[68:71], v[212:215]
    v_rcp_f32 v0, v0
    v_mfma_f32_16x16x32_bf16 v[216:219], v[24:27], v[56:59], v[216:219]
    v_rcp_f32 v1, v1
    v_mfma_f32_16x16x32_bf16 v[216:219], v[28:31], v[72:75], v[216:219]
    v_mul_f32 v189, v173, v189
    v_mul_f32 v0, v0, v188
    v_mfma_f32_16x16x32_bf16 v[220:223], v[24:27], v[60:63], v[220:223]
    v_mul_f32 v1, v1, v189
    v_cvt_pk_bf16_f32 v94, v0, v1
    v_mfma_f32_16x16x32_bf16 v[220:223], v[28:31], v[76:79], v[220:223]
    s_waitcnt vmcnt(16) lgkmcnt(0)
    v_fmaak_f32 v0, v174, v174, 0x409d30fc
    v_fmaak_f32 v1, v175, v175, 0x409d30fc
    v_mfma_f32_16x16x32_bf16 v[224:227], v[32:35], v[48:51], v[224:227]
    s_barrier
    v_mfma_f32_16x16x32_bf16 v[224:227], v[36:39], v[64:67], v[224:227]
    s_add_u32 s87, s87, 2048
    v_add_u32 v5, 49152, v5
    v_mul_f32 v0, v0, v174
    v_mfma_f32_16x16x32_bf16 v[228:231], v[32:35], v[52:55], v[228:231]
    buffer_load_dword v20, v7, s[32:35], s87 offen
    v_mfma_f32_16x16x32_bf16 v[228:231], v[36:39], v[68:71], v[228:231]
    ds_read_b64_tr_b16 v[24:25], v5 offset:0
    ds_read_b64_tr_b16 v[26:27], v5 offset:512
    v_mfma_f32_16x16x32_bf16 v[232:235], v[32:35], v[56:59], v[232:235]
    ds_read_b64_tr_b16 v[28:29], v5 offset:2048
    v_mul_f32 v1, v1, v175
    v_mfma_f32_16x16x32_bf16 v[232:235], v[36:39], v[72:75], v[232:235]
    buffer_load_dword v20, v14, s[36:39], s76 offen offset:0
    v_mfma_f32_16x16x32_bf16 v[236:239], v[32:35], v[60:63], v[236:239]
    v_exp_f32 v0, v0
    v_mfma_f32_16x16x32_bf16 v[236:239], v[36:39], v[76:79], v[236:239]
    ds_read_b64_tr_b16 v[30:31], v5 offset:2560
    v_add_u32 v4, 1769472, v4
    v_mfma_f32_16x16x32_bf16 v[240:243], v[40:43], v[48:51], v[240:243]
    ds_read_b64_tr_b16 v[32:33], v5 offset:8192
    v_exp_f32 v1, v1
    v_mfma_f32_16x16x32_bf16 v[240:243], v[44:47], v[64:67], v[240:243]
    ds_read_b64_tr_b16 v[34:35], v5 offset:8704
    v_mul_f32 v190, v174, v190
    v_mfma_f32_16x16x32_bf16 v[244:247], v[40:43], v[52:55], v[244:247]
    ds_read_b64_tr_b16 v[36:37], v5 offset:10240
    v_fma_f32 v0, v0, s50, s50
    v_mfma_f32_16x16x32_bf16 v[244:247], v[44:47], v[68:71], v[244:247]
    s_add_u32 m0, s55, 49152
    ds_read_b64_tr_b16 v[38:39], v5 offset:10752
    v_fma_f32 v1, v1, s50, s50
    v_mfma_f32_16x16x32_bf16 v[248:251], v[40:43], v[56:59], v[248:251]
    v_rcp_f32 v0, v0
    v_mfma_f32_16x16x32_bf16 v[248:251], v[44:47], v[72:75], v[248:251]
    v_rcp_f32 v1, v1
    v_mfma_f32_16x16x32_bf16 v[252:255], v[40:43], v[60:63], v[252:255]
    v_mul_f32 v191, v175, v191
    v_mul_f32 v0, v0, v190
    v_mfma_f32_16x16x32_bf16 v[252:255], v[44:47], v[76:79], v[252:255]
    s_waitcnt lgkmcnt(4)
    v_mul_f32 v1, v1, v191
    v_cvt_pk_bf16_f32 v95, v0, v1
    v_mfma_f32_16x16x32_bf16 v[128:131], v[24:27], a[0:3], 0
    v_add_u32 v6, 49152, v6
    v_mfma_f32_16x16x32_bf16 v[128:131], v[28:31], a[16:19], v[128:131]
    ds_read_b64_tr_b16 v[40:41], v6 offset:0
    v_mfma_f32_16x16x32_bf16 v[132:135], v[24:27], a[4:7], 0
    buffer_load_dwordx4 v4, s[32:35], s64 offen offset:0 lds
    v_mfma_f32_16x16x32_bf16 v[132:135], v[28:31], a[20:23], v[132:135]
    ds_read_b64_tr_b16 v[42:43], v6 offset:512
    v_mfma_f32_16x16x32_bf16 v[136:139], v[24:27], a[8:11], 0
    ds_read_b64_tr_b16 v[44:45], v6 offset:2048
    v_fmaak_f32 v0, v192, v192, 0x409d30fc
    v_mfma_f32_16x16x32_bf16 v[136:139], v[28:31], a[24:27], v[136:139]
    buffer_load_dwordx4 v4, s[32:35], s65 offen offset:1024 lds
    v_mfma_f32_16x16x32_bf16 v[140:143], v[24:27], a[12:15], 0
    ds_read_b64_tr_b16 v[46:47], v6 offset:2560
    v_fmaak_f32 v1, v193, v193, 0x409d30fc
    v_mfma_f32_16x16x32_bf16 v[140:143], v[28:31], a[28:31], v[140:143]
    s_waitcnt lgkmcnt(4)
    v_mul_f32 v0, v0, v192
    v_mul_f32 v1, v1, v193
    v_mfma_f32_16x16x32_bf16 v[144:147], v[32:35], a[0:3], 0
    ds_read_b64_tr_b16 v[24:25], v6 offset:8192
    v_mfma_f32_16x16x32_bf16 v[144:147], v[36:39], a[16:19], v[144:147]
    v_exp_f32 v0, v0
    v_mfma_f32_16x16x32_bf16 v[148:151], v[32:35], a[4:7], 0
    v_exp_f32 v1, v1
    v_mfma_f32_16x16x32_bf16 v[148:151], v[36:39], a[20:23], v[148:151]
    buffer_load_dwordx4 v4, s[32:35], s66 offen offset:2048 lds
    v_mfma_f32_16x16x32_bf16 v[152:155], v[32:35], a[8:11], 0
    ds_read_b64_tr_b16 v[26:27], v6 offset:8704
    v_mul_f32 v208, v192, v208
    v_mfma_f32_16x16x32_bf16 v[152:155], v[36:39], a[24:27], v[152:155]
    ds_read_b64_tr_b16 v[28:29], v6 offset:10240
    v_fma_f32 v0, v0, s50, s50
    v_mfma_f32_16x16x32_bf16 v[156:159], v[32:35], a[12:15], 0
    ds_read_b64_tr_b16 v[30:31], v6 offset:10752
    v_fma_f32 v1, v1, s50, s50
    v_mfma_f32_16x16x32_bf16 v[156:159], v[36:39], a[28:31], v[156:159]
    s_waitcnt lgkmcnt(4)
    v_rcp_f32 v0, v0
    v_mfma_f32_16x16x32_bf16 v[160:163], v[40:43], a[0:3], 0
    v_rcp_f32 v1, v1
    v_mfma_f32_16x16x32_bf16 v[160:163], v[44:47], a[16:19], v[160:163]
    buffer_load_dwordx4 v4, s[32:35], s67 offen offset:3072 lds
    v_mfma_f32_16x16x32_bf16 v[164:167], v[40:43], a[4:7], 0
    ds_read_b64_tr_b16 v[32:33], v5 offset:16384
    v_mul_f32 v209, v193, v209
    v_mfma_f32_16x16x32_bf16 v[164:167], v[44:47], a[20:23], v[164:167]
    ds_read_b64_tr_b16 v[34:35], v5 offset:16896
    v_mul_f32 v0, v0, v208
    v_mfma_f32_16x16x32_bf16 v[168:171], v[40:43], a[8:11], 0
    ds_read_b64_tr_b16 v[36:37], v5 offset:18432
    v_mul_f32 v1, v1, v209
    v_mfma_f32_16x16x32_bf16 v[168:171], v[44:47], a[24:27], v[168:171]
    s_add_u32 m0, s55, 65536
    ds_read_b64_tr_b16 v[38:39], v5 offset:18944
    v_cvt_pk_bf16_f32 v96, v0, v1
    v_mfma_f32_16x16x32_bf16 v[172:175], v[40:43], a[12:15], 0
    v_fmaak_f32 v0, v194, v194, 0x409d30fc
    v_fmaak_f32 v1, v195, v195, 0x409d30fc
    v_mfma_f32_16x16x32_bf16 v[172:175], v[44:47], a[28:31], v[172:175]
    s_waitcnt lgkmcnt(4)
    v_mul_f32 v0, v0, v194
    v_mul_f32 v1, v1, v195
    v_mfma_f32_16x16x32_bf16 v[176:179], v[24:27], a[0:3], 0
    ds_read_b64_tr_b16 v[40:41], v5 offset:24576
    v_mfma_f32_16x16x32_bf16 v[176:179], v[28:31], a[16:19], v[176:179]
    v_exp_f32 v0, v0
    v_mfma_f32_16x16x32_bf16 v[180:183], v[24:27], a[4:7], 0
    v_exp_f32 v1, v1
    v_mfma_f32_16x16x32_bf16 v[180:183], v[28:31], a[20:23], v[180:183]
    buffer_load_dwordx4 v4, s[32:35], s68 offen offset:0 lds
    v_mfma_f32_16x16x32_bf16 v[184:187], v[24:27], a[8:11], 0
    ds_read_b64_tr_b16 v[42:43], v5 offset:25088
    v_mul_f32 v210, v194, v210
    v_mfma_f32_16x16x32_bf16 v[184:187], v[28:31], a[24:27], v[184:187]
    ds_read_b64_tr_b16 v[44:45], v5 offset:26624
    v_fma_f32 v0, v0, s50, s50
    v_mfma_f32_16x16x32_bf16 v[188:191], v[24:27], a[12:15], 0
    ds_read_b64_tr_b16 v[46:47], v5 offset:27136
    v_fma_f32 v1, v1, s50, s50
    v_mfma_f32_16x16x32_bf16 v[188:191], v[28:31], a[28:31], v[188:191]
    s_waitcnt lgkmcnt(4)
    v_rcp_f32 v0, v0
    v_mfma_f32_16x16x32_bf16 v[128:131], v[32:35], a[32:35], v[128:131]
    ds_read_b64_tr_b16 v[24:25], v6 offset:16384
    v_mfma_f32_16x16x32_bf16 v[128:131], v[36:39], a[48:51], v[128:131]
    buffer_load_dwordx4 v4, s[32:35], s69 offen offset:1024 lds
    v_mfma_f32_16x16x32_bf16 v[132:135], v[32:35], a[36:39], v[132:135]
    v_rcp_f32 v1, v1
    v_mfma_f32_16x16x32_bf16 v[132:135], v[36:39], a[52:55], v[132:135]
    ds_read_b64_tr_b16 v[26:27], v6 offset:16896
    v_mul_f32 v211, v195, v211
    v_mfma_f32_16x16x32_bf16 v[136:139], v[32:35], a[40:43], v[136:139]
    ds_read_b64_tr_b16 v[28:29], v6 offset:18432
    v_mul_f32 v0, v0, v210
    v_mfma_f32_16x16x32_bf16 v[136:139], v[36:39], a[56:59], v[136:139]
    buffer_load_dwordx4 v4, s[32:35], s70 offen offset:2048 lds
    v_mfma_f32_16x16x32_bf16 v[140:143], v[32:35], a[44:47], v[140:143]
    ds_read_b64_tr_b16 v[30:31], v6 offset:18944
    v_mul_f32 v1, v1, v211
    v_mfma_f32_16x16x32_bf16 v[140:143], v[36:39], a[60:63], v[140:143]
    s_waitcnt lgkmcnt(4)
    v_cvt_pk_bf16_f32 v97, v0, v1
    v_fmaak_f32 v0, v196, v196, 0x409d30fc
    v_mfma_f32_16x16x32_bf16 v[144:147], v[40:43], a[32:35], v[144:147]
    ds_read_b64_tr_b16 v[32:33], v6 offset:24576
    v_fmaak_f32 v1, v197, v197, 0x409d30fc
    v_mfma_f32_16x16x32_bf16 v[144:147], v[44:47], a[48:51], v[144:147]
    ds_read_b64_tr_b16 v[34:35], v6 offset:25088
    v_mul_f32 v0, v0, v196
    v_mfma_f32_16x16x32_bf16 v[148:151], v[40:43], a[36:39], v[148:151]
    ds_read_b64_tr_b16 v[36:37], v6 offset:26624
    v_mul_f32 v1, v1, v197
    v_mfma_f32_16x16x32_bf16 v[148:151], v[44:47], a[52:55], v[148:151]
    buffer_load_dwordx4 v4, s[32:35], s71 offen offset:3072 lds
    v_mfma_f32_16x16x32_bf16 v[152:155], v[40:43], a[40:43], v[152:155]
    ds_read_b64_tr_b16 v[38:39], v6 offset:27136
    v_mfma_f32_16x16x32_bf16 v[152:155], v[44:47], a[56:59], v[152:155]
    v_exp_f32 v0, v0
    v_mfma_f32_16x16x32_bf16 v[156:159], v[40:43], a[44:47], v[156:159]
    v_exp_f32 v1, v1
    v_mfma_f32_16x16x32_bf16 v[156:159], v[44:47], a[60:63], v[156:159]
    s_waitcnt lgkmcnt(4)
    v_mul_f32 v212, v196, v212
    v_fma_f32 v0, v0, s50, s50
    v_mfma_f32_16x16x32_bf16 v[160:163], v[24:27], a[32:35], v[160:163]
    ds_read_b64_tr_b16 v[40:41], v5 offset:32768
    v_fma_f32 v1, v1, s50, s50
    v_mfma_f32_16x16x32_bf16 v[160:163], v[28:31], a[48:51], v[160:163]
    s_add_u32 m0, s55, 81920
    v_rcp_f32 v0, v0
    v_mfma_f32_16x16x32_bf16 v[164:167], v[24:27], a[36:39], v[164:167]
    v_rcp_f32 v1, v1
    v_mfma_f32_16x16x32_bf16 v[164:167], v[28:31], a[52:55], v[164:167]
    ds_read_b64_tr_b16 v[42:43], v5 offset:33280
    v_mul_f32 v213, v197, v213
    v_mfma_f32_16x16x32_bf16 v[168:171], v[24:27], a[40:43], v[168:171]
    ds_read_b64_tr_b16 v[44:45], v5 offset:34816
    v_mul_f32 v0, v0, v212
    v_mfma_f32_16x16x32_bf16 v[168:171], v[28:31], a[56:59], v[168:171]
    buffer_load_dwordx4 v4, s[32:35], s72 offen offset:0 lds
    v_mfma_f32_16x16x32_bf16 v[172:175], v[24:27], a[44:47], v[172:175]
    ds_read_b64_tr_b16 v[46:47], v5 offset:35328
    v_mul_f32 v1, v1, v213
    v_mfma_f32_16x16x32_bf16 v[172:175], v[28:31], a[60:63], v[172:175]
    s_waitcnt lgkmcnt(4)
    v_cvt_pk_bf16_f32 v100, v0, v1
    v_fmaak_f32 v0, v198, v198, 0x409d30fc
    v_mfma_f32_16x16x32_bf16 v[176:179], v[32:35], a[32:35], v[176:179]
    ds_read_b64_tr_b16 v[24:25], v5 offset:40960
    v_fmaak_f32 v1, v199, v199, 0x409d30fc
    v_mfma_f32_16x16x32_bf16 v[176:179], v[36:39], a[48:51], v[176:179]
    ds_read_b64_tr_b16 v[26:27], v5 offset:41472
    v_mul_f32 v0, v0, v198
    v_mfma_f32_16x16x32_bf16 v[180:183], v[32:35], a[36:39], v[180:183]
    ds_read_b64_tr_b16 v[28:29], v5 offset:43008
    v_mul_f32 v1, v1, v199
    v_mfma_f32_16x16x32_bf16 v[180:183], v[36:39], a[52:55], v[180:183]
    buffer_load_dwordx4 v4, s[32:35], s73 offen offset:1024 lds
    v_mfma_f32_16x16x32_bf16 v[184:187], v[32:35], a[40:43], v[184:187]
    ds_read_b64_tr_b16 v[30:31], v5 offset:43520
    v_mfma_f32_16x16x32_bf16 v[184:187], v[36:39], a[56:59], v[184:187]
    v_exp_f32 v0, v0
    v_mfma_f32_16x16x32_bf16 v[188:191], v[32:35], a[44:47], v[188:191]
    v_exp_f32 v1, v1
    v_mfma_f32_16x16x32_bf16 v[188:191], v[36:39], a[60:63], v[188:191]
    s_waitcnt lgkmcnt(4)
    v_mul_f32 v214, v198, v214
    v_fma_f32 v0, v0, s50, s50
    v_mfma_f32_16x16x32_bf16 v[128:131], v[40:43], a[64:67], v[128:131]
    ds_read_b64_tr_b16 v[32:33], v6 offset:32768
    v_fma_f32 v1, v1, s50, s50
    v_mfma_f32_16x16x32_bf16 v[128:131], v[44:47], a[80:83], v[128:131]
    buffer_load_dwordx4 v4, s[32:35], s74 offen offset:2048 lds
    v_mfma_f32_16x16x32_bf16 v[132:135], v[40:43], a[68:71], v[132:135]
    ds_read_b64_tr_b16 v[34:35], v6 offset:33280
    v_mfma_f32_16x16x32_bf16 v[132:135], v[44:47], a[84:87], v[132:135]
    v_rcp_f32 v0, v0
    v_mfma_f32_16x16x32_bf16 v[136:139], v[40:43], a[72:75], v[136:139]
    v_rcp_f32 v1, v1
    v_mfma_f32_16x16x32_bf16 v[136:139], v[44:47], a[88:91], v[136:139]
    buffer_load_dwordx4 v4, s[32:35], s75 offen offset:3072 lds
    v_mfma_f32_16x16x32_bf16 v[140:143], v[40:43], a[76:79], v[140:143]
    ds_read_b64_tr_b16 v[36:37], v6 offset:34816
    v_mul_f32 v215, v199, v215
    v_mfma_f32_16x16x32_bf16 v[140:143], v[44:47], a[92:95], v[140:143]
    s_waitcnt lgkmcnt(3)
    ds_read_b64_tr_b16 v[38:39], v6 offset:35328
    v_mul_f32 v0, v0, v214
    v_mfma_f32_16x16x32_bf16 v[144:147], v[24:27], a[64:67], v[144:147]
    ds_read_b64_tr_b16 v[40:41], v6 offset:40960
    v_mul_f32 v1, v1, v215
    v_mfma_f32_16x16x32_bf16 v[144:147], v[28:31], a[80:83], v[144:147]
    ds_read_b64_tr_b16 v[42:43], v6 offset:41472
    v_cvt_pk_bf16_f32 v101, v0, v1
    v_mfma_f32_16x16x32_bf16 v[148:151], v[24:27], a[68:71], v[148:151]
    ds_read_b64_tr_b16 v[44:45], v6 offset:43008
    v_fmaak_f32 v0, v200, v200, 0x409d30fc
    v_mfma_f32_16x16x32_bf16 v[148:151], v[28:31], a[84:87], v[148:151]
    ds_read_b64_tr_b16 v[46:47], v6 offset:43520
    v_fmaak_f32 v1, v201, v201, 0x409d30fc
    v_mfma_f32_16x16x32_bf16 v[152:155], v[24:27], a[72:75], v[152:155]
    v_mul_f32 v0, v0, v200
    v_mul_f32 v1, v1, v201
    v_mfma_f32_16x16x32_bf16 v[152:155], v[28:31], a[88:91], v[152:155]
    v_exp_f32 v0, v0
    v_mfma_f32_16x16x32_bf16 v[156:159], v[24:27], a[76:79], v[156:159]
    v_exp_f32 v1, v1
    v_mfma_f32_16x16x32_bf16 v[156:159], v[28:31], a[92:95], v[156:159]
    s_waitcnt vmcnt(14) lgkmcnt(0)
    v_mul_f32 v216, v200, v216
    v_fma_f32 v0, v0, s50, s50
    v_mfma_f32_16x16x32_bf16 v[160:163], v[32:35], a[64:67], v[160:163]
    s_barrier
    v_mfma_f32_16x16x32_bf16 v[160:163], v[36:39], a[80:83], v[160:163]
    s_add_u32 s88, s88, 2048
    v_add_u32 v5, 4294868992, v5
    v_mov_b32 v2, s48
    v_mfma_f32_16x16x32_bf16 v[164:167], v[32:35], a[68:71], v[164:167]
    buffer_load_dword v20, v7, s[32:35], s88 offen
    v_mfma_f32_16x16x32_bf16 v[164:167], v[36:39], a[84:87], v[164:167]
    ds_read_b64_tr_b16 v[24:25], v5 offset:0
    v_fma_f32 v1, v1, s50, s50
L_pg0_3:
L_pgx3:
    s_cbranch_execz L_pgx7
    v_mfma_f32_16x16x32_bf16 v[168:171], v[32:35], a[72:75], v[168:171]
    ds_read_b64_tr_b16 v[26:27], v5 offset:512
    ds_read_b64_tr_b16 v[28:29], v5 offset:2048
    v_mfma_f32_16x16x32_bf16 v[168:171], v[36:39], a[88:91], v[168:171]
    s_add_u32 s87, s87, s92
    ds_read_b64_tr_b16 v[30:31], v5 offset:2560
    v_mov_b32 v3, s49
    v_mfma_f32_16x16x32_bf16 v[172:175], v[32:35], a[76:79], v[172:175]
    v_rcp_f32 v0, v0
    v_mfma_f32_16x16x32_bf16 v[172:175], v[36:39], a[92:95], v[172:175]
    buffer_load_dword v20, v7, s[32:35], s87 offen
    v_mfma_f32_16x16x32_bf16 v[176:179], v[40:43], a[64:67], v[176:179]
    buffer_store_dwordx2 v[2:3], v8, s[40:43], s98 offen offset:0 sc1
    v_mfma_f32_16x16x32_bf16 v[176:179], v[44:47], a[80:83], v[176:179]
    ds_read_b64_tr_b16 v[32:33], v5 offset:8192
    v_add_u32 v4, 4291430400, v4
    v_mfma_f32_16x16x32_bf16 v[180:183], v[40:43], a[68:71], v[180:183]
    v_rcp_f32 v1, v1
    v_mfma_f32_16x16x32_bf16 v[180:183], v[44:47], a[84:87], v[180:183]
    ds_read_b64_tr_b16 v[34:35], v5 offset:8704
    v_mul_f32 v217, v201, v217
    v_mfma_f32_16x16x32_bf16 v[184:187], v[40:43], a[72:75], v[184:187]
    ds_read_b64_tr_b16 v[36:37], v5 offset:10240
    v_mul_f32 v0, v0, v216
    v_mfma_f32_16x16x32_bf16 v[184:187], v[44:47], a[88:91], v[184:187]
    s_add_u32 m0, s55, 98304
    ds_read_b64_tr_b16 v[38:39], v5 offset:10752
    v_mul_f32 v1, v1, v217
    v_mfma_f32_16x16x32_bf16 v[188:191], v[40:43], a[76:79], v[188:191]
    v_cvt_pk_bf16_f32 v104, v0, v1
    v_fmaak_f32 v0, v202, v202, 0x409d30fc
    v_mfma_f32_16x16x32_bf16 v[188:191], v[44:47], a[92:95], v[188:191]
    s_waitcnt lgkmcnt(4)
    v_fmaak_f32 v1, v203, v203, 0x409d30fc
    v_mul_f32 v0, v0, v202
    v_mfma_f32_16x16x32_bf16 v[128:131], v[24:27], a[96:99], v[128:131]
    v_add_u32 v6, 4294868992, v6
    v_mul_f32 v1, v1, v203
    v_mfma_f32_16x16x32_bf16 v[128:131], v[28:31], a[112:115], v[128:131]
    ds_read_b64_tr_b16 v[40:41], v6 offset:0
    v_mfma_f32_16x16x32_bf16 v[132:135], v[24:27], a[100:103], v[132:135]
    buffer_load_dwordx4 v4, s[32:35], s64 offen offset:0 lds
    v_mfma_f32_16x16x32_bf16 v[132:135], v[28:31], a[116:119], v[132:135]
    v_exp_f32 v0, v0
    v_mfma_f32_16x16x32_bf16 v[136:139], v[24:27], a[104:107], v[136:139]
    v_exp_f32 v1, v1
    v_mfma_f32_16x16x32_bf16 v[136:139], v[28:31], a[120:123], v[136:139]
    ds_read_b64_tr_b16 v[42:43], v6 offset:512
    v_mul_f32 v218, v202, v218
    v_mfma_f32_16x16x32_bf16 v[140:143], v[24:27], a[108:111], v[140:143]
    ds_read_b64_tr_b16 v[44:45], v6 offset:2048
    v_fma_f32 v0, v0, s50, s50
    v_mfma_f32_16x16x32_bf16 v[140:143], v[28:31], a[124:127], v[140:143]
    s_waitcnt lgkmcnt(3)
    ds_read_b64_tr_b16 v[46:47], v6 offset:2560
    v_fma_f32 v1, v1, s50, s50
    v_mfma_f32_16x16x32_bf16 v[144:147], v[32:35], a[96:99], v[144:147]
    v_rcp_f32 v0, v0
    v_mfma_f32_16x16x32_bf16 v[144:147], v[36:39], a[112:115], v[144:147]
    buffer_load_dwordx4 v4, s[32:35], s65 offen offset:1024 lds
    v_mfma_f32_16x16x32_bf16 v[148:151], v[32:35], a[100:103], v[148:151]
    v_rcp_f32 v1, v1
    v_mfma_f32_16x16x32_bf16 v[148:151], v[36:39], a[116:119], v[148:151]
    ds_read_b64_tr_b16 v[24:25], v6 offset:8192
    v_mul_f32 v219, v203, v219
    v_mfma_f32_16x16x32_bf16 v[152:155], v[32:35], a[104:107], v[152:155]
    ds_read_b64_tr_b16 v[26:27], v6 offset:8704
    v_mul_f32 v0, v0, v218
    v_mfma_f32_16x16x32_bf16 v[152:155], v[36:39], a[120:123], v[152:155]
    buffer_load_dwordx4 v4, s[32:35], s66 offen offset:2048 lds
    v_mfma_f32_16x16x32_bf16 v[156:159], v[32:35], a[108:111], v[156:159]
    ds_read_b64_tr_b16 v[28:29], v6 offset:10240
    v_mul_f32 v1, v1, v219
    v_mfma_f32_16x16x32_bf16 v[156:159], v[36:39], a[124:127], v[156:159]
    s_waitcnt lgkmcnt(3)
    ds_read_b64_tr_b16 v[30:31], v6 offset:10752
    v_cvt_pk_bf16_f32 v105, v0, v1
    v_mfma_f32_16x16x32_bf16 v[160:163], v[40:43], a[96:99], v[160:163]
    ds_read_b64_tr_b16 v[32:33], v5 offset:16384
    v_fmaak_f32 v0, v204, v204, 0x409d30fc
    v_mfma_f32_16x16x32_bf16 v[160:163], v[44:47], a[112:115], v[160:163]
    buffer_load_dwordx4 v4, s[32:35], s67 offen offset:3072 lds
    v_mfma_f32_16x16x32_bf16 v[164:167], v[40:43], a[100:103], v[164:167]
    ds_read_b64_tr_b16 v[34:35], v5 offset:16896
    v_fmaak_f32 v1, v205, v205, 0x409d30fc
    v_mfma_f32_16x16x32_bf16 v[164:167], v[44:47], a[116:119], v[164:167]
    ds_read_b64_tr_b16 v[36:37], v5 offset:18432
    v_mul_f32 v0, v0, v204
    v_mfma_f32_16x16x32_bf16 v[168:171], v[40:43], a[104:107], v[168:171]
    ds_read_b64_tr_b16 v[38:39], v5 offset:18944
    v_mul_f32 v1, v1, v205
    v_mfma_f32_16x16x32_bf16 v[168:171], v[44:47], a[120:123], v[168:171]
    v_exp_f32 v0, v0
    v_mfma_f32_16x16x32_bf16 v[172:175], v[40:43], a[108:111], v[172:175]
    v_exp_f32 v1, v1
    v_mfma_f32_16x16x32_bf16 v[172:175], v[44:47], a[124:127], v[172:175]
    s_waitcnt lgkmcnt(4)
    v_mul_f32 v220, v204, v220
    v_fma_f32 v0, v0, s50, s50
    v_mfma_f32_16x16x32_bf16 v[176:179], v[24:27], a[96:99], v[176:179]
    ds_read_b64_tr_b16 v[40:41], v5 offset:24576
    v_fma_f32 v1, v1, s50, s50
    v_mfma_f32_16x16x32_bf16 v[176:179], v[28:31], a[112:115], v[176:179]
    s_add_u32 m0, s55, 114688
    v_rcp_f32 v0, v0
    v_mfma_f32_16x16x32_bf16 v[180:183], v[24:27], a[100:103], v[180:183]
    v_rcp_f32 v1, v1
    v_mfma_f32_16x16x32_bf16 v[180:183], v[28:31], a[116:119], v[180:183]
    ds_read_b64_tr_b16 v[42:43], v5 offset:25088
    v_mul_f32 v221, v205, v221
    v_mfma_f32_16x16x32_bf16 v[184:187], v[24:27], a[104:107], v[184:187]
    ds_read_b64_tr_b16 v[44:45], v5 offset:26624
    v_mul_f32 v0, v0, v220
    v_mfma_f32_16x16x32_bf16 v[184:187], v[28:31], a[120:123], v[184:187]
    buffer_load_dwordx4 v4, s[32:35], s68 offen offset:0 lds
    v_mfma_f32_16x16x32_bf16 v[188:191], v[24:27], a[108:111], v[188:191]
    ds_read_b64_tr_b16 v[46:47], v5 offset:27136
    v_mul_f32 v1, v1, v221
    v_mfma_f32_16x16x32_bf16 v[188:191], v[28:31], a[124:127], v[188:191]
    s_waitcnt lgkmcnt(4)
    v_cvt_pk_bf16_f32 v108, v0, v1
    v_fmaak_f32 v0, v206, v206, 0x409d30fc
    v_mfma_f32_16x16x32_bf16 v[128:131], v[32:35], a[128:131], v[128:131]
    ds_read_b64_tr_b16 v[24:25], v6 offset:16384
    v_fmaak_f32 v1, v207, v207, 0x409d30fc
    v_mfma_f32_16x16x32_bf16 v[128:131], v[36:39], a[144:147], v[128:131]
    buffer_load_dwordx4 v4, s[32:35], s69 offen offset:1024 lds
    v_mfma_f32_16x16x32_bf16 v[132:135], v[32:35], a[132:135], v[132:135]
    ds_read_b64_tr_b16 v[26:27], v6 offset:16896
    v_mul_f32 v0, v0, v206
    v_mfma_f32_16x16x32_bf16 v[132:135], v[36:39], a[148:151], v[132:135]
    ds_read_b64_tr_b16 v[28:29], v6 offset:18432
    v_mul_f32 v1, v1, v207
    v_mfma_f32_16x16x32_bf16 v[136:139], v[32:35], a[136:139], v[136:139]
    v_exp_f32 v0, v0
    v_mfma_f32_16x16x32_bf16 v[136:139], v[36:39], a[152:155], v[136:139]
    v_exp_f32 v1, v1
    v_mfma_f32_16x16x32_bf16 v[140:143], v[32:35], a[140:143], v[140:143]
    ds_read_b64_tr_b16 v[30:31], v6 offset:18944
    v_mul_f32 v222, v206, v222
    v_mfma_f32_16x16x32_bf16 v[140:143], v[36:39], a[156:159], v[140:143]
    s_waitcnt lgkmcnt(4)
    buffer_load_dwordx4 v4, s[32:35], s70 offen offset:2048 lds
    v_mfma_f32_16x16x32_bf16 v[144:147], v[40:43], a[128:131], v[144:147]
    ds_read_b64_tr_b16 v[32:33], v6 offset:24576
    v_fma_f32 v0, v0, s50, s50
    v_mfma_f32_16x16x32_bf16 v[144:147], v[44:47], a[144:147], v[144:147]
    ds_read_b64_tr_b16 v[34:35], v6 offset:25088
    v_fma_f32 v1, v1, s50, s50
    v_mfma_f32_16x16x32_bf16 v[148:151], v[40:43], a[132:135], v[148:151]
    v_rcp_f32 v0, v0
    v_mfma_f32_16x16x32_bf16 v[148:151], v[44:47], a[148:151], v[148:151]
    buffer_load_dwordx4 v4, s[32:35], s71 offen offset:3072 lds
    v_mfma_f32_16x16x32_bf16 v[152:155], v[40:43], a[136:139], v[152:155]
    v_rcp_f32 v1, v1
    v_mfma_f32_16x16x32_bf16 v[152:155], v[44:47], a[152:155], v[152:155]
    ds_read_b64_tr_b16 v[36:37], v6 offset:26624
    v_mul_f32 v223, v207, v223
    v_mfma_f32_16x16x32_bf16 v[156:159], v[40:43], a[140:143], v[156:159]
    ds_read_b64_tr_b16 v[38:39], v6 offset:27136
    v_mul_f32 v0, v0, v222
    v_mfma_f32_16x16x32_bf16 v[156:159], v[44:47], a[156:159], v[156:159]
    s_waitcnt lgkmcnt(4)
    v_mul_f32 v1, v1, v223
    v_cvt_pk_bf16_f32 v109, v0, v1
    v_mfma_f32_16x16x32_bf16 v[160:163], v[24:27], a[128:131], v[160:163]
    ds_read_b64_tr_b16 v[40:41], v5 offset:32768
    v_fmaak_f32 v0, v224, v224, 0x409d30fc
    v_mfma_f32_16x16x32_bf16 v[160:163], v[28:31], a[144:147], v[160:163]
    s_add_u32 m0, s55, 131072
    ds_read_b64_tr_b16 v[42:43], v5 offset:33280
    v_fmaak_f32 v1, v225, v225, 0x409d30fc
    v_mfma_f32_16x16x32_bf16 v[164:167], v[24:27], a[132:135], v[164:167]
    ds_read_b64_tr_b16 v[44:45], v5 offset:34816
    v_mul_f32 v0, v0, v224
    v_mfma_f32_16x16x32_bf16 v[164:167], v[28:31], a[148:151], v[164:167]
    ds_read_b64_tr_b16 v[46:47], v5 offset:35328
    v_mul_f32 v1, v1, v225
    v_mfma_f32_16x16x32_bf16 v[168:171], v[24:27], a[136:139], v[168:171]
    v_exp_f32 v0, v0
    v_mfma_f32_16x16x32_bf16 v[168:171], v[28:31], a[152:155], v[168:171]
    v_exp_f32 v1, v1
    v_mfma_f32_16x16x32_bf16 v[172:175], v[24:27], a[140:143], v[172:175]
    v_mul_f32 v240, v224, v240
    v_mfma_f32_16x16x32_bf16 v[172:175], v[28:31], a[156:159], v[172:175]
    s_waitcnt lgkmcnt(4)
    buffer_load_dwordx4 v4, s[32:35], s72 offen offset:0 lds
    v_mfma_f32_16x16x32_bf16 v[176:179], v[32:35], a[128:131], v[176:179]
    ds_read_b64_tr_b16 v[24:25], v5 offset:40960
    v_fma_f32 v0, v0, s50, s50
    v_mfma_f32_16x16x32_bf16 v[176:179], v[36:39], a[144:147], v[176:179]
    ds_read_b64_tr_b16 v[26:27], v5 offset:41472
    v_fma_f32 v1, v1, s50, s50
    v_mfma_f32_16x16x32_bf16 v[180:183], v[32:35], a[132:135], v[180:183]
    v_rcp_f32 v0, v0
    v_mfma_f32_16x16x32_bf16 v[180:183], v[36:39], a[148:151], v[180:183]
    buffer_load_dwordx4 v4, s[32:35], s73 offen offset:1024 lds
    v_mfma_f32_16x16x32_bf16 v[184:187], v[32:35], a[136:139], v[184:187]
    v_rcp_f32 v1, v1
    v_mfma_f32_16x16x32_bf16 v[184:187], v[36:39], a[152:155], v[184:187]
    s_getpc_b64 s[10:11]
    ds_read_b64_tr_b16 v[28:29], v5 offset:43008
L_ct1:
    v_mul_f32 v241, v225, v241
    v_mfma_f32_16x16x32_bf16 v[188:191], v[32:35], a[140:143], v[188:191]
    ds_read_b64_tr_b16 v[30:31], v5 offset:43520
    v_mul_f32 v0, v0, v240
    v_mfma_f32_16x16x32_bf16 v[188:191], v[36:39], a[156:159], v[188:191]
    s_waitcnt lgkmcnt(4)
    v_mul_f32 v1, v1, v241
    v_cvt_pk_bf16_f32 v98, v0, v1
    v_mfma_f32_16x16x32_bf16 v[128:131], v[40:43], a[160:163], v[128:131]
    ds_read_b64_tr_b16 v[32:33], v6 offset:32768
    v_lshrrev_b32 v2, 7, v22
    v_mfma_f32_16x16x32_bf16 v[128:131], v[44:47], a[176:179], v[128:131]
    buffer_load_dwordx4 v4, s[32:35], s74 offen offset:2048 lds
    v_mfma_f32_16x16x32_bf16 v[132:135], v[40:43], a[164:167], v[132:135]
    ds_read_b64_tr_b16 v[34:35], v6 offset:33280
    v_fmaak_f32 v0, v226, v226, 0x409d30fc
    v_mfma_f32_16x16x32_bf16 v[132:135], v[44:47], a[180:183], v[132:135]
    ds_read_b64_tr_b16 v[36:37], v6 offset:34816
    v_fmaak_f32 v1, v227, v227, 0x409d30fc
    v_mfma_f32_16x16x32_bf16 v[136:139], v[40:43], a[168:171], v[136:139]
    ds_read_b64_tr_b16 v[38:39], v6 offset:35328
    v_add_u32 v2, s18, v2
    v_mfma_f32_16x16x32_bf16 v[136:139], v[44:47], a[184:187], v[136:139]
    buffer_load_dwordx4 v4, s[32:35], s75 offen offset:3072 lds
    v_mfma_f32_16x16x32_bf16 v[140:143], v[40:43], a[172:175], v[140:143]
    v_mul_f32 v0, v0, v226
    v_mul_f32 v1, v1, v227
    v_mfma_f32_16x16x32_bf16 v[140:143], v[44:47], a[188:191], v[140:143]
    s_waitcnt lgkmcnt(4)
    v_exp_f32 v0, v0
    v_mfma_f32_16x16x32_bf16 v[144:147], v[24:27], a[160:163], v[144:147]
    ds_read_b64_tr_b16 v[40:41], v6 offset:40960
    v_min_u32 v2, (L_tab_end-L_ct1)/128-1, v2
    v_mfma_f32_16x16x32_bf16 v[144:147], v[28:31], a[176:179], v[144:147]
    ds_read_b64_tr_b16 v[42:43], v6 offset:41472
    ds_read_b64_tr_b16 v[44:45], v6 offset:43008
    v_mfma_f32_16x16x32_bf16 v[148:151], v[24:27], a[164:167], v[148:151]
    ds_read_b64_tr_b16 v[46:47], v6 offset:43520
    v_mfma_f32_16x16x32_bf16 v[148:151], v[28:31], a[180:183], v[148:151]
    v_exp_f32 v1, v1
    v_mfma_f32_16x16x32_bf16 v[152:155], v[24:27], a[168:171], v[152:155]
    v_lshlrev_b32 v2, 7, v2
    v_mul_f32 v242, v226, v242
    v_mfma_f32_16x16x32_bf16 v[152:155], v[28:31], a[184:187], v[152:155]
    v_fma_f32 v0, v0, s50, s50
    v_fma_f32 v1, v1, s50, s50
    v_mfma_f32_16x16x32_bf16 v[156:159], v[24:27], a[172:175], v[156:159]
    v_rcp_f32 v0, v0
    v_mfma_f32_16x16x32_bf16 v[156:159], v[28:31], a[188:191], v[156:159]
    s_waitcnt vmcnt(15) lgkmcnt(0)
    v_rcp_f32 v1, v1
    v_mfma_f32_16x16x32_bf16 v[160:163], v[32:35], a[160:163], v[160:163]
    s_barrier
    v_mfma_f32_16x16x32_bf16 v[160:163], v[36:39], a[176:179], v[160:163]
    s_add_u32 s89, s89, 2048
    global_load_dword v20, v2, s[10:11]
    v_mfma_f32_16x16x32_bf16 v[164:167], v[32:35], a[164:167], v[164:167]
    buffer_load_dword v20, v7, s[32:35], s89 offen
    v_mfma_f32_16x16x32_bf16 v[164:167], v[36:39], a[180:183], v[164:167]
    v_add_u32 v5, 49152, v5
    v_mul_f32 v243, v227, v243
    v_mfma_f32_16x16x32_bf16 v[168:171], v[32:35], a[168:171], v[168:171]
    ds_read_b64_tr_b16 v[24:25], v5 offset:0
    v_mul_f32 v0, v0, v242
    v_mfma_f32_16x16x32_bf16 v[168:171], v[36:39], a[184:187], v[168:171]
    s_add_u32 s88, s88, s92
    ds_read_b64_tr_b16 v[26:27], v5 offset:512
    v_mul_f32 v1, v1, v243
    v_mfma_f32_16x16x32_bf16 v[172:175], v[32:35], a[172:175], v[172:175]
    ds_read_b64_tr_b16 v[28:29], v5 offset:2048
    v_cvt_pk_bf16_f32 v99, v0, v1
    v_mfma_f32_16x16x32_bf16 v[172:175], v[36:39], a[188:191], v[172:175]
    ds_read_b64_tr_b16 v[30:31], v5 offset:2560
    buffer_load_dword v20, v7, s[32:35], s88 offen
    v_mfma_f32_16x16x32_bf16 v[176:179], v[40:43], a[160:163], v[176:179]
    ds_read_b64_tr_b16 v[32:33], v5 offset:8192
    v_fmaak_f32 v0, v228, v228, 0x409d30fc
    v_mfma_f32_16x16x32_bf16 v[176:179], v[44:47], a[176:179], v[176:179]
    s_add_u32 s89, s89, s92
    ds_read_b64_tr_b16 v[34:35], v5 offset:8704
    v_fmaak_f32 v1, v229, v229, 0x409d30fc
    v_mfma_f32_16x16x32_bf16 v[180:183], v[40:43], a[164:167], v[180:183]
    v_mul_f32 v0, v0, v228
    v_mul_f32 v1, v1, v229
    v_mfma_f32_16x16x32_bf16 v[180:183], v[44:47], a[180:183], v[180:183]
    buffer_load_dword v20, v7, s[32:35], s89 offen
    v_mfma_f32_16x16x32_bf16 v[184:187], v[40:43], a[168:171], v[184:187]
    v_exp_f32 v0, v0
    v_mfma_f32_16x16x32_bf16 v[184:187], v[44:47], a[184:187], v[184:187]
    ds_read_b64_tr_b16 v[36:37], v5 offset:10240
    v_add_u32 v4, 1769472, v4
    v_mfma_f32_16x16x32_bf16 v[188:191], v[40:43], a[172:175], v[188:191]
    v_exp_f32 v1, v1
    v_mfma_f32_16x16x32_bf16 v[188:191], v[44:47], a[188:191], v[188:191]
    s_waitcnt lgkmcnt(3)
    ds_read_b64_tr_b16 v[38:39], v5 offset:10752
    v_mul_f32 v244, v228, v244
    v_mfma_f32_16x16x32_bf16 v[128:131], v[24:27], a[192:195], v[128:131]
    v_add_u32 v6, 49152, v6
    v_fma_f32 v0, v0, s50, s50
    v_mfma_f32_16x16x32_bf16 v[128:131], v[28:31], a[208:211], v[128:131]
    ds_read_b64_tr_b16 v[40:41], v6 offset:0
    v_fma_f32 v1, v1, s50, s50
    v_mfma_f32_16x16x32_bf16 v[132:135], v[24:27], a[196:199], v[132:135]
    s_add_u32 m0, s55, 0
    v_rcp_f32 v0, v0
    v_mfma_f32_16x16x32_bf16 v[132:135], v[28:31], a[212:215], v[132:135]
    v_rcp_f32 v1, v1
    v_mfma_f32_16x16x32_bf16 v[136:139], v[24:27], a[200:203], v[136:139]
    ds_read_b64_tr_b16 v[42:43], v6 offset:512
    v_mul_f32 v245, v229, v245
    v_mfma_f32_16x16x32_bf16 v[136:139], v[28:31], a[216:219], v[136:139]
    buffer_load_dwordx4 v4, s[32:35], s64 offen offset:0 lds
    v_mfma_f32_16x16x32_bf16 v[140:143], v[24:27], a[204:207], v[140:143]
    ds_read_b64_tr_b16 v[44:45], v6 offset:2048
    v_mul_f32 v0, v0, v244
    v_mfma_f32_16x16x32_bf16 v[140:143], v[28:31], a[220:223], v[140:143]
    s_waitcnt lgkmcnt(3)
    ds_read_b64_tr_b16 v[46:47], v6 offset:2560
    v_mul_f32 v1, v1, v245
    v_mfma_f32_16x16x32_bf16 v[144:147], v[32:35], a[192:195], v[144:147]
    ds_read_b64_tr_b16 v[24:25], v6 offset:8192
    v_cvt_pk_bf16_f32 v102, v0, v1
    v_mfma_f32_16x16x32_bf16 v[144:147], v[36:39], a[208:211], v[144:147]
    ds_read_b64_tr_b16 v[26:27], v6 offset:8704
    v_fmaak_f32 v0, v230, v230, 0x409d30fc
    v_mfma_f32_16x16x32_bf16 v[148:151], v[32:35], a[196:199], v[148:151]
    ds_read_b64_tr_b16 v[28:29], v6 offset:10240
    v_fmaak_f32 v1, v231, v231, 0x409d30fc
    v_mfma_f32_16x16x32_bf16 v[148:151], v[36:39], a[212:215], v[148:151]
    buffer_load_dwordx4 v4, s[32:35], s65 offen offset:1024 lds
    v_mfma_f32_16x16x32_bf16 v[152:155], v[32:35], a[200:203], v[152:155]
    v_mul_f32 v0, v0, v230
    v_mul_f32 v1, v1, v231
    v_mfma_f32_16x16x32_bf16 v[152:155], v[36:39], a[216:219], v[152:155]
    v_exp_f32 v0, v0
    v_mfma_f32_16x16x32_bf16 v[156:159], v[32:35], a[204:207], v[156:159]
    v_exp_f32 v1, v1
    v_mfma_f32_16x16x32_bf16 v[156:159], v[36:39], a[220:223], v[156:159]
    s_waitcnt lgkmcnt(3)
    ds_read_b64_tr_b16 v[30:31], v6 offset:10752
    v_mul_f32 v246, v230, v246
    v_mfma_f32_16x16x32_bf16 v[160:163], v[40:43], a[192:195], v[160:163]
    ds_read_b64_tr_b16 v[32:33], v5 offset:16384
    v_fma_f32 v0, v0, s50, s50
    v_mfma_f32_16x16x32_bf16 v[160:163], v[44:47], a[208:211], v[160:163]
    buffer_load_dwordx4 v4, s[32:35], s66 offen offset:2048 lds
    v_mfma_f32_16x16x32_bf16 v[164:167], v[40:43], a[196:199], v[164:167]
    ds_read_b64_tr_b16 v[34:35], v5 offset:16896
    v_fma_f32 v1, v1, s50, s50
    v_mfma_f32_16x16x32_bf16 v[164:167], v[44:47], a[212:215], v[164:167]
    v_rcp_f32 v0, v0
    v_mfma_f32_16x16x32_bf16 v[168:171], v[40:43], a[200:203], v[168:171]
    v_rcp_f32 v1, v1
    v_mfma_f32_16x16x32_bf16 v[168:171], v[44:47], a[216:219], v[168:171]
    buffer_load_dwordx4 v4, s[32:35], s67 offen offset:3072 lds
    v_mfma_f32_16x16x32_bf16 v[172:175], v[40:43], a[204:207], v[172:175]
    ds_read_b64_tr_b16 v[36:37], v5 offset:18432
    v_mul_f32 v247, v231, v247
    v_mfma_f32_16x16x32_bf16 v[172:175], v[44:47], a[220:223], v[172:175]
    s_waitcnt lgkmcnt(3)
    ds_read_b64_tr_b16 v[38:39], v5 offset:18944
    v_mul_f32 v0, v0, v246
    v_mfma_f32_16x16x32_bf16 v[176:179], v[24:27], a[192:195], v[176:179]
    ds_read_b64_tr_b16 v[40:41], v5 offset:24576
    v_mul_f32 v1, v1, v247
    v_mfma_f32_16x16x32_bf16 v[176:179], v[28:31], a[208:211], v[176:179]
    s_add_u32 m0, s55, 16384
    ds_read_b64_tr_b16 v[42:43], v5 offset:25088
    v_cvt_pk_bf16_f32 v103, v0, v1
    v_mfma_f32_16x16x32_bf16 v[180:183], v[24:27], a[196:199], v[180:183]
    ds_read_b64_tr_b16 v[44:45], v5 offset:26624
    v_fmaak_f32 v0, v232, v232, 0x409d30fc
    v_mfma_f32_16x16x32_bf16 v[180:183], v[28:31], a[212:215], v[180:183]
    ds_read_b64_tr_b16 v[46:47], v5 offset:27136
    v_fmaak_f32 v1, v233, v233, 0x409d30fc
    v_mfma_f32_16x16x32_bf16 v[184:187], v[24:27], a[200:203], v[184:187]
    v_mul_f32 v0, v0, v232
    v_mul_f32 v1, v1, v233
    v_mfma_f32_16x16x32_bf16 v[184:187], v[28:31], a[216:219], v[184:187]
    v_exp_f32 v0, v0
    v_mfma_f32_16x16x32_bf16 v[188:191], v[24:27], a[204:207], v[188:191]
    v_exp_f32 v1, v1
    v_mfma_f32_16x16x32_bf16 v[188:191], v[28:31], a[220:223], v[188:191]
    s_waitcnt lgkmcnt(4)
    buffer_load_dwordx4 v4, s[32:35], s68 offen offset:0 lds
    v_mfma_f32_16x16x32_bf16 v[128:131], v[32:35], a[224:227], v[128:131]
    ds_read_b64_tr_b16 v[24:25], v6 offset:16384
    v_mfma_f32_16x16x32_bf16 v[128:131], v[36:39], a[240:243], v[128:131]
    ds_read_b64_tr_b16 v[26:27], v6 offset:16896
    v_mul_f32 v248, v232, v248
    v_mfma_f32_16x16x32_bf16 v[132:135], v[32:35], a[228:231], v[132:135]
    ds_read_b64_tr_b16 v[28:29], v6 offset:18432
    v_fma_f32 v0, v0, s50, s50
    v_mfma_f32_16x16x32_bf16 v[132:135], v[36:39], a[244:247], v[132:135]
    buffer_load_dwordx4 v4, s[32:35], s69 offen offset:1024 lds
    v_mfma_f32_16x16x32_bf16 v[136:139], v[32:35], a[232:235], v[136:139]
    ds_read_b64_tr_b16 v[30:31], v6 offset:18944
    v_fma_f32 v1, v1, s50, s50
    v_mfma_f32_16x16x32_bf16 v[136:139], v[36:39], a[248:251], v[136:139]
    v_rcp_f32 v0, v0
    v_mfma_f32_16x16x32_bf16 v[140:143], v[32:35], a[236:239], v[140:143]
    v_rcp_f32 v1, v1
    v_mfma_f32_16x16x32_bf16 v[140:143], v[36:39], a[252:255], v[140:143]
    s_waitcnt lgkmcnt(4)
    v_mul_f32 v249, v233, v249
    v_mul_f32 v0, v0, v248
    v_mfma_f32_16x16x32_bf16 v[144:147], v[40:43], a[224:227], v[144:147]
    ds_read_b64_tr_b16 v[32:33], v6 offset:24576
    v_mul_f32 v1, v1, v249
    v_mfma_f32_16x16x32_bf16 v[144:147], v[44:47], a[240:243], v[144:147]
    buffer_load_dwordx4 v4, s[32:35], s70 offen offset:2048 lds
    v_mfma_f32_16x16x32_bf16 v[148:151], v[40:43], a[228:231], v[148:151]
    ds_read_b64_tr_b16 v[34:35], v6 offset:25088
    v_cvt_pk_bf16_f32 v106, v0, v1
    v_mfma_f32_16x16x32_bf16 v[148:151], v[44:47], a[244:247], v[148:151]
    ds_read_b64_tr_b16 v[36:37], v6 offset:26624
    v_fmaak_f32 v0, v234, v234, 0x409d30fc
    v_mfma_f32_16x16x32_bf16 v[152:155], v[40:43], a[232:235], v[152:155]
    ds_read_b64_tr_b16 v[38:39], v6 offset:27136
    v_fmaak_f32 v1, v235, v235, 0x409d30fc
    v_mfma_f32_16x16x32_bf16 v[152:155], v[44:47], a[248:251], v[152:155]
    buffer_load_dwordx4 v4, s[32:35], s71 offen offset:3072 lds
    v_mfma_f32_16x16x32_bf16 v[156:159], v[40:43], a[236:239], v[156:159]
    v_mul_f32 v0, v0, v234
    v_mul_f32 v1, v1, v235
    v_mfma_f32_16x16x32_bf16 v[156:159], v[44:47], a[252:255], v[156:159]
    s_waitcnt lgkmcnt(4)
    v_exp_f32 v0, v0
    v_mfma_f32_16x16x32_bf16 v[160:163], v[24:27], a[224:227], v[160:163]
    ds_read_b64_tr_b16 v[40:41], v5 offset:32768
    v_mfma_f32_16x16x32_bf16 v[160:163], v[28:31], a[240:243], v[160:163]
    v_exp_f32 v1, v1
    v_mfma_f32_16x16x32_bf16 v[164:167], v[24:27], a[228:231], v[164:167]
    ds_read_b64_tr_b16 v[42:43], v5 offset:33280
    v_mul_f32 v250, v234, v250
    v_mfma_f32_16x16x32_bf16 v[164:167], v[28:31], a[244:247], v[164:167]
    s_add_u32 m0, s55, 32768
    ds_read_b64_tr_b16 v[44:45], v5 offset:34816
    v_fma_f32 v0, v0, s50, s50
    v_mfma_f32_16x16x32_bf16 v[168:171], v[24:27], a[232:235], v[168:171]
    ds_read_b64_tr_b16 v[46:47], v5 offset:35328
    v_fma_f32 v1, v1, s50, s50
    v_mfma_f32_16x16x32_bf16 v[168:171], v[28:31], a[248:251], v[168:171]
    v_rcp_f32 v0, v0
    v_mfma_f32_16x16x32_bf16 v[172:175], v[24:27], a[236:239], v[172:175]
    v_rcp_f32 v1, v1
    v_mfma_f32_16x16x32_bf16 v[172:175], v[28:31], a[252:255], v[172:175]
    s_waitcnt lgkmcnt(4)
    v_mul_f32 v251, v235, v251
    v_mul_f32 v0, v0, v250
    v_mfma_f32_16x16x32_bf16 v[176:179], v[32:35], a[224:227], v[176:179]
    ds_read_b64_tr_b16 v[24:25], v5 offset:40960
    v_mul_f32 v1, v1, v251
    v_mfma_f32_16x16x32_bf16 v[176:179], v[36:39], a[240:243], v[176:179]
    buffer_load_dwordx4 v4, s[32:35], s72 offen offset:0 lds
    v_mfma_f32_16x16x32_bf16 v[180:183], v[32:35], a[228:231], v[180:183]
    ds_read_b64_tr_b16 v[26:27], v5 offset:41472
    v_cvt_pk_bf16_f32 v107, v0, v1
    v_mfma_f32_16x16x32_bf16 v[180:183], v[36:39], a[244:247], v[180:183]
    ds_read_b64_tr_b16 v[28:29], v5 offset:43008
    v_fmaak_f32 v0, v236, v236, 0x409d30fc
    v_mfma_f32_16x16x32_bf16 v[184:187], v[32:35], a[232:235], v[184:187]
    ds_read_b64_tr_b16 v[30:31], v5 offset:43520
    v_fmaak_f32 v1, v237, v237, 0x409d30fc
    v_mfma_f32_16x16x32_bf16 v[184:187], v[36:39], a[248:251], v[184:187]
    buffer_load_dwordx4 v4, s[32:35], s73 offen offset:1024 lds
    v_mfma_f32_16x16x32_bf16 v[188:191], v[32:35], a[236:239], v[188:191]
    v_mul_f32 v0, v0, v236
    v_mul_f32 v1, v1, v237
    v_mfma_f32_16x16x32_bf16 v[188:191], v[36:39], a[252:255], v[188:191]
    s_waitcnt lgkmcnt(4)
    v_exp_f32 v0, v0
    v_mfma_f32_16x16x32_bf16 v[128:131], v[40:43], v[48:51], v[128:131]
    ds_read_b64_tr_b16 v[32:33], v6 offset:32768
    v_mfma_f32_16x16x32_bf16 v[128:131], v[44:47], v[64:67], v[128:131]
    buffer_load_dwordx4 v4, s[32:35], s74 offen offset:2048 lds
    v_mfma_f32_16x16x32_bf16 v[132:135], v[40:43], v[52:55], v[132:135]
    v_exp_f32 v1, v1
    v_mfma_f32_16x16x32_bf16 v[132:135], v[44:47], v[68:71], v[132:135]
    ds_read_b64_tr_b16 v[34:35], v6 offset:33280
    v_mul_f32 v252, v236, v252
    v_mfma_f32_16x16x32_bf16 v[136:139], v[40:43], v[56:59], v[136:139]
    ds_read_b64_tr_b16 v[36:37], v6 offset:34816
    v_fma_f32 v0, v0, s50, s50
    v_mfma_f32_16x16x32_bf16 v[136:139], v[44:47], v[72:75], v[136:139]
    ds_read_b64_tr_b16 v[38:39], v6 offset:35328
    v_fma_f32 v1, v1, s50, s50
    v_mfma_f32_16x16x32_bf16 v[140:143], v[40:43], v[60:63], v[140:143]
    v_rcp_f32 v0, v0
    v_mfma_f32_16x16x32_bf16 v[140:143], v[44:47], v[76:79], v[140:143]
    s_waitcnt lgkmcnt(4)
    buffer_load_dwordx4 v4, s[32:35], s75 offen offset:3072 lds
    v_mfma_f32_16x16x32_bf16 v[144:147], v[24:27], v[48:51], v[144:147]
    buffer_load_dwordx2 v[2:3], v22, s[40:43], s51 offen sc1
    v_mfma_f32_16x16x32_bf16 v[144:147], v[28:31], v[64:67], v[144:147]
    ds_read_b64_tr_b16 v[40:41], v6 offset:40960
    ds_read_b64_tr_b16 v[42:43], v6 offset:41472
    v_mfma_f32_16x16x32_bf16 v[148:151], v[24:27], v[52:55], v[148:151]
    ds_read_b64_tr_b16 v[44:45], v6 offset:43008
    v_mfma_f32_16x16x32_bf16 v[148:151], v[28:31], v[68:71], v[148:151]
    ds_read_b64_tr_b16 v[46:47], v6 offset:43520
    v_mfma_f32_16x16x32_bf16 v[152:155], v[24:27], v[56:59], v[152:155]
    v_rcp_f32 v1, v1
    v_mfma_f32_16x16x32_bf16 v[152:155], v[28:31], v[72:75], v[152:155]
    v_mul_f32 v253, v237, v253
    v_mul_f32 v0, v0, v252
    v_mfma_f32_16x16x32_bf16 v[156:159], v[24:27], v[60:63], v[156:159]
    v_mul_f32 v1, v1, v253
    v_cvt_pk_bf16_f32 v110, v0, v1
    v_mfma_f32_16x16x32_bf16 v[156:159], v[28:31], v[76:79], v[156:159]
    s_waitcnt vmcnt(17) lgkmcnt(0)
    v_fmaak_f32 v0, v238, v238, 0x409d30fc
    v_fmaak_f32 v1, v239, v239, 0x409d30fc
    v_mfma_f32_16x16x32_bf16 v[160:163], v[32:35], v[48:51], v[160:163]
    s_barrier
    v_add_u32 v5, 49152, v5
    v_mfma_f32_16x16x32_bf16 v[160:163], v[36:39], v[64:67], v[160:163]
    buffer_load_dword v20, v14, s[36:39], s78 offen offset:2048
    v_mfma_f32_16x16x32_bf16 v[164:167], v[32:35], v[52:55], v[164:167]
    ds_read_b64_tr_b16 v[24:25], v5 offset:0
    v_add_u32 v4, 1769472, v4
    v_mfma_f32_16x16x32_bf16 v[164:167], v[36:39], v[68:71], v[164:167]
    ds_read_b64_tr_b16 v[26:27], v5 offset:512
    v_mul_f32 v0, v0, v238
    v_mfma_f32_16x16x32_bf16 v[168:171], v[32:35], v[56:59], v[168:171]
    ds_read_b64_tr_b16 v[28:29], v5 offset:2048
    v_mul_f32 v1, v1, v239
    v_mfma_f32_16x16x32_bf16 v[168:171], v[36:39], v[72:75], v[168:171]
    v_exp_f32 v0, v0
    v_mfma_f32_16x16x32_bf16 v[172:175], v[32:35], v[60:63], v[172:175]
    v_exp_f32 v1, v1
    v_mfma_f32_16x16x32_bf16 v[172:175], v[36:39], v[76:79], v[172:175]
    ds_read_b64_tr_b16 v[30:31], v5 offset:2560
    v_mul_f32 v254, v238, v254
    v_mfma_f32_16x16x32_bf16 v[176:179], v[40:43], v[48:51], v[176:179]
    ds_read_b64_tr_b16 v[32:33], v5 offset:8192
    v_fma_f32 v0, v0, s50, s50
    v_mfma_f32_16x16x32_bf16 v[176:179], v[44:47], v[64:67], v[176:179]
    s_add_u32 m0, s55, 49152
    ds_read_b64_tr_b16 v[34:35], v5 offset:8704
    v_fma_f32 v1, v1, s50, s50
    v_mfma_f32_16x16x32_bf16 v[180:183], v[40:43], v[52:55], v[180:183]
    v_rcp_f32 v0, v0
    v_mfma_f32_16x16x32_bf16 v[180:183], v[44:47], v[68:71], v[180:183]
    v_rcp_f32 v1, v1
    v_mfma_f32_16x16x32_bf16 v[184:187], v[40:43], v[56:59], v[184:187]
    ds_read_b64_tr_b16 v[36:37], v5 offset:10240
    v_mul_f32 v255, v239, v255
    v_mfma_f32_16x16x32_bf16 v[184:187], v[44:47], v[72:75], v[184:187]
    buffer_load_dwordx4 v4, s[32:35], s64 offen offset:0 lds
    v_mfma_f32_16x16x32_bf16 v[188:191], v[40:43], v[60:63], v[188:191]
    ds_read_b64_tr_b16 v[38:39], v5 offset:10752
    v_mul_f32 v0, v0, v254
    v_mfma_f32_16x16x32_bf16 v[188:191], v[44:47], v[76:79], v[188:191]
    s_waitcnt lgkmcnt(4)
    v_mul_f32 v1, v1, v255
    v_cvt_pk_bf16_f32 v111, v0, v1
    v_mfma_f32_16x16x32_bf16 v[192:195], v[24:27], a[0:3], 0
    v_add_u32 v6, 49152, v6
    v_mfma_f32_16x16x32_bf16 v[192:195], v[28:31], a[16:19], v[192:195]
    ds_read_b64_tr_b16 v[40:41], v6 offset:0
    v_mfma_f32_16x16x32_bf16 v[196:199], v[24:27], a[4:7], 0
    buffer_load_dwordx4 v4, s[32:35], s65 offen offset:1024 lds
    v_mfma_f32_16x16x32_bf16 v[196:199], v[28:31], a[20:23], v[196:199]
    ds_read_b64_tr_b16 v[42:43], v6 offset:512
    v_mfma_f32_16x16x32_bf16 v[200:203], v[24:27], a[8:11], 0
    ds_read_b64_tr_b16 v[44:45], v6 offset:2048
    v_fmaak_f32 v0, v128, v128, 0x409d30fc
    v_mfma_f32_16x16x32_bf16 v[200:203], v[28:31], a[24:27], v[200:203]
    ds_read_b64_tr_b16 v[46:47], v6 offset:2560
    v_fmaak_f32 v1, v129, v129, 0x409d30fc
    v_mfma_f32_16x16x32_bf16 v[204:207], v[24:27], a[12:15], 0
    v_mul_f32 v0, v0, v128
    v_mul_f32 v1, v1, v129
    v_mfma_f32_16x16x32_bf16 v[204:207], v[28:31], a[28:31], v[204:207]
    s_waitcnt lgkmcnt(4)
    v_exp_f32 v0, v0
    v_mfma_f32_16x16x32_bf16 v[208:211], v[32:35], a[0:3], 0
    ds_read_b64_tr_b16 v[24:25], v6 offset:8192
    v_mfma_f32_16x16x32_bf16 v[208:211], v[36:39], a[16:19], v[208:211]
    buffer_load_dwordx4 v4, s[32:35], s66 offen offset:2048 lds
    v_mfma_f32_16x16x32_bf16 v[212:215], v[32:35], a[4:7], 0
    v_exp_f32 v1, v1
    v_mfma_f32_16x16x32_bf16 v[212:215], v[36:39], a[20:23], v[212:215]
    ds_read_b64_tr_b16 v[26:27], v6 offset:8704
    v_mul_f32 v144, v128, v144
L_pgx4:
    s_cbranch_execz L_back0
    v_mfma_f32_16x16x32_bf16 v[216:219], v[32:35], a[8:11], 0
    ds_read_b64_tr_b16 v[28:29], v6 offset:10240
    v_fma_f32 v0, v0, s50, s50
    v_mfma_f32_16x16x32_bf16 v[216:219], v[36:39], a[24:27], v[216:219]
    buffer_load_dwordx4 v4, s[32:35], s67 offen offset:3072 lds
    v_mfma_f32_16x16x32_bf16 v[220:223], v[32:35], a[12:15], 0
    ds_read_b64_tr_b16 v[30:31], v6 offset:10752
    v_fma_f32 v1, v1, s50, s50
    v_mfma_f32_16x16x32_bf16 v[220:223], v[36:39], a[28:31], v[220:223]
    s_waitcnt lgkmcnt(4)
    v_rcp_f32 v0, v0
    v_mfma_f32_16x16x32_bf16 v[224:227], v[40:43], a[0:3], 0
    v_rcp_f32 v1, v1
    v_mfma_f32_16x16x32_bf16 v[224:227], v[44:47], a[16:19], v[224:227]
    ds_read_b64_tr_b16 v[32:33], v5 offset:16384
    v_mul_f32 v145, v129, v145
    v_mfma_f32_16x16x32_bf16 v[228:231], v[40:43], a[4:7], 0
    ds_read_b64_tr_b16 v[34:35], v5 offset:16896
    v_mul_f32 v0, v0, v144
    v_mfma_f32_16x16x32_bf16 v[228:231], v[44:47], a[20:23], v[228:231]
    s_add_u32 m0, s55, 65536
    ds_read_b64_tr_b16 v[36:37], v5 offset:18432
    v_mul_f32 v1, v1, v145
    v_mfma_f32_16x16x32_bf16 v[232:235], v[40:43], a[8:11], 0
    ds_read_b64_tr_b16 v[38:39], v5 offset:18944
    v_cvt_pk_bf16_f32 v112, v0, v1
    v_mfma_f32_16x16x32_bf16 v[232:235], v[44:47], a[24:27], v[232:235]
    v_fmaak_f32 v0, v130, v130, 0x409d30fc
    v_fmaak_f32 v1, v131, v131, 0x409d30fc
    v_mfma_f32_16x16x32_bf16 v[236:239], v[40:43], a[12:15], 0
    v_mul_f32 v0, v0, v130
    v_mul_f32 v1, v1, v131
    v_mfma_f32_16x16x32_bf16 v[236:239], v[44:47], a[28:31], v[236:239]
    s_waitcnt lgkmcnt(4)
    v_exp_f32 v0, v0
    v_mfma_f32_16x16x32_bf16 v[240:243], v[24:27], a[0:3], 0
    ds_read_b64_tr_b16 v[40:41], v5 offset:24576
    v_mfma_f32_16x16x32_bf16 v[240:243], v[28:31], a[16:19], v[240:243]
    buffer_load_dwordx4 v4, s[32:35], s68 offen offset:0 lds
    v_mfma_f32_16x16x32_bf16 v[244:247], v[24:27], a[4:7], 0
    v_exp_f32 v1, v1
    v_mfma_f32_16x16x32_bf16 v[244:247], v[28:31], a[20:23], v[244:247]
    ds_read_b64_tr_b16 v[42:43], v5 offset:25088
    v_mul_f32 v146, v130, v146
    v_mfma_f32_16x16x32_bf16 v[248:251], v[24:27], a[8:11], 0
    ds_read_b64_tr_b16 v[44:45], v5 offset:26624
    v_fma_f32 v0, v0, s50, s50
    v_mfma_f32_16x16x32_bf16 v[248:251], v[28:31], a[24:27], v[248:251]
    ds_read_b64_tr_b16 v[46:47], v5 offset:27136
    v_fma_f32 v1, v1, s50, s50
    v_mfma_f32_16x16x32_bf16 v[252:255], v[24:27], a[12:15], 0
    v_rcp_f32 v0, v0
    v_mfma_f32_16x16x32_bf16 v[252:255], v[28:31], a[28:31], v[252:255]
    s_waitcnt lgkmcnt(4)
    buffer_load_dwordx4 v4, s[32:35], s69 offen offset:1024 lds
    v_mfma_f32_16x16x32_bf16 v[192:195], v[32:35], a[32:35], v[192:195]
    ds_read_b64_tr_b16 v[24:25], v6 offset:16384
    v_mfma_f32_16x16x32_bf16 v[192:195], v[36:39], a[48:51], v[192:195]
    v_rcp_f32 v1, v1
    v_mfma_f32_16x16x32_bf16 v[196:199], v[32:35], a[36:39], v[196:199]
    ds_read_b64_tr_b16 v[26:27], v6 offset:16896
    v_mul_f32 v147, v131, v147
    v_mfma_f32_16x16x32_bf16 v[196:199], v[36:39], a[52:55], v[196:199]
    ds_read_b64_tr_b16 v[28:29], v6 offset:18432
    v_mul_f32 v0, v0, v146
    v_mfma_f32_16x16x32_bf16 v[200:203], v[32:35], a[40:43], v[200:203]
    ds_read_b64_tr_b16 v[30:31], v6 offset:18944
    v_mul_f32 v1, v1, v147
    v_mfma_f32_16x16x32_bf16 v[200:203], v[36:39], a[56:59], v[200:203]
    buffer_load_dwordx4 v4, s[32:35], s70 offen offset:2048 lds
    v_mfma_f32_16x16x32_bf16 v[204:207], v[32:35], a[44:47], v[204:207]
    v_cvt_pk_bf16_f32 v113, v0, v1
    v_fmaak_f32 v0, v132, v132, 0x409d30fc
    v_mfma_f32_16x16x32_bf16 v[204:207], v[36:39], a[60:63], v[204:207]
    s_waitcnt lgkmcnt(4)
    v_fmaak_f32 v1, v133, v133, 0x409d30fc
    v_mul_f32 v0, v0, v132
    v_mfma_f32_16x16x32_bf16 v[208:211], v[40:43], a[32:35], v[208:211]
    ds_read_b64_tr_b16 v[32:33], v6 offset:24576
    v_mfma_f32_16x16x32_bf16 v[208:211], v[44:47], a[48:51], v[208:211]
    buffer_load_dwordx4 v4, s[32:35], s71 offen offset:3072 lds
    v_mfma_f32_16x16x32_bf16 v[212:215], v[40:43], a[36:39], v[212:215]
    ds_read_b64_tr_b16 v[34:35], v6 offset:25088
    v_mul_f32 v1, v1, v133
    v_mfma_f32_16x16x32_bf16 v[212:215], v[44:47], a[52:55], v[212:215]
    v_exp_f32 v0, v0
    v_mfma_f32_16x16x32_bf16 v[216:219], v[40:43], a[40:43], v[216:219]
    v_exp_f32 v1, v1
    v_mfma_f32_16x16x32_bf16 v[216:219], v[44:47], a[56:59], v[216:219]
    ds_read_b64_tr_b16 v[36:37], v6 offset:26624
    v_mul_f32 v148, v132, v148
    v_mfma_f32_16x16x32_bf16 v[220:223], v[40:43], a[44:47], v[220:223]
    ds_read_b64_tr_b16 v[38:39], v6 offset:27136
    v_fma_f32 v0, v0, s50, s50
    v_mfma_f32_16x16x32_bf16 v[220:223], v[44:47], a[60:63], v[220:223]
    s_waitcnt lgkmcnt(4)
    v_fma_f32 v1, v1, s50, s50
    v_mfma_f32_16x16x32_bf16 v[224:227], v[24:27], a[32:35], v[224:227]
    v_rcp_f32 v0, v0
    v_mfma_f32_16x16x32_bf16 v[224:227], v[28:31], a[48:51], v[224:227]
    s_add_u32 m0, s55, 81920
    v_rcp_f32 v1, v1
    v_mfma_f32_16x16x32_bf16 v[228:231], v[24:27], a[36:39], v[228:231]
    ds_read_b64_tr_b16 v[40:41], v5 offset:32768
    v_mul_f32 v149, v133, v149
    v_mfma_f32_16x16x32_bf16 v[228:231], v[28:31], a[52:55], v[228:231]
    ds_read_b64_tr_b16 v[42:43], v5 offset:33280
    v_mul_f32 v0, v0, v148
    v_mfma_f32_16x16x32_bf16 v[232:235], v[24:27], a[40:43], v[232:235]
    ds_read_b64_tr_b16 v[44:45], v5 offset:34816
    v_mul_f32 v1, v1, v149
    v_mfma_f32_16x16x32_bf16 v[232:235], v[28:31], a[56:59], v[232:235]
    buffer_load_dwordx4 v4, s[32:35], s72 offen offset:0 lds
    v_mfma_f32_16x16x32_bf16 v[236:239], v[24:27], a[44:47], v[236:239]
    ds_read_b64_tr_b16 v[46:47], v5 offset:35328
    v_cvt_pk_bf16_f32 v116, v0, v1
    v_mfma_f32_16x16x32_bf16 v[236:239], v[28:31], a[60:63], v[236:239]
    s_waitcnt lgkmcnt(4)
    v_fmaak_f32 v0, v134, v134, 0x409d30fc
    v_fmaak_f32 v1, v135, v135, 0x409d30fc
    v_mfma_f32_16x16x32_bf16 v[240:243], v[32:35], a[32:35], v[240:243]
    ds_read_b64_tr_b16 v[24:25], v5 offset:40960
    v_mul_f32 v0, v0, v134
    v_mfma_f32_16x16x32_bf16 v[240:243], v[36:39], a[48:51], v[240:243]
    ds_read_b64_tr_b16 v[26:27], v5 offset:41472
    v_mul_f32 v1, v1, v135
    v_mfma_f32_16x16x32_bf16 v[244:247], v[32:35], a[36:39], v[244:247]
    ds_read_b64_tr_b16 v[28:29], v5 offset:43008
    v_mfma_f32_16x16x32_bf16 v[244:247], v[36:39], a[52:55], v[244:247]
    buffer_load_dwordx4 v4, s[32:35], s73 offen offset:1024 lds
    v_mfma_f32_16x16x32_bf16 v[248:251], v[32:35], a[40:43], v[248:251]
    v_exp_f32 v0, v0
    v_mfma_f32_16x16x32_bf16 v[248:251], v[36:39], a[56:59], v[248:251]
    v_exp_f32 v1, v1
    v_mfma_f32_16x16x32_bf16 v[252:255], v[32:35], a[44:47], v[252:255]
    ds_read_b64_tr_b16 v[30:31], v5 offset:43520
    v_mul_f32 v150, v134, v150
    v_mfma_f32_16x16x32_bf16 v[252:255], v[36:39], a[60:63], v[252:255]
    s_waitcnt lgkmcnt(4)
    v_fma_f32 v0, v0, s50, s50
    v_fma_f32 v1, v1, s50, s50
    v_mfma_f32_16x16x32_bf16 v[192:195], v[40:43], a[64:67], v[192:195]
    v_rcp_f32 v0, v0
    v_mfma_f32_16x16x32_bf16 v[192:195], v[44:47], a[80:83], v[192:195]
    buffer_load_dwordx4 v4, s[32:35], s74 offen offset:2048 lds
    v_mfma_f32_16x16x32_bf16 v[196:199], v[40:43], a[68:71], v[196:199]
    v_rcp_f32 v1, v1
    v_mfma_f32_16x16x32_bf16 v[196:199], v[44:47], a[84:87], v[196:199]
    ds_read_b64_tr_b16 v[32:33], v6 offset:32768
    v_mul_f32 v151, v135, v151
    v_mfma_f32_16x16x32_bf16 v[200:203], v[40:43], a[72:75], v[200:203]
    ds_read_b64_tr_b16 v[34:35], v6 offset:33280
    s_waitcnt vmcnt(12)
    v_cmp_ne_u64 vcc, s[48:49], v[2:3]
    v_mfma_f32_16x16x32_bf16 v[200:203], v[44:47], a[88:91], v[200:203]
    buffer_load_dwordx4 v4, s[32:35], s75 offen offset:3072 lds
    v_mfma_f32_16x16x32_bf16 v[204:207], v[40:43], a[76:79], v[204:207]
    ds_read_b64_tr_b16 v[36:37], v6 offset:34816
    v_mul_f32 v0, v0, v150
    v_mfma_f32_16x16x32_bf16 v[204:207], v[44:47], a[92:95], v[204:207]
    s_waitcnt lgkmcnt(3)
    ds_read_b64_tr_b16 v[38:39], v6 offset:35328
    v_mul_f32 v1, v1, v151
    v_mfma_f32_16x16x32_bf16 v[208:211], v[24:27], a[64:67], v[208:211]
    ds_read_b64_tr_b16 v[40:41], v6 offset:40960
    v_cvt_pk_bf16_f32 v117, v0, v1
    v_mfma_f32_16x16x32_bf16 v[208:211], v[28:31], a[80:83], v[208:211]
    s_cmp_lg_u64 vcc, 0
    ds_read_b64_tr_b16 v[42:43], v6 offset:41472
    s_cbranch_scc1 L_p0_slow
L_p0_ok:
    v_mfma_f32_16x16x32_bf16 v[212:215], v[24:27], a[68:71], v[212:215]
    ds_read_b64_tr_b16 v[44:45], v6 offset:43008
    v_fmaak_f32 v0, v136, v136, 0x409d30fc
    v_mfma_f32_16x16x32_bf16 v[212:215], v[28:31], a[84:87], v[212:215]
    ds_read_b64_tr_b16 v[46:47], v6 offset:43520
    v_fmaak_f32 v1, v137, v137, 0x409d30fc
    v_mfma_f32_16x16x32_bf16 v[216:219], v[24:27], a[72:75], v[216:219]
    v_mul_f32 v0, v0, v136
    v_mul_f32 v1, v1, v137
    v_mfma_f32_16x16x32_bf16 v[216:219], v[28:31], a[88:91], v[216:219]
    v_exp_f32 v0, v0
    v_mfma_f32_16x16x32_bf16 v[220:223], v[24:27], a[76:79], v[220:223]
    v_exp_f32 v1, v1
    v_mfma_f32_16x16x32_bf16 v[220:223], v[28:31], a[92:95], v[220:223]
    s_waitcnt lgkmcnt(0)
    v_mul_f32 v152, v136, v152
    v_mfma_f32_16x16x32_bf16 v[224:227], v[32:35], a[64:67], v[224:227]
    s_barrier
    v_mfma_f32_16x16x32_bf16 v[224:227], v[36:39], a[80:83], v[224:227]
    buffer_load_dword v20, v14, s[36:39], s80 offen offset:0
    v_mfma_f32_16x16x32_bf16 v[228:231], v[32:35], a[68:71], v[228:231]
    v_add_u32 v5, 4294868992, v5
    v_or_b32 v3, s27, v8
    v_mfma_f32_16x16x32_bf16 v[228:231], v[36:39], a[84:87], v[228:231]
    ds_read_b64_tr_b16 v[24:25], v5 offset:0
    v_fma_f32 v0, v0, s50, s50
    v_mfma_f32_16x16x32_bf16 v[232:235], v[32:35], a[72:75], v[232:235]
    ds_read_b64_tr_b16 v[26:27], v5 offset:512
    v_fma_f32 v1, v1, s50, s50
    v_mfma_f32_16x16x32_bf16 v[232:235], v[36:39], a[88:91], v[232:235]
    ds_read_b64_tr_b16 v[28:29], v5 offset:2048
    v_mov_b32 v2, s48
    v_mfma_f32_16x16x32_bf16 v[236:239], v[32:35], a[76:79], v[236:239]
    ds_read_b64_tr_b16 v[30:31], v5 offset:2560
    v_mfma_f32_16x16x32_bf16 v[236:239], v[36:39], a[92:95], v[236:239]
    v_rcp_f32 v0, v0
    v_mfma_f32_16x16x32_bf16 v[240:243], v[40:43], a[64:67], v[240:243]
    v_rcp_f32 v1, v1
    v_mfma_f32_16x16x32_bf16 v[240:243], v[44:47], a[80:83], v[240:243]
    s_mov_b32 s57, 208896
    ds_read_b64_tr_b16 v[32:33], v5 offset:8192
    v_mul_f32 v153, v137, v153
    v_mfma_f32_16x16x32_bf16 v[244:247], v[40:43], a[68:71], v[244:247]
    ds_read_b64_tr_b16 v[34:35], v5 offset:8704
    v_mul_f32 v0, v0, v152
    v_mfma_f32_16x16x32_bf16 v[244:247], v[44:47], a[84:87], v[244:247]
    buffer_store_dword v2, v3, s[40:43], s57 offen sc1
    v_mfma_f32_16x16x32_bf16 v[248:251], v[40:43], a[72:75], v[248:251]
    ds_read_b64_tr_b16 v[36:37], v5 offset:10240
    v_mul_f32 v1, v1, v153
    v_mfma_f32_16x16x32_bf16 v[248:251], v[44:47], a[88:91], v[248:251]
    s_add_u32 s51, s51, 4096
    ds_read_b64_tr_b16 v[38:39], v5 offset:10752
    v_cvt_pk_bf16_f32 v120, v0, v1
    v_mfma_f32_16x16x32_bf16 v[252:255], v[40:43], a[76:79], v[252:255]
    v_fmaak_f32 v0, v138, v138, 0x409d30fc
    v_fmaak_f32 v1, v139, v139, 0x409d30fc
    v_mfma_f32_16x16x32_bf16 v[252:255], v[44:47], a[92:95], v[252:255]
    s_waitcnt lgkmcnt(4)
    v_mul_f32 v0, v0, v138
    v_mul_f32 v1, v1, v139
    v_mfma_f32_16x16x32_bf16 v[192:195], v[24:27], a[96:99], v[192:195]
    v_add_u32 v6, 4294868992, v6
    v_mov_b32 v2, 0
    v_mfma_f32_16x16x32_bf16 v[192:195], v[28:31], a[112:115], v[192:195]
    v_exp_f32 v0, v0
    v_mfma_f32_16x16x32_bf16 v[196:199], v[24:27], a[100:103], v[196:199]
    ds_read_b64_tr_b16 v[40:41], v6 offset:0
    v_mov_b32 v3, 0
    v_mfma_f32_16x16x32_bf16 v[196:199], v[28:31], a[116:119], v[196:199]
    v_exp_f32 v1, v1
    v_mfma_f32_16x16x32_bf16 v[200:203], v[24:27], a[104:107], v[200:203]
    ds_read_b64_tr_b16 v[42:43], v6 offset:512
    v_mul_f32 v154, v138, v154
    v_mfma_f32_16x16x32_bf16 v[200:203], v[28:31], a[120:123], v[200:203]
    s_mov_b32 s59, s26
    ds_read_b64_tr_b16 v[44:45], v6 offset:2048
    v_fma_f32 v0, v0, s50, s50
    v_mfma_f32_16x16x32_bf16 v[204:207], v[24:27], a[108:111], v[204:207]
    ds_read_b64_tr_b16 v[46:47], v6 offset:2560
    v_fma_f32 v1, v1, s50, s50
    v_mfma_f32_16x16x32_bf16 v[204:207], v[28:31], a[124:127], v[204:207]
    s_waitcnt lgkmcnt(4)
    v_rcp_f32 v0, v0
    v_mfma_f32_16x16x32_bf16 v[208:211], v[32:35], a[96:99], v[208:211]
    v_rcp_f32 v1, v1
    v_mfma_f32_16x16x32_bf16 v[208:211], v[36:39], a[112:115], v[208:211]
    buffer_store_dwordx2 v[2:3], v8, s[40:43], s59 offen sc1
    v_mfma_f32_16x16x32_bf16 v[212:215], v[32:35], a[100:103], v[212:215]
    ds_read_b64_tr_b16 v[24:25], v6 offset:8192
    v_mul_f32 v155, v139, v155
    v_mfma_f32_16x16x32_bf16 v[212:215], v[36:39], a[116:119], v[212:215]
    s_add_u32 m0, s4, 98304
    ds_read_b64_tr_b16 v[26:27], v6 offset:8704
    v_mul_f32 v0, v0, v154
    v_mfma_f32_16x16x32_bf16 v[216:219], v[32:35], a[104:107], v[216:219]
    ds_read_b64_tr_b16 v[28:29], v6 offset:10240
    v_mul_f32 v1, v1, v155
    v_mfma_f32_16x16x32_bf16 v[216:219], v[36:39], a[120:123], v[216:219]
    s_add_u32 s57, s5, 3538944
    ds_read_b64_tr_b16 v[30:31], v6 offset:10752
    v_cvt_pk_bf16_f32 v121, v0, v1
    v_mfma_f32_16x16x32_bf16 v[220:223], v[32:35], a[108:111], v[220:223]
    v_fmaak_f32 v0, v140, v140, 0x409d30fc
    v_fmaak_f32 v1, v141, v141, 0x409d30fc
    v_mfma_f32_16x16x32_bf16 v[220:223], v[36:39], a[124:127], v[220:223]
    s_waitcnt lgkmcnt(4)
    v_mul_f32 v0, v0, v140
    v_mul_f32 v1, v1, v141
    v_mfma_f32_16x16x32_bf16 v[224:227], v[40:43], a[96:99], v[224:227]
    ds_read_b64_tr_b16 v[32:33], v5 offset:16384
    v_mfma_f32_16x16x32_bf16 v[224:227], v[44:47], a[112:115], v[224:227]
    buffer_load_dwordx4 v22, s[40:43], s57 offen offset:0 sc1 lds
    v_mfma_f32_16x16x32_bf16 v[228:231], v[40:43], a[100:103], v[228:231]
    ds_read_b64_tr_b16 v[34:35], v5 offset:16896
    v_mfma_f32_16x16x32_bf16 v[228:231], v[44:47], a[116:119], v[228:231]
    buffer_load_dwordx4 v22, s[40:43], s57 offen offset:1024 sc1 lds
    v_mfma_f32_16x16x32_bf16 v[232:235], v[40:43], a[104:107], v[232:235]
    ds_read_b64_tr_b16 v[36:37], v5 offset:18432
    v_mfma_f32_16x16x32_bf16 v[232:235], v[44:47], a[120:123], v[232:235]
    buffer_load_dwordx4 v22, s[40:43], s57 offen offset:2048 sc1 lds
    v_mfma_f32_16x16x32_bf16 v[236:239], v[40:43], a[108:111], v[236:239]
    v_exp_f32 v0, v0
    v_mfma_f32_16x16x32_bf16 v[236:239], v[44:47], a[124:127], v[236:239]
    s_waitcnt lgkmcnt(3)
    ds_read_b64_tr_b16 v[38:39], v5 offset:18944
    v_mfma_f32_16x16x32_bf16 v[240:243], v[24:27], a[96:99], v[240:243]
    v_exp_f32 v1, v1
    v_mfma_f32_16x16x32_bf16 v[240:243], v[28:31], a[112:115], v[240:243]
    buffer_load_dwordx4 v22, s[40:43], s57 offen offset:3072 sc1 lds
    v_mfma_f32_16x16x32_bf16 v[244:247], v[24:27], a[100:103], v[244:247]
    ds_read_b64_tr_b16 v[40:41], v5 offset:24576
    v_mul_f32 v156, v140, v156
    v_mfma_f32_16x16x32_bf16 v[244:247], v[28:31], a[116:119], v[244:247]
    s_add_u32 m0, s4, 102400
    ds_read_b64_tr_b16 v[42:43], v5 offset:25088
    v_fma_f32 v0, v0, s50, s50
    v_mfma_f32_16x16x32_bf16 v[248:251], v[24:27], a[104:107], v[248:251]
    ds_read_b64_tr_b16 v[44:45], v5 offset:26624
    v_fma_f32 v1, v1, s50, s50
    v_mfma_f32_16x16x32_bf16 v[248:251], v[28:31], a[120:123], v[248:251]
    s_add_u32 s57, s5, 3543040
    v_rcp_f32 v0, v0
    v_mfma_f32_16x16x32_bf16 v[252:255], v[24:27], a[108:111], v[252:255]
    v_rcp_f32 v1, v1
    v_mfma_f32_16x16x32_bf16 v[252:255], v[28:31], a[124:127], v[252:255]
    s_waitcnt lgkmcnt(3)
    ds_read_b64_tr_b16 v[46:47], v5 offset:27136
    v_mul_f32 v157, v141, v157
    v_mfma_f32_16x16x32_bf16 v[192:195], v[32:35], a[128:131], v[192:195]
    ds_read_b64_tr_b16 v[24:25], v6 offset:16384
    v_mul_f32 v0, v0, v156
    v_mfma_f32_16x16x32_bf16 v[192:195], v[36:39], a[144:147], v[192:195]
    buffer_load_dwordx4 v22, s[40:43], s57 offen offset:0 sc1 lds
    v_mfma_f32_16x16x32_bf16 v[196:199], v[32:35], a[132:135], v[196:199]
    v_mul_f32 v1, v1, v157
    v_cvt_pk_bf16_f32 v124, v0, v1
    v_mfma_f32_16x16x32_bf16 v[196:199], v[36:39], a[148:151], v[196:199]
    buffer_load_dwordx4 v22, s[40:43], s57 offen offset:1024 sc1 lds
    v_mfma_f32_16x16x32_bf16 v[200:203], v[32:35], a[136:139], v[200:203]
    ds_read_b64_tr_b16 v[26:27], v6 offset:16896
    v_fmaak_f32 v0, v142, v142, 0x409d30fc
    v_mfma_f32_16x16x32_bf16 v[200:203], v[36:39], a[152:155], v[200:203]
    buffer_load_dwordx4 v22, s[40:43], s57 offen offset:2048 sc1 lds
    v_mfma_f32_16x16x32_bf16 v[204:207], v[32:35], a[140:143], v[204:207]
    ds_read_b64_tr_b16 v[28:29], v6 offset:18432
    v_fmaak_f32 v1, v143, v143, 0x409d30fc
    v_mfma_f32_16x16x32_bf16 v[204:207], v[36:39], a[156:159], v[204:207]
    s_waitcnt lgkmcnt(3)
    ds_read_b64_tr_b16 v[30:31], v6 offset:18944
    v_mul_f32 v0, v0, v142
    v_mfma_f32_16x16x32_bf16 v[208:211], v[40:43], a[128:131], v[208:211]
    ds_read_b64_tr_b16 v[32:33], v6 offset:24576
    v_mul_f32 v1, v1, v143
    v_mfma_f32_16x16x32_bf16 v[208:211], v[44:47], a[144:147], v[208:211]
    buffer_load_dwordx4 v22, s[40:43], s57 offen offset:3072 sc1 lds
    v_mfma_f32_16x16x32_bf16 v[212:215], v[40:43], a[132:135], v[212:215]
    v_exp_f32 v0, v0
    v_mfma_f32_16x16x32_bf16 v[212:215], v[44:47], a[148:151], v[212:215]
    s_add_u32 m0, s4, 106496
    v_exp_f32 v1, v1
    v_mfma_f32_16x16x32_bf16 v[216:219], v[40:43], a[136:139], v[216:219]
    ds_read_b64_tr_b16 v[34:35], v6 offset:25088
    v_mul_f32 v158, v142, v158
    v_mfma_f32_16x16x32_bf16 v[216:219], v[44:47], a[152:155], v[216:219]
    s_add_u32 s57, s5, 3547136
    ds_read_b64_tr_b16 v[36:37], v6 offset:26624
    v_fma_f32 v0, v0, s50, s50
    v_mfma_f32_16x16x32_bf16 v[220:223], v[40:43], a[140:143], v[220:223]
    ds_read_b64_tr_b16 v[38:39], v6 offset:27136
    v_fma_f32 v1, v1, s50, s50
    v_mfma_f32_16x16x32_bf16 v[220:223], v[44:47], a[156:159], v[220:223]
    s_waitcnt lgkmcnt(4)
    v_rcp_f32 v0, v0
    v_mfma_f32_16x16x32_bf16 v[224:227], v[24:27], a[128:131], v[224:227]
    v_rcp_f32 v1, v1
    v_mfma_f32_16x16x32_bf16 v[224:227], v[28:31], a[144:147], v[224:227]
    buffer_load_dwordx4 v22, s[40:43], s57 offen offset:0 sc1 lds
    v_mfma_f32_16x16x32_bf16 v[228:231], v[24:27], a[132:135], v[228:231]
    ds_read_b64_tr_b16 v[40:41], v5 offset:32768
    v_mul_f32 v159, v143, v159
    v_mfma_f32_16x16x32_bf16 v[228:231], v[28:31], a[148:151], v[228:231]
    buffer_load_dwordx4 v22, s[40:43], s57 offen offset:1024 sc1 lds
    v_mfma_f32_16x16x32_bf16 v[232:235], v[24:27], a[136:139], v[232:235]
    ds_read_b64_tr_b16 v[42:43], v5 offset:33280
    v_mul_f32 v0, v0, v158
    v_mfma_f32_16x16x32_bf16 v[232:235], v[28:31], a[152:155], v[232:235]
    buffer_load_dwordx4 v22, s[40:43], s57 offen offset:2048 sc1 lds
    v_mfma_f32_16x16x32_bf16 v[236:239], v[24:27], a[140:143], v[236:239]
    ds_read_b64_tr_b16 v[44:45], v5 offset:34816
    v_mul_f32 v1, v1, v159
    v_mfma_f32_16x16x32_bf16 v[236:239], v[28:31], a[156:159], v[236:239]
    s_waitcnt lgkmcnt(3)
    ds_read_b64_tr_b16 v[46:47], v5 offset:35328
    v_cvt_pk_bf16_f32 v125, v0, v1
    v_mfma_f32_16x16x32_bf16 v[240:243], v[32:35], a[128:131], v[240:243]
    ds_read_b64_tr_b16 v[24:25], v5 offset:40960
    v_fmaak_f32 v0, v160, v160, 0x409d30fc
    v_mfma_f32_16x16x32_bf16 v[240:243], v[36:39], a[144:147], v[240:243]
    buffer_load_dwordx4 v22, s[40:43], s57 offen offset:3072 sc1 lds
    v_mfma_f32_16x16x32_bf16 v[244:247], v[32:35], a[132:135], v[244:247]
    ds_read_b64_tr_b16 v[26:27], v5 offset:41472
    v_fmaak_f32 v1, v161, v161, 0x409d30fc
    v_mfma_f32_16x16x32_bf16 v[244:247], v[36:39], a[148:151], v[244:247]
    s_add_u32 m0, s4, 110592
    ds_read_b64_tr_b16 v[28:29], v5 offset:43008
    v_mul_f32 v0, v0, v160
    v_mfma_f32_16x16x32_bf16 v[248:251], v[32:35], a[136:139], v[248:251]
    ds_read_b64_tr_b16 v[30:31], v5 offset:43520
    v_mul_f32 v1, v1, v161
    v_mfma_f32_16x16x32_bf16 v[248:251], v[36:39], a[152:155], v[248:251]
    s_add_u32 s57, s5, 3551232
    v_exp_f32 v0, v0
    v_mfma_f32_16x16x32_bf16 v[252:255], v[32:35], a[140:143], v[252:255]
    v_exp_f32 v1, v1
    v_mfma_f32_16x16x32_bf16 v[252:255], v[36:39], a[156:159], v[252:255]
    s_waitcnt lgkmcnt(4)
    v_mul_f32 v176, v160, v176
    v_fma_f32 v0, v0, s50, s50
    v_mfma_f32_16x16x32_bf16 v[192:195], v[40:43], a[160:163], v[192:195]
    ds_read_b64_tr_b16 v[32:33], v6 offset:32768
    v_fma_f32 v1, v1, s50, s50
    v_mfma_f32_16x16x32_bf16 v[192:195], v[44:47], a[176:179], v[192:195]
    buffer_load_dwordx4 v22, s[40:43], s57 offen offset:0 sc1 lds
    v_mfma_f32_16x16x32_bf16 v[196:199], v[40:43], a[164:167], v[196:199]
    ds_read_b64_tr_b16 v[34:35], v6 offset:33280
    v_mfma_f32_16x16x32_bf16 v[196:199], v[44:47], a[180:183], v[196:199]
    buffer_load_dwordx4 v22, s[40:43], s57 offen offset:1024 sc1 lds
    v_mfma_f32_16x16x32_bf16 v[200:203], v[40:43], a[168:171], v[200:203]
    v_rcp_f32 v0, v0
    v_mfma_f32_16x16x32_bf16 v[200:203], v[44:47], a[184:187], v[200:203]
    s_add_u32 s32, s32, s19
    ds_read_b64_tr_b16 v[36:37], v6 offset:34816
    s_addc_u32 s33, s33, 0
    v_mfma_f32_16x16x32_bf16 v[204:207], v[40:43], a[172:175], v[204:207]
    v_rcp_f32 v1, v1
    v_mfma_f32_16x16x32_bf16 v[204:207], v[44:47], a[188:191], v[204:207]
    s_waitcnt lgkmcnt(3)
    ds_read_b64_tr_b16 v[38:39], v6 offset:35328
    v_mul_f32 v177, v161, v177
    v_mfma_f32_16x16x32_bf16 v[208:211], v[24:27], a[160:163], v[208:211]
    s_sub_u32 s34, s34, s19
    ds_read_b64_tr_b16 v[40:41], v6 offset:40960
    v_mul_f32 v0, v0, v176
    v_mfma_f32_16x16x32_bf16 v[208:211], v[28:31], a[176:179], v[208:211]
    ds_read_b64_tr_b16 v[42:43], v6 offset:41472
    v_mul_f32 v1, v1, v177
    v_mfma_f32_16x16x32_bf16 v[212:215], v[24:27], a[164:167], v[212:215]
    ds_read_b64_tr_b16 v[44:45], v6 offset:43008
    v_cvt_pk_bf16_f32 v114, v0, v1
    v_mfma_f32_16x16x32_bf16 v[212:215], v[28:31], a[180:183], v[212:215]
    ds_read_b64_tr_b16 v[46:47], v6 offset:43520
    v_fmaak_f32 v0, v162, v162, 0x409d30fc
    v_mfma_f32_16x16x32_bf16 v[216:219], v[24:27], a[168:171], v[216:219]
    v_fmaak_f32 v1, v163, v163, 0x409d30fc
    v_mul_f32 v0, v0, v162
    v_mfma_f32_16x16x32_bf16 v[216:219], v[28:31], a[184:187], v[216:219]
    v_mul_f32 v1, v1, v163
    v_mfma_f32_16x16x32_bf16 v[220:223], v[24:27], a[172:175], v[220:223]
    v_exp_f32 v0, v0
    v_mfma_f32_16x16x32_bf16 v[220:223], v[28:31], a[188:191], v[220:223]
    s_waitcnt vmcnt(17) lgkmcnt(0)
    v_exp_f32 v1, v1
    v_mfma_f32_16x16x32_bf16 v[224:227], v[32:35], a[160:163], v[224:227]
    s_barrier
    v_mfma_f32_16x16x32_bf16 v[224:227], v[36:39], a[176:179], v[224:227]
    v_add_u32 v5, 49152, v5
    v_mul_f32 v178, v162, v178
    v_mfma_f32_16x16x32_bf16 v[228:231], v[32:35], a[164:167], v[228:231]
    s_add_u32 m0, s86, 0
    ds_read_b64_tr_b16 v[24:25], v5 offset:0
    v_fma_f32 v0, v0, s50, s50
    v_mfma_f32_16x16x32_bf16 v[228:231], v[36:39], a[180:183], v[228:231]
    ds_read_b64_tr_b16 v[26:27], v5 offset:512
    v_fma_f32 v1, v1, s50, s50
    v_mfma_f32_16x16x32_bf16 v[232:235], v[32:35], a[168:171], v[232:235]
    ds_read_b64_tr_b16 v[28:29], v5 offset:2048
    v_mfma_f32_16x16x32_bf16 v[232:235], v[36:39], a[184:187], v[232:235]
    buffer_load_dwordx4 v21, s[32:35], s64 offen offset:0 lds
    v_mfma_f32_16x16x32_bf16 v[236:239], v[32:35], a[172:175], v[236:239]
    ds_read_b64_tr_b16 v[30:31], v5 offset:2560
    v_mfma_f32_16x16x32_bf16 v[236:239], v[36:39], a[188:191], v[236:239]
    v_rcp_f32 v0, v0
    v_mfma_f32_16x16x32_bf16 v[240:243], v[40:43], a[160:163], v[240:243]
    v_rcp_f32 v1, v1
    v_mfma_f32_16x16x32_bf16 v[240:243], v[44:47], a[176:179], v[240:243]
    buffer_load_dwordx4 v21, s[32:35], s66 offen offset:2048 lds
    v_mfma_f32_16x16x32_bf16 v[244:247], v[40:43], a[164:167], v[244:247]
    ds_read_b64_tr_b16 v[32:33], v5 offset:8192
    v_mul_f32 v179, v163, v179
    v_mfma_f32_16x16x32_bf16 v[244:247], v[44:47], a[180:183], v[244:247]
    ds_read_b64_tr_b16 v[34:35], v5 offset:8704
    v_mul_f32 v0, v0, v178
    v_mfma_f32_16x16x32_bf16 v[248:251], v[40:43], a[168:171], v[248:251]
    ds_read_b64_tr_b16 v[36:37], v5 offset:10240
    v_mul_f32 v1, v1, v179
    v_mfma_f32_16x16x32_bf16 v[248:251], v[44:47], a[184:187], v[248:251]
    ds_read_b64_tr_b16 v[38:39], v5 offset:10752
    v_cvt_pk_bf16_f32 v115, v0, v1
    v_mfma_f32_16x16x32_bf16 v[252:255], v[40:43], a[172:175], v[252:255]
    s_add_u32 m0, s86, 4096
    v_fmaak_f32 v0, v164, v164, 0x409d30fc
    v_fmaak_f32 v1, v165, v165, 0x409d30fc
    v_mfma_f32_16x16x32_bf16 v[252:255], v[44:47], a[188:191], v[252:255]
    s_waitcnt lgkmcnt(4)
    v_mul_f32 v0, v0, v164
    v_mul_f32 v1, v1, v165
    v_mfma_f32_16x16x32_bf16 v[192:195], v[24:27], a[192:195], v[192:195]
    v_exp_f32 v0, v0
    v_mfma_f32_16x16x32_bf16 v[192:195], v[28:31], a[208:211], v[192:195]
    v_exp_f32 v1, v1
    v_mfma_f32_16x16x32_bf16 v[196:199], v[24:27], a[196:199], v[196:199]
    v_add_u32 v6, 49152, v6
    v_mul_f32 v180, v164, v180
    v_mfma_f32_16x16x32_bf16 v[196:199], v[28:31], a[212:215], v[196:199]
    ds_read_b64_tr_b16 v[40:41], v6 offset:0
    v_fma_f32 v0, v0, s50, s50
    v_mfma_f32_16x16x32_bf16 v[200:203], v[24:27], a[200:203], v[200:203]
    ds_read_b64_tr_b16 v[42:43], v6 offset:512
    v_fma_f32 v1, v1, s50, s50
    v_mfma_f32_16x16x32_bf16 v[200:203], v[28:31], a[216:219], v[200:203]
    buffer_load_dwordx4 v21, s[32:35], s68 offen offset:0 lds
    v_mfma_f32_16x16x32_bf16 v[204:207], v[24:27], a[204:207], v[204:207]
    ds_read_b64_tr_b16 v[44:45], v6 offset:2048
    v_mfma_f32_16x16x32_bf16 v[204:207], v[28:31], a[220:223], v[204:207]
    s_waitcnt lgkmcnt(3)
    ds_read_b64_tr_b16 v[46:47], v6 offset:2560
    v_mfma_f32_16x16x32_bf16 v[208:211], v[32:35], a[192:195], v[208:211]
    v_rcp_f32 v0, v0
    v_mfma_f32_16x16x32_bf16 v[208:211], v[36:39], a[208:211], v[208:211]
    buffer_load_dwordx4 v21, s[32:35], s70 offen offset:2048 lds
    v_mfma_f32_16x16x32_bf16 v[212:215], v[32:35], a[196:199], v[212:215]
    v_rcp_f32 v1, v1
    v_mfma_f32_16x16x32_bf16 v[212:215], v[36:39], a[212:215], v[212:215]
    ds_read_b64_tr_b16 v[24:25], v6 offset:8192
    v_mul_f32 v181, v165, v181
    v_mfma_f32_16x16x32_bf16 v[216:219], v[32:35], a[200:203], v[216:219]
    ds_read_b64_tr_b16 v[26:27], v6 offset:8704
    v_mul_f32 v0, v0, v180
    v_mfma_f32_16x16x32_bf16 v[216:219], v[36:39], a[216:219], v[216:219]
    s_add_u32 m0, s86, 8192
    ds_read_b64_tr_b16 v[28:29], v6 offset:10240
    v_mul_f32 v1, v1, v181
    v_mfma_f32_16x16x32_bf16 v[220:223], v[32:35], a[204:207], v[220:223]
    ds_read_b64_tr_b16 v[30:31], v6 offset:10752
    v_cvt_pk_bf16_f32 v118, v0, v1
    v_mfma_f32_16x16x32_bf16 v[220:223], v[36:39], a[220:223], v[220:223]
    s_waitcnt lgkmcnt(4)
    v_fmaak_f32 v0, v166, v166, 0x409d30fc
    v_fmaak_f32 v1, v167, v167, 0x409d30fc
    v_mfma_f32_16x16x32_bf16 v[224:227], v[40:43], a[192:195], v[224:227]
    ds_read_b64_tr_b16 v[32:33], v5 offset:16384
    v_mul_f32 v0, v0, v166
    v_mfma_f32_16x16x32_bf16 v[224:227], v[44:47], a[208:211], v[224:227]
    buffer_load_dwordx4 v21, s[32:35], s72 offen offset:0 lds
    v_mfma_f32_16x16x32_bf16 v[228:231], v[40:43], a[196:199], v[228:231]
    ds_read_b64_tr_b16 v[34:35], v5 offset:16896
    v_mul_f32 v1, v1, v167
    v_mfma_f32_16x16x32_bf16 v[228:231], v[44:47], a[212:215], v[228:231]
    v_exp_f32 v0, v0
    v_mfma_f32_16x16x32_bf16 v[232:235], v[40:43], a[200:203], v[232:235]
    v_exp_f32 v1, v1
    v_mfma_f32_16x16x32_bf16 v[232:235], v[44:47], a[216:219], v[232:235]
    ds_read_b64_tr_b16 v[36:37], v5 offset:18432
    v_mul_f32 v182, v166, v182
    v_mfma_f32_16x16x32_bf16 v[236:239], v[40:43], a[204:207], v[236:239]
    ds_read_b64_tr_b16 v[38:39], v5 offset:18944
    v_fma_f32 v0, v0, s50, s50
    v_mfma_f32_16x16x32_bf16 v[236:239], v[44:47], a[220:223], v[236:239]
    s_waitcnt lgkmcnt(4)
    buffer_load_dwordx4 v21, s[32:35], s74 offen offset:2048 lds
    v_mfma_f32_16x16x32_bf16 v[240:243], v[24:27], a[192:195], v[240:243]
    ds_read_b64_tr_b16 v[40:41], v5 offset:24576
    v_fma_f32 v1, v1, s50, s50
    v_mfma_f32_16x16x32_bf16 v[240:243], v[28:31], a[208:211], v[240:243]
    v_rcp_f32 v0, v0
    v_mfma_f32_16x16x32_bf16 v[244:247], v[24:27], a[196:199], v[244:247]
    v_rcp_f32 v1, v1
    v_mfma_f32_16x16x32_bf16 v[244:247], v[28:31], a[212:215], v[244:247]
    ds_read_b64_tr_b16 v[42:43], v5 offset:25088
    v_add_u32 v21, 1769472, v21
    v_mfma_f32_16x16x32_bf16 v[248:251], v[24:27], a[200:203], v[248:251]
    ds_read_b64_tr_b16 v[44:45], v5 offset:26624
    v_mul_f32 v183, v167, v183
    v_mfma_f32_16x16x32_bf16 v[248:251], v[28:31], a[216:219], v[248:251]
    ds_read_b64_tr_b16 v[46:47], v5 offset:27136
    v_mul_f32 v0, v0, v182
    v_mfma_f32_16x16x32_bf16 v[252:255], v[24:27], a[204:207], v[252:255]
    v_mul_f32 v1, v1, v183
    v_cvt_pk_bf16_f32 v119, v0, v1
    v_mfma_f32_16x16x32_bf16 v[252:255], v[28:31], a[220:223], v[252:255]
    s_waitcnt lgkmcnt(4)
    v_fmaak_f32 v0, v168, v168, 0x409d30fc
    v_fmaak_f32 v1, v169, v169, 0x409d30fc
    v_mfma_f32_16x16x32_bf16 v[192:195], v[32:35], a[224:227], v[192:195]
    ds_read_b64_tr_b16 v[24:25], v6 offset:16384
    v_mul_f32 v0, v0, v168
    v_mfma_f32_16x16x32_bf16 v[192:195], v[36:39], a[240:243], v[192:195]
    s_add_u32 m0, s86, 24576
    ds_read_b64_tr_b16 v[26:27], v6 offset:16896
L_pgx5:
    s_cbranch_execz L_back0
    v_mul_f32 v1, v1, v169
    v_mfma_f32_16x16x32_bf16 v[196:199], v[32:35], a[228:231], v[196:199]
    v_exp_f32 v0, v0
    v_mfma_f32_16x16x32_bf16 v[196:199], v[36:39], a[244:247], v[196:199]
    v_exp_f32 v1, v1
    v_mfma_f32_16x16x32_bf16 v[200:203], v[32:35], a[232:235], v[200:203]
    ds_read_b64_tr_b16 v[28:29], v6 offset:18432
    v_mul_f32 v184, v168, v184
    v_mfma_f32_16x16x32_bf16 v[200:203], v[36:39], a[248:251], v[200:203]
    buffer_load_dwordx4 v21, s[32:35], s64 offen offset:0 lds
    v_mfma_f32_16x16x32_bf16 v[204:207], v[32:35], a[236:239], v[204:207]
    ds_read_b64_tr_b16 v[30:31], v6 offset:18944
    v_fma_f32 v0, v0, s50, s50
    v_mfma_f32_16x16x32_bf16 v[204:207], v[36:39], a[252:255], v[204:207]
    s_waitcnt lgkmcnt(4)
    v_fma_f32 v1, v1, s50, s50
    v_mfma_f32_16x16x32_bf16 v[208:211], v[40:43], a[224:227], v[208:211]
    v_rcp_f32 v0, v0
    v_mfma_f32_16x16x32_bf16 v[208:211], v[44:47], a[240:243], v[208:211]
    buffer_load_dwordx4 v21, s[32:35], s66 offen offset:2048 lds
    v_mfma_f32_16x16x32_bf16 v[212:215], v[40:43], a[228:231], v[212:215]
    v_rcp_f32 v1, v1
    v_mfma_f32_16x16x32_bf16 v[212:215], v[44:47], a[244:247], v[212:215]
    ds_read_b64_tr_b16 v[32:33], v6 offset:24576
    v_mul_f32 v185, v169, v185
    v_mfma_f32_16x16x32_bf16 v[216:219], v[40:43], a[232:235], v[216:219]
    ds_read_b64_tr_b16 v[34:35], v6 offset:25088
    v_mul_f32 v0, v0, v184
    v_mfma_f32_16x16x32_bf16 v[216:219], v[44:47], a[248:251], v[216:219]
    ds_read_b64_tr_b16 v[36:37], v6 offset:26624
    v_mul_f32 v1, v1, v185
    v_mfma_f32_16x16x32_bf16 v[220:223], v[40:43], a[236:239], v[220:223]
    s_add_u32 m0, s86, 28672
    ds_read_b64_tr_b16 v[38:39], v6 offset:27136
    v_cvt_pk_bf16_f32 v122, v0, v1
    v_mfma_f32_16x16x32_bf16 v[220:223], v[44:47], a[252:255], v[220:223]
    s_waitcnt lgkmcnt(4)
    v_fmaak_f32 v0, v170, v170, 0x409d30fc
    v_fmaak_f32 v1, v171, v171, 0x409d30fc
    v_mfma_f32_16x16x32_bf16 v[224:227], v[24:27], a[224:227], v[224:227]
    ds_read_b64_tr_b16 v[40:41], v5 offset:32768
    v_mul_f32 v0, v0, v170
    v_mfma_f32_16x16x32_bf16 v[224:227], v[28:31], a[240:243], v[224:227]
    ds_read_b64_tr_b16 v[42:43], v5 offset:33280
    v_mul_f32 v1, v1, v171
    v_mfma_f32_16x16x32_bf16 v[228:231], v[24:27], a[228:231], v[228:231]
    ds_read_b64_tr_b16 v[44:45], v5 offset:34816
    v_mfma_f32_16x16x32_bf16 v[228:231], v[28:31], a[244:247], v[228:231]
    buffer_load_dwordx4 v21, s[32:35], s68 offen offset:0 lds
    v_mfma_f32_16x16x32_bf16 v[232:235], v[24:27], a[232:235], v[232:235]
    v_exp_f32 v0, v0
    v_mfma_f32_16x16x32_bf16 v[232:235], v[28:31], a[248:251], v[232:235]
    v_exp_f32 v1, v1
    v_mfma_f32_16x16x32_bf16 v[236:239], v[24:27], a[236:239], v[236:239]
    ds_read_b64_tr_b16 v[46:47], v5 offset:35328
    v_mul_f32 v186, v170, v186
    v_mfma_f32_16x16x32_bf16 v[236:239], v[28:31], a[252:255], v[236:239]
    s_waitcnt lgkmcnt(4)
    v_fma_f32 v0, v0, s50, s50
    v_fma_f32 v1, v1, s50, s50
    v_mfma_f32_16x16x32_bf16 v[240:243], v[32:35], a[224:227], v[240:243]
    ds_read_b64_tr_b16 v[24:25], v5 offset:40960
    v_mfma_f32_16x16x32_bf16 v[240:243], v[36:39], a[240:243], v[240:243]
    buffer_load_dwordx4 v21, s[32:35], s70 offen offset:2048 lds
    v_mfma_f32_16x16x32_bf16 v[244:247], v[32:35], a[228:231], v[244:247]
    v_rcp_f32 v0, v0
    v_mfma_f32_16x16x32_bf16 v[244:247], v[36:39], a[244:247], v[244:247]
    v_rcp_f32 v1, v1
    v_mfma_f32_16x16x32_bf16 v[248:251], v[32:35], a[232:235], v[248:251]
    ds_read_b64_tr_b16 v[26:27], v5 offset:41472
    v_mul_f32 v187, v171, v187
    v_mfma_f32_16x16x32_bf16 v[248:251], v[36:39], a[248:251], v[248:251]
    s_add_u32 m0, s86, 32768
    ds_read_b64_tr_b16 v[28:29], v5 offset:43008
    v_mul_f32 v0, v0, v186
    v_mfma_f32_16x16x32_bf16 v[252:255], v[32:35], a[236:239], v[252:255]
    ds_read_b64_tr_b16 v[30:31], v5 offset:43520
    v_mul_f32 v1, v1, v187
    v_mfma_f32_16x16x32_bf16 v[252:255], v[36:39], a[252:255], v[252:255]
    s_waitcnt lgkmcnt(4)
    v_cvt_pk_bf16_f32 v123, v0, v1
    v_fmaak_f32 v0, v172, v172, 0x409d30fc
    v_mfma_f32_16x16x32_bf16 v[192:195], v[40:43], v[48:51], v[192:195]
    ds_read_b64_tr_b16 v[32:33], v6 offset:32768
    v_fmaak_f32 v1, v173, v173, 0x409d30fc
    v_mfma_f32_16x16x32_bf16 v[192:195], v[44:47], v[64:67], v[192:195]
    buffer_load_dwordx4 v21, s[32:35], s72 offen offset:0 lds
    v_mfma_f32_16x16x32_bf16 v[196:199], v[40:43], v[52:55], v[196:199]
    ds_read_b64_tr_b16 v[34:35], v6 offset:33280
    v_mul_f32 v0, v0, v172
    v_mfma_f32_16x16x32_bf16 v[196:199], v[44:47], v[68:71], v[196:199]
    ds_read_b64_tr_b16 v[36:37], v6 offset:34816
    v_mul_f32 v1, v1, v173
    v_mfma_f32_16x16x32_bf16 v[200:203], v[40:43], v[56:59], v[200:203]
    v_exp_f32 v0, v0
    v_mfma_f32_16x16x32_bf16 v[200:203], v[44:47], v[72:75], v[200:203]
    v_exp_f32 v1, v1
    v_mfma_f32_16x16x32_bf16 v[204:207], v[40:43], v[60:63], v[204:207]
    ds_read_b64_tr_b16 v[38:39], v6 offset:35328
    v_mul_f32 v188, v172, v188
    v_mfma_f32_16x16x32_bf16 v[204:207], v[44:47], v[76:79], v[204:207]
    s_waitcnt lgkmcnt(4)
    buffer_load_dwordx4 v21, s[32:35], s74 offen offset:2048 lds
    v_mfma_f32_16x16x32_bf16 v[208:211], v[24:27], v[48:51], v[208:211]
    ds_read_b64_tr_b16 v[40:41], v6 offset:40960
    ds_read_b64_tr_b16 v[42:43], v6 offset:41472
    v_mfma_f32_16x16x32_bf16 v[208:211], v[28:31], v[64:67], v[208:211]
    ds_read_b64_tr_b16 v[44:45], v6 offset:43008
    v_fma_f32 v0, v0, s50, s50
    v_mfma_f32_16x16x32_bf16 v[212:215], v[24:27], v[52:55], v[212:215]
    ds_read_b64_tr_b16 v[46:47], v6 offset:43520
    v_fma_f32 v1, v1, s50, s50
    v_mfma_f32_16x16x32_bf16 v[212:215], v[28:31], v[68:71], v[212:215]
    v_rcp_f32 v0, v0
    v_mfma_f32_16x16x32_bf16 v[216:219], v[24:27], v[56:59], v[216:219]
    v_rcp_f32 v1, v1
    v_mfma_f32_16x16x32_bf16 v[216:219], v[28:31], v[72:75], v[216:219]
    v_mul_f32 v189, v173, v189
    v_mul_f32 v0, v0, v188
    v_mfma_f32_16x16x32_bf16 v[220:223], v[24:27], v[60:63], v[220:223]
    v_mul_f32 v1, v1, v189
    v_cvt_pk_bf16_f32 v126, v0, v1
    v_mfma_f32_16x16x32_bf16 v[220:223], v[28:31], v[76:79], v[220:223]
    s_waitcnt vmcnt(12) lgkmcnt(0)
    v_fmaak_f32 v0, v174, v174, 0x409d30fc
    v_fmaak_f32 v1, v175, v175, 0x409d30fc
    v_mfma_f32_16x16x32_bf16 v[224:227], v[32:35], v[48:51], v[224:227]
    s_barrier
    v_mfma_f32_16x16x32_bf16 v[224:227], v[36:39], v[64:67], v[224:227]
    global_load_dwordx4 v[4:7], v22, s[0:1] offset:1024
    v_mfma_f32_16x16x32_bf16 v[228:231], v[32:35], v[52:55], v[228:231]
    v_add_u32 v2, 98304, v22
    v_mul_f32 v0, v0, v174
    v_mfma_f32_16x16x32_bf16 v[228:231], v[36:39], v[68:71], v[228:231]
    ds_read_b128 v[24:27], v2 offset:0
    v_add_u32 v21, 1769472, v21
    v_mfma_f32_16x16x32_bf16 v[232:235], v[32:35], v[56:59], v[232:235]
    ds_read_b128 v[28:31], v2 offset:3072
    v_mul_f32 v1, v1, v175
    v_mfma_f32_16x16x32_bf16 v[232:235], v[36:39], v[72:75], v[232:235]
    v_exp_f32 v0, v0
    v_mfma_f32_16x16x32_bf16 v[236:239], v[32:35], v[60:63], v[236:239]
    s_add_u32 m0, s86, 49152
    v_exp_f32 v1, v1
    v_mfma_f32_16x16x32_bf16 v[236:239], v[36:39], v[76:79], v[236:239]
    v_mul_f32 v190, v174, v190
    v_fma_f32 v0, v0, s50, s50
    v_mfma_f32_16x16x32_bf16 v[240:243], v[40:43], v[48:51], v[240:243]
    ds_read_b128 v[32:35], v2 offset:1024
    v_fma_f32 v1, v1, s50, s50
    v_mfma_f32_16x16x32_bf16 v[240:243], v[44:47], v[64:67], v[240:243]
    buffer_load_dwordx4 v21, s[32:35], s64 offen offset:0 lds
    v_mfma_f32_16x16x32_bf16 v[244:247], v[40:43], v[52:55], v[244:247]
    ds_read_b128 v[36:39], v2 offset:4096
    v_mfma_f32_16x16x32_bf16 v[244:247], v[44:47], v[68:71], v[244:247]
    v_rcp_f32 v0, v0
    v_mfma_f32_16x16x32_bf16 v[248:251], v[40:43], v[56:59], v[248:251]
    v_rcp_f32 v1, v1
    v_mfma_f32_16x16x32_bf16 v[248:251], v[44:47], v[72:75], v[248:251]
    buffer_load_dwordx4 v21, s[32:35], s66 offen offset:2048 lds
    v_mfma_f32_16x16x32_bf16 v[252:255], v[40:43], v[60:63], v[252:255]
    v_mul_f32 v191, v175, v191
    v_mul_f32 v0, v0, v190
    v_mfma_f32_16x16x32_bf16 v[252:255], v[44:47], v[76:79], v[252:255]
    s_waitcnt lgkmcnt(2)
    v_mul_f32 v1, v1, v191
    v_cvt_pk_bf16_f32 v127, v0, v1
    v_mfma_f32_16x16x32_bf16 v[160:163], v[24:27], a[0:3], 0
    ds_read_b128 v[40:43], v2 offset:2048
    v_mfma_f32_16x16x32_bf16 v[160:163], v[28:31], a[16:19], v[160:163]
    s_add_u32 m0, s86, 53248
    ds_read_b128 v[44:47], v2 offset:5120
    v_mfma_f32_16x16x32_bf16 v[164:167], v[24:27], a[4:7], 0
    v_mfma_f32_16x16x32_bf16 v[164:167], v[28:31], a[20:23], v[164:167]
    s_waitcnt lgkmcnt(2)
    v_mfma_f32_16x16x32_bf16 v[168:171], v[32:35], a[0:3], 0
    ds_read_b128 v[24:27], v2 offset:6144
    v_fmaak_f32 v0, v192, v192, 0x409d30fc
    v_fmaak_f32 v1, v193, v193, 0x409d30fc
    v_mfma_f32_16x16x32_bf16 v[168:171], v[36:39], a[16:19], v[168:171]
    buffer_load_dwordx4 v21, s[32:35], s68 offen offset:0 lds
    v_mfma_f32_16x16x32_bf16 v[172:175], v[32:35], a[4:7], 0
    v_mul_f32 v0, v0, v192
    v_mul_f32 v1, v1, v193
    v_mfma_f32_16x16x32_bf16 v[172:175], v[36:39], a[20:23], v[172:175]
    s_waitcnt lgkmcnt(1)
    ds_read_b128 v[28:31], v2 offset:9216
    buffer_load_dwordx4 v21, s[32:35], s70 offen offset:2048 lds
    v_mfma_f32_16x16x32_bf16 v[176:179], v[40:43], a[0:3], 0
    ds_read_b128 v[32:35], v2 offset:7168
    v_exp_f32 v0, v0
    v_mfma_f32_16x16x32_bf16 v[176:179], v[44:47], a[16:19], v[176:179]
    ds_read_b128 v[36:39], v2 offset:10240
    v_exp_f32 v1, v1
    v_mfma_f32_16x16x32_bf16 v[180:183], v[40:43], a[4:7], 0
    s_add_u32 m0, s86, 57344
    v_mul_f32 v208, v192, v208
    v_fma_f32 v0, v0, s50, s50
    v_mfma_f32_16x16x32_bf16 v[180:183], v[44:47], a[20:23], v[180:183]
    s_waitcnt lgkmcnt(2)
    v_fma_f32 v1, v1, s50, s50
    v_rcp_f32 v0, v0
    v_mfma_f32_16x16x32_bf16 v[160:163], v[24:27], a[32:35], v[160:163]
    ds_read_b128 v[40:43], v2 offset:8192
    v_rcp_f32 v1, v1
    v_mfma_f32_16x16x32_bf16 v[160:163], v[28:31], a[48:51], v[160:163]
    buffer_load_dwordx4 v21, s[32:35], s72 offen offset:0 lds
    v_mfma_f32_16x16x32_bf16 v[164:167], v[24:27], a[36:39], v[164:167]
    ds_read_b128 v[44:47], v2 offset:11264
    v_mul_f32 v209, v193, v209
    v_mul_f32 v0, v0, v208
    v_mfma_f32_16x16x32_bf16 v[164:167], v[28:31], a[52:55], v[164:167]
    s_waitcnt lgkmcnt(2)
    v_mul_f32 v1, v1, v209
    v_cvt_pk_bf16_f32 v192, v0, v1
    v_fmaak_f32 v0, v194, v194, 0x409d30fc
    v_mfma_f32_16x16x32_bf16 v[168:171], v[32:35], a[32:35], v[168:171]
    ds_read_b128 v[24:27], v2 offset:12288
    v_fmaak_f32 v1, v195, v195, 0x409d30fc
    v_mfma_f32_16x16x32_bf16 v[168:171], v[36:39], a[48:51], v[168:171]
    buffer_load_dwordx4 v21, s[32:35], s74 offen offset:2048 lds
    v_mul_f32 v0, v0, v194
    v_mfma_f32_16x16x32_bf16 v[172:175], v[32:35], a[36:39], v[172:175]
    ds_read_b128 v[28:31], v2 offset:15360
    v_mul_f32 v1, v1, v195
    v_mfma_f32_16x16x32_bf16 v[172:175], v[36:39], a[52:55], v[172:175]
    s_waitcnt lgkmcnt(2)
    v_exp_f32 v0, v0
    v_exp_f32 v1, v1
    v_mfma_f32_16x16x32_bf16 v[176:179], v[40:43], a[32:35], v[176:179]
    ds_read_b128 v[32:35], v2 offset:13312
    v_mul_f32 v210, v194, v210
    v_mfma_f32_16x16x32_bf16 v[176:179], v[44:47], a[48:51], v[176:179]
    global_load_dwordx4 v[184:187], v22, s[0:1] offset:2048
    v_mfma_f32_16x16x32_bf16 v[180:183], v[40:43], a[36:39], v[180:183]
    v_fma_f32 v0, v0, s50, s50
    v_fma_f32 v1, v1, s50, s50
    v_mfma_f32_16x16x32_bf16 v[180:183], v[44:47], a[52:55], v[180:183]
    s_waitcnt lgkmcnt(1)
    ds_read_b128 v[36:39], v2 offset:16384
    global_load_dword v190, v22, s[0:1] offset:3072
    v_mfma_f32_16x16x32_bf16 v[160:163], v[24:27], a[64:67], v[160:163]
    ds_read_b128 v[40:43], v2 offset:14336
    v_rcp_f32 v0, v0
    v_mfma_f32_16x16x32_bf16 v[160:163], v[28:31], a[80:83], v[160:163]
    s_add_u32 s0, s0, 8192
    ds_read_b128 v[44:47], v2 offset:17408
    s_addc_u32 s1, s1, 0
    v_rcp_f32 v1, v1
    v_mfma_f32_16x16x32_bf16 v[164:167], v[24:27], a[68:71], v[164:167]
    v_mul_f32 v211, v195, v211
    v_mul_f32 v0, v0, v210
    v_mfma_f32_16x16x32_bf16 v[164:167], v[28:31], a[84:87], v[164:167]
    s_waitcnt lgkmcnt(2)
    v_lshrrev_b32 v3, 2, v22
    v_mul_f32 v1, v1, v211
    v_mfma_f32_16x16x32_bf16 v[168:171], v[32:35], a[64:67], v[168:171]
    ds_read_b128 v[24:27], v2 offset:18432
    v_cvt_pk_bf16_f32 v193, v0, v1
    v_fmaak_f32 v0, v196, v196, 0x409d30fc
    v_mfma_f32_16x16x32_bf16 v[168:171], v[36:39], a[80:83], v[168:171]
    v_add_u32 v3, s6, v3
    v_fmaak_f32 v1, v197, v197, 0x409d30fc
    v_mfma_f32_16x16x32_bf16 v[172:175], v[32:35], a[68:71], v[172:175]
    v_mul_f32 v0, v0, v196
    v_mul_f32 v1, v1, v197
    v_mfma_f32_16x16x32_bf16 v[172:175], v[36:39], a[84:87], v[172:175]
    s_waitcnt lgkmcnt(1)
    ds_read_b128 v[28:31], v2 offset:21504
    global_load_dword v188, v3, s[0:1] offset:-4096
    v_mfma_f32_16x16x32_bf16 v[176:179], v[40:43], a[64:67], v[176:179]
    ds_read_b128 v[32:35], v2 offset:19456
    v_exp_f32 v0, v0
    v_mfma_f32_16x16x32_bf16 v[176:179], v[44:47], a[80:83], v[176:179]
    buffer_load_dword v20, v14, s[36:39], s82 offen offset:2048
    v_mfma_f32_16x16x32_bf16 v[180:183], v[40:43], a[68:71], v[180:183]
    ds_read_b128 v[36:39], v2 offset:22528
    v_exp_f32 v1, v1
    v_mfma_f32_16x16x32_bf16 v[180:183], v[44:47], a[84:87], v[180:183]
    s_waitcnt lgkmcnt(2)
    v_lshrrev_b32 v14, 1, v14
    v_mul_f32 v212, v196, v212
    v_fma_f32 v0, v0, s50, s50
    v_mfma_f32_16x16x32_bf16 v[160:163], v[24:27], a[96:99], v[160:163]
    ds_read_b128 v[40:43], v2 offset:20480
    v_fma_f32 v1, v1, s50, s50
    v_mfma_f32_16x16x32_bf16 v[160:163], v[28:31], a[112:115], v[160:163]
    buffer_load_dword v20, v14, s[36:39], s84 offen offset:0
    v_rcp_f32 v0, v0
    v_mfma_f32_16x16x32_bf16 v[164:167], v[24:27], a[100:103], v[164:167]
    ds_read_b128 v[44:47], v2 offset:23552
    v_rcp_f32 v1, v1
    v_mfma_f32_16x16x32_bf16 v[164:167], v[28:31], a[116:119], v[164:167]
    s_waitcnt lgkmcnt(2)
    v_mul_f32 v213, v197, v213
    v_mul_f32 v0, v0, v212
    v_mfma_f32_16x16x32_bf16 v[168:171], v[32:35], a[96:99], v[168:171]
    ds_read_b128 v[24:27], v2 offset:24576
    v_mul_f32 v1, v1, v213
    v_cvt_pk_bf16_f32 v196, v0, v1
    v_mfma_f32_16x16x32_bf16 v[168:171], v[36:39], a[112:115], v[168:171]
    buffer_load_dword v20, v16, s[28:31], 0 offen
    v_mfma_f32_16x16x32_bf16 v[172:175], v[32:35], a[100:103], v[172:175]
    ds_read_b128 v[28:31], v2 offset:27648
    v_fmaak_f32 v0, v198, v198, 0x409d30fc
    v_fmaak_f32 v1, v199, v199, 0x409d30fc
    v_mfma_f32_16x16x32_bf16 v[172:175], v[36:39], a[116:119], v[172:175]
    s_waitcnt lgkmcnt(2)
    v_mul_f32 v0, v0, v198
    v_mul_f32 v1, v1, v199
    v_mfma_f32_16x16x32_bf16 v[176:179], v[40:43], a[96:99], v[176:179]
    ds_read_b128 v[32:35], v2 offset:25600
    v_exp_f32 v0, v0
    v_mfma_f32_16x16x32_bf16 v[176:179], v[44:47], a[112:115], v[176:179]
    ds_read_b128 v[36:39], v2 offset:28672
    v_exp_f32 v1, v1
    v_mul_f32 v214, v198, v214
    v_mfma_f32_16x16x32_bf16 v[180:183], v[40:43], a[100:103], v[180:183]
    v_fma_f32 v0, v0, s50, s50
    v_fma_f32 v1, v1, s50, s50
    v_mfma_f32_16x16x32_bf16 v[180:183], v[44:47], a[116:119], v[180:183]
    s_waitcnt lgkmcnt(2)
    v_rcp_f32 v0, v0
    v_mfma_f32_16x16x32_bf16 v[160:163], v[24:27], a[128:131], v[160:163]
    ds_read_b128 v[40:43], v2 offset:26624
    v_rcp_f32 v1, v1
    v_mfma_f32_16x16x32_bf16 v[160:163], v[28:31], a[144:147], v[160:163]
    ds_read_b128 v[44:47], v2 offset:29696
    v_mul_f32 v215, v199, v215
    v_mul_f32 v0, v0, v214
    v_mul_f32 v1, v1, v215
    v_mfma_f32_16x16x32_bf16 v[164:167], v[24:27], a[132:135], v[164:167]
    v_cvt_pk_bf16_f32 v197, v0, v1
    v_fmaak_f32 v0, v200, v200, 0x409d30fc
    v_mfma_f32_16x16x32_bf16 v[164:167], v[28:31], a[148:151], v[164:167]
    s_waitcnt lgkmcnt(2)
    v_fmaak_f32 v1, v201, v201, 0x409d30fc
    v_mul_f32 v0, v0, v200
    v_mfma_f32_16x16x32_bf16 v[168:171], v[32:35], a[128:131], v[168:171]
    ds_read_b128 v[24:27], v2 offset:30720
    v_mul_f32 v1, v1, v201
    v_mfma_f32_16x16x32_bf16 v[168:171], v[36:39], a[144:147], v[168:171]
    ds_read_b128 v[28:31], v2 offset:33792
    v_exp_f32 v0, v0
    v_mfma_f32_16x16x32_bf16 v[172:175], v[32:35], a[132:135], v[172:175]
    v_exp_f32 v1, v1
    v_mul_f32 v216, v200, v216
    v_mfma_f32_16x16x32_bf16 v[172:175], v[36:39], a[148:151], v[172:175]
    s_waitcnt lgkmcnt(2)
    v_fma_f32 v0, v0, s50, s50
    v_fma_f32 v1, v1, s50, s50
    v_mfma_f32_16x16x32_bf16 v[176:179], v[40:43], a[128:131], v[176:179]
    ds_read_b128 v[32:35], v2 offset:31744
    v_rcp_f32 v0, v0
    v_mfma_f32_16x16x32_bf16 v[176:179], v[44:47], a[144:147], v[176:179]
    ds_read_b128 v[36:39], v2 offset:34816
    v_rcp_f32 v1, v1
    v_mul_f32 v217, v201, v217
    v_mfma_f32_16x16x32_bf16 v[180:183], v[40:43], a[132:135], v[180:183]
    v_mul_f32 v0, v0, v216
    v_mul_f32 v1, v1, v217
    v_mfma_f32_16x16x32_bf16 v[180:183], v[44:47], a[148:151], v[180:183]
    s_waitcnt lgkmcnt(2)
    v_cvt_pk_bf16_f32 v200, v0, v1
    v_fmaak_f32 v0, v202, v202, 0x409d30fc
    v_fmaak_f32 v1, v203, v203, 0x409d30fc
    v_mfma_f32_16x16x32_bf16 v[160:163], v[24:27], a[160:163], v[160:163]
    ds_read_b128 v[40:43], v2 offset:32768
    v_mul_f32 v0, v0, v202
    v_mfma_f32_16x16x32_bf16 v[160:163], v[28:31], a[176:179], v[160:163]
    ds_read_b128 v[44:47], v2 offset:35840
    v_mul_f32 v1, v1, v203
    v_exp_f32 v0, v0
    v_mfma_f32_16x16x32_bf16 v[164:167], v[24:27], a[164:167], v[164:167]
    v_exp_f32 v1, v1
    v_mfma_f32_16x16x32_bf16 v[164:167], v[28:31], a[180:183], v[164:167]
    s_waitcnt lgkmcnt(2)
    v_mul_f32 v218, v202, v218
    v_fma_f32 v0, v0, s50, s50
    v_fma_f32 v1, v1, s50, s50
    v_mfma_f32_16x16x32_bf16 v[168:171], v[32:35], a[160:163], v[168:171]
    ds_read_b128 v[24:27], v2 offset:36864
    v_rcp_f32 v0, v0
    v_mfma_f32_16x16x32_bf16 v[168:171], v[36:39], a[176:179], v[168:171]
    ds_read_b128 v[28:31], v2 offset:39936
    v_rcp_f32 v1, v1
    v_mfma_f32_16x16x32_bf16 v[172:175], v[32:35], a[164:167], v[172:175]
    v_mul_f32 v219, v203, v219
    v_mul_f32 v0, v0, v218
    v_mfma_f32_16x16x32_bf16 v[172:175], v[36:39], a[180:183], v[172:175]
    s_waitcnt lgkmcnt(2)
    v_mul_f32 v1, v1, v219
    v_cvt_pk_bf16_f32 v201, v0, v1
    v_mfma_f32_16x16x32_bf16 v[176:179], v[40:43], a[160:163], v[176:179]
    ds_read_b128 v[32:35], v2 offset:37888
    v_fmaak_f32 v0, v204, v204, 0x409d30fc
    v_fmaak_f32 v1, v205, v205, 0x409d30fc
    v_mfma_f32_16x16x32_bf16 v[176:179], v[44:47], a[176:179], v[176:179]
    v_mul_f32 v0, v0, v204
    v_mul_f32 v1, v1, v205
    v_mfma_f32_16x16x32_bf16 v[180:183], v[40:43], a[164:167], v[180:183]
    v_exp_f32 v0, v0
    v_mfma_f32_16x16x32_bf16 v[180:183], v[44:47], a[180:183], v[180:183]
    s_waitcnt lgkmcnt(1)
    ds_read_b128 v[36:39], v2 offset:40960
    global_load_dwordx4 v[208:211], v22, s[0:1] offset:-2048
    v_mfma_f32_16x16x32_bf16 v[160:163], v[24:27], a[192:195], v[160:163]
    ds_read_b128 v[40:43], v2 offset:38912
    v_exp_f32 v1, v1
    v_mfma_f32_16x16x32_bf16 v[160:163], v[28:31], a[208:211], v[160:163]
    ds_read_b128 v[44:47], v2 offset:41984
    v_mul_f32 v220, v204, v220
    v_fma_f32 v0, v0, s50, s50
    v_fma_f32 v1, v1, s50, s50
    v_mfma_f32_16x16x32_bf16 v[164:167], v[24:27], a[196:199], v[164:167]
    v_rcp_f32 v0, v0
    v_mfma_f32_16x16x32_bf16 v[164:167], v[28:31], a[212:215], v[164:167]
    s_waitcnt lgkmcnt(2)
    v_rcp_f32 v1, v1
    v_mfma_f32_16x16x32_bf16 v[168:171], v[32:35], a[192:195], v[168:171]
    ds_read_b128 v[24:27], v2 offset:43008
    v_mul_f32 v221, v205, v221
    v_mul_f32 v0, v0, v220
    v_mfma_f32_16x16x32_bf16 v[168:171], v[36:39], a[208:211], v[168:171]
    ds_read_b128 v[28:31], v2 offset:46080
    v_mul_f32 v1, v1, v221
    v_cvt_pk_bf16_f32 v204, v0, v1
    v_mfma_f32_16x16x32_bf16 v[172:175], v[32:35], a[196:199], v[172:175]
    v_fmaak_f32 v0, v206, v206, 0x409d30fc
    v_fmaak_f32 v1, v207, v207, 0x409d30fc
    v_mfma_f32_16x16x32_bf16 v[172:175], v[36:39], a[212:215], v[172:175]
    s_waitcnt lgkmcnt(2)
    v_mul_f32 v0, v0, v206
    v_mul_f32 v1, v1, v207
    v_mfma_f32_16x16x32_bf16 v[176:179], v[40:43], a[192:195], v[176:179]
    ds_read_b128 v[32:35], v2 offset:44032
    v_exp_f32 v0, v0
    v_mfma_f32_16x16x32_bf16 v[176:179], v[44:47], a[208:211], v[176:179]
    ds_read_b128 v[36:39], v2 offset:47104
    v_exp_f32 v1, v1
    v_mul_f32 v222, v206, v222
    v_mfma_f32_16x16x32_bf16 v[180:183], v[40:43], a[196:199], v[180:183]
    v_fma_f32 v0, v0, s50, s50
    v_fma_f32 v1, v1, s50, s50
    v_mfma_f32_16x16x32_bf16 v[180:183], v[44:47], a[212:215], v[180:183]
    s_waitcnt lgkmcnt(2)
    v_rcp_f32 v0, v0
    v_mfma_f32_16x16x32_bf16 v[160:163], v[24:27], a[224:227], v[160:163]
    ds_read_b128 v[40:43], v2 offset:45056
    v_rcp_f32 v1, v1
    v_mfma_f32_16x16x32_bf16 v[160:163], v[28:31], a[240:243], v[160:163]
    global_load_dwordx4 v[212:215], v22, s[0:1] offset:-1024
    v_mul_f32 v223, v207, v223
    v_mfma_f32_16x16x32_bf16 v[164:167], v[24:27], a[228:231], v[164:167]
    ds_read_b128 v[44:47], v2 offset:48128
    v_mul_f32 v0, v0, v222
    v_mul_f32 v1, v1, v223
    v_mfma_f32_16x16x32_bf16 v[164:167], v[28:31], a[244:247], v[164:167]
    s_waitcnt lgkmcnt(2)
    v_cvt_pk_bf16_f32 v205, v0, v1
    v_fmaak_f32 v0, v224, v224, 0x409d30fc
    v_fmaak_f32 v1, v225, v225, 0x409d30fc
    v_mfma_f32_16x16x32_bf16 v[168:171], v[32:35], a[224:227], v[168:171]
    ds_read_b128 v[24:27], v2 offset:49152
    v_mul_f32 v0, v0, v224
    v_mfma_f32_16x16x32_bf16 v[168:171], v[36:39], a[240:243], v[168:171]
    ds_read_b128 v[28:31], v2 offset:52224
    v_mul_f32 v1, v1, v225
    v_exp_f32 v0, v0
    v_mfma_f32_16x16x32_bf16 v[172:175], v[32:35], a[228:231], v[172:175]
    v_exp_f32 v1, v1
    v_mfma_f32_16x16x32_bf16 v[172:175], v[36:39], a[244:247], v[172:175]
    s_waitcnt lgkmcnt(2)
    v_mul_f32 v240, v224, v240
    v_fma_f32 v0, v0, s50, s50
    v_mfma_f32_16x16x32_bf16 v[176:179], v[40:43], a[224:227], v[176:179]
    ds_read_b128 v[32:35], v2 offset:50176
    v_fma_f32 v1, v1, s50, s50
    v_mfma_f32_16x16x32_bf16 v[176:179], v[44:47], a[240:243], v[176:179]
    ds_read_b128 v[36:39], v2 offset:53248
    v_rcp_f32 v0, v0
    v_mfma_f32_16x16x32_bf16 v[180:183], v[40:43], a[228:231], v[180:183]
    v_rcp_f32 v1, v1
    v_mul_f32 v241, v225, v241
    v_mfma_f32_16x16x32_bf16 v[180:183], v[44:47], a[244:247], v[180:183]
    s_waitcnt lgkmcnt(2)
    v_mul_f32 v0, v0, v240
    v_mul_f32 v1, v1, v241
    v_cvt_pk_bf16_f32 v194, v0, v1
    v_mfma_f32_16x16x32_bf16 v[160:163], v[24:27], v[48:51], v[160:163]
    ds_read_b128 v[40:43], v2 offset:51200
    v_fmaak_f32 v0, v226, v226, 0x409d30fc
    v_fmaak_f32 v1, v227, v227, 0x409d30fc
    v_mfma_f32_16x16x32_bf16 v[160:163], v[28:31], v[64:67], v[160:163]
    ds_read_b128 v[44:47], v2 offset:54272
    v_mul_f32 v0, v0, v226
    v_mfma_f32_16x16x32_bf16 v[164:167], v[24:27], v[52:55], v[164:167]
    v_mul_f32 v1, v1, v227
    v_exp_f32 v0, v0
    v_mfma_f32_16x16x32_bf16 v[164:167], v[28:31], v[68:71], v[164:167]
    s_waitcnt vmcnt(21) lgkmcnt(0)
    v_exp_f32 v1, v1
    v_mul_f32 v242, v226, v242
    v_mfma_f32_16x16x32_bf16 v[168:171], v[32:35], v[48:51], v[168:171]
    s_barrier
    s_waitcnt vmcnt(14)
    ds_read_b64_tr_b16 v[24:25], v5 offset:0
    v_mfma_f32_16x16x32_bf16 v[168:171], v[36:39], v[64:67], v[168:171]
    s_add_u32 m0, s85, 73728
    ds_read_b64_tr_b16 v[26:27], v5 offset:256
    v_fma_f32 v0, v0, s50, s50
    v_fma_f32 v1, v1, s50, s50
    v_mfma_f32_16x16x32_bf16 v[172:175], v[32:35], v[52:55], v[172:175]
    ds_read_b64_tr_b16 v[28:29], v5 offset:2048
    v_rcp_f32 v0, v0
    v_mfma_f32_16x16x32_bf16 v[172:175], v[36:39], v[68:71], v[172:175]
    ds_read_b64_tr_b16 v[30:31], v5 offset:2304
    v_rcp_f32 v1, v1
    v_mfma_f32_16x16x32_bf16 v[176:179], v[40:43], v[48:51], v[176:179]
    ds_read_b64_tr_b16 v[32:33], v5 offset:12288
    ds_read_b64_tr_b16 v[34:35], v5 offset:12544
    v_mul_f32 v243, v227, v243
    v_mfma_f32_16x16x32_bf16 v[176:179], v[44:47], v[64:67], v[176:179]
    ds_read_b64_tr_b16 v[36:37], v5 offset:14336
    v_mul_f32 v0, v0, v242
    v_mfma_f32_16x16x32_bf16 v[180:183], v[40:43], v[52:55], v[180:183]
    buffer_load_dwordx4 v4, s[36:39], s76 offen offset:0 lds
    v_mfma_f32_16x16x32_bf16 v[180:183], v[44:47], v[68:71], v[180:183]
    s_waitcnt lgkmcnt(3)
    ds_read_b64_tr_b16 v[38:39], v5 offset:14592
    v_mul_f32 v1, v1, v243
    v_cvt_pk_bf16_f32 v195, v0, v1
    v_mfma_f32_16x16x32_bf16 v[128:131], v[24:27], a[0:3], 0
    ds_read_b64_tr_b16 v[40:41], v5 offset:4096
    v_mfma_f32_16x16x32_bf16 v[128:131], v[28:31], a[16:19], v[128:131]
    ds_read_b64_tr_b16 v[42:43], v5 offset:4352
    v_mfma_f32_16x16x32_bf16 v[132:135], v[24:27], a[4:7], 0
    ds_read_b64_tr_b16 v[44:45], v5 offset:6144
    v_mfma_f32_16x16x32_bf16 v[132:135], v[28:31], a[20:23], v[132:135]
    ds_read_b64_tr_b16 v[46:47], v5 offset:6400
    v_mfma_f32_16x16x32_bf16 v[136:139], v[24:27], a[8:11], 0
    s_mov_b32 s58, 0xbf39be31
    s_waitcnt vmcnt(7)
    v_mul_f32 v176, v190, v176
    v_mul_f32 v177, v190, v177
    v_mfma_f32_16x16x32_bf16 v[136:139], v[28:31], a[24:27], v[136:139]
    buffer_load_dwordx4 v4, s[36:39], s77 offen offset:1024 lds
    v_mul_f32 v178, v190, v178
    v_mfma_f32_16x16x32_bf16 v[140:143], v[24:27], a[12:15], 0
    v_mul_f32 v179, v190, v179
    v_cvt_pk_bf16_f32 v176, v176, v177
    v_cvt_pk_bf16_f32 v177, v178, v179
    v_mfma_f32_16x16x32_bf16 v[140:143], v[28:31], a[28:31], v[140:143]
    s_waitcnt lgkmcnt(4)
    ds_write_b64 v187, v[176:177] offset:0
    v_mfma_f32_16x16x32_bf16 v[144:147], v[32:35], a[0:3], 0
    ds_read_b64_tr_b16 v[24:25], v5 offset:16384
    v_mul_f32 v180, v190, v180
    v_mfma_f32_16x16x32_bf16 v[144:147], v[36:39], a[16:19], v[144:147]
    ds_read_b64_tr_b16 v[26:27], v5 offset:16640
    v_mul_f32 v181, v190, v181
    v_mfma_f32_16x16x32_bf16 v[148:151], v[32:35], a[4:7], 0
    ds_read_b64_tr_b16 v[28:29], v5 offset:18432
    v_mul_f32 v182, v190, v182
    v_mul_f32 v183, v190, v183
    v_mfma_f32_16x16x32_bf16 v[148:151], v[36:39], a[20:23], v[148:151]
    buffer_load_dwordx4 v4, s[36:39], s78 offen offset:2048 lds
    v_cvt_pk_bf16_f32 v180, v180, v181
    v_mfma_f32_16x16x32_bf16 v[152:155], v[32:35], a[8:11], 0
    ds_read_b64_tr_b16 v[30:31], v5 offset:18688
    v_cvt_pk_bf16_f32 v181, v182, v183
    v_mfma_f32_16x16x32_bf16 v[152:155], v[36:39], a[24:27], v[152:155]
    ds_write_b64 v187, v[180:181] offset:1152
    v_mfma_f32_16x16x32_bf16 v[156:159], v[32:35], a[12:15], 0
    ds_read_b64 v[178:179], v184
    ds_read_b64_tr_b16 v[182:183], v185
    v_mfma_f32_16x16x32_bf16 v[156:159], v[36:39], a[28:31], v[156:159]
    s_waitcnt lgkmcnt(8)
    v_mul_f32 v160, s58, v160
    v_mul_f32 v161, s58, v161
    v_mul_f32 v162, s58, v162
    v_mfma_f32_16x16x32_bf16 v[128:131], v[40:43], a[32:35], v[128:131]
    ds_read_b64_tr_b16 v[32:33], v5 offset:8192
    v_mul_f32 v163, s58, v163
    v_cvt_pk_bf16_f32 v160, v160, v161
    v_mfma_f32_16x16x32_bf16 v[128:131], v[44:47], a[48:51], v[128:131]
    buffer_load_dwordx4 v4, s[36:39], s79 offen offset:3072 lds
    v_mfma_f32_16x16x32_bf16 v[132:135], v[40:43], a[36:39], v[132:135]
    ds_read_b64_tr_b16 v[34:35], v5 offset:8448
    v_cvt_pk_bf16_f32 v161, v162, v163
    v_mfma_f32_16x16x32_bf16 v[132:135], v[44:47], a[52:55], v[132:135]
    ds_write_b64 v186, v[160:161] offset:0
    v_mul_f32 v164, s58, v164
    v_mul_f32 v165, s58, v165
    v_mfma_f32_16x16x32_bf16 v[136:139], v[40:43], a[40:43], v[136:139]
    ds_read_b64_tr_b16 v[36:37], v5 offset:10240
    v_mul_f32 v166, s58, v166
    v_mul_f32 v167, s58, v167
    v_mfma_f32_16x16x32_bf16 v[136:139], v[44:47], a[56:59], v[136:139]
    ds_read_b64_tr_b16 v[38:39], v5 offset:10496
    v_cvt_pk_bf16_f32 v164, v164, v165
    v_cvt_pk_bf16_f32 v165, v166, v167
    v_mfma_f32_16x16x32_bf16 v[140:143], v[40:43], a[44:47], v[140:143]
    s_add_u32 m0, s85, 77824
    ds_write_b64 v186, v[164:165] offset:1152
    v_mfma_f32_16x16x32_bf16 v[140:143], v[44:47], a[60:63], v[140:143]
    s_waitcnt lgkmcnt(9)
    v_mov_b32 v176, 0x3f803f80
    s_waitcnt lgkmcnt(7)
    v_cndmask_b32 v178, v178, v179, s[100:101]
    v_mfma_f32_16x16x32_bf16 v[144:147], v[24:27], a[32:35], v[144:147]
L_pgx6:
    s_cbranch_execz L_back0
    ds_read_b64_tr_b16 v[40:41], v5 offset:20480
    v_cndmask_b32 v179, v179, v176, s[100:101]
    s_waitcnt lgkmcnt(7)
    v_cndmask_b32 v178, v178, v182, s[62:63]
    v_mfma_f32_16x16x32_bf16 v[144:147], v[28:31], a[48:51], v[144:147]
    ds_read_b64_tr_b16 v[42:43], v5 offset:20736
    v_cndmask_b32 v179, v179, v183, s[62:63]
    v_mfma_f32_16x16x32_bf16 v[148:151], v[24:27], a[36:39], v[148:151]
    ds_read_b64_tr_b16 v[44:45], v5 offset:22528
    v_cndmask_b32 v178, v178, v176, s[20:21]
    v_mfma_f32_16x16x32_bf16 v[148:151], v[28:31], a[52:55], v[148:151]
    ds_read_b64_tr_b16 v[46:47], v5 offset:22784
    v_cndmask_b32 v179, v179, v176, s[20:21]
    v_mfma_f32_16x16x32_bf16 v[152:155], v[24:27], a[40:43], v[152:155]
    buffer_load_dwordx4 v4, s[36:39], s80 offen offset:0 lds
    v_mfma_f32_16x16x32_bf16 v[152:155], v[28:31], a[56:59], v[152:155]
    s_waitcnt vmcnt(10)
    buffer_store_dwordx2 v[178:179], v188, s[40:43], s99 offen sc1
    v_mul_f32 v168, s58, v168
    v_mul_f32 v169, s58, v169
    v_mfma_f32_16x16x32_bf16 v[156:159], v[24:27], a[44:47], v[156:159]
    v_mul_f32 v170, s58, v170
    v_mul_f32 v171, s58, v171
    v_cvt_pk_bf16_f32 v168, v168, v169
    v_cvt_pk_bf16_f32 v169, v170, v171
    v_mfma_f32_16x16x32_bf16 v[156:159], v[28:31], a[60:63], v[156:159]
    s_waitcnt lgkmcnt(0)
    ds_write_b64 v186, v[168:169] offset:40
    v_mfma_f32_16x16x32_bf16 v[128:131], v[32:35], a[64:67], v[128:131]
    s_waitcnt lgkmcnt(0)
    s_barrier
    ds_read_b64_tr_b16 v[24:25], v5 offset:24576
    v_mfma_f32_16x16x32_bf16 v[128:131], v[36:39], a[80:83], v[128:131]
    ds_write_b64 v6, v[80:81] offset:0
    v_mfma_f32_16x16x32_bf16 v[132:135], v[32:35], a[68:71], v[132:135]
    ds_read_b64_tr_b16 v[26:27], v5 offset:24832
    v_mul_f32 v172, s58, v172
    v_mfma_f32_16x16x32_bf16 v[132:135], v[36:39], a[84:87], v[132:135]
    buffer_load_dwordx4 v4, s[36:39], s81 offen offset:1024 lds
    v_mul_f32 v173, s58, v173
    v_mfma_f32_16x16x32_bf16 v[136:139], v[32:35], a[72:75], v[136:139]
    ds_read_b64_tr_b16 v[28:29], v5 offset:26624
    v_mul_f32 v174, s58, v174
    v_mul_f32 v175, s58, v175
    v_mfma_f32_16x16x32_bf16 v[136:139], v[36:39], a[88:91], v[136:139]
    ds_write_b64 v6, v[82:83] offset:512
    v_mfma_f32_16x16x32_bf16 v[140:143], v[32:35], a[76:79], v[140:143]
    ds_read_b64_tr_b16 v[30:31], v5 offset:26880
    v_cvt_pk_bf16_f32 v172, v172, v173
    v_mfma_f32_16x16x32_bf16 v[140:143], v[36:39], a[92:95], v[140:143]
    ds_write_b64 v6, v[84:85] offset:1024
    v_mfma_f32_16x16x32_bf16 v[144:147], v[40:43], a[64:67], v[144:147]
    ds_read_b64_tr_b16 v[32:33], v5 offset:36864
    v_cvt_pk_bf16_f32 v173, v174, v175
    v_mfma_f32_16x16x32_bf16 v[144:147], v[44:47], a[80:83], v[144:147]
    buffer_load_dwordx4 v4, s[36:39], s82 offen offset:2048 lds
    v_mfma_f32_16x16x32_bf16 v[148:151], v[40:43], a[68:71], v[148:151]
    ds_write_b64 v186, v[172:173] offset:1192
    v_fmaak_f32 v0, v228, v228, 0x409d30fc
    v_mfma_f32_16x16x32_bf16 v[148:151], v[44:47], a[84:87], v[148:151]
    ds_write_b64 v6, v[86:87] offset:1536
    v_mfma_f32_16x16x32_bf16 v[152:155], v[40:43], a[72:75], v[152:155]
    ds_read_b64_tr_b16 v[34:35], v5 offset:37120
    v_fmaak_f32 v1, v229, v229, 0x409d30fc
    v_mul_f32 v0, v0, v228
    v_mfma_f32_16x16x32_bf16 v[152:155], v[44:47], a[88:91], v[152:155]
    ds_read_b64_tr_b16 v[36:37], v5 offset:38912
    v_mul_f32 v1, v1, v229
    v_exp_f32 v0, v0
    v_mfma_f32_16x16x32_bf16 v[156:159], v[40:43], a[76:79], v[156:159]
    ds_write_b64 v6, v[88:89] offset:2048
    v_mfma_f32_16x16x32_bf16 v[156:159], v[44:47], a[92:95], v[156:159]
    s_waitcnt lgkmcnt(7)
    ds_read_b64_tr_b16 v[38:39], v5 offset:39168
    buffer_load_dwordx4 v4, s[36:39], s83 offen offset:3072 lds
    v_mfma_f32_16x16x32_bf16 v[128:131], v[24:27], a[96:99], v[128:131]
    ds_read_b64_tr_b16 v[40:41], v5 offset:28672
    v_exp_f32 v1, v1
    v_mfma_f32_16x16x32_bf16 v[128:131], v[28:31], a[112:115], v[128:131]
    ds_write_b64 v6, v[90:91] offset:2560
    v_mfma_f32_16x16x32_bf16 v[132:135], v[24:27], a[100:103], v[132:135]
    ds_read_b64_tr_b16 v[42:43], v5 offset:28928
    v_mul_f32 v244, v228, v244
    v_fma_f32 v0, v0, s50, s50
    v_mfma_f32_16x16x32_bf16 v[132:135], v[28:31], a[116:119], v[132:135]
    ds_read_b64_tr_b16 v[44:45], v5 offset:30720
    v_fma_f32 v1, v1, s50, s50
    v_rcp_f32 v0, v0
    v_mfma_f32_16x16x32_bf16 v[136:139], v[24:27], a[104:107], v[136:139]
    ds_read_b64_tr_b16 v[46:47], v5 offset:30976
    v_rcp_f32 v1, v1
    v_mfma_f32_16x16x32_bf16 v[136:139], v[28:31], a[120:123], v[136:139]
    s_add_u32 m0, s85, 81920
    ds_write_b64 v6, v[92:93] offset:3072
    v_mfma_f32_16x16x32_bf16 v[140:143], v[24:27], a[108:111], v[140:143]
    v_mul_f32 v245, v229, v245
    v_mul_f32 v0, v0, v244
    v_mfma_f32_16x16x32_bf16 v[140:143], v[28:31], a[124:127], v[140:143]
    s_waitcnt lgkmcnt(6)
    v_mul_f32 v1, v1, v245
    v_cvt_pk_bf16_f32 v198, v0, v1
    v_mfma_f32_16x16x32_bf16 v[144:147], v[32:35], a[96:99], v[144:147]
    ds_read_b64_tr_b16 v[24:25], v5 offset:40960
    v_fmaak_f32 v0, v230, v230, 0x409d30fc
    v_fmaak_f32 v1, v231, v231, 0x409d30fc
    v_mfma_f32_16x16x32_bf16 v[144:147], v[36:39], a[112:115], v[144:147]
    ds_write_b64 v6, v[94:95] offset:3584
    v_mfma_f32_16x16x32_bf16 v[148:151], v[32:35], a[100:103], v[148:151]
    ds_read_b64_tr_b16 v[26:27], v5 offset:41216
    v_mul_f32 v0, v0, v230
    v_mul_f32 v1, v1, v231
    v_mfma_f32_16x16x32_bf16 v[148:151], v[36:39], a[116:119], v[148:151]
    buffer_load_dwordx4 v4, s[36:39], s84 offen offset:0 lds
    v_mfma_f32_16x16x32_bf16 v[152:155], v[32:35], a[104:107], v[152:155]
    ds_read_b64_tr_b16 v[28:29], v5 offset:43008
    v_exp_f32 v0, v0
    v_mfma_f32_16x16x32_bf16 v[152:155], v[36:39], a[120:123], v[152:155]
    ds_write_b64 v6, v[96:97] offset:4096
    v_mfma_f32_16x16x32_bf16 v[156:159], v[32:35], a[108:111], v[156:159]
    ds_read_b64_tr_b16 v[30:31], v5 offset:43264
    v_exp_f32 v1, v1
    v_mfma_f32_16x16x32_bf16 v[156:159], v[36:39], a[124:127], v[156:159]
    s_waitcnt lgkmcnt(7)
    ds_write_b64 v6, v[98:99] offset:4608
    v_mfma_f32_16x16x32_bf16 v[128:131], v[40:43], a[128:131], v[128:131]
    ds_read_b64_tr_b16 v[32:33], v5 offset:32768
    v_mul_f32 v246, v230, v246
    v_fma_f32 v0, v0, s50, s50
    v_mfma_f32_16x16x32_bf16 v[128:131], v[44:47], a[144:147], v[128:131]
    ds_read_b64_tr_b16 v[34:35], v5 offset:33024
    v_add_u32 v4, 128, v4
    v_fma_f32 v1, v1, s50, s50
    v_rcp_f32 v0, v0
    v_mfma_f32_16x16x32_bf16 v[132:135], v[40:43], a[132:135], v[132:135]
    ds_read_b64_tr_b16 v[36:37], v5 offset:34816
    v_rcp_f32 v1, v1
    v_mfma_f32_16x16x32_bf16 v[132:135], v[44:47], a[148:151], v[132:135]
    ds_write_b64 v6, v[100:101] offset:5120
    v_mfma_f32_16x16x32_bf16 v[136:139], v[40:43], a[136:139], v[136:139]
    ds_read_b64_tr_b16 v[38:39], v5 offset:35072
    v_mul_f32 v247, v231, v247
    v_mfma_f32_16x16x32_bf16 v[136:139], v[44:47], a[152:155], v[136:139]
    v_mul_f32 v0, v0, v246
    v_mul_f32 v1, v1, v247
    v_cvt_pk_bf16_f32 v199, v0, v1
    v_mfma_f32_16x16x32_bf16 v[140:143], v[40:43], a[140:143], v[140:143]
    s_add_u32 m0, s85, 110592
    v_fmaak_f32 v0, v232, v232, 0x409d30fc
    v_fmaak_f32 v1, v233, v233, 0x409d30fc
    v_mfma_f32_16x16x32_bf16 v[140:143], v[44:47], a[156:159], v[140:143]
    s_waitcnt lgkmcnt(6)
    ds_write_b64 v6, v[102:103] offset:5632
    v_mfma_f32_16x16x32_bf16 v[144:147], v[24:27], a[128:131], v[144:147]
    ds_read_b64_tr_b16 v[40:41], v5 offset:45056
    v_mul_f32 v0, v0, v232
    v_mfma_f32_16x16x32_bf16 v[144:147], v[28:31], a[144:147], v[144:147]
    ds_read_b64_tr_b16 v[42:43], v5 offset:45312
    v_mul_f32 v1, v1, v233
    v_exp_f32 v0, v0
    v_mfma_f32_16x16x32_bf16 v[148:151], v[24:27], a[132:135], v[148:151]
    ds_read_b64_tr_b16 v[44:45], v5 offset:47104
    v_exp_f32 v1, v1
    v_mfma_f32_16x16x32_bf16 v[148:151], v[28:31], a[148:151], v[148:151]
    ds_read_b64_tr_b16 v[46:47], v5 offset:47360
    v_mul_f32 v248, v232, v248
    v_mfma_f32_16x16x32_bf16 v[152:155], v[24:27], a[136:139], v[152:155]
    buffer_load_dwordx4 v4, s[36:39], s76 offen offset:0 lds
    v_fma_f32 v0, v0, s50, s50
    v_mfma_f32_16x16x32_bf16 v[152:155], v[28:31], a[152:155], v[152:155]
    v_fma_f32 v1, v1, s50, s50
    v_rcp_f32 v0, v0
    v_mfma_f32_16x16x32_bf16 v[156:159], v[24:27], a[140:143], v[156:159]
    v_rcp_f32 v1, v1
    v_mul_f32 v249, v233, v249
    v_mfma_f32_16x16x32_bf16 v[156:159], v[28:31], a[156:159], v[156:159]
    s_waitcnt lgkmcnt(0)
    v_mul_f32 v0, v0, v248
    v_mul_f32 v1, v1, v249
    v_cvt_pk_bf16_f32 v202, v0, v1
    v_mfma_f32_16x16x32_bf16 v[128:131], v[32:35], a[160:163], v[128:131]
    s_barrier
    v_add_u32 v5, 49152, v5
    v_mfma_f32_16x16x32_bf16 v[128:131], v[36:39], a[176:179], v[128:131]
    ds_read_b64_tr_b16 v[24:25], v5 offset:0
    ds_read_b64_tr_b16 v[26:27], v5 offset:256
    ds_read2st64_b64 a[8:11], v7 offset0:0 offset1:1
    v_mfma_f32_16x16x32_bf16 v[132:135], v[32:35], a[164:167], v[132:135]
    buffer_load_dwordx4 v4, s[36:39], s77 offen offset:1024 lds
    v_fmaak_f32 v0, v234, v234, 0x409d30fc
    v_mfma_f32_16x16x32_bf16 v[132:135], v[36:39], a[180:183], v[132:135]
    ds_write_b64 v6, v[104:105] offset:24576
    v_mfma_f32_16x16x32_bf16 v[136:139], v[32:35], a[168:171], v[136:139]
    ds_read_b64_tr_b16 v[28:29], v5 offset:2048
    v_fmaak_f32 v1, v235, v235, 0x409d30fc
    v_mul_f32 v0, v0, v234
    v_mfma_f32_16x16x32_bf16 v[136:139], v[36:39], a[184:187], v[136:139]
    ds_write_b64 v6, v[106:107] offset:25088
    v_mfma_f32_16x16x32_bf16 v[140:143], v[32:35], a[172:175], v[140:143]
    ds_read_b64_tr_b16 v[30:31], v5 offset:2304
    v_mul_f32 v1, v1, v235
    v_mfma_f32_16x16x32_bf16 v[140:143], v[36:39], a[188:191], v[140:143]
    ds_read2st64_b64 a[12:15], v7 offset0:2 offset1:3
    v_exp_f32 v0, v0
    v_mfma_f32_16x16x32_bf16 v[144:147], v[40:43], a[160:163], v[144:147]
    ds_read_b64_tr_b16 v[32:33], v5 offset:12288
    v_exp_f32 v1, v1
    v_mfma_f32_16x16x32_bf16 v[144:147], v[44:47], a[176:179], v[144:147]
    buffer_load_dwordx4 v4, s[36:39], s78 offen offset:2048 lds
    v_mul_f32 v250, v234, v250
    v_mfma_f32_16x16x32_bf16 v[148:151], v[40:43], a[164:167], v[148:151]
    ds_write_b64 v6, v[108:109] offset:25600
    v_mfma_f32_16x16x32_bf16 v[148:151], v[44:47], a[180:183], v[148:151]
    ds_write_b64 v6, v[110:111] offset:26112
    v_mfma_f32_16x16x32_bf16 v[152:155], v[40:43], a[168:171], v[152:155]
    ds_read_b64_tr_b16 v[34:35], v5 offset:12544
    v_fma_f32 v0, v0, s50, s50
    v_fma_f32 v1, v1, s50, s50
    v_mfma_f32_16x16x32_bf16 v[152:155], v[44:47], a[184:187], v[152:155]
    ds_read_b64_tr_b16 v[36:37], v5 offset:14336
    v_rcp_f32 v0, v0
    v_mfma_f32_16x16x32_bf16 v[156:159], v[40:43], a[172:175], v[156:159]
    ds_read2st64_b64 a[0:3], v7 offset0:4 offset1:5
    v_rcp_f32 v1, v1
    v_mfma_f32_16x16x32_bf16 v[156:159], v[44:47], a[188:191], v[156:159]
    s_waitcnt lgkmcnt(7)
    ds_read_b64_tr_b16 v[38:39], v5 offset:14592
    buffer_load_dwordx4 v4, s[36:39], s79 offen offset:3072 lds
    v_mfma_f32_16x16x32_bf16 v[128:131], v[24:27], a[192:195], v[128:131]
    ds_read_b64_tr_b16 v[40:41], v5 offset:4096
    v_mul_f32 v251, v235, v251
    v_mfma_f32_16x16x32_bf16 v[128:131], v[28:31], a[208:211], v[128:131]
    ds_write_b64 v6, v[112:113] offset:26624
    v_mfma_f32_16x16x32_bf16 v[132:135], v[24:27], a[196:199], v[132:135]
    ds_read_b64_tr_b16 v[42:43], v5 offset:4352
    v_mul_f32 v0, v0, v250
    v_mul_f32 v1, v1, v251
    v_mfma_f32_16x16x32_bf16 v[132:135], v[28:31], a[212:215], v[132:135]
    ds_write_b64 v6, v[114:115] offset:27136
    v_mfma_f32_16x16x32_bf16 v[136:139], v[24:27], a[200:203], v[136:139]
    ds_read_b64_tr_b16 v[44:45], v5 offset:6144
    v_cvt_pk_bf16_f32 v203, v0, v1
    v_fmaak_f32 v0, v236, v236, 0x409d30fc
    v_mfma_f32_16x16x32_bf16 v[136:139], v[28:31], a[216:219], v[136:139]
    s_add_u32 m0, s85, 114688
    ds_read2st64_b64 a[4:7], v7 offset0:6 offset1:7
    v_fmaak_f32 v1, v237, v237, 0x409d30fc
    v_mul_f32 v0, v0, v236
    v_mfma_f32_16x16x32_bf16 v[140:143], v[24:27], a[204:207], v[140:143]
    ds_read_b64_tr_b16 v[46:47], v5 offset:6400
    v_mul_f32 v1, v1, v237
    v_mfma_f32_16x16x32_bf16 v[140:143], v[28:31], a[220:223], v[140:143]
    s_waitcnt lgkmcnt(7)
    ds_write_b64 v6, v[116:117] offset:27648
    v_mfma_f32_16x16x32_bf16 v[144:147], v[32:35], a[192:195], v[144:147]
    ds_read_b64_tr_b16 v[24:25], v5 offset:16384
    v_exp_f32 v0, v0
    v_mfma_f32_16x16x32_bf16 v[144:147], v[36:39], a[208:211], v[144:147]
    ds_write_b64 v6, v[118:119] offset:28160
    v_mfma_f32_16x16x32_bf16 v[148:151], v[32:35], a[196:199], v[148:151]
    ds_read_b64_tr_b16 v[26:27], v5 offset:16640
    v_exp_f32 v1, v1
    v_mfma_f32_16x16x32_bf16 v[148:151], v[36:39], a[212:215], v[148:151]
    buffer_load_dwordx4 v4, s[36:39], s80 offen offset:0 lds
    v_mul_f32 v252, v236, v252
    v_mfma_f32_16x16x32_bf16 v[152:155], v[32:35], a[200:203], v[152:155]
    ds_read_b64_tr_b16 v[28:29], v5 offset:18432
    v_fma_f32 v0, v0, s50, s50
    v_fma_f32 v1, v1, s50, s50
    v_mfma_f32_16x16x32_bf16 v[152:155], v[36:39], a[216:219], v[152:155]
    ds_read2st64_b64 a[24:27], v7 offset0:8 offset1:9
    v_rcp_f32 v0, v0
    v_mfma_f32_16x16x32_bf16 v[156:159], v[32:35], a[204:207], v[156:159]
    ds_read_b64_tr_b16 v[30:31], v5 offset:18688
    v_rcp_f32 v1, v1
    v_mfma_f32_16x16x32_bf16 v[156:159], v[36:39], a[220:223], v[156:159]
    s_waitcnt lgkmcnt(7)
    ds_write_b64 v6, v[120:121] offset:28672
    v_mfma_f32_16x16x32_bf16 v[128:131], v[40:43], a[224:227], v[128:131]
    ds_write_b64 v6, v[122:123] offset:29184
    v_mfma_f32_16x16x32_bf16 v[128:131], v[44:47], a[240:243], v[128:131]
    buffer_load_dwordx4 v4, s[36:39], s81 offen offset:1024 lds
    v_mul_f32 v253, v237, v253
    v_mfma_f32_16x16x32_bf16 v[132:135], v[40:43], a[228:231], v[132:135]
    ds_read_b64_tr_b16 v[32:33], v5 offset:8192
    v_mul_f32 v0, v0, v252
    v_mfma_f32_16x16x32_bf16 v[132:135], v[44:47], a[244:247], v[132:135]
    ds_read2st64_b64 a[28:31], v7 offset0:10 offset1:11
    v_mul_f32 v1, v1, v253
    v_cvt_pk_bf16_f32 v206, v0, v1
    v_mfma_f32_16x16x32_bf16 v[136:139], v[40:43], a[232:235], v[136:139]
    ds_read_b64_tr_b16 v[34:35], v5 offset:8448
    v_fmaak_f32 v0, v238, v238, 0x409d30fc
    v_fmaak_f32 v1, v239, v239, 0x409d30fc
    v_mfma_f32_16x16x32_bf16 v[136:139], v[44:47], a[248:251], v[136:139]
    ds_write_b64 v6, v[124:125] offset:29696
    v_mfma_f32_16x16x32_bf16 v[140:143], v[40:43], a[236:239], v[140:143]
    ds_read_b64_tr_b16 v[36:37], v5 offset:10240
    v_mul_f32 v0, v0, v238
    v_mul_f32 v1, v1, v239
    v_mfma_f32_16x16x32_bf16 v[140:143], v[44:47], a[252:255], v[140:143]
    s_waitcnt lgkmcnt(7)
    ds_read_b64_tr_b16 v[38:39], v5 offset:10496
    buffer_load_dwordx4 v4, s[36:39], s82 offen offset:2048 lds
    v_mfma_f32_16x16x32_bf16 v[144:147], v[24:27], a[224:227], v[144:147]
    ds_read_b64_tr_b16 v[40:41], v5 offset:20480
    ds_write_b64 v6, v[126:127] offset:30208
    v_mfma_f32_16x16x32_bf16 v[144:147], v[28:31], a[240:243], v[144:147]
    ds_read_b64_tr_b16 v[42:43], v5 offset:20736
    v_exp_f32 v0, v0
    v_mfma_f32_16x16x32_bf16 v[148:151], v[24:27], a[228:231], v[148:151]
    ds_read_b64_tr_b16 v[44:45], v5 offset:22528
    v_exp_f32 v1, v1
    v_mfma_f32_16x16x32_bf16 v[148:151], v[28:31], a[244:247], v[148:151]
    ds_read_b64_tr_b16 v[46:47], v5 offset:22784
    v_mul_f32 v254, v238, v254
    v_fma_f32 v0, v0, s50, s50
    v_mfma_f32_16x16x32_bf16 v[152:155], v[24:27], a[232:235], v[152:155]
    v_fma_f32 v1, v1, s50, s50
    v_rcp_f32 v0, v0
    v_mfma_f32_16x16x32_bf16 v[152:155], v[28:31], a[248:251], v[152:155]
    buffer_load_dwordx4 v4, s[36:39], s83 offen offset:3072 lds
    v_mfma_f32_16x16x32_bf16 v[156:159], v[24:27], a[236:239], v[156:159]
    v_rcp_f32 v1, v1
    v_mul_f32 v255, v239, v255
    v_mfma_f32_16x16x32_bf16 v[156:159], v[28:31], a[252:255], v[156:159]
    s_waitcnt vmcnt(8) lgkmcnt(0)
    v_mul_f32 v0, v0, v254
    v_mul_f32 v1, v1, v255
    v_cvt_pk_bf16_f32 v207, v0, v1
    v_mfma_f32_16x16x32_bf16 v[128:131], v[32:35], v[48:51], v[128:131]
    s_barrier
    ds_read2st64_b64 a[16:19], v7 offset0:48 offset1:49
    v_mfma_f32_16x16x32_bf16 v[128:131], v[36:39], v[64:67], v[128:131]
    ds_write_b64 v6, v[192:193] offset:49152
    v_mfma_f32_16x16x32_bf16 v[132:135], v[32:35], v[52:55], v[132:135]
    ds_read_b64_tr_b16 v[24:25], v208 offset:0
    v_mov_b32 v2, s48
    v_mfma_f32_16x16x32_bf16 v[132:135], v[36:39], v[68:71], v[132:135]
    s_add_u32 m0, s85, 118784
    ds_write_b64 v6, v[194:195] offset:49664
    v_mfma_f32_16x16x32_bf16 v[136:139], v[32:35], v[56:59], v[136:139]
    ds_read_b64_tr_b16 v[26:27], v208 offset:18432
    v_mov_b32 v3, s49
    v_mfma_f32_16x16x32_bf16 v[136:139], v[36:39], v[72:75], v[136:139]
    ds_read_b64_tr_b16 v[28:29], v208 offset:2048
    ds_read2st64_b64 a[20:23], v7 offset0:50 offset1:51
    v_mfma_f32_16x16x32_bf16 v[140:143], v[32:35], v[60:63], v[140:143]
    s_add_u32 s98, s98, 4096
    ds_read_b64_tr_b16 v[30:31], v208 offset:20480
    v_mfma_f32_16x16x32_bf16 v[140:143], v[36:39], v[76:79], v[140:143]
    ds_write_b64 v6, v[196:197] offset:50176
    v_mfma_f32_16x16x32_bf16 v[144:147], v[40:43], v[48:51], v[144:147]
    ds_read_b64_tr_b16 v[32:33], v208 offset:4096
    ds_read2st64_b64 a[40:43], v7 offset0:52 offset1:53
    v_mfma_f32_16x16x32_bf16 v[144:147], v[44:47], v[64:67], v[144:147]
    buffer_load_dwordx4 v4, s[36:39], s84 offen offset:0 lds
    v_mfma_f32_16x16x32_bf16 v[148:151], v[40:43], v[52:55], v[148:151]
    buffer_store_dwordx2 v[2:3], v8, s[40:43], s98 offen offset:0 sc1
    v_mfma_f32_16x16x32_bf16 v[148:151], v[44:47], v[68:71], v[148:151]
    ds_write_b64 v6, v[198:199] offset:50688
    v_mfma_f32_16x16x32_bf16 v[152:155], v[40:43], v[56:59], v[152:155]
    ds_read_b64_tr_b16 v[34:35], v208 offset:22528
    ds_read2st64_b64 a[44:47], v7 offset0:54 offset1:55
    v_mfma_f32_16x16x32_bf16 v[152:155], v[44:47], v[72:75], v[152:155]
    ds_write_b64 v6, v[200:201] offset:51200
    v_mfma_f32_16x16x32_bf16 v[156:159], v[40:43], v[60:63], v[156:159]
    ds_read_b64_tr_b16 v[36:37], v208 offset:6144
    ds_read_b64_tr_b16 v[38:39], v208 offset:24576
    v_mfma_f32_16x16x32_bf16 v[156:159], v[44:47], v[76:79], v[156:159]
    s_waitcnt lgkmcnt(9)
    ds_write_b64 v6, v[202:203] offset:51712
    v_mfma_f32_16x16x32_bf16 v[224:227], v[24:27], v[80:83], 0
    ds_read_b64_tr_b16 v[40:41], v209 offset:0
    ds_read_b64_tr_b16 v[42:43], v209 offset:18432
    v_mfma_f32_16x16x32_bf16 v[224:227], v[28:31], v[96:99], v[224:227]
    ds_read_b64_tr_b16 v[44:45], v209 offset:2048
    ds_read2st64_b64 a[32:35], v7 offset0:56 offset1:57
    v_mfma_f32_16x16x32_bf16 v[228:231], v[24:27], v[84:87], 0
    ds_read_b64_tr_b16 v[46:47], v209 offset:20480
    v_fmaak_f32 v0, v128, v128, 0x409d30fc
    v_fmaak_f32 v1, v129, v129, 0x409d30fc
    v_mul_f32 v0, v0, v128
    v_mul_f32 v1, v1, v129
    v_exp_f32 v0, v0
    v_mfma_f32_16x16x32_bf16 v[228:231], v[28:31], v[100:103], v[228:231]
    ds_write_b64 v6, v[204:205] offset:52224
    v_exp_f32 v1, v1
    v_mul_f32 v144, v128, v144
    v_fma_f32 v0, v0, s50, s50
    v_mfma_f32_16x16x32_bf16 v[232:235], v[24:27], v[88:91], 0
    v_fma_f32 v1, v1, s50, s50
    v_rcp_f32 v0, v0
    v_rcp_f32 v1, v1
    v_mul_f32 v145, v129, v145
    v_mfma_f32_16x16x32_bf16 v[232:235], v[28:31], v[104:107], v[232:235]
    ds_read2st64_b64 a[36:39], v7 offset0:58 offset1:59
    v_mul_f32 v0, v0, v144
    v_mul_f32 v1, v1, v145
    v_cvt_pk_bf16_f32 v128, v0, v1
    v_fmaak_f32 v0, v130, v130, 0x409d30fc
    v_fmaak_f32 v1, v131, v131, 0x409d30fc
    v_mul_f32 v0, v0, v130
    v_mfma_f32_16x16x32_bf16 v[236:239], v[24:27], v[92:95], 0
    v_mul_f32 v1, v1, v131
    v_exp_f32 v0, v0
    v_exp_f32 v1, v1
    v_mfma_f32_16x16x32_bf16 v[236:239], v[28:31], v[108:111], v[236:239]
    s_waitcnt lgkmcnt(8)
    ds_write_b64 v6, v[206:207] offset:52736
    v_mul_f32 v146, v130, v146
    v_fma_f32 v0, v0, s50, s50
    v_fma_f32 v1, v1, s50, s50
    v_rcp_f32 v0, v0
    v_mfma_f32_16x16x32_bf16 v[224:227], v[32:35], v[112:115], v[224:227]
    ds_read_b64_tr_b16 v[24:25], v209 offset:4096
    v_rcp_f32 v1, v1
    v_mul_f32 v147, v131, v147
    v_mul_f32 v0, v0, v146
    v_mul_f32 v1, v1, v147
    v_cvt_pk_bf16_f32 v129, v0, v1
    v_mfma_f32_16x16x32_bf16 v[224:227], v[36:39], v[192:195], v[224:227]
    ds_write_b64 v214, v[128:129] offset:53248
    v_fmaak_f32 v0, v132, v132, 0x409d30fc
    v_fmaak_f32 v1, v133, v133, 0x409d30fc
    v_mul_f32 v0, v0, v132
    v_mfma_f32_16x16x32_bf16 v[228:231], v[32:35], v[116:119], v[228:231]
    ds_read_b64_tr_b16 v[26:27], v209 offset:22528
    v_mul_f32 v1, v1, v133
    v_exp_f32 v0, v0
    v_exp_f32 v1, v1
    v_mul_f32 v148, v132, v148
    v_mfma_f32_16x16x32_bf16 v[228:231], v[36:39], v[196:199], v[228:231]
    ds_read_b64_tr_b16 v[28:29], v209 offset:6144
    v_fma_f32 v0, v0, s50, s50
    v_fma_f32 v1, v1, s50, s50
    v_rcp_f32 v0, v0
    v_rcp_f32 v1, v1
    v_mul_f32 v149, v133, v149
    v_mfma_f32_16x16x32_bf16 v[232:235], v[32:35], v[120:123], v[232:235]
    ds_read_b64_tr_b16 v[30:31], v209 offset:24576
    v_mul_f32 v0, v0, v148
    v_mul_f32 v1, v1, v149
    v_cvt_pk_bf16_f32 v132, v0, v1
    v_fmaak_f32 v0, v134, v134, 0x409d30fc
    v_fmaak_f32 v1, v135, v135, 0x409d30fc
    v_mul_f32 v0, v0, v134
    v_mfma_f32_16x16x32_bf16 v[232:235], v[36:39], v[200:203], v[232:235]
    v_mul_f32 v1, v1, v135
    v_exp_f32 v0, v0
    v_exp_f32 v1, v1
    v_mul_f32 v150, v134, v150
    v_fma_f32 v0, v0, s50, s50
    v_mfma_f32_16x16x32_bf16 v[236:239], v[32:35], v[124:127], v[236:239]
    v_fma_f32 v1, v1, s50, s50
    v_rcp_f32 v0, v0
    v_rcp_f32 v1, v1
    v_mul_f32 v151, v135, v151
    v_mul_f32 v0, v0, v150
    v_mul_f32 v1, v1, v151
    v_cvt_pk_bf16_f32 v133, v0, v1
    v_mfma_f32_16x16x32_bf16 v[236:239], v[36:39], v[204:207], v[236:239]
    s_waitcnt lgkmcnt(8)
    ds_write_b64 v214, v[132:133] offset:54272
    v_mfma_f32_16x16x32_bf16 v[240:243], v[40:43], v[80:83], 0
    ds_read_b64_tr_b16 v[32:33], v210 offset:0
    v_fmaak_f32 v0, v136, v136, 0x409d30fc
    v_fmaak_f32 v1, v137, v137, 0x409d30fc
    v_mul_f32 v0, v0, v136
    v_mul_f32 v1, v1, v137
    v_exp_f32 v0, v0
    v_mfma_f32_16x16x32_bf16 v[240:243], v[44:47], v[96:99], v[240:243]
    ds_read_b64_tr_b16 v[34:35], v210 offset:18432
    v_exp_f32 v1, v1
    v_mul_f32 v152, v136, v152
    v_fma_f32 v0, v0, s50, s50
    v_fma_f32 v1, v1, s50, s50
    v_rcp_f32 v0, v0
    v_mfma_f32_16x16x32_bf16 v[244:247], v[40:43], v[84:87], 0
    ds_read_b64_tr_b16 v[36:37], v210 offset:2048
    v_rcp_f32 v1, v1
    v_mul_f32 v153, v137, v153
    v_mul_f32 v0, v0, v152
    v_mul_f32 v1, v1, v153
    v_cvt_pk_bf16_f32 v136, v0, v1
    v_mfma_f32_16x16x32_bf16 v[244:247], v[44:47], v[100:103], v[244:247]
    ds_read_b64_tr_b16 v[38:39], v210 offset:20480
    v_fmaak_f32 v0, v138, v138, 0x409d30fc
    v_fmaak_f32 v1, v139, v139, 0x409d30fc
    v_mul_f32 v0, v0, v138
    v_mul_f32 v1, v1, v139
    v_exp_f32 v0, v0
    v_exp_f32 v1, v1
    v_mfma_f32_16x16x32_bf16 v[248:251], v[40:43], v[88:91], 0
    v_mul_f32 v154, v138, v154
    v_fma_f32 v0, v0, s50, s50
    v_fma_f32 v1, v1, s50, s50
    v_rcp_f32 v0, v0
    v_mfma_f32_16x16x32_bf16 v[248:251], v[44:47], v[104:107], v[248:251]
    v_rcp_f32 v1, v1
    v_mul_f32 v155, v139, v155
    v_mul_f32 v0, v0, v154
    v_mul_f32 v1, v1, v155
    v_cvt_pk_bf16_f32 v137, v0, v1
    v_mfma_f32_16x16x32_bf16 v[252:255], v[40:43], v[92:95], 0
    ds_write_b64 v215, v[136:137] offset:53248
    v_fmaak_f32 v0, v140, v140, 0x409d30fc
    v_fmaak_f32 v1, v141, v141, 0x409d30fc
    v_mul_f32 v0, v0, v140
    v_mul_f32 v1, v1, v141
    v_mfma_f32_16x16x32_bf16 v[252:255], v[44:47], v[108:111], v[252:255]
    s_waitcnt lgkmcnt(6)
    v_exp_f32 v0, v0
    v_exp_f32 v1, v1
    v_mul_f32 v156, v140, v156
    v_fma_f32 v0, v0, s50, s50
    v_fma_f32 v1, v1, s50, s50
    v_mfma_f32_16x16x32_bf16 v[240:243], v[24:27], v[112:115], v[240:243]
    ds_read_b64_tr_b16 v[40:41], v210 offset:4096
    v_rcp_f32 v0, v0
    v_rcp_f32 v1, v1
    v_mul_f32 v157, v141, v157
    v_mfma_f32_16x16x32_bf16 v[240:243], v[28:31], v[192:195], v[240:243]
    ds_read_b64_tr_b16 v[42:43], v210 offset:22528
    v_mul_f32 v0, v0, v156
    v_mul_f32 v1, v1, v157
    v_cvt_pk_bf16_f32 v140, v0, v1
    v_fmaak_f32 v0, v142, v142, 0x409d30fc
    v_fmaak_f32 v1, v143, v143, 0x409d30fc
    v_mul_f32 v0, v0, v142
    v_mfma_f32_16x16x32_bf16 v[244:247], v[24:27], v[116:119], v[244:247]
    ds_read_b64_tr_b16 v[44:45], v210 offset:6144
    v_mul_f32 v1, v1, v143
    v_exp_f32 v0, v0
    v_exp_f32 v1, v1
    v_mul_f32 v158, v142, v158
    v_fma_f32 v0, v0, s50, s50
    v_mfma_f32_16x16x32_bf16 v[244:247], v[28:31], v[196:199], v[244:247]
    ds_read_b64_tr_b16 v[46:47], v210 offset:24576
    v_fma_f32 v1, v1, s50, s50
    v_rcp_f32 v0, v0
    v_rcp_f32 v1, v1
    v_mul_f32 v159, v143, v159
    v_mul_f32 v0, v0, v158
    v_mul_f32 v1, v1, v159
    v_cvt_pk_bf16_f32 v141, v0, v1
    v_mfma_f32_16x16x32_bf16 v[248:251], v[24:27], v[120:123], v[248:251]
    ds_write_b64 v215, v[140:141] offset:54272
    v_mfma_f32_16x16x32_bf16 v[248:251], v[28:31], v[200:203], v[248:251]
    v_mfma_f32_16x16x32_bf16 v[252:255], v[24:27], v[124:127], v[252:255]
    v_mfma_f32_16x16x32_bf16 v[252:255], v[28:31], v[204:207], v[252:255]
    s_waitcnt lgkmcnt(0)
    v_mfma_f32_16x16x32_bf16 v[224:227], v[32:35], a[0:3], v[224:227]
    s_barrier
    v_mfma_f32_16x16x32_bf16 v[224:227], v[36:39], a[16:19], v[224:227]
    ds_read2st64_b64 a[48:51], v7 offset0:100 offset1:101
    v_add_u32 v4, 128, v4
    v_mfma_f32_16x16x32_bf16 v[228:231], v[32:35], a[4:7], v[228:231]
    ds_read_b64_tr_b16 v[24:25], v211 offset:0
    ds_read2st64_b64 a[52:55], v7 offset0:102 offset1:103
    v_mfma_f32_16x16x32_bf16 v[228:231], v[36:39], a[20:23], v[228:231]
    ds_read_b64_tr_b16 v[26:27], v211 offset:18432
    ds_read2st64_b64 a[56:59], v7 offset0:96 offset1:97
    v_mfma_f32_16x16x32_bf16 v[232:235], v[32:35], a[8:11], v[232:235]
    ds_read2st64_b64 a[60:63], v7 offset0:98 offset1:99
    v_mfma_f32_16x16x32_bf16 v[232:235], v[36:39], a[24:27], v[232:235]
    s_add_u32 m0, s85, 0
    ds_read_b64_tr_b16 v[28:29], v211 offset:2048
    v_mfma_f32_16x16x32_bf16 v[236:239], v[32:35], a[12:15], v[236:239]
    ds_read_b64_tr_b16 v[30:31], v211 offset:20480
    v_mfma_f32_16x16x32_bf16 v[236:239], v[36:39], a[28:31], v[236:239]
    ds_read2st64_b64 a[64:67], v6 offset0:104 offset1:105
    v_mfma_f32_16x16x32_bf16 v[224:227], v[40:43], a[32:35], v[224:227]
    ds_read_b64_tr_b16 v[32:33], v211 offset:4096
    s_waitcnt lgkmcnt(9)
    v_mfma_f32_16x16x32_bf16 v[224:227], v[44:47], a[48:51], v[224:227]
    ds_read2st64_b64 a[68:71], v6 offset0:106 offset1:107
    v_mfma_f32_16x16x32_bf16 v[228:231], v[40:43], a[36:39], v[228:231]
    ds_read_b64_tr_b16 v[34:35], v211 offset:22528
    s_waitcnt lgkmcnt(9)
    v_mfma_f32_16x16x32_bf16 v[228:231], v[44:47], a[52:55], v[228:231]
    buffer_load_dwordx4 v4, s[36:39], s76 offen offset:0 lds
    v_mfma_f32_16x16x32_bf16 v[232:235], v[40:43], a[40:43], v[232:235]
    ds_read_b64_tr_b16 v[36:37], v211 offset:6144
    s_waitcnt lgkmcnt(8)
    v_mfma_f32_16x16x32_bf16 v[232:235], v[44:47], a[56:59], v[232:235]
    ds_read2st64_b64 a[72:75], v7 offset0:104 offset1:105
    v_mfma_f32_16x16x32_bf16 v[236:239], v[40:43], a[44:47], v[236:239]
    ds_read_b64_tr_b16 v[38:39], v211 offset:24576
    s_waitcnt lgkmcnt(9)
    v_mfma_f32_16x16x32_bf16 v[236:239], v[44:47], a[60:63], v[236:239]
    s_waitcnt lgkmcnt(7)
    ds_read2st64_b64 a[76:79], v7 offset0:106 offset1:107
    buffer_load_dwordx4 v4, s[36:39], s77 offen offset:1024 lds
    v_mfma_f32_16x16x32_bf16 v[240:243], v[24:27], a[0:3], v[240:243]
    ds_read_b64_tr_b16 v[40:41], v212 offset:0
    v_mfma_f32_16x16x32_bf16 v[240:243], v[28:31], a[16:19], v[240:243]
    ds_read_b64_tr_b16 v[42:43], v212 offset:18432
    v_mfma_f32_16x16x32_bf16 v[244:247], v[24:27], a[4:7], v[244:247]
    ds_read_b64_tr_b16 v[44:45], v213 offset:0
    v_mfma_f32_16x16x32_bf16 v[244:247], v[28:31], a[20:23], v[244:247]
    ds_read_b64_tr_b16 v[46:47], v213 offset:18432
L_pgx7:
    s_cbranch_execz L_back0
    v_mfma_f32_16x16x32_bf16 v[248:251], v[24:27], a[8:11], v[248:251]
    buffer_load_dwordx4 v4, s[36:39], s78 offen offset:2048 lds
    v_mfma_f32_16x16x32_bf16 v[248:251], v[28:31], a[24:27], v[248:251]
    v_mfma_f32_16x16x32_bf16 v[252:255], v[24:27], a[12:15], v[252:255]
    v_mfma_f32_16x16x32_bf16 v[252:255], v[28:31], a[28:31], v[252:255]
    s_waitcnt vmcnt(4) lgkmcnt(0)
    v_mfma_f32_16x16x32_bf16 v[240:243], v[32:35], a[32:35], v[240:243]
    s_barrier
    v_mfma_f32_16x16x32_bf16 v[240:243], v[36:39], a[48:51], v[240:243]
    v_add_u32 v208, 36864, v208
    v_mfma_f32_16x16x32_bf16 v[244:247], v[32:35], a[36:39], v[244:247]
    buffer_load_dwordx4 v4, s[36:39], s79 offen offset:3072 lds
    v_mfma_f32_16x16x32_bf16 v[244:247], v[36:39], a[52:55], v[244:247]
    ds_read_b64_tr_b16 v[24:25], v208 offset:0
    v_mfma_f32_16x16x32_bf16 v[248:251], v[32:35], a[40:43], v[248:251]
    ds_read_b64_tr_b16 v[26:27], v208 offset:18432
    v_mfma_f32_16x16x32_bf16 v[248:251], v[36:39], a[56:59], v[248:251]
    ds_read_b64_tr_b16 v[28:29], v208 offset:2048
    v_mfma_f32_16x16x32_bf16 v[252:255], v[32:35], a[44:47], v[252:255]
    s_add_u32 m0, s85, 4096
    ds_read_b64_tr_b16 v[30:31], v208 offset:20480
    v_mfma_f32_16x16x32_bf16 v[252:255], v[36:39], a[60:63], v[252:255]
    v_mfma_f32_16x16x32_bf16 v[224:227], v[40:43], a[64:67], v[224:227]
    ds_read_b64_tr_b16 v[32:33], v208 offset:4096
    v_mfma_f32_16x16x32_bf16 v[228:231], v[40:43], a[68:71], v[228:231]
    ds_read_b64_tr_b16 v[34:35], v208 offset:22528
    v_mfma_f32_16x16x32_bf16 v[232:235], v[40:43], a[72:75], v[232:235]
    ds_read_b64_tr_b16 v[36:37], v208 offset:6144
    v_mfma_f32_16x16x32_bf16 v[236:239], v[40:43], a[76:79], v[236:239]
    buffer_load_dwordx4 v4, s[36:39], s80 offen offset:0 lds
    v_mfma_f32_16x16x32_bf16 v[240:243], v[44:47], a[64:67], v[240:243]
    ds_read_b64_tr_b16 v[38:39], v208 offset:24576
    v_mfma_f32_16x16x32_bf16 v[244:247], v[44:47], a[68:71], v[244:247]
    v_mfma_f32_16x16x32_bf16 v[248:251], v[44:47], a[72:75], v[248:251]
    v_mfma_f32_16x16x32_bf16 v[252:255], v[44:47], a[76:79], v[252:255]
    s_waitcnt lgkmcnt(4)
    v_mfma_f32_16x16x32_bf16 v[160:163], v[24:27], v[80:83], 0
    v_add_u32 v209, 36864, v209
    v_mfma_f32_16x16x32_bf16 v[160:163], v[28:31], v[96:99], v[160:163]
    ds_read_b64_tr_b16 v[40:41], v209 offset:0
    v_mfma_f32_16x16x32_bf16 v[164:167], v[24:27], v[84:87], 0
    buffer_load_dwordx4 v4, s[36:39], s81 offen offset:1024 lds
    v_mfma_f32_16x16x32_bf16 v[164:167], v[28:31], v[100:103], v[164:167]
    ds_read_b64_tr_b16 v[42:43], v209 offset:18432
    v_mfma_f32_16x16x32_bf16 v[168:171], v[24:27], v[88:91], 0
    ds_read_b64_tr_b16 v[44:45], v209 offset:2048
    v_mfma_f32_16x16x32_bf16 v[168:171], v[28:31], v[104:107], v[168:171]
    buffer_load_dwordx4 v4, s[36:39], s82 offen offset:2048 lds
    v_mfma_f32_16x16x32_bf16 v[172:175], v[24:27], v[92:95], 0
    s_lshl_b32 s58, s60, 4
    ds_read_b64_tr_b16 v[46:47], v209 offset:20480
    v_mfma_f32_16x16x32_bf16 v[172:175], v[28:31], v[108:111], v[172:175]
    s_waitcnt lgkmcnt(4)
    s_add_u32 s58, s58, s53
    v_mfma_f32_16x16x32_bf16 v[160:163], v[32:35], v[112:115], v[160:163]
    s_xor_b32 s59, s58, 16
    ds_read_b64_tr_b16 v[24:25], v209 offset:4096
    v_mfma_f32_16x16x32_bf16 v[160:163], v[36:39], v[192:195], v[160:163]
    s_mul_i32 s58, s58, 36864
    ds_read_b64_tr_b16 v[26:27], v209 offset:22528
    v_mfma_f32_16x16x32_bf16 v[164:167], v[32:35], v[116:119], v[164:167]
    s_mul_i32 s59, s59, 36864
    ds_read_b64_tr_b16 v[28:29], v209 offset:6144
    v_mfma_f32_16x16x32_bf16 v[164:167], v[36:39], v[196:199], v[164:167]
    buffer_load_dwordx4 v4, s[36:39], s83 offen offset:3072 lds
    v_mfma_f32_16x16x32_bf16 v[168:171], v[32:35], v[120:123], v[168:171]
    ds_read_b64_tr_b16 v[30:31], v209 offset:24576
    v_mfma_f32_16x16x32_bf16 v[168:171], v[36:39], v[200:203], v[168:171]
    s_and_b32 s61, s54, 1
    v_mfma_f32_16x16x32_bf16 v[172:175], v[32:35], v[124:127], v[172:175]
    v_lshl_add_u32 v20, s61, 11, v22
    v_mfma_f32_16x16x32_bf16 v[172:175], v[36:39], v[204:207], v[172:175]
    s_waitcnt lgkmcnt(4)
    s_add_u32 m0, s85, 8192
    v_mfma_f32_16x16x32_bf16 v[176:179], v[40:43], v[80:83], 0
    v_add_u32 v210, 36864, v210
    v_add_u32 v21, s59, v20
    v_mfma_f32_16x16x32_bf16 v[176:179], v[44:47], v[96:99], v[176:179]
    ds_read_b64_tr_b16 v[32:33], v210 offset:0
    v_mfma_f32_16x16x32_bf16 v[180:183], v[40:43], v[84:87], 0
    ds_read_b64_tr_b16 v[34:35], v210 offset:18432
    v_add_u32 v20, s58, v20
    v_mfma_f32_16x16x32_bf16 v[180:183], v[44:47], v[100:103], v[180:183]
    s_mov_b32 s34, 37748736
    ds_read_b64_tr_b16 v[36:37], v210 offset:2048
    v_mfma_f32_16x16x32_bf16 v[184:187], v[40:43], v[88:91], 0
    ds_read_b64_tr_b16 v[38:39], v210 offset:20480
    v_mfma_f32_16x16x32_bf16 v[184:187], v[44:47], v[104:107], v[184:187]
    buffer_load_dwordx4 v4, s[36:39], s84 offen offset:0 lds
    v_mfma_f32_16x16x32_bf16 v[188:191], v[40:43], v[92:95], 0
    v_mfma_f32_16x16x32_bf16 v[188:191], v[44:47], v[108:111], v[188:191]
    s_waitcnt lgkmcnt(4)
    s_add_u32 s32, s40, 4456448
    s_addc_u32 s33, s41, 0
    v_mfma_f32_16x16x32_bf16 v[176:179], v[24:27], v[112:115], v[176:179]
    ds_read_b64_tr_b16 v[40:41], v210 offset:4096
    v_cvt_pk_bf16_f32 v48, v224, v225
    v_mfma_f32_16x16x32_bf16 v[176:179], v[28:31], v[192:195], v[176:179]
    ds_read_b64_tr_b16 v[42:43], v210 offset:22528
    v_add_u32 v4, 128, v4
    v_mfma_f32_16x16x32_bf16 v[180:183], v[24:27], v[116:119], v[180:183]
    ds_read_b64_tr_b16 v[44:45], v210 offset:6144
    v_cvt_pk_bf16_f32 v49, v226, v227
    v_mfma_f32_16x16x32_bf16 v[180:183], v[28:31], v[196:199], v[180:183]
    ds_read_b64_tr_b16 v[46:47], v210 offset:24576
    v_cvt_pk_bf16_f32 v50, v228, v229
    v_mfma_f32_16x16x32_bf16 v[184:187], v[24:27], v[120:123], v[184:187]
    v_cvt_pk_bf16_f32 v51, v230, v231
    v_mfma_f32_16x16x32_bf16 v[184:187], v[28:31], v[200:203], v[184:187]
    buffer_store_dwordx4 v[48:51], v20, s[32:35], 0 offen offset:0 sc1
    v_mfma_f32_16x16x32_bf16 v[188:191], v[24:27], v[124:127], v[188:191]
    s_add_u32 m0, s85, 36864
    v_mfma_f32_16x16x32_bf16 v[188:191], v[28:31], v[204:207], v[188:191]
    s_waitcnt lgkmcnt(4)
    v_cvt_pk_bf16_f32 v52, v232, v233
    v_mfma_f32_16x16x32_bf16 v[160:163], v[32:35], a[0:3], v[160:163]
    v_add_u32 v211, 36864, v211
    v_mfma_f32_16x16x32_bf16 v[160:163], v[36:39], a[16:19], v[160:163]
    ds_read_b64_tr_b16 v[24:25], v211 offset:0
    v_cvt_pk_bf16_f32 v53, v234, v235
    v_mfma_f32_16x16x32_bf16 v[164:167], v[32:35], a[4:7], v[164:167]
    ds_read_b64_tr_b16 v[26:27], v211 offset:18432
    v_cvt_pk_bf16_f32 v54, v236, v237
    v_mfma_f32_16x16x32_bf16 v[164:167], v[36:39], a[20:23], v[164:167]
    ds_read_b64_tr_b16 v[28:29], v211 offset:2048
    v_cvt_pk_bf16_f32 v55, v238, v239
    v_mfma_f32_16x16x32_bf16 v[168:171], v[32:35], a[8:11], v[168:171]
    ds_read_b64_tr_b16 v[30:31], v211 offset:20480
    v_mfma_f32_16x16x32_bf16 v[168:171], v[36:39], a[24:27], v[168:171]
    buffer_load_dwordx4 v4, s[36:39], s76 offen offset:0 lds
    v_mfma_f32_16x16x32_bf16 v[172:175], v[32:35], a[12:15], v[172:175]
    v_mfma_f32_16x16x32_bf16 v[172:175], v[36:39], a[28:31], v[172:175]
    s_waitcnt lgkmcnt(4)
    v_accvgpr_write_b32 a164, v52
    v_accvgpr_write_b32 a165, v53
    v_mfma_f32_16x16x32_bf16 v[160:163], v[40:43], a[32:35], v[160:163]
    ds_read_b64_tr_b16 v[32:33], v211 offset:4096
    v_mfma_f32_16x16x32_bf16 v[160:163], v[44:47], a[48:51], v[160:163]
    buffer_load_dwordx4 v4, s[36:39], s77 offen offset:1024 lds
    v_mfma_f32_16x16x32_bf16 v[164:167], v[40:43], a[36:39], v[164:167]
    ds_read_b64_tr_b16 v[34:35], v211 offset:22528
    v_accvgpr_write_b32 a166, v54
    v_mfma_f32_16x16x32_bf16 v[164:167], v[44:47], a[52:55], v[164:167]
    ds_read_b64_tr_b16 v[36:37], v211 offset:6144
    v_accvgpr_write_b32 a167, v55
    v_mfma_f32_16x16x32_bf16 v[168:171], v[40:43], a[40:43], v[168:171]
    ds_read_b64_tr_b16 v[38:39], v211 offset:24576
    v_cvt_pk_bf16_f32 v56, v240, v241
    v_mfma_f32_16x16x32_bf16 v[168:171], v[44:47], a[56:59], v[168:171]
    buffer_load_dwordx4 v4, s[36:39], s78 offen offset:2048 lds
    v_mfma_f32_16x16x32_bf16 v[172:175], v[40:43], a[44:47], v[172:175]
    v_mfma_f32_16x16x32_bf16 v[172:175], v[44:47], a[60:63], v[172:175]
    s_waitcnt lgkmcnt(4)
    v_cvt_pk_bf16_f32 v57, v242, v243
    v_mfma_f32_16x16x32_bf16 v[176:179], v[24:27], a[0:3], v[176:179]
    v_add_u32 v212, 36864, v212
    v_mfma_f32_16x16x32_bf16 v[176:179], v[28:31], a[16:19], v[176:179]
    ds_read_b64_tr_b16 v[40:41], v212 offset:0
    v_cvt_pk_bf16_f32 v58, v244, v245
    v_mfma_f32_16x16x32_bf16 v[180:183], v[24:27], a[4:7], v[180:183]
    ds_read_b64_tr_b16 v[42:43], v212 offset:18432
    v_add_u32 v213, 36864, v213
    v_mfma_f32_16x16x32_bf16 v[180:183], v[28:31], a[20:23], v[180:183]
    ds_read_b64_tr_b16 v[44:45], v213 offset:0
    ds_read_b64_tr_b16 v[46:47], v213 offset:18432
    v_mfma_f32_16x16x32_bf16 v[184:187], v[24:27], a[8:11], v[184:187]
    buffer_load_dwordx4 v4, s[36:39], s79 offen offset:3072 lds
    v_mfma_f32_16x16x32_bf16 v[184:187], v[28:31], a[24:27], v[184:187]
    v_cvt_pk_bf16_f32 v59, v246, v247
    v_mfma_f32_16x16x32_bf16 v[188:191], v[24:27], a[12:15], v[188:191]
    buffer_store_dwordx4 v[56:59], v20, s[32:35], 0 offen offset:1024 sc1
    v_mfma_f32_16x16x32_bf16 v[188:191], v[28:31], a[28:31], v[188:191]
    s_waitcnt vmcnt(6) lgkmcnt(0)
    s_add_u32 m0, s85, 40960
    v_cvt_pk_bf16_f32 v60, v248, v249
    v_mfma_f32_16x16x32_bf16 v[176:179], v[32:35], a[32:35], v[176:179]
    s_barrier
    v_mfma_f32_16x16x32_bf16 v[176:179], v[36:39], a[48:51], v[176:179]
    v_add_u32 v208, 4294856704, v208
    v_mfma_f32_16x16x32_bf16 v[180:183], v[32:35], a[36:39], v[180:183]
    global_load_dwordx3 v[0:2], v22, s[0:1] offset:0
    v_mfma_f32_16x16x32_bf16 v[180:183], v[36:39], a[52:55], v[180:183]
    ds_read_b64_tr_b16 v[24:25], v208 offset:0
    v_cvt_pk_bf16_f32 v61, v250, v251
    v_mfma_f32_16x16x32_bf16 v[184:187], v[32:35], a[40:43], v[184:187]
    ds_read_b64_tr_b16 v[26:27], v208 offset:18432
    v_mfma_f32_16x16x32_bf16 v[184:187], v[36:39], a[56:59], v[184:187]
    buffer_load_dwordx4 v4, s[36:39], s80 offen offset:0 lds
    v_mfma_f32_16x16x32_bf16 v[188:191], v[32:35], a[44:47], v[188:191]
    ds_read_b64_tr_b16 v[28:29], v208 offset:2048
    v_cvt_pk_bf16_f32 v62, v252, v253
    v_mfma_f32_16x16x32_bf16 v[188:191], v[36:39], a[60:63], v[188:191]
    ds_read_b64_tr_b16 v[30:31], v208 offset:20480
    v_cvt_pk_bf16_f32 v63, v254, v255
    v_mfma_f32_16x16x32_bf16 v[160:163], v[40:43], a[64:67], v[160:163]
    ds_read_b64_tr_b16 v[32:33], v208 offset:4096
    v_mfma_f32_16x16x32_bf16 v[164:167], v[40:43], a[68:71], v[164:167]
    buffer_load_dwordx4 v4, s[36:39], s81 offen offset:1024 lds
    v_mfma_f32_16x16x32_bf16 v[168:171], v[40:43], a[72:75], v[168:171]
    ds_read_b64_tr_b16 v[34:35], v208 offset:22528
    v_accvgpr_write_b32 a168, v60
    v_mfma_f32_16x16x32_bf16 v[172:175], v[40:43], a[76:79], v[172:175]
    ds_read_b64_tr_b16 v[36:37], v208 offset:6144
    v_accvgpr_write_b32 a169, v61
    v_mfma_f32_16x16x32_bf16 v[176:179], v[44:47], a[64:67], v[176:179]
    ds_read_b64_tr_b16 v[38:39], v208 offset:24576
    v_accvgpr_write_b32 a170, v62
    v_mfma_f32_16x16x32_bf16 v[180:183], v[44:47], a[68:71], v[180:183]
    v_accvgpr_write_b32 a171, v63
    v_mfma_f32_16x16x32_bf16 v[184:187], v[44:47], a[72:75], v[184:187]
    v_mfma_f32_16x16x32_bf16 v[188:191], v[44:47], a[76:79], v[188:191]
    s_waitcnt lgkmcnt(4)
    buffer_load_dwordx4 v4, s[36:39], s82 offen offset:2048 lds
    v_mfma_f32_16x16x32_bf16 v[224:227], v[24:27], v[80:83], 0
    v_add_u32 v209, 4294856704, v209
    v_mfma_f32_16x16x32_bf16 v[224:227], v[28:31], v[96:99], v[224:227]
    ds_read_b64_tr_b16 v[40:41], v209 offset:0
    v_mfma_f32_16x16x32_bf16 v[228:231], v[24:27], v[84:87], 0
    ds_read_b64_tr_b16 v[42:43], v209 offset:18432
    v_mfma_f32_16x16x32_bf16 v[228:231], v[28:31], v[100:103], v[228:231]
    ds_read_b64_tr_b16 v[44:45], v209 offset:2048
    v_mfma_f32_16x16x32_bf16 v[232:235], v[24:27], v[88:91], 0
    ds_read_b64_tr_b16 v[46:47], v209 offset:20480
    v_mfma_f32_16x16x32_bf16 v[232:235], v[28:31], v[104:107], v[232:235]
    buffer_load_dwordx4 v4, s[36:39], s83 offen offset:3072 lds
    v_mfma_f32_16x16x32_bf16 v[236:239], v[24:27], v[92:95], 0
    v_mfma_f32_16x16x32_bf16 v[236:239], v[28:31], v[108:111], v[236:239]
    s_waitcnt lgkmcnt(4)
    s_add_u32 s32, s40, 4460544
    s_addc_u32 s33, s41, 0
    v_mfma_f32_16x16x32_bf16 v[224:227], v[32:35], v[112:115], v[224:227]
    ds_read_b64_tr_b16 v[24:25], v209 offset:4096
    v_cvt_pk_bf16_f32 v48, v160, v161
    v_mfma_f32_16x16x32_bf16 v[224:227], v[36:39], v[192:195], v[224:227]
    s_add_u32 m0, s85, 45056
    ds_read_b64_tr_b16 v[26:27], v209 offset:22528
    v_cvt_pk_bf16_f32 v49, v162, v163
    v_mfma_f32_16x16x32_bf16 v[228:231], v[32:35], v[116:119], v[228:231]
    ds_read_b64_tr_b16 v[28:29], v209 offset:6144
    v_cvt_pk_bf16_f32 v50, v164, v165
    v_mfma_f32_16x16x32_bf16 v[228:231], v[36:39], v[196:199], v[228:231]
    ds_read_b64_tr_b16 v[30:31], v209 offset:24576
    v_cvt_pk_bf16_f32 v51, v166, v167
    v_mfma_f32_16x16x32_bf16 v[232:235], v[32:35], v[120:123], v[232:235]
    v_mfma_f32_16x16x32_bf16 v[232:235], v[36:39], v[200:203], v[232:235]
    buffer_load_dwordx4 v4, s[36:39], s84 offen offset:0 lds
    v_mfma_f32_16x16x32_bf16 v[236:239], v[32:35], v[124:127], v[236:239]
    buffer_store_dwordx4 v[48:51], v20, s[32:35], 0 offen offset:0 sc1
    v_mfma_f32_16x16x32_bf16 v[236:239], v[36:39], v[204:207], v[236:239]
    s_waitcnt lgkmcnt(4)
    v_mfma_f32_16x16x32_bf16 v[240:243], v[40:43], v[80:83], 0
    v_add_u32 v210, 4294856704, v210
    v_cvt_pk_bf16_f32 v52, v168, v169
    v_mfma_f32_16x16x32_bf16 v[240:243], v[44:47], v[96:99], v[240:243]
    ds_read_b64_tr_b16 v[32:33], v210 offset:0
    v_mfma_f32_16x16x32_bf16 v[244:247], v[40:43], v[84:87], 0
    ds_read_b64_tr_b16 v[34:35], v210 offset:18432
    v_add_u32 v4, 128, v4
    v_mfma_f32_16x16x32_bf16 v[244:247], v[44:47], v[100:103], v[244:247]
    ds_read_b64_tr_b16 v[36:37], v210 offset:2048
    v_cvt_pk_bf16_f32 v53, v170, v171
    v_mfma_f32_16x16x32_bf16 v[248:251], v[40:43], v[88:91], 0
    ds_read_b64_tr_b16 v[38:39], v210 offset:20480
    v_cvt_pk_bf16_f32 v54, v172, v173
    v_mfma_f32_16x16x32_bf16 v[248:251], v[44:47], v[104:107], v[248:251]
    v_cvt_pk_bf16_f32 v55, v174, v175
    v_mfma_f32_16x16x32_bf16 v[252:255], v[40:43], v[92:95], 0
    v_accvgpr_write_b32 a172, v52
    v_mfma_f32_16x16x32_bf16 v[252:255], v[44:47], v[108:111], v[252:255]
    s_waitcnt lgkmcnt(4)
    v_accvgpr_write_b32 a173, v53
    v_mfma_f32_16x16x32_bf16 v[240:243], v[24:27], v[112:115], v[240:243]
    ds_read_b64_tr_b16 v[40:41], v210 offset:4096
    v_mfma_f32_16x16x32_bf16 v[240:243], v[28:31], v[192:195], v[240:243]
    s_add_u32 m0, s85, 73728
    ds_read_b64_tr_b16 v[42:43], v210 offset:22528
    v_accvgpr_write_b32 a174, v54
    v_mfma_f32_16x16x32_bf16 v[244:247], v[24:27], v[116:119], v[244:247]
    ds_read_b64_tr_b16 v[44:45], v210 offset:6144
    v_accvgpr_write_b32 a175, v55
    v_mfma_f32_16x16x32_bf16 v[244:247], v[28:31], v[196:199], v[244:247]
    ds_read_b64_tr_b16 v[46:47], v210 offset:24576
    v_cvt_pk_bf16_f32 v56, v176, v177
    v_mfma_f32_16x16x32_bf16 v[248:251], v[24:27], v[120:123], v[248:251]
    v_cvt_pk_bf16_f32 v57, v178, v179
    v_mfma_f32_16x16x32_bf16 v[248:251], v[28:31], v[200:203], v[248:251]
    buffer_load_dwordx4 v4, s[36:39], s76 offen offset:0 lds
    v_mfma_f32_16x16x32_bf16 v[252:255], v[24:27], v[124:127], v[252:255]
    v_cvt_pk_bf16_f32 v58, v180, v181
    v_mfma_f32_16x16x32_bf16 v[252:255], v[28:31], v[204:207], v[252:255]
    s_waitcnt lgkmcnt(4)
    v_cvt_pk_bf16_f32 v59, v182, v183
    v_mfma_f32_16x16x32_bf16 v[224:227], v[32:35], a[0:3], v[224:227]
    v_add_u32 v211, 4294856704, v211
    v_accvgpr_write_b32 a176, v56
    v_mfma_f32_16x16x32_bf16 v[224:227], v[36:39], a[16:19], v[224:227]
    ds_read_b64_tr_b16 v[24:25], v211 offset:0
    v_mfma_f32_16x16x32_bf16 v[228:231], v[32:35], a[4:7], v[228:231]
    buffer_load_dwordx4 v4, s[36:39], s77 offen offset:1024 lds
    v_mfma_f32_16x16x32_bf16 v[228:231], v[36:39], a[20:23], v[228:231]
    ds_read_b64_tr_b16 v[26:27], v211 offset:18432
    v_mfma_f32_16x16x32_bf16 v[232:235], v[32:35], a[8:11], v[232:235]
    ds_read_b64_tr_b16 v[28:29], v211 offset:2048
    v_accvgpr_write_b32 a177, v57
    v_mfma_f32_16x16x32_bf16 v[232:235], v[36:39], a[24:27], v[232:235]
    ds_read_b64_tr_b16 v[30:31], v211 offset:20480
    v_accvgpr_write_b32 a178, v58
    v_mfma_f32_16x16x32_bf16 v[236:239], v[32:35], a[12:15], v[236:239]
    v_accvgpr_write_b32 a179, v59
    v_mfma_f32_16x16x32_bf16 v[236:239], v[36:39], a[28:31], v[236:239]
    s_waitcnt lgkmcnt(4)
    buffer_load_dwordx4 v4, s[36:39], s78 offen offset:2048 lds
    v_mfma_f32_16x16x32_bf16 v[224:227], v[40:43], a[32:35], v[224:227]
    ds_read_b64_tr_b16 v[32:33], v211 offset:4096
    v_mfma_f32_16x16x32_bf16 v[224:227], v[44:47], a[48:51], v[224:227]
    ds_read_b64_tr_b16 v[34:35], v211 offset:22528
    v_cvt_pk_bf16_f32 v60, v184, v185
    v_mfma_f32_16x16x32_bf16 v[228:231], v[40:43], a[36:39], v[228:231]
    ds_read_b64_tr_b16 v[36:37], v211 offset:6144
    v_cvt_pk_bf16_f32 v61, v186, v187
    v_mfma_f32_16x16x32_bf16 v[228:231], v[44:47], a[52:55], v[228:231]
    buffer_load_dwordx4 v4, s[36:39], s79 offen offset:3072 lds
    v_mfma_f32_16x16x32_bf16 v[232:235], v[40:43], a[40:43], v[232:235]
    ds_read_b64_tr_b16 v[38:39], v211 offset:24576
    v_mfma_f32_16x16x32_bf16 v[232:235], v[44:47], a[56:59], v[232:235]
    v_cvt_pk_bf16_f32 v62, v188, v189
    v_cvt_pk_bf16_f32 v63, v190, v191
    v_mfma_f32_16x16x32_bf16 v[236:239], v[40:43], a[44:47], v[236:239]
    v_mfma_f32_16x16x32_bf16 v[236:239], v[44:47], a[60:63], v[236:239]
    s_waitcnt lgkmcnt(4)
    v_accvgpr_write_b32 a180, v60
    v_accvgpr_write_b32 a181, v61
    v_mfma_f32_16x16x32_bf16 v[240:243], v[24:27], a[0:3], v[240:243]
    v_add_u32 v212, 4294856704, v212
    v_mfma_f32_16x16x32_bf16 v[240:243], v[28:31], a[16:19], v[240:243]
    s_add_u32 m0, s85, 77824
    ds_read_b64_tr_b16 v[40:41], v212 offset:0
    v_mfma_f32_16x16x32_bf16 v[244:247], v[24:27], a[4:7], v[244:247]
    ds_read_b64_tr_b16 v[42:43], v212 offset:18432
    v_add_u32 v213, 4294856704, v213
    v_mfma_f32_16x16x32_bf16 v[244:247], v[28:31], a[20:23], v[244:247]
    ds_read_b64_tr_b16 v[44:45], v213 offset:0
    ds_read_b64_tr_b16 v[46:47], v213 offset:18432
    v_mfma_f32_16x16x32_bf16 v[248:251], v[24:27], a[8:11], v[248:251]
    v_accvgpr_write_b32 a182, v62
    v_accvgpr_write_b32 a183, v63
    v_mfma_f32_16x16x32_bf16 v[248:251], v[28:31], a[24:27], v[248:251]
    buffer_load_dwordx4 v4, s[36:39], s80 offen offset:0 lds
    v_mfma_f32_16x16x32_bf16 v[252:255], v[24:27], a[12:15], v[252:255]
    s_add_u32 s64, s40, s97
    s_addc_u32 s65, s41, 0
    v_mfma_f32_16x16x32_bf16 v[252:255], v[28:31], a[28:31], v[252:255]
    s_waitcnt vmcnt(6) lgkmcnt(0)
    s_mov_b32 s66, 2432
    v_mfma_f32_16x16x32_bf16 v[240:243], v[32:35], a[32:35], v[240:243]
    s_barrier
    v_mfma_f32_16x16x32_bf16 v[240:243], v[36:39], a[48:51], v[240:243]
    global_load_dwordx4 v[64:67], v22, s[0:1] offset:1024
    v_mfma_f32_16x16x32_bf16 v[244:247], v[32:35], a[36:39], v[244:247]
    buffer_load_dwordx4 v4, s[36:39], s81 offen offset:1024 lds
    v_mfma_f32_16x16x32_bf16 v[244:247], v[36:39], a[52:55], v[244:247]
    v_add_u32 v208, 36864, v208
    v_mfma_f32_16x16x32_bf16 v[248:251], v[32:35], a[40:43], v[248:251]
    s_mov_b32 s67, 0x20000
    ds_read_b64_tr_b16 v[24:25], v208 offset:0
    v_mfma_f32_16x16x32_bf16 v[248:251], v[36:39], a[56:59], v[248:251]
    ds_read_b64_tr_b16 v[26:27], v208 offset:18432
    v_mov_b32 v216, -1
    v_mfma_f32_16x16x32_bf16 v[252:255], v[32:35], a[44:47], v[252:255]
    ds_read_b64_tr_b16 v[28:29], v208 offset:2048
    v_mov_b32 v217, -1
    v_mfma_f32_16x16x32_bf16 v[252:255], v[36:39], a[60:63], v[252:255]
    ds_read_b64_tr_b16 v[30:31], v208 offset:20480
    v_mov_b32 v218, -1
    v_mfma_f32_16x16x32_bf16 v[224:227], v[40:43], a[64:67], v[224:227]
    ds_read_b64_tr_b16 v[32:33], v208 offset:4096
    v_mov_b32 v219, -1
    v_mfma_f32_16x16x32_bf16 v[228:231], v[40:43], a[68:71], v[228:231]
    buffer_load_dwordx4 v4, s[36:39], s82 offen offset:2048 lds
    v_mfma_f32_16x16x32_bf16 v[232:235], v[40:43], a[72:75], v[232:235]
    ds_read_b64_tr_b16 v[34:35], v208 offset:22528
    v_mfma_f32_16x16x32_bf16 v[236:239], v[40:43], a[76:79], v[236:239]
    ds_read_b64_tr_b16 v[36:37], v208 offset:6144
    v_mfma_f32_16x16x32_bf16 v[240:243], v[44:47], a[64:67], v[240:243]
    buffer_store_dwordx4 v[216:219], v22, s[64:67], 0 offen sc1
    v_mfma_f32_16x16x32_bf16 v[244:247], v[44:47], a[68:71], v[244:247]
    buffer_load_dwordx4 v4, s[36:39], s83 offen offset:3072 lds
    v_mfma_f32_16x16x32_bf16 v[248:251], v[44:47], a[72:75], v[248:251]
    ds_read_b64_tr_b16 v[38:39], v208 offset:24576
    v_mfma_f32_16x16x32_bf16 v[252:255], v[44:47], a[76:79], v[252:255]
    s_waitcnt lgkmcnt(4)
    v_mfma_f32_16x16x32_bf16 v[160:163], v[24:27], v[80:83], 0
    v_add_u32 v209, 36864, v209
    v_mfma_f32_16x16x32_bf16 v[160:163], v[28:31], v[96:99], v[160:163]
    ds_read_b64_tr_b16 v[40:41], v209 offset:0
    v_mfma_f32_16x16x32_bf16 v[164:167], v[24:27], v[84:87], 0
    s_add_u32 m0, s85, 81920
    ds_read_b64_tr_b16 v[42:43], v209 offset:18432
    v_mfma_f32_16x16x32_bf16 v[164:167], v[28:31], v[100:103], v[164:167]
    ds_read_b64_tr_b16 v[44:45], v209 offset:2048
    v_mfma_f32_16x16x32_bf16 v[168:171], v[24:27], v[88:91], 0
    ds_read_b64_tr_b16 v[46:47], v209 offset:20480
    v_mfma_f32_16x16x32_bf16 v[168:171], v[28:31], v[104:107], v[168:171]
    s_add_u32 s32, s40, 4464640
    s_addc_u32 s33, s41, 0
    v_mfma_f32_16x16x32_bf16 v[172:175], v[24:27], v[92:95], 0
    v_mfma_f32_16x16x32_bf16 v[172:175], v[28:31], v[108:111], v[172:175]
    s_waitcnt lgkmcnt(4)
    buffer_load_dwordx4 v4, s[36:39], s84 offen offset:0 lds
    v_mfma_f32_16x16x32_bf16 v[160:163], v[32:35], v[112:115], v[160:163]
    ds_read_b64_tr_b16 v[24:25], v209 offset:4096
    v_cvt_pk_bf16_f32 v48, v224, v225
    v_mfma_f32_16x16x32_bf16 v[160:163], v[36:39], v[192:195], v[160:163]
    ds_read_b64_tr_b16 v[26:27], v209 offset:22528
    v_cvt_pk_bf16_f32 v49, v226, v227
    v_mfma_f32_16x16x32_bf16 v[164:167], v[32:35], v[116:119], v[164:167]
    ds_read_b64_tr_b16 v[28:29], v209 offset:6144
    v_cvt_pk_bf16_f32 v50, v228, v229
    v_mfma_f32_16x16x32_bf16 v[164:167], v[36:39], v[196:199], v[164:167]
    ds_read_b64_tr_b16 v[30:31], v209 offset:24576
    v_add_u32 v4, 128, v4
    v_mfma_f32_16x16x32_bf16 v[168:171], v[32:35], v[120:123], v[168:171]
    v_cvt_pk_bf16_f32 v51, v230, v231
    v_mfma_f32_16x16x32_bf16 v[168:171], v[36:39], v[200:203], v[168:171]
    global_load_dwordx4 v[68:71], v22, s[0:1] offset:2048
    v_mfma_f32_16x16x32_bf16 v[172:175], v[32:35], v[124:127], v[172:175]
    buffer_store_dwordx4 v[48:51], v20, s[32:35], 0 offen offset:0 sc1
    v_mfma_f32_16x16x32_bf16 v[172:175], v[36:39], v[204:207], v[172:175]
    s_waitcnt lgkmcnt(4)
    v_mfma_f32_16x16x32_bf16 v[176:179], v[40:43], v[80:83], 0
    v_add_u32 v210, 36864, v210
    v_mfma_f32_16x16x32_bf16 v[176:179], v[44:47], v[96:99], v[176:179]
    ds_read_b64_tr_b16 v[32:33], v210 offset:0
    v_mfma_f32_16x16x32_bf16 v[180:183], v[40:43], v[84:87], 0
    s_add_u32 m0, s85, 110592
    ds_read_b64_tr_b16 v[34:35], v210 offset:18432
    v_cvt_pk_bf16_f32 v52, v232, v233
    v_mfma_f32_16x16x32_bf16 v[180:183], v[44:47], v[100:103], v[180:183]
    ds_read_b64_tr_b16 v[36:37], v210 offset:2048
    v_cvt_pk_bf16_f32 v53, v234, v235
    v_mfma_f32_16x16x32_bf16 v[184:187], v[40:43], v[88:91], 0
    ds_read_b64_tr_b16 v[38:39], v210 offset:20480
    v_mfma_f32_16x16x32_bf16 v[184:187], v[44:47], v[104:107], v[184:187]
    buffer_load_dwordx4 v4, s[36:39], s76 offen offset:0 lds
    v_mfma_f32_16x16x32_bf16 v[188:191], v[40:43], v[92:95], 0
    v_mfma_f32_16x16x32_bf16 v[188:191], v[44:47], v[108:111], v[188:191]
    s_waitcnt lgkmcnt(4)
    v_cvt_pk_bf16_f32 v54, v236, v237
    v_cvt_pk_bf16_f32 v55, v238, v239
    v_mfma_f32_16x16x32_bf16 v[176:179], v[24:27], v[112:115], v[176:179]
    ds_read_b64_tr_b16 v[40:41], v210 offset:4096
    v_mfma_f32_16x16x32_bf16 v[176:179], v[28:31], v[192:195], v[176:179]
    ds_read_b64_tr_b16 v[42:43], v210 offset:22528
    v_accvgpr_write_b32 a184, v52
    v_mfma_f32_16x16x32_bf16 v[180:183], v[24:27], v[116:119], v[180:183]
    ds_read_b64_tr_b16 v[44:45], v210 offset:6144
    v_accvgpr_write_b32 a185, v53
    v_mfma_f32_16x16x32_bf16 v[180:183], v[28:31], v[196:199], v[180:183]
    buffer_load_dwordx4 v4, s[36:39], s77 offen offset:1024 lds
    v_mfma_f32_16x16x32_bf16 v[184:187], v[24:27], v[120:123], v[184:187]
    ds_read_b64_tr_b16 v[46:47], v210 offset:24576
    v_mfma_f32_16x16x32_bf16 v[184:187], v[28:31], v[200:203], v[184:187]
    v_accvgpr_write_b32 a186, v54
    v_accvgpr_write_b32 a187, v55
    v_mfma_f32_16x16x32_bf16 v[188:191], v[24:27], v[124:127], v[188:191]
    v_mfma_f32_16x16x32_bf16 v[188:191], v[28:31], v[204:207], v[188:191]
    s_waitcnt lgkmcnt(4)
    buffer_load_dwordx4 v4, s[36:39], s78 offen offset:2048 lds
    v_mfma_f32_16x16x32_bf16 v[160:163], v[32:35], a[0:3], v[160:163]
    v_add_u32 v211, 36864, v211
    v_cvt_pk_bf16_f32 v56, v240, v241
    v_mfma_f32_16x16x32_bf16 v[160:163], v[36:39], a[16:19], v[160:163]
    ds_read_b64_tr_b16 v[24:25], v211 offset:0
    v_mfma_f32_16x16x32_bf16 v[164:167], v[32:35], a[4:7], v[164:167]
    ds_read_b64_tr_b16 v[26:27], v211 offset:18432
    v_cvt_pk_bf16_f32 v57, v242, v243
    v_mfma_f32_16x16x32_bf16 v[164:167], v[36:39], a[20:23], v[164:167]
    ds_read_b64_tr_b16 v[28:29], v211 offset:2048
    v_cvt_pk_bf16_f32 v58, v244, v245
    v_mfma_f32_16x16x32_bf16 v[168:171], v[32:35], a[8:11], v[168:171]
    ds_read_b64_tr_b16 v[30:31], v211 offset:20480
    v_mfma_f32_16x16x32_bf16 v[168:171], v[36:39], a[24:27], v[168:171]
    buffer_load_dwordx4 v4, s[36:39], s79 offen offset:3072 lds
    v_mfma_f32_16x16x32_bf16 v[172:175], v[32:35], a[12:15], v[172:175]
    v_cvt_pk_bf16_f32 v59, v246, v247
    v_mfma_f32_16x16x32_bf16 v[172:175], v[36:39], a[28:31], v[172:175]
    s_waitcnt lgkmcnt(4)
    v_accvgpr_write_b32 a188, v56
    v_mfma_f32_16x16x32_bf16 v[160:163], v[40:43], a[32:35], v[160:163]
    ds_read_b64_tr_b16 v[32:33], v211 offset:4096
    v_accvgpr_write_b32 a189, v57
    v_mfma_f32_16x16x32_bf16 v[160:163], v[44:47], a[48:51], v[160:163]
    s_add_u32 m0, s85, 114688
    ds_read_b64_tr_b16 v[34:35], v211 offset:22528
    v_accvgpr_write_b32 a190, v58
    v_mfma_f32_16x16x32_bf16 v[164:167], v[40:43], a[36:39], v[164:167]
    ds_read_b64_tr_b16 v[36:37], v211 offset:6144
    v_mfma_f32_16x16x32_bf16 v[164:167], v[44:47], a[52:55], v[164:167]
    global_load_dwordx4 v[72:75], v22, s[0:1] offset:3072
    v_mfma_f32_16x16x32_bf16 v[168:171], v[40:43], a[40:43], v[168:171]
    ds_read_b64_tr_b16 v[38:39], v211 offset:24576
    v_accvgpr_write_b32 a191, v59
    v_mfma_f32_16x16x32_bf16 v[168:171], v[44:47], a[56:59], v[168:171]
    v_cvt_pk_bf16_f32 v60, v248, v249
    v_mfma_f32_16x16x32_bf16 v[172:175], v[40:43], a[44:47], v[172:175]
    v_cvt_pk_bf16_f32 v61, v250, v251
    v_mfma_f32_16x16x32_bf16 v[172:175], v[44:47], a[60:63], v[172:175]
    s_waitcnt lgkmcnt(4)
    buffer_load_dwordx4 v4, s[36:39], s80 offen offset:0 lds
    v_mfma_f32_16x16x32_bf16 v[176:179], v[24:27], a[0:3], v[176:179]
    v_add_u32 v212, 36864, v212
    v_mfma_f32_16x16x32_bf16 v[176:179], v[28:31], a[16:19], v[176:179]
    ds_read_b64_tr_b16 v[40:41], v212 offset:0
    v_mfma_f32_16x16x32_bf16 v[180:183], v[24:27], a[4:7], v[180:183]
    ds_read_b64_tr_b16 v[42:43], v212 offset:18432
    v_add_u32 v213, 36864, v213
    v_mfma_f32_16x16x32_bf16 v[180:183], v[28:31], a[20:23], v[180:183]
    ds_read_b64_tr_b16 v[44:45], v213 offset:0
    ds_read_b64_tr_b16 v[46:47], v213 offset:18432
    v_mfma_f32_16x16x32_bf16 v[184:187], v[24:27], a[8:11], v[184:187]
    buffer_load_dwordx4 v4, s[36:39], s81 offen offset:1024 lds
    v_mfma_f32_16x16x32_bf16 v[184:187], v[28:31], a[24:27], v[184:187]
    v_cvt_pk_bf16_f32 v62, v252, v253
    v_cvt_pk_bf16_f32 v63, v254, v255
    v_mfma_f32_16x16x32_bf16 v[188:191], v[24:27], a[12:15], v[188:191]
    v_accvgpr_write_b32 a192, v60
    v_mfma_f32_16x16x32_bf16 v[188:191], v[28:31], a[28:31], v[188:191]
    s_waitcnt vmcnt(9) lgkmcnt(0)
    v_accvgpr_write_b32 a193, v61
    v_accvgpr_write_b32 a194, v62
    v_mfma_f32_16x16x32_bf16 v[176:179], v[32:35], a[32:35], v[176:179]
    s_barrier
    v_mfma_f32_16x16x32_bf16 v[176:179], v[36:39], a[48:51], v[176:179]
    v_add_u32 v208, 36864, v208
L_pg1_0:
L_pgx8:
    s_cbranch_execz L_pgx12
    v_mfma_f32_16x16x32_bf16 v[180:183], v[32:35], a[36:39], v[180:183]
    buffer_load_dwordx4 v4, s[36:39], s82 offen offset:2048 lds
    v_mfma_f32_16x16x32_bf16 v[180:183], v[36:39], a[52:55], v[180:183]
    ds_read_b64_tr_b16 v[24:25], v208 offset:0
    ds_read_b64_tr_b16 v[26:27], v208 offset:18432
    v_mfma_f32_16x16x32_bf16 v[184:187], v[32:35], a[40:43], v[184:187]
    ds_read_b64_tr_b16 v[28:29], v208 offset:2048
    v_accvgpr_write_b32 a195, v63
    v_mfma_f32_16x16x32_bf16 v[184:187], v[36:39], a[56:59], v[184:187]
    buffer_load_dwordx4 v4, s[36:39], s83 offen offset:3072 lds
    v_mfma_f32_16x16x32_bf16 v[188:191], v[32:35], a[44:47], v[188:191]
    ds_read_b64_tr_b16 v[30:31], v208 offset:20480
    v_mfma_f32_16x16x32_bf16 v[188:191], v[36:39], a[60:63], v[188:191]
    ds_read2_b64 v[10:13], v0 offset0:0 offset1:1
    v_mfma_f32_16x16x32_bf16 v[160:163], v[40:43], a[64:67], v[160:163]
    ds_read_b64_tr_b16 v[32:33], v208 offset:4096
    ds_read_b64_tr_b16 v[34:35], v208 offset:22528
    v_mfma_f32_16x16x32_bf16 v[164:167], v[40:43], a[68:71], v[164:167]
    ds_read_b64_tr_b16 v[36:37], v208 offset:6144
    v_mfma_f32_16x16x32_bf16 v[168:171], v[40:43], a[72:75], v[168:171]
    ds_read2_b32 v[14:15], v0 offset0:9 offset1:10
    v_mfma_f32_16x16x32_bf16 v[172:175], v[40:43], a[76:79], v[172:175]
    s_add_u32 m0, s85, 118784
    ds_read2_b32 v[16:17], v0 offset0:11 offset1:12
    v_mfma_f32_16x16x32_bf16 v[176:179], v[44:47], a[64:67], v[176:179]
    ds_read_b32 v18, v1 offset:32
    v_mov_b32 v19, 0
    v_mfma_f32_16x16x32_bf16 v[180:183], v[44:47], a[68:71], v[180:183]
    buffer_store_dwordx4 v[216:219], v22, s[64:67], 0 offen offset:1024 sc1
    v_mfma_f32_16x16x32_bf16 v[184:187], v[44:47], a[72:75], v[184:187]
    s_add_u32 s0, s0, 8192
    ds_read_b64_tr_b16 v[38:39], v208 offset:24576
    s_addc_u32 s1, s1, 0
    v_mfma_f32_16x16x32_bf16 v[188:191], v[44:47], a[76:79], v[188:191]
    s_waitcnt lgkmcnt(8)
    buffer_load_dwordx4 v4, s[36:39], s84 offen offset:0 lds
    v_mfma_f32_16x16x32_bf16 v[224:227], v[24:27], v[80:83], 0
    v_add_u32 v209, 36864, v209
    v_mfma_f32_16x16x32_bf16 v[224:227], v[28:31], v[96:99], v[224:227]
    ds_read_b64_tr_b16 v[40:41], v209 offset:0
    v_mfma_f32_16x16x32_bf16 v[228:231], v[24:27], v[84:87], 0
    ds_read_b64_tr_b16 v[42:43], v209 offset:18432
    v_mfma_f32_16x16x32_bf16 v[228:231], v[28:31], v[100:103], v[228:231]
    ds_read_b64_tr_b16 v[44:45], v209 offset:2048
    v_mfma_f32_16x16x32_bf16 v[232:235], v[24:27], v[88:91], 0
    ds_read_b64_tr_b16 v[46:47], v209 offset:20480
    v_mfma_f32_16x16x32_bf16 v[232:235], v[28:31], v[104:107], v[232:235]
    v_add_u32 v4, 128, v4
    v_mfma_f32_16x16x32_bf16 v[236:239], v[24:27], v[92:95], 0
    s_add_u32 s32, s40, 4468736
    s_addc_u32 s33, s41, 0
    v_mfma_f32_16x16x32_bf16 v[236:239], v[28:31], v[108:111], v[236:239]
    s_waitcnt lgkmcnt(4)
    v_cvt_pk_bf16_f32 v48, v160, v161
    v_mfma_f32_16x16x32_bf16 v[224:227], v[32:35], v[112:115], v[224:227]
    ds_read_b64_tr_b16 v[24:25], v209 offset:4096
    v_cvt_pk_bf16_f32 v49, v162, v163
    v_mfma_f32_16x16x32_bf16 v[224:227], v[36:39], v[192:195], v[224:227]
    s_add_u32 m0, s85, 0
    ds_read_b64_tr_b16 v[26:27], v209 offset:22528
    v_cvt_pk_bf16_f32 v50, v164, v165
    v_mfma_f32_16x16x32_bf16 v[228:231], v[32:35], v[116:119], v[228:231]
    ds_read_b64_tr_b16 v[28:29], v209 offset:6144
    v_cvt_pk_bf16_f32 v51, v166, v167
    v_mfma_f32_16x16x32_bf16 v[228:231], v[36:39], v[196:199], v[228:231]
    ds_read_b64_tr_b16 v[30:31], v209 offset:24576
    v_mfma_f32_16x16x32_bf16 v[232:235], v[32:35], v[120:123], v[232:235]
    buffer_store_dwordx4 v[48:51], v20, s[32:35], 0 offen offset:0 sc1
    v_mfma_f32_16x16x32_bf16 v[232:235], v[36:39], v[200:203], v[232:235]
    v_cvt_pk_bf16_f32 v52, v168, v169
    v_cvt_pk_bf16_f32 v53, v170, v171
    v_mfma_f32_16x16x32_bf16 v[236:239], v[32:35], v[124:127], v[236:239]
    v_mfma_f32_16x16x32_bf16 v[236:239], v[36:39], v[204:207], v[236:239]
    s_waitcnt lgkmcnt(4)
    buffer_load_dwordx4 v4, s[36:39], s76 offen offset:0 lds
    v_mfma_f32_16x16x32_bf16 v[240:243], v[40:43], v[80:83], 0
    v_add_u32 v210, 36864, v210
    v_cvt_pk_bf16_f32 v54, v172, v173
    v_mfma_f32_16x16x32_bf16 v[240:243], v[44:47], v[96:99], v[240:243]
    ds_read_b64_tr_b16 v[32:33], v210 offset:0
    v_cvt_pk_bf16_f32 v55, v174, v175
    v_mfma_f32_16x16x32_bf16 v[244:247], v[40:43], v[84:87], 0
    ds_read_b64_tr_b16 v[34:35], v210 offset:18432
    v_accvgpr_write_b32 a196, v52
    v_mfma_f32_16x16x32_bf16 v[244:247], v[44:47], v[100:103], v[244:247]
    ds_read_b64_tr_b16 v[36:37], v210 offset:2048
    v_accvgpr_write_b32 a197, v53
    v_mfma_f32_16x16x32_bf16 v[248:251], v[40:43], v[88:91], 0
    ds_read_b64_tr_b16 v[38:39], v210 offset:20480
    v_mfma_f32_16x16x32_bf16 v[248:251], v[44:47], v[104:107], v[248:251]
    buffer_load_dwordx4 v4, s[36:39], s77 offen offset:1024 lds
    v_mfma_f32_16x16x32_bf16 v[252:255], v[40:43], v[92:95], 0
    v_accvgpr_write_b32 a198, v54
    v_mfma_f32_16x16x32_bf16 v[252:255], v[44:47], v[108:111], v[252:255]
    s_waitcnt lgkmcnt(4)
    v_accvgpr_write_b32 a199, v55
    v_cvt_pk_bf16_f32 v56, v176, v177
    v_mfma_f32_16x16x32_bf16 v[240:243], v[24:27], v[112:115], v[240:243]
    ds_read_b64_tr_b16 v[40:41], v210 offset:4096
    v_mfma_f32_16x16x32_bf16 v[240:243], v[28:31], v[192:195], v[240:243]
    buffer_load_dwordx4 v4, s[36:39], s78 offen offset:2048 lds
    v_mfma_f32_16x16x32_bf16 v[244:247], v[24:27], v[116:119], v[244:247]
    ds_read_b64_tr_b16 v[42:43], v210 offset:22528
    v_cvt_pk_bf16_f32 v57, v178, v179
    v_mfma_f32_16x16x32_bf16 v[244:247], v[28:31], v[196:199], v[244:247]
    global_load_dwordx4 v[76:79], v22, s[0:1] offset:-4096
    v_mfma_f32_16x16x32_bf16 v[248:251], v[24:27], v[120:123], v[248:251]
    ds_read_b64_tr_b16 v[44:45], v210 offset:6144
    v_mfma_f32_16x16x32_bf16 v[248:251], v[28:31], v[200:203], v[248:251]
    buffer_load_dwordx4 v4, s[36:39], s79 offen offset:3072 lds
    v_mfma_f32_16x16x32_bf16 v[252:255], v[24:27], v[124:127], v[252:255]
    ds_read_b64_tr_b16 v[46:47], v210 offset:24576
    v_cvt_pk_bf16_f32 v58, v180, v181
    v_mfma_f32_16x16x32_bf16 v[252:255], v[28:31], v[204:207], v[252:255]
    s_waitcnt lgkmcnt(4)
    v_cvt_pk_bf16_f32 v59, v182, v183
    v_mfma_f32_16x16x32_bf16 v[224:227], v[32:35], a[0:3], v[224:227]
    v_add_u32 v211, 36864, v211
    v_accvgpr_write_b32 a200, v56
    v_mfma_f32_16x16x32_bf16 v[224:227], v[36:39], a[16:19], v[224:227]
    ds_read_b64_tr_b16 v[24:25], v211 offset:0
    v_accvgpr_write_b32 a201, v57
    v_mfma_f32_16x16x32_bf16 v[228:231], v[32:35], a[4:7], v[228:231]
    s_add_u32 m0, s85, 4096
    ds_read_b64_tr_b16 v[26:27], v211 offset:18432
    v_accvgpr_write_b32 a202, v58
    v_mfma_f32_16x16x32_bf16 v[228:231], v[36:39], a[20:23], v[228:231]
    ds_read_b64_tr_b16 v[28:29], v211 offset:2048
    v_accvgpr_write_b32 a203, v59
    v_mfma_f32_16x16x32_bf16 v[232:235], v[32:35], a[8:11], v[232:235]
    ds_read_b64_tr_b16 v[30:31], v211 offset:20480
    v_mfma_f32_16x16x32_bf16 v[232:235], v[36:39], a[24:27], v[232:235]
    v_cvt_pk_bf16_f32 v60, v184, v185
    v_cvt_pk_bf16_f32 v61, v186, v187
    v_mfma_f32_16x16x32_bf16 v[236:239], v[32:35], a[12:15], v[236:239]
    v_cvt_pk_bf16_f32 v62, v188, v189
    v_mfma_f32_16x16x32_bf16 v[236:239], v[36:39], a[28:31], v[236:239]
    s_waitcnt lgkmcnt(4)
    v_cvt_pk_bf16_f32 v63, v190, v191
    v_mfma_f32_16x16x32_bf16 v[224:227], v[40:43], a[32:35], v[224:227]
    ds_read_b64_tr_b16 v[32:33], v211 offset:4096
    v_accvgpr_write_b32 a204, v60
    v_mfma_f32_16x16x32_bf16 v[224:227], v[44:47], a[48:51], v[224:227]
    buffer_load_dwordx4 v4, s[36:39], s80 offen offset:0 lds
    v_mfma_f32_16x16x32_bf16 v[228:231], v[40:43], a[36:39], v[228:231]
    ds_read_b64_tr_b16 v[34:35], v211 offset:22528
    v_accvgpr_write_b32 a205, v61
    v_mfma_f32_16x16x32_bf16 v[228:231], v[44:47], a[52:55], v[228:231]
    ds_read_b64_tr_b16 v[36:37], v211 offset:6144
    v_accvgpr_write_b32 a206, v62
    v_mfma_f32_16x16x32_bf16 v[232:235], v[40:43], a[40:43], v[232:235]
    ds_read_b64_tr_b16 v[38:39], v211 offset:24576
    v_accvgpr_write_b32 a207, v63
    v_mfma_f32_16x16x32_bf16 v[232:235], v[44:47], a[56:59], v[232:235]
    buffer_load_dwordx4 v4, s[36:39], s81 offen offset:1024 lds
    v_mfma_f32_16x16x32_bf16 v[236:239], v[40:43], a[44:47], v[236:239]
    buffer_store_dwordx2 v[216:217], v2, s[64:67], 0 offen offset:2048 sc1
    v_mfma_f32_16x16x32_bf16 v[236:239], v[44:47], a[60:63], v[236:239]
    s_waitcnt lgkmcnt(4)
    v_mfma_f32_16x16x32_bf16 v[240:243], v[24:27], a[0:3], v[240:243]
    v_add_u32 v212, 36864, v212
    v_mfma_f32_16x16x32_bf16 v[240:243], v[28:31], a[16:19], v[240:243]
    ds_read_b64_tr_b16 v[40:41], v212 offset:0
    buffer_load_dwordx4 v4, s[36:39], s82 offen offset:2048 lds
    v_mfma_f32_16x16x32_bf16 v[244:247], v[24:27], a[4:7], v[244:247]
    ds_read_b64_tr_b16 v[42:43], v212 offset:18432
    v_add_u32 v213, 36864, v213
    v_mfma_f32_16x16x32_bf16 v[244:247], v[28:31], a[20:23], v[244:247]
    ds_read_b64_tr_b16 v[44:45], v213 offset:0
    ds_read_b64_tr_b16 v[46:47], v213 offset:18432
    v_mfma_f32_16x16x32_bf16 v[248:251], v[24:27], a[8:11], v[248:251]
    s_lshr_b32 s59, s53, 2
    s_lshl_b32 s4, s52, 2
    v_mfma_f32_16x16x32_bf16 v[248:251], v[28:31], a[24:27], v[248:251]
    s_add_u32 s4, s4, s59
    v_mfma_f32_16x16x32_bf16 v[252:255], v[24:27], a[12:15], v[252:255]
    buffer_load_dwordx4 v4, s[36:39], s83 offen offset:3072 lds
    v_mfma_f32_16x16x32_bf16 v[252:255], v[28:31], a[28:31], v[252:255]
    s_waitcnt vmcnt(11) lgkmcnt(0)
    s_and_b32 s5, s53, 3
    s_mul_i32 s6, s4, 9216
    v_mfma_f32_16x16x32_bf16 v[240:243], v[32:35], a[32:35], v[240:243]
    s_barrier
    v_mfma_f32_16x16x32_bf16 v[240:243], v[36:39], a[48:51], v[240:243]
    s_mul_i32 s59, s5, 288
    v_add_u32 v208, 36864, v208
    v_mfma_f32_16x16x32_bf16 v[244:247], v[32:35], a[36:39], v[244:247]
    s_add_u32 s6, s6, s59
    ds_read_b64_tr_b16 v[24:25], v208 offset:0
    v_mfma_f32_16x16x32_bf16 v[244:247], v[36:39], a[52:55], v[244:247]
    ds_read_b64_tr_b16 v[26:27], v208 offset:18432
    v_mfma_f32_16x16x32_bf16 v[248:251], v[32:35], a[40:43], v[248:251]
    s_add_u32 s44, s22, s6
    ds_read_b64_tr_b16 v[28:29], v208 offset:2048
    s_addc_u32 s45, s23, 0
    v_mfma_f32_16x16x32_bf16 v[248:251], v[36:39], a[56:59], v[248:251]
    s_add_u32 m0, s85, 8192
    ds_read_b64_tr_b16 v[30:31], v208 offset:20480
    s_sub_u32 s46, 2359296, s6
    v_mfma_f32_16x16x32_bf16 v[252:255], v[32:35], a[44:47], v[252:255]
    v_mfma_f32_16x16x32_bf16 v[252:255], v[36:39], a[60:63], v[252:255]
    s_mul_i32 s12, s5, 9216
    s_mul_i32 s7, s54, 147456
    v_mfma_f32_16x16x32_bf16 v[224:227], v[40:43], a[64:67], v[224:227]
    s_add_u32 s7, s7, s12
    ds_read_b64_tr_b16 v[32:33], v208 offset:4096
    v_mfma_f32_16x16x32_bf16 v[228:231], v[40:43], a[68:71], v[228:231]
    buffer_load_dwordx4 v4, s[36:39], s84 offen offset:0 lds
    v_mfma_f32_16x16x32_bf16 v[232:235], v[40:43], a[72:75], v[232:235]
    ds_read_b64_tr_b16 v[34:35], v208 offset:22528
    v_mfma_f32_16x16x32_bf16 v[236:239], v[40:43], a[76:79], v[236:239]
    s_lshl2_add_u32 s8, s4, s54
    ds_read_b64_tr_b16 v[36:37], v208 offset:6144
    s_mul_i32 s8, s8, 147456
    v_mfma_f32_16x16x32_bf16 v[240:243], v[44:47], a[64:67], v[240:243]
    ds_read_b64_tr_b16 v[38:39], v208 offset:24576
    v_mfma_f32_16x16x32_bf16 v[244:247], v[44:47], a[68:71], v[244:247]
    v_add_u32 v4, 128, v4
    s_add_u32 s8, s8, s12
    v_mfma_f32_16x16x32_bf16 v[248:251], v[44:47], a[72:75], v[248:251]
    v_mfma_f32_16x16x32_bf16 v[252:255], v[44:47], a[76:79], v[252:255]
    s_waitcnt lgkmcnt(4)
    v_mfma_f32_16x16x32_bf16 v[160:163], v[24:27], v[80:83], 0
    v_add_u32 v209, 36864, v209
    v_mfma_f32_16x16x32_bf16 v[160:163], v[28:31], v[96:99], v[160:163]
    ds_read_b64_tr_b16 v[40:41], v209 offset:0
    v_mfma_f32_16x16x32_bf16 v[164:167], v[24:27], v[84:87], 0
    s_add_u32 m0, s85, 36864
    ds_read_b64_tr_b16 v[42:43], v209 offset:18432
    v_mfma_f32_16x16x32_bf16 v[164:167], v[28:31], v[100:103], v[164:167]
    ds_read_b64_tr_b16 v[44:45], v209 offset:2048
    v_mfma_f32_16x16x32_bf16 v[168:171], v[24:27], v[88:91], 0
    ds_read_b64_tr_b16 v[46:47], v209 offset:20480
    v_mfma_f32_16x16x32_bf16 v[168:171], v[28:31], v[104:107], v[168:171]
    s_add_u32 s32, s40, 4472832
    s_addc_u32 s33, s41, 0
    v_mfma_f32_16x16x32_bf16 v[172:175], v[24:27], v[92:95], 0
    v_mfma_f32_16x16x32_bf16 v[172:175], v[28:31], v[108:111], v[172:175]
    s_waitcnt lgkmcnt(4)
    v_cvt_pk_bf16_f32 v48, v224, v225
    v_cvt_pk_bf16_f32 v49, v226, v227
    v_mfma_f32_16x16x32_bf16 v[160:163], v[32:35], v[112:115], v[160:163]
    ds_read_b64_tr_b16 v[24:25], v209 offset:4096
    v_mfma_f32_16x16x32_bf16 v[160:163], v[36:39], v[192:195], v[160:163]
    buffer_load_dwordx4 v4, s[36:39], s76 offen offset:0 lds
    v_mfma_f32_16x16x32_bf16 v[164:167], v[32:35], v[116:119], v[164:167]
    ds_read_b64_tr_b16 v[26:27], v209 offset:22528
    v_cvt_pk_bf16_f32 v50, v228, v229
    v_mfma_f32_16x16x32_bf16 v[164:167], v[36:39], v[196:199], v[164:167]
    ds_read_b64_tr_b16 v[28:29], v209 offset:6144
    v_cvt_pk_bf16_f32 v51, v230, v231
    v_mfma_f32_16x16x32_bf16 v[168:171], v[32:35], v[120:123], v[168:171]
    ds_read_b64_tr_b16 v[30:31], v209 offset:24576
    v_mfma_f32_16x16x32_bf16 v[168:171], v[36:39], v[200:203], v[168:171]
    buffer_load_dwordx4 v4, s[36:39], s77 offen offset:1024 lds
    v_mfma_f32_16x16x32_bf16 v[172:175], v[32:35], v[124:127], v[172:175]
    buffer_store_dwordx4 v[48:51], v20, s[32:35], 0 offen offset:0 sc1
    v_mfma_f32_16x16x32_bf16 v[172:175], v[36:39], v[204:207], v[172:175]
    s_waitcnt lgkmcnt(4)
    v_cvt_pk_bf16_f32 v52, v232, v233
    v_mfma_f32_16x16x32_bf16 v[176:179], v[40:43], v[80:83], 0
    v_add_u32 v210, 36864, v210
    v_mfma_f32_16x16x32_bf16 v[176:179], v[44:47], v[96:99], v[176:179]
    ds_read_b64_tr_b16 v[32:33], v210 offset:0
    v_mfma_f32_16x16x32_bf16 v[180:183], v[40:43], v[84:87], 0
    buffer_load_dwordx4 v4, s[36:39], s78 offen offset:2048 lds
    v_mfma_f32_16x16x32_bf16 v[180:183], v[44:47], v[100:103], v[180:183]
    ds_read_b64_tr_b16 v[34:35], v210 offset:18432
    v_cvt_pk_bf16_f32 v53, v234, v235
    v_mfma_f32_16x16x32_bf16 v[184:187], v[40:43], v[88:91], 0
    ds_read_b64_tr_b16 v[36:37], v210 offset:2048
    v_mfma_f32_16x16x32_bf16 v[184:187], v[44:47], v[104:107], v[184:187]
    ds_read_b64_tr_b16 v[38:39], v210 offset:20480
    v_cvt_pk_bf16_f32 v54, v236, v237
    v_mfma_f32_16x16x32_bf16 v[188:191], v[40:43], v[92:95], 0
    v_cvt_pk_bf16_f32 v55, v238, v239
    v_mfma_f32_16x16x32_bf16 v[188:191], v[44:47], v[108:111], v[188:191]
    s_waitcnt lgkmcnt(4)
    buffer_load_dwordx4 v4, s[36:39], s79 offen offset:3072 lds
    v_mfma_f32_16x16x32_bf16 v[176:179], v[24:27], v[112:115], v[176:179]
    ds_read_b64_tr_b16 v[40:41], v210 offset:4096
    v_accvgpr_write_b32 a208, v52
    v_mfma_f32_16x16x32_bf16 v[176:179], v[28:31], v[192:195], v[176:179]
    ds_read_b64_tr_b16 v[42:43], v210 offset:22528
    v_accvgpr_write_b32 a209, v53
    v_mfma_f32_16x16x32_bf16 v[180:183], v[24:27], v[116:119], v[180:183]
    ds_read_b64_tr_b16 v[44:45], v210 offset:6144
    v_accvgpr_write_b32 a210, v54
    v_mfma_f32_16x16x32_bf16 v[180:183], v[28:31], v[196:199], v[180:183]
    s_add_u32 m0, s85, 40960
    ds_read_b64_tr_b16 v[46:47], v210 offset:24576
    v_accvgpr_write_b32 a211, v55
    v_mfma_f32_16x16x32_bf16 v[184:187], v[24:27], v[120:123], v[184:187]
    v_cvt_pk_bf16_f32 v56, v240, v241
    v_mfma_f32_16x16x32_bf16 v[184:187], v[28:31], v[200:203], v[184:187]
    v_cvt_pk_bf16_f32 v57, v242, v243
    v_mfma_f32_16x16x32_bf16 v[188:191], v[24:27], v[124:127], v[188:191]
    v_mfma_f32_16x16x32_bf16 v[188:191], v[28:31], v[204:207], v[188:191]
    s_waitcnt lgkmcnt(4)
    v_cvt_pk_bf16_f32 v58, v244, v245
    v_cvt_pk_bf16_f32 v59, v246, v247
    v_mfma_f32_16x16x32_bf16 v[160:163], v[32:35], a[0:3], v[160:163]
    v_add_u32 v211, 36864, v211
    v_mfma_f32_16x16x32_bf16 v[160:163], v[36:39], a[16:19], v[160:163]
    ds_read_b64_tr_b16 v[24:25], v211 offset:0
    v_mfma_f32_16x16x32_bf16 v[164:167], v[32:35], a[4:7], v[164:167]
    buffer_load_dwordx4 v4, s[36:39], s80 offen offset:0 lds
    v_mfma_f32_16x16x32_bf16 v[164:167], v[36:39], a[20:23], v[164:167]
    ds_read_b64_tr_b16 v[26:27], v211 offset:18432
    v_mfma_f32_16x16x32_bf16 v[168:171], v[32:35], a[8:11], v[168:171]
    ds_read_b64_tr_b16 v[28:29], v211 offset:2048
    v_mfma_f32_16x16x32_bf16 v[168:171], v[36:39], a[24:27], v[168:171]
    buffer_load_dwordx4 v4, s[36:39], s81 offen offset:1024 lds
    v_mfma_f32_16x16x32_bf16 v[172:175], v[32:35], a[12:15], v[172:175]
    buffer_store_dwordx4 v[56:59], v20, s[32:35], 0 offen offset:1024 sc1
    v_mfma_f32_16x16x32_bf16 v[172:175], v[36:39], a[28:31], v[172:175]
    s_waitcnt lgkmcnt(3)
    ds_read_b64_tr_b16 v[30:31], v211 offset:20480
    v_cvt_pk_bf16_f32 v60, v248, v249
    v_mfma_f32_16x16x32_bf16 v[160:163], v[40:43], a[32:35], v[160:163]
    ds_read_b64_tr_b16 v[32:33], v211 offset:4096
    v_cvt_pk_bf16_f32 v61, v250, v251
    v_mfma_f32_16x16x32_bf16 v[160:163], v[44:47], a[48:51], v[160:163]
    ds_read_b64_tr_b16 v[34:35], v211 offset:22528
    v_cvt_pk_bf16_f32 v62, v252, v253
    v_mfma_f32_16x16x32_bf16 v[164:167], v[40:43], a[36:39], v[164:167]
    ds_read_b64_tr_b16 v[36:37], v211 offset:6144
    v_cvt_pk_bf16_f32 v63, v254, v255
    v_mfma_f32_16x16x32_bf16 v[164:167], v[44:47], a[52:55], v[164:167]
    buffer_load_dwordx4 v4, s[36:39], s82 offen offset:2048 lds
    v_mfma_f32_16x16x32_bf16 v[168:171], v[40:43], a[40:43], v[168:171]
    ds_read_b64_tr_b16 v[38:39], v211 offset:24576
    v_mfma_f32_16x16x32_bf16 v[168:171], v[44:47], a[56:59], v[168:171]
    v_accvgpr_write_b32 a212, v60
    v_accvgpr_write_b32 a213, v61
    v_mfma_f32_16x16x32_bf16 v[172:175], v[40:43], a[44:47], v[172:175]
    v_mfma_f32_16x16x32_bf16 v[172:175], v[44:47], a[60:63], v[172:175]
    s_waitcnt lgkmcnt(4)
    buffer_load_dwordx4 v4, s[36:39], s83 offen offset:3072 lds
    v_mfma_f32_16x16x32_bf16 v[176:179], v[24:27], a[0:3], v[176:179]
    v_add_u32 v212, 36864, v212
    v_mfma_f32_16x16x32_bf16 v[176:179], v[28:31], a[16:19], v[176:179]
    ds_read_b64_tr_b16 v[40:41], v212 offset:0
    v_accvgpr_write_b32 a214, v62
    v_mfma_f32_16x16x32_bf16 v[180:183], v[24:27], a[4:7], v[180:183]
    ds_read_b64_tr_b16 v[42:43], v212 offset:18432
    v_add_u32 v213, 36864, v213
    v_mfma_f32_16x16x32_bf16 v[180:183], v[28:31], a[20:23], v[180:183]
    ds_read_b64_tr_b16 v[44:45], v213 offset:0
    ds_read_b64_tr_b16 v[46:47], v213 offset:18432
    v_mfma_f32_16x16x32_bf16 v[184:187], v[24:27], a[8:11], v[184:187]
    s_add_u32 m0, s85, 45056
    v_accvgpr_write_b32 a215, v63
    s_add_u32 s8, s8, 4456448
    v_mfma_f32_16x16x32_bf16 v[184:187], v[28:31], a[24:27], v[184:187]
    buffer_load_dwordx2 v[2:3], v22, s[40:43], s51 offen sc1
    v_mfma_f32_16x16x32_bf16 v[188:191], v[24:27], a[12:15], v[188:191]
    s_add_u32 s7, s7, 262144
    v_mfma_f32_16x16x32_bf16 v[188:191], v[28:31], a[28:31], v[188:191]
    s_waitcnt vmcnt(11) lgkmcnt(0)
    s_lshl_b32 s13, s54, 2
    s_add_u32 s13, s13, s5
    v_mfma_f32_16x16x32_bf16 v[176:179], v[32:35], a[32:35], v[176:179]
    s_barrier
    v_mfma_f32_16x16x32_bf16 v[176:179], v[36:39], a[48:51], v[176:179]
    v_add_u32 v208, 4294856704, v208
    v_mfma_f32_16x16x32_bf16 v[180:183], v[32:35], a[36:39], v[180:183]
    buffer_load_dwordx4 v4, s[36:39], s84 offen offset:0 lds
    v_mfma_f32_16x16x32_bf16 v[180:183], v[36:39], a[52:55], v[180:183]
    ds_read_b64_tr_b16 v[24:25], v208 offset:0
    v_mfma_f32_16x16x32_bf16 v[184:187], v[32:35], a[40:43], v[184:187]
    s_mul_i32 s13, s13, 5120
    ds_read_b64_tr_b16 v[26:27], v208 offset:18432
    v_mfma_f32_16x16x32_bf16 v[184:187], v[36:39], a[56:59], v[184:187]
    s_add_u32 s13, s13, 851968
    ds_read_b64_tr_b16 v[28:29], v208 offset:2048
    v_mfma_f32_16x16x32_bf16 v[188:191], v[32:35], a[44:47], v[188:191]
    s_lshl_b32 s14, s4, 2
    ds_read_b64_tr_b16 v[30:31], v208 offset:20480
    v_mfma_f32_16x16x32_bf16 v[188:191], v[36:39], a[60:63], v[188:191]
    v_add_u32 v4, 128, v4
    v_mfma_f32_16x16x32_bf16 v[160:163], v[40:43], a[64:67], v[160:163]
    s_add_u32 s14, s14, s54
    ds_read_b64_tr_b16 v[32:33], v208 offset:4096
    v_mfma_f32_16x16x32_bf16 v[164:167], v[40:43], a[68:71], v[164:167]
    s_mul_i32 s14, s14, 9728
    ds_read_b64_tr_b16 v[34:35], v208 offset:22528
    v_mfma_f32_16x16x32_bf16 v[168:171], v[40:43], a[72:75], v[168:171]
    s_add_u32 s14, s14, 1048576
    ds_read_b64_tr_b16 v[36:37], v208 offset:6144
    v_mfma_f32_16x16x32_bf16 v[172:175], v[40:43], a[76:79], v[172:175]
    s_add_u32 m0, s85, 73728
    ds_read_b64_tr_b16 v[38:39], v208 offset:24576
    s_add_u32 s15, s14, 4864
    v_mfma_f32_16x16x32_bf16 v[176:179], v[44:47], a[64:67], v[176:179]
    s_lshl_b32 s9, s60, 6
    v_mfma_f32_16x16x32_bf16 v[180:183], v[44:47], a[68:71], v[180:183]
    s_add_u32 s9, s9, 200712
    v_mfma_f32_16x16x32_bf16 v[184:187], v[44:47], a[72:75], v[184:187]
    v_mfma_f32_16x16x32_bf16 v[188:191], v[44:47], a[76:79], v[188:191]
    s_waitcnt lgkmcnt(4)
    v_mfma_f32_16x16x32_bf16 v[224:227], v[24:27], v[80:83], 0
    v_add_u32 v209, 4294856704, v209
    v_mfma_f32_16x16x32_bf16 v[224:227], v[28:31], v[96:99], v[224:227]
    ds_read_b64_tr_b16 v[40:41], v209 offset:0
    v_mfma_f32_16x16x32_bf16 v[228:231], v[24:27], v[84:87], 0
    buffer_load_dwordx4 v4, s[36:39], s76 offen offset:0 lds
    v_mfma_f32_16x16x32_bf16 v[228:231], v[28:31], v[100:103], v[228:231]
    ds_read_b64_tr_b16 v[42:43], v209 offset:18432
    v_mfma_f32_16x16x32_bf16 v[232:235], v[24:27], v[88:91], 0
    ds_read_b64_tr_b16 v[44:45], v209 offset:2048
    v_mfma_f32_16x16x32_bf16 v[232:235], v[28:31], v[104:107], v[232:235]
    buffer_load_dwordx4 v4, s[36:39], s77 offen offset:1024 lds
    v_mfma_f32_16x16x32_bf16 v[236:239], v[24:27], v[92:95], 0
    ds_read_b64_tr_b16 v[46:47], v209 offset:20480
    v_mfma_f32_16x16x32_bf16 v[236:239], v[28:31], v[108:111], v[236:239]
    s_waitcnt lgkmcnt(4)
    s_add_u32 s32, s40, 4476928
    s_addc_u32 s33, s41, 0
    v_mfma_f32_16x16x32_bf16 v[224:227], v[32:35], v[112:115], v[224:227]
    ds_read_b64_tr_b16 v[24:25], v209 offset:4096
    v_mfma_f32_16x16x32_bf16 v[224:227], v[36:39], v[192:195], v[224:227]
    ds_read_b64_tr_b16 v[26:27], v209 offset:22528
    v_cvt_pk_bf16_f32 v48, v160, v161
    v_mfma_f32_16x16x32_bf16 v[228:231], v[32:35], v[116:119], v[228:231]
    ds_read_b64_tr_b16 v[28:29], v209 offset:6144
    v_cvt_pk_bf16_f32 v49, v162, v163
    v_mfma_f32_16x16x32_bf16 v[228:231], v[36:39], v[196:199], v[228:231]
    buffer_load_dwordx4 v4, s[36:39], s78 offen offset:2048 lds
    v_mfma_f32_16x16x32_bf16 v[232:235], v[32:35], v[120:123], v[232:235]
    ds_read_b64_tr_b16 v[30:31], v209 offset:24576
    v_mfma_f32_16x16x32_bf16 v[232:235], v[36:39], v[200:203], v[232:235]
    v_cvt_pk_bf16_f32 v50, v164, v165
    v_mfma_f32_16x16x32_bf16 v[236:239], v[32:35], v[124:127], v[236:239]
    v_mfma_f32_16x16x32_bf16 v[236:239], v[36:39], v[204:207], v[236:239]
    s_waitcnt lgkmcnt(4)
    buffer_load_dwordx4 v4, s[36:39], s79 offen offset:3072 lds
    v_mfma_f32_16x16x32_bf16 v[240:243], v[40:43], v[80:83], 0
    v_add_u32 v210, 4294856704, v210
    v_cvt_pk_bf16_f32 v51, v166, v167
    v_mfma_f32_16x16x32_bf16 v[240:243], v[44:47], v[96:99], v[240:243]
    ds_read_b64_tr_b16 v[32:33], v210 offset:0
    v_mfma_f32_16x16x32_bf16 v[244:247], v[40:43], v[84:87], 0
    ds_read_b64_tr_b16 v[34:35], v210 offset:18432
    v_mfma_f32_16x16x32_bf16 v[244:247], v[44:47], v[100:103], v[244:247]
    ds_read_b64_tr_b16 v[36:37], v210 offset:2048
    v_mfma_f32_16x16x32_bf16 v[248:251], v[40:43], v[88:91], 0
    buffer_store_dwordx4 v[48:51], v20, s[32:35], 0 offen offset:0 sc1
    v_mfma_f32_16x16x32_bf16 v[248:251], v[44:47], v[104:107], v[248:251]
    s_add_u32 m0, s85, 77824
    ds_read_b64_tr_b16 v[38:39], v210 offset:20480
    v_cvt_pk_bf16_f32 v52, v168, v169
    v_mfma_f32_16x16x32_bf16 v[252:255], v[40:43], v[92:95], 0
    v_mfma_f32_16x16x32_bf16 v[252:255], v[44:47], v[108:111], v[252:255]
    s_waitcnt lgkmcnt(4)
    v_cvt_pk_bf16_f32 v53, v170, v171
    v_cvt_pk_bf16_f32 v54, v172, v173
    v_mfma_f32_16x16x32_bf16 v[240:243], v[24:27], v[112:115], v[240:243]
    ds_read_b64_tr_b16 v[40:41], v210 offset:4096
    v_mfma_f32_16x16x32_bf16 v[240:243], v[28:31], v[192:195], v[240:243]
    buffer_load_dwordx4 v4, s[36:39], s80 offen offset:0 lds
    v_mfma_f32_16x16x32_bf16 v[244:247], v[24:27], v[116:119], v[244:247]
    ds_read_b64_tr_b16 v[42:43], v210 offset:22528
    v_mfma_f32_16x16x32_bf16 v[244:247], v[28:31], v[196:199], v[244:247]
    ds_read_b64_tr_b16 v[44:45], v210 offset:6144
    v_cvt_pk_bf16_f32 v55, v174, v175
    v_mfma_f32_16x16x32_bf16 v[248:251], v[24:27], v[120:123], v[248:251]
    ds_read_b64_tr_b16 v[46:47], v210 offset:24576
    v_accvgpr_write_b32 a216, v52
    v_mfma_f32_16x16x32_bf16 v[248:251], v[28:31], v[200:203], v[248:251]
    v_accvgpr_write_b32 a217, v53
    v_mfma_f32_16x16x32_bf16 v[252:255], v[24:27], v[124:127], v[252:255]
    v_mfma_f32_16x16x32_bf16 v[252:255], v[28:31], v[204:207], v[252:255]
    s_waitcnt lgkmcnt(4)
    buffer_load_dwordx4 v4, s[36:39], s81 offen offset:1024 lds
    v_mfma_f32_16x16x32_bf16 v[224:227], v[32:35], a[0:3], v[224:227]
    v_add_u32 v211, 4294856704, v211
    v_mfma_f32_16x16x32_bf16 v[224:227], v[36:39], a[16:19], v[224:227]
    ds_read_b64_tr_b16 v[24:25], v211 offset:0
    v_accvgpr_write_b32 a218, v54
    v_mfma_f32_16x16x32_bf16 v[228:231], v[32:35], a[4:7], v[228:231]
    ds_read_b64_tr_b16 v[26:27], v211 offset:18432
    v_accvgpr_write_b32 a219, v55
    v_mfma_f32_16x16x32_bf16 v[228:231], v[36:39], a[20:23], v[228:231]
    ds_read_b64_tr_b16 v[28:29], v211 offset:2048
    v_mfma_f32_16x16x32_bf16 v[232:235], v[32:35], a[8:11], v[232:235]
    ds_read_b64_tr_b16 v[30:31], v211 offset:20480
    v_cvt_pk_bf16_f32 v56, v176, v177
    v_mfma_f32_16x16x32_bf16 v[232:235], v[36:39], a[24:27], v[232:235]
    buffer_load_dwordx4 v4, s[36:39], s82 offen offset:2048 lds
    v_mfma_f32_16x16x32_bf16 v[236:239], v[32:35], a[12:15], v[236:239]
    v_mfma_f32_16x16x32_bf16 v[236:239], v[36:39], a[28:31], v[236:239]
    s_waitcnt lgkmcnt(4)
    v_cvt_pk_bf16_f32 v57, v178, v179
    v_mfma_f32_16x16x32_bf16 v[224:227], v[40:43], a[32:35], v[224:227]
    ds_read_b64_tr_b16 v[32:33], v211 offset:4096
    v_mfma_f32_16x16x32_bf16 v[224:227], v[44:47], a[48:51], v[224:227]
    buffer_load_dwordx4 v4, s[36:39], s83 offen offset:3072 lds
    v_mfma_f32_16x16x32_bf16 v[228:231], v[40:43], a[36:39], v[228:231]
    ds_read_b64_tr_b16 v[34:35], v211 offset:22528
    v_cvt_pk_bf16_f32 v58, v180, v181
    v_mfma_f32_16x16x32_bf16 v[228:231], v[44:47], a[52:55], v[228:231]
    ds_read_b64_tr_b16 v[36:37], v211 offset:6144
    v_cvt_pk_bf16_f32 v59, v182, v183
    v_mfma_f32_16x16x32_bf16 v[232:235], v[40:43], a[40:43], v[232:235]
    ds_read_b64_tr_b16 v[38:39], v211 offset:24576
    v_mfma_f32_16x16x32_bf16 v[232:235], v[44:47], a[56:59], v[232:235]
    s_add_u32 m0, s85, 81920
    s_waitcnt vmcnt(10)
    v_cmp_ne_u64 vcc, s[48:49], v[2:3]
    v_mfma_f32_16x16x32_bf16 v[236:239], v[40:43], a[44:47], v[236:239]
    v_accvgpr_write_b32 a220, v56
    v_mfma_f32_16x16x32_bf16 v[236:239], v[44:47], a[60:63], v[236:239]
    s_waitcnt lgkmcnt(4)
    s_cmp_lg_u64 vcc, 0
    s_cbranch_scc1 L_pa_slow
L_pa_ok:
    v_mfma_f32_16x16x32_bf16 v[240:243], v[24:27], a[0:3], v[240:243]
    v_add_u32 v212, 4294856704, v212
    v_mfma_f32_16x16x32_bf16 v[240:243], v[28:31], a[16:19], v[240:243]
    ds_read_b64_tr_b16 v[40:41], v212 offset:0
    v_mfma_f32_16x16x32_bf16 v[244:247], v[24:27], a[4:7], v[244:247]
    ds_read_b64_tr_b16 v[42:43], v212 offset:18432
    v_add_u32 v213, 4294856704, v213
    v_mfma_f32_16x16x32_bf16 v[244:247], v[28:31], a[20:23], v[244:247]
    s_mul_i32 s56, s54, 13312
    ds_read_b64_tr_b16 v[44:45], v213 offset:0
    ds_read_b64_tr_b16 v[46:47], v213 offset:18432
    v_mfma_f32_16x16x32_bf16 v[248:251], v[24:27], a[8:11], v[248:251]
    buffer_load_dwordx4 v4, s[36:39], s84 offen offset:0 lds
    v_mfma_f32_16x16x32_bf16 v[248:251], v[28:31], a[24:27], v[248:251]
    v_accvgpr_write_b32 a221, v57
    v_accvgpr_write_b32 a222, v58
    v_mfma_f32_16x16x32_bf16 v[252:255], v[24:27], a[12:15], v[252:255]
    v_accvgpr_write_b32 a223, v59
    v_mfma_f32_16x16x32_bf16 v[252:255], v[28:31], a[28:31], v[252:255]
    s_waitcnt vmcnt(10) lgkmcnt(0)
    v_cvt_pk_bf16_f32 v60, v184, v185
L_pg1_1:
L_pgx9:
    s_cbranch_execz L_pgx13
    v_mfma_f32_16x16x32_bf16 v[240:243], v[32:35], a[32:35], v[240:243]
    s_barrier
    v_mfma_f32_16x16x32_bf16 v[240:243], v[36:39], a[48:51], v[240:243]
    v_add_u32 v208, 36864, v208
    v_mfma_f32_16x16x32_bf16 v[244:247], v[32:35], a[36:39], v[244:247]
    s_add_u32 m0, s56, 110592
    ds_read_b64_tr_b16 v[24:25], v208 offset:0
    v_cvt_pk_bf16_f32 v61, v186, v187
    v_mfma_f32_16x16x32_bf16 v[244:247], v[36:39], a[52:55], v[244:247]
    ds_read_b64_tr_b16 v[26:27], v208 offset:18432
    v_cvt_pk_bf16_f32 v62, v188, v189
    v_mfma_f32_16x16x32_bf16 v[248:251], v[32:35], a[40:43], v[248:251]
    ds_read_b64_tr_b16 v[28:29], v208 offset:2048
    v_mfma_f32_16x16x32_bf16 v[248:251], v[36:39], a[56:59], v[248:251]
    s_add_u32 s57, s56, 0
    ds_read_b64_tr_b16 v[30:31], v208 offset:20480
    v_cvt_pk_bf16_f32 v63, v190, v191
    v_mfma_f32_16x16x32_bf16 v[252:255], v[32:35], a[44:47], v[252:255]
    v_accvgpr_write_b32 a224, v60
    v_mfma_f32_16x16x32_bf16 v[252:255], v[36:39], a[60:63], v[252:255]
    v_accvgpr_write_b32 a225, v61
    v_mfma_f32_16x16x32_bf16 v[224:227], v[40:43], a[64:67], v[224:227]
    ds_read_b64_tr_b16 v[32:33], v208 offset:4096
    v_mfma_f32_16x16x32_bf16 v[228:231], v[40:43], a[68:71], v[228:231]
    buffer_load_dwordx4 v22, s[40:43], s57 offen offset:0 sc1 lds
    v_mfma_f32_16x16x32_bf16 v[232:235], v[40:43], a[72:75], v[232:235]
    ds_read_b64_tr_b16 v[34:35], v208 offset:22528
    v_mfma_f32_16x16x32_bf16 v[236:239], v[40:43], a[76:79], v[236:239]
    ds_read_b64_tr_b16 v[36:37], v208 offset:6144
    v_accvgpr_write_b32 a226, v62
    v_mfma_f32_16x16x32_bf16 v[240:243], v[44:47], a[64:67], v[240:243]
    ds_read_b64_tr_b16 v[38:39], v208 offset:24576
    v_accvgpr_write_b32 a227, v63
    v_mfma_f32_16x16x32_bf16 v[244:247], v[44:47], a[68:71], v[244:247]
    buffer_load_dwordx4 v22, s[40:43], s57 offen offset:1024 sc1 lds
    v_mfma_f32_16x16x32_bf16 v[248:251], v[44:47], a[72:75], v[248:251]
    v_mfma_f32_16x16x32_bf16 v[252:255], v[44:47], a[76:79], v[252:255]
    s_waitcnt lgkmcnt(4)
    v_mfma_f32_16x16x32_bf16 v[160:163], v[24:27], v[80:83], 0
    v_add_u32 v209, 36864, v209
    v_mfma_f32_16x16x32_bf16 v[160:163], v[28:31], v[96:99], v[160:163]
    ds_read_b64_tr_b16 v[40:41], v209 offset:0
    v_mfma_f32_16x16x32_bf16 v[164:167], v[24:27], v[84:87], 0
    buffer_load_dwordx4 v22, s[40:43], s57 offen offset:2048 sc1 lds
    v_mfma_f32_16x16x32_bf16 v[164:167], v[28:31], v[100:103], v[164:167]
    ds_read_b64_tr_b16 v[42:43], v209 offset:18432
    v_mfma_f32_16x16x32_bf16 v[168:171], v[24:27], v[88:91], 0
    ds_read_b64_tr_b16 v[44:45], v209 offset:2048
    v_mfma_f32_16x16x32_bf16 v[168:171], v[28:31], v[104:107], v[168:171]
    buffer_load_dwordx4 v22, s[40:43], s57 offen offset:3072 sc1 lds
    v_mfma_f32_16x16x32_bf16 v[172:175], v[24:27], v[92:95], 0
    ds_read_b64_tr_b16 v[46:47], v209 offset:20480
    v_mfma_f32_16x16x32_bf16 v[172:175], v[28:31], v[108:111], v[172:175]
    s_waitcnt lgkmcnt(4)
    s_add_u32 s32, s40, 4481024
    s_addc_u32 s33, s41, 0
    v_mfma_f32_16x16x32_bf16 v[160:163], v[32:35], v[112:115], v[160:163]
    ds_read_b64_tr_b16 v[24:25], v209 offset:4096
    v_cvt_pk_bf16_f32 v48, v224, v225
    v_mfma_f32_16x16x32_bf16 v[160:163], v[36:39], v[192:195], v[160:163]
    s_add_u32 m0, s56, 114688
    ds_read_b64_tr_b16 v[26:27], v209 offset:22528
    v_cvt_pk_bf16_f32 v49, v226, v227
    v_mfma_f32_16x16x32_bf16 v[164:167], v[32:35], v[116:119], v[164:167]
    ds_read_b64_tr_b16 v[28:29], v209 offset:6144
    v_mfma_f32_16x16x32_bf16 v[164:167], v[36:39], v[196:199], v[164:167]
    ds_read_b64_tr_b16 v[30:31], v209 offset:24576
    v_cvt_pk_bf16_f32 v50, v228, v229
    v_mfma_f32_16x16x32_bf16 v[168:171], v[32:35], v[120:123], v[168:171]
    v_cvt_pk_bf16_f32 v51, v230, v231
    v_mfma_f32_16x16x32_bf16 v[168:171], v[36:39], v[200:203], v[168:171]
    s_add_u32 s57, s56, 4096
    v_mfma_f32_16x16x32_bf16 v[172:175], v[32:35], v[124:127], v[172:175]
    buffer_store_dwordx4 v[48:51], v20, s[32:35], 0 offen offset:0 sc1
    v_mfma_f32_16x16x32_bf16 v[172:175], v[36:39], v[204:207], v[172:175]
    s_waitcnt lgkmcnt(4)
    v_cvt_pk_bf16_f32 v52, v232, v233
    v_mfma_f32_16x16x32_bf16 v[176:179], v[40:43], v[80:83], 0
    v_add_u32 v210, 36864, v210
    v_cvt_pk_bf16_f32 v53, v234, v235
    v_mfma_f32_16x16x32_bf16 v[176:179], v[44:47], v[96:99], v[176:179]
    ds_read_b64_tr_b16 v[32:33], v210 offset:0
    v_mfma_f32_16x16x32_bf16 v[180:183], v[40:43], v[84:87], 0
    buffer_load_dwordx4 v22, s[40:43], s57 offen offset:0 sc1 lds
    v_mfma_f32_16x16x32_bf16 v[180:183], v[44:47], v[100:103], v[180:183]
    ds_read_b64_tr_b16 v[34:35], v210 offset:18432
    v_mfma_f32_16x16x32_bf16 v[184:187], v[40:43], v[88:91], 0
    ds_read_b64_tr_b16 v[36:37], v210 offset:2048
    v_cvt_pk_bf16_f32 v54, v236, v237
    v_mfma_f32_16x16x32_bf16 v[184:187], v[44:47], v[104:107], v[184:187]
    buffer_load_dwordx4 v22, s[40:43], s57 offen offset:1024 sc1 lds
    v_mfma_f32_16x16x32_bf16 v[188:191], v[40:43], v[92:95], 0
    ds_read_b64_tr_b16 v[38:39], v210 offset:20480
    v_mfma_f32_16x16x32_bf16 v[188:191], v[44:47], v[108:111], v[188:191]
    s_waitcnt lgkmcnt(4)
    v_cvt_pk_bf16_f32 v55, v238, v239
    v_mfma_f32_16x16x32_bf16 v[176:179], v[24:27], v[112:115], v[176:179]
    ds_read_b64_tr_b16 v[40:41], v210 offset:4096
    v_accvgpr_write_b32 a228, v52
    v_mfma_f32_16x16x32_bf16 v[176:179], v[28:31], v[192:195], v[176:179]
    ds_read_b64_tr_b16 v[42:43], v210 offset:22528
    v_mov_b32 v2, 0
    v_mfma_f32_16x16x32_bf16 v[180:183], v[24:27], v[116:119], v[180:183]
    ds_read_b64_tr_b16 v[44:45], v210 offset:6144
    v_accvgpr_write_b32 a229, v53
    v_mfma_f32_16x16x32_bf16 v[180:183], v[28:31], v[196:199], v[180:183]
    buffer_load_dwordx4 v22, s[40:43], s57 offen offset:2048 sc1 lds
    v_mfma_f32_16x16x32_bf16 v[184:187], v[24:27], v[120:123], v[184:187]
    ds_read_b64_tr_b16 v[46:47], v210 offset:24576
    v_mfma_f32_16x16x32_bf16 v[184:187], v[28:31], v[200:203], v[184:187]
    v_mov_b32 v3, 0
    v_mfma_f32_16x16x32_bf16 v[188:191], v[24:27], v[124:127], v[188:191]
    v_accvgpr_write_b32 a230, v54
    v_mfma_f32_16x16x32_bf16 v[188:191], v[28:31], v[204:207], v[188:191]
    s_waitcnt lgkmcnt(4)
    v_accvgpr_write_b32 a231, v55
    v_mfma_f32_16x16x32_bf16 v[160:163], v[32:35], a[0:3], v[160:163]
    v_add_u32 v211, 36864, v211
    v_mfma_f32_16x16x32_bf16 v[160:163], v[36:39], a[16:19], v[160:163]
    ds_read_b64_tr_b16 v[24:25], v211 offset:0
    v_cvt_pk_bf16_f32 v56, v240, v241
    v_mfma_f32_16x16x32_bf16 v[164:167], v[32:35], a[4:7], v[164:167]
    s_sub_u32 s59, s98, 4096
    buffer_load_dwordx4 v22, s[40:43], s57 offen offset:3072 sc1 lds
    v_mfma_f32_16x16x32_bf16 v[164:167], v[36:39], a[20:23], v[164:167]
    ds_read_b64_tr_b16 v[26:27], v211 offset:18432
    v_mfma_f32_16x16x32_bf16 v[168:171], v[32:35], a[8:11], v[168:171]
    ds_read_b64_tr_b16 v[28:29], v211 offset:2048
    v_cvt_pk_bf16_f32 v57, v242, v243
    v_mfma_f32_16x16x32_bf16 v[168:171], v[36:39], a[24:27], v[168:171]
    buffer_store_dwordx2 v[2:3], v8, s[40:43], s59 offen sc1
    v_mfma_f32_16x16x32_bf16 v[172:175], v[32:35], a[12:15], v[172:175]
    ds_read_b64_tr_b16 v[30:31], v211 offset:20480
    v_mfma_f32_16x16x32_bf16 v[172:175], v[36:39], a[28:31], v[172:175]
    s_waitcnt lgkmcnt(4)
    v_cvt_pk_bf16_f32 v58, v244, v245
    v_mfma_f32_16x16x32_bf16 v[160:163], v[40:43], a[32:35], v[160:163]
    ds_read_b64_tr_b16 v[32:33], v211 offset:4096
    v_cvt_pk_bf16_f32 v59, v246, v247
    v_mfma_f32_16x16x32_bf16 v[160:163], v[44:47], a[48:51], v[160:163]
    s_add_u32 m0, s56, 118784
    ds_read_b64_tr_b16 v[34:35], v211 offset:22528
    v_mfma_f32_16x16x32_bf16 v[164:167], v[40:43], a[36:39], v[164:167]
    ds_read_b64_tr_b16 v[36:37], v211 offset:6144
    v_mfma_f32_16x16x32_bf16 v[164:167], v[44:47], a[52:55], v[164:167]
    buffer_store_dwordx4 v[56:59], v20, s[32:35], 0 offen offset:1024 sc1
    v_mfma_f32_16x16x32_bf16 v[168:171], v[40:43], a[40:43], v[168:171]
    ds_read_b64_tr_b16 v[38:39], v211 offset:24576
    v_cvt_pk_bf16_f32 v60, v248, v249
    v_mfma_f32_16x16x32_bf16 v[168:171], v[44:47], a[56:59], v[168:171]
    v_cvt_pk_bf16_f32 v61, v250, v251
    v_cvt_pk_bf16_f32 v62, v252, v253
    v_mfma_f32_16x16x32_bf16 v[172:175], v[40:43], a[44:47], v[172:175]
    s_add_u32 s57, s56, 8192
    v_mfma_f32_16x16x32_bf16 v[172:175], v[44:47], a[60:63], v[172:175]
    s_waitcnt lgkmcnt(4)
    v_cvt_pk_bf16_f32 v63, v254, v255
    v_mfma_f32_16x16x32_bf16 v[176:179], v[24:27], a[0:3], v[176:179]
    v_add_u32 v212, 36864, v212
    v_mfma_f32_16x16x32_bf16 v[176:179], v[28:31], a[16:19], v[176:179]
    ds_read_b64_tr_b16 v[40:41], v212 offset:0
    v_accvgpr_write_b32 a232, v60
    v_mfma_f32_16x16x32_bf16 v[180:183], v[24:27], a[4:7], v[180:183]
    ds_read_b64_tr_b16 v[42:43], v212 offset:18432
    v_add_u32 v213, 36864, v213
    v_mfma_f32_16x16x32_bf16 v[180:183], v[28:31], a[20:23], v[180:183]
    ds_read_b64_tr_b16 v[44:45], v213 offset:0
    ds_read_b64_tr_b16 v[46:47], v213 offset:18432
    v_mfma_f32_16x16x32_bf16 v[184:187], v[24:27], a[8:11], v[184:187]
    buffer_load_dwordx4 v22, s[40:43], s57 offen offset:0 sc1 lds
    v_mfma_f32_16x16x32_bf16 v[184:187], v[28:31], a[24:27], v[184:187]
    v_accvgpr_write_b32 a233, v61
    v_mfma_f32_16x16x32_bf16 v[188:191], v[24:27], a[12:15], v[188:191]
    v_accvgpr_write_b32 a234, v62
    v_accvgpr_write_b32 a235, v63
    v_mfma_f32_16x16x32_bf16 v[188:191], v[28:31], a[28:31], v[188:191]
    s_waitcnt vmcnt(6) lgkmcnt(0)
    s_add_u32 s72, s40, s7
    s_addc_u32 s73, s41, 0
    v_mfma_f32_16x16x32_bf16 v[176:179], v[32:35], a[32:35], v[176:179]
    s_barrier
    ds_read_b128 v[220:223], v69
    v_mfma_f32_16x16x32_bf16 v[176:179], v[36:39], a[48:51], v[176:179]
    ds_read_b128 v[216:219], v68
    v_mfma_f32_16x16x32_bf16 v[180:183], v[32:35], a[36:39], v[180:183]
    v_add_u32 v208, 36864, v208
    v_mfma_f32_16x16x32_bf16 v[180:183], v[36:39], a[52:55], v[180:183]
    ds_read_b64_tr_b16 v[24:25], v208 offset:0
    v_mfma_f32_16x16x32_bf16 v[184:187], v[32:35], a[40:43], v[184:187]
    s_add_u32 s74, s40, s8
    ds_read_b64_tr_b16 v[26:27], v208 offset:18432
    s_addc_u32 s75, s41, 0
    v_mfma_f32_16x16x32_bf16 v[184:187], v[36:39], a[56:59], v[184:187]
    buffer_load_dwordx4 v22, s[40:43], s57 offen offset:1024 sc1 lds
    v_mfma_f32_16x16x32_bf16 v[188:191], v[32:35], a[44:47], v[188:191]
    ds_read_b64_tr_b16 v[28:29], v208 offset:2048
    v_mfma_f32_16x16x32_bf16 v[188:191], v[36:39], a[60:63], v[188:191]
    ds_read_b64_tr_b16 v[30:31], v208 offset:20480
    v_mfma_f32_16x16x32_bf16 v[160:163], v[40:43], a[64:67], v[160:163]
    s_add_u32 s76, s40, s85
    ds_read_b64_tr_b16 v[32:33], v208 offset:4096
    s_addc_u32 s77, s41, 0
    v_mfma_f32_16x16x32_bf16 v[164:167], v[40:43], a[68:71], v[164:167]
    buffer_load_dwordx4 v22, s[40:43], s57 offen offset:2048 sc1 lds
    s_waitcnt lgkmcnt(6)
    v_mfma_f32_32x32x4_2b_bf16 v[128:159], v[220:221], v[18:19], 0
    v_mfma_f32_16x16x32_bf16 v[168:171], v[40:43], a[72:75], v[168:171]
    ds_read_b64_tr_b16 v[34:35], v208 offset:22528
    v_mfma_f32_16x16x32_bf16 v[172:175], v[40:43], a[76:79], v[172:175]
    s_mov_b32 s38, 4096
    ds_read_b64_tr_b16 v[36:37], v208 offset:6144
    v_mfma_f32_16x16x32_bf16 v[176:179], v[44:47], a[64:67], v[176:179]
    s_mov_b32 s70, 4096
    ds_read_b64_tr_b16 v[38:39], v208 offset:24576
    v_mfma_f32_16x16x32_bf16 v[180:183], v[44:47], a[68:71], v[180:183]
    s_mov_b32 s71, 0x20000
    v_mfma_f32_16x16x32_bf16 v[184:187], v[44:47], a[72:75], v[184:187]
    v_mfma_f32_16x16x32_bf16 v[188:191], v[44:47], a[76:79], v[188:191]
    s_waitcnt lgkmcnt(4)
    v_mfma_f32_16x16x32_bf16 v[224:227], v[24:27], v[80:83], 0
    v_add_u32 v209, 36864, v209
    v_mfma_f32_16x16x32_bf16 v[224:227], v[28:31], v[96:99], v[224:227]
    ds_read_b64_tr_b16 v[40:41], v209 offset:0
    v_mfma_f32_16x16x32_bf16 v[228:231], v[24:27], v[84:87], 0
    buffer_load_dwordx4 v22, s[40:43], s57 offen offset:3072 sc1 lds
    v_mfma_f32_16x16x32_bf16 v[228:231], v[28:31], v[100:103], v[228:231]
    ds_read_b64_tr_b16 v[42:43], v209 offset:18432
    v_mfma_f32_32x32x16_bf16 v[128:143], v[216:219], v[10:13], v[128:143]
    v_mfma_f32_16x16x32_bf16 v[232:235], v[24:27], v[88:91], 0
    ds_read_b64_tr_b16 v[44:45], v209 offset:2048
    v_mfma_f32_16x16x32_bf16 v[232:235], v[28:31], v[104:107], v[232:235]
    ds_read_b64_tr_b16 v[46:47], v209 offset:20480
    v_mfma_f32_32x32x16_bf16 v[144:159], v[216:219], v[14:17], v[144:159]
    v_mfma_f32_16x16x32_bf16 v[236:239], v[24:27], v[92:95], 0
    s_add_u32 m0, s56, 122880
    s_add_u32 s32, s40, 4485120
    s_addc_u32 s33, s41, 0
    v_mfma_f32_16x16x32_bf16 v[236:239], v[28:31], v[108:111], v[236:239]
    s_waitcnt lgkmcnt(4)
    v_cvt_pk_bf16_f32 v48, v160, v161
    v_mfma_f32_16x16x32_bf16 v[224:227], v[32:35], v[112:115], v[224:227]
    ds_read_b64_tr_b16 v[24:25], v209 offset:4096
    v_cvt_pk_bf16_f32 v49, v162, v163
    v_mfma_f32_16x16x32_bf16 v[224:227], v[36:39], v[192:195], v[224:227]
    ds_read_b64_tr_b16 v[26:27], v209 offset:22528
    v_cvt_pk_bf16_f32 v50, v164, v165
    v_mfma_f32_16x16x32_bf16 v[228:231], v[32:35], v[116:119], v[228:231]
    ds_read_b64_tr_b16 v[28:29], v209 offset:6144
    v_cvt_pk_bf16_f32 v51, v166, v167
    v_mfma_f32_16x16x32_bf16 v[228:231], v[36:39], v[196:199], v[228:231]
    ds_read_b64_tr_b16 v[30:31], v209 offset:24576
    v_max3_f32 v0, v128, v129, v130
    v_mfma_f32_16x16x32_bf16 v[232:235], v[32:35], v[120:123], v[232:235]
    v_max3_f32 v0, v0, v131, v132
    v_mfma_f32_16x16x32_bf16 v[232:235], v[36:39], v[200:203], v[232:235]
    s_add_u32 s57, s56, 12288
    v_max3_f32 v0, v0, v133, v134
    v_mfma_f32_16x16x32_bf16 v[236:239], v[32:35], v[124:127], v[236:239]
    buffer_store_dwordx4 v[48:51], v20, s[32:35], 0 offen offset:0 sc1
    v_mfma_f32_16x16x32_bf16 v[236:239], v[36:39], v[204:207], v[236:239]
    s_waitcnt lgkmcnt(4)
    v_max3_f32 v0, v0, v135, v136
    v_cvt_pk_bf16_f32 v52, v168, v169
    v_mfma_f32_16x16x32_bf16 v[240:243], v[40:43], v[80:83], 0
    v_add_u32 v210, 36864, v210
    v_max3_f32 v0, v0, v137, v138
    v_mfma_f32_16x16x32_bf16 v[240:243], v[44:47], v[96:99], v[240:243]
    ds_read_b64_tr_b16 v[32:33], v210 offset:0
    v_max3_f32 v0, v0, v139, v140
    v_mfma_f32_16x16x32_bf16 v[244:247], v[40:43], v[84:87], 0
    ds_read_b64_tr_b16 v[34:35], v210 offset:18432
    v_max3_f32 v0, v0, v141, v142
    v_mfma_f32_16x16x32_bf16 v[244:247], v[44:47], v[100:103], v[244:247]
    ds_read_b64_tr_b16 v[36:37], v210 offset:2048
    v_max_f32 v0, v0, v143
    v_mfma_f32_16x16x32_bf16 v[248:251], v[40:43], v[88:91], 0
    ds_read_b64_tr_b16 v[38:39], v210 offset:20480
    v_cvt_pk_bf16_f32 v53, v170, v171
    v_mfma_f32_16x16x32_bf16 v[248:251], v[44:47], v[104:107], v[248:251]
    buffer_load_dwordx4 v22, s[40:43], s57 offen offset:0 sc1 lds
    v_max3_f32 v1, v144, v145, v146
    v_mfma_f32_16x16x32_bf16 v[252:255], v[40:43], v[92:95], 0
    v_max3_f32 v1, v1, v147, v148
    v_mfma_f32_16x16x32_bf16 v[252:255], v[44:47], v[108:111], v[252:255]
    s_waitcnt lgkmcnt(4)
    v_max3_f32 v1, v1, v149, v150
    v_cvt_pk_bf16_f32 v54, v172, v173
    v_mfma_f32_16x16x32_bf16 v[240:243], v[24:27], v[112:115], v[240:243]
    ds_read_b64_tr_b16 v[40:41], v210 offset:4096
    v_cvt_pk_bf16_f32 v55, v174, v175
    v_mfma_f32_16x16x32_bf16 v[240:243], v[28:31], v[192:195], v[240:243]
    ds_read_b64_tr_b16 v[42:43], v210 offset:22528
    v_max3_f32 v1, v1, v151, v152
    v_mfma_f32_16x16x32_bf16 v[244:247], v[24:27], v[116:119], v[244:247]
    ds_read_b64_tr_b16 v[44:45], v210 offset:6144
    v_max3_f32 v1, v1, v153, v154
    v_mfma_f32_16x16x32_bf16 v[244:247], v[28:31], v[196:199], v[244:247]
    ds_read_b64_tr_b16 v[46:47], v210 offset:24576
    v_max3_f32 v1, v1, v155, v156
    v_mfma_f32_16x16x32_bf16 v[248:251], v[24:27], v[120:123], v[248:251]
    v_max3_f32 v1, v1, v157, v158
    v_mfma_f32_16x16x32_bf16 v[248:251], v[28:31], v[200:203], v[248:251]
    v_max_f32 v1, v1, v159
    v_accvgpr_write_b32 a236, v52
    v_mfma_f32_16x16x32_bf16 v[252:255], v[24:27], v[124:127], v[252:255]
    v_accvgpr_write_b32 a237, v53
    v_mfma_f32_16x16x32_bf16 v[252:255], v[28:31], v[204:207], v[252:255]
    s_waitcnt lgkmcnt(4)
    v_permlane32_swap_b32 v0, v1
    v_mfma_f32_16x16x32_bf16 v[224:227], v[32:35], a[0:3], v[224:227]
    v_add_u32 v211, 36864, v211
    v_max_f32 v0, v0, v1
    v_mfma_f32_16x16x32_bf16 v[224:227], v[36:39], a[16:19], v[224:227]
    ds_read_b64_tr_b16 v[24:25], v211 offset:0
    v_sub_f32 v0, 0xc2c00000, v0
    v_mov_b32 v96, 0
    v_mfma_f32_16x16x32_bf16 v[228:231], v[32:35], a[4:7], v[228:231]
    v_cvt_pk_bf16_f32 v1, v0, v0
    v_mov_b32 v97, 0
    v_mfma_f32_16x16x32_bf16 v[228:231], v[36:39], a[20:23], v[228:231]
    ds_read_b64_tr_b16 v[26:27], v211 offset:18432
    v_mov_b32 v98, 0
    v_mfma_f32_16x16x32_bf16 v[232:235], v[32:35], a[8:11], v[232:235]
    ds_read_b64_tr_b16 v[28:29], v211 offset:2048
    v_and_b32 v1, 0xffff0000, v1
    v_mfma_f32_16x16x32_bf16 v[232:235], v[36:39], a[24:27], v[232:235]
    v_sub_f32 v0, v0, v1
    v_mov_b32 v99, 0
    v_mfma_f32_16x16x32_bf16 v[236:239], v[32:35], a[12:15], v[236:239]
    ds_read_b64_tr_b16 v[30:31], v211 offset:20480
    v_mov_b32 v100, 0
    v_mfma_f32_16x16x32_bf16 v[236:239], v[36:39], a[28:31], v[236:239]
    s_waitcnt lgkmcnt(4)
    v_cvt_pk_bf16_f32 v19, v1, v0
    v_mov_b32 v101, 0
    v_mfma_f32_16x16x32_bf16 v[224:227], v[40:43], a[32:35], v[224:227]
    ds_read_b64_tr_b16 v[32:33], v211 offset:4096
    v_accvgpr_write_b32 a238, v54
    v_mfma_f32_16x16x32_bf16 v[224:227], v[44:47], a[48:51], v[224:227]
    ds_read_b64_tr_b16 v[34:35], v211 offset:22528
    v_mov_b32 v102, 0
    v_mfma_f32_16x16x32_bf16 v[228:231], v[40:43], a[36:39], v[228:231]
    ds_read_b64_tr_b16 v[36:37], v211 offset:6144
    v_mfma_f32_32x32x4_2b_bf16 v[128:159], v[220:221], v[18:19], 0
    v_mfma_f32_16x16x32_bf16 v[228:231], v[44:47], a[52:55], v[228:231]
    ds_read_b64_tr_b16 v[38:39], v211 offset:24576
    v_mov_b32 v103, 0
    v_mfma_f32_16x16x32_bf16 v[232:235], v[40:43], a[40:43], v[232:235]
    v_mov_b32 v104, 0
    v_mfma_f32_16x16x32_bf16 v[232:235], v[44:47], a[56:59], v[232:235]
    v_mov_b32 v105, 0
    v_accvgpr_write_b32 a239, v55
    v_mfma_f32_16x16x32_bf16 v[236:239], v[40:43], a[44:47], v[236:239]
    v_cvt_pk_bf16_f32 v56, v176, v177
    v_mfma_f32_16x16x32_bf16 v[236:239], v[44:47], a[60:63], v[236:239]
    s_waitcnt lgkmcnt(4)
    v_mov_b32 v106, 0
    v_mfma_f32_16x16x32_bf16 v[240:243], v[24:27], a[0:3], v[240:243]
    v_add_u32 v212, 36864, v212
    v_mov_b32 v107, 0
    v_mfma_f32_16x16x32_bf16 v[240:243], v[28:31], a[16:19], v[240:243]
    ds_read_b64_tr_b16 v[40:41], v212 offset:0
    v_mov_b32 v112, 0
    v_mfma_f32_16x16x32_bf16 v[244:247], v[24:27], a[4:7], v[244:247]
    ds_read_b64_tr_b16 v[42:43], v212 offset:18432
    v_add_u32 v213, 36864, v213
    v_mfma_f32_16x16x32_bf16 v[244:247], v[28:31], a[20:23], v[244:247]
    ds_read_b64_tr_b16 v[44:45], v213 offset:0
    ds_read_b64_tr_b16 v[46:47], v213 offset:18432
    v_mov_b32 v113, 0
    v_mfma_f32_16x16x32_bf16 v[248:251], v[24:27], a[8:11], v[248:251]
    v_mfma_f32_32x32x16_bf16 v[128:143], v[216:219], v[10:13], v[128:143]
    v_mov_b32 v114, 0
    v_mfma_f32_16x16x32_bf16 v[248:251], v[28:31], a[24:27], v[248:251]
    v_mov_b32 v115, 0
    v_cvt_pk_bf16_f32 v57, v178, v179
    v_mfma_f32_16x16x32_bf16 v[252:255], v[24:27], a[12:15], v[252:255]
    v_mfma_f32_32x32x16_bf16 v[144:159], v[216:219], v[14:17], v[144:159]
    v_mfma_f32_16x16x32_bf16 v[252:255], v[28:31], a[28:31], v[252:255]
    s_waitcnt vmcnt(0) lgkmcnt(0)
    v_mov_b32 v116, 0
    v_cvt_pk_bf16_f32 v58, v180, v181
    v_mfma_f32_16x16x32_bf16 v[240:243], v[32:35], a[32:35], v[240:243]
    s_barrier
    v_mfma_f32_16x16x32_bf16 v[240:243], v[36:39], a[48:51], v[240:243]
    v_mov_b32 v117, 0
    v_cvt_pk_bf16_f32 v59, v182, v183
    v_mfma_f32_16x16x32_bf16 v[244:247], v[32:35], a[36:39], v[244:247]
    v_mov_b32 v118, 0
    v_mfma_f32_16x16x32_bf16 v[244:247], v[36:39], a[52:55], v[244:247]
    v_mov_b32 v119, 0
    v_mfma_f32_16x16x32_bf16 v[248:251], v[32:35], a[40:43], v[248:251]
    v_mov_b32 v120, 0
    v_mfma_f32_16x16x32_bf16 v[248:251], v[36:39], a[56:59], v[248:251]
    buffer_store_dwordx4 v[56:59], v20, s[32:35], 0 offen offset:1024 sc1
    v_mfma_f32_16x16x32_bf16 v[252:255], v[32:35], a[44:47], v[252:255]
    v_mov_b32 v121, 0
    v_cvt_pk_bf16_f32 v60, v184, v185
    v_mfma_f32_16x16x32_bf16 v[252:255], v[36:39], a[60:63], v[252:255]
    v_mov_b32 v122, 0
    v_cvt_pk_bf16_f32 v61, v186, v187
    v_mfma_f32_16x16x32_bf16 v[224:227], v[40:43], a[64:67], v[224:227]
    v_cvt_pk_bf16_f32 v62, v188, v189
    v_cvt_pk_bf16_f32 v63, v190, v191
    v_mfma_f32_16x16x32_bf16 v[228:231], v[40:43], a[68:71], v[228:231]
    v_mov_b32 v123, 0
    v_accvgpr_write_b32 a240, v60
    v_mfma_f32_16x16x32_bf16 v[232:235], v[40:43], a[72:75], v[232:235]
    ds_read_b128 v[88:91], v69 offset:0
    v_mfma_f32_16x16x32_bf16 v[236:239], v[40:43], a[76:79], v[236:239]
    ds_read_b128 v[84:87], v68 offset:1024
    v_accvgpr_write_b32 a241, v61
    v_mfma_f32_16x16x32_bf16 v[240:243], v[44:47], a[64:67], v[240:243]
    v_accvgpr_write_b32 a242, v62
    v_mfma_f32_16x16x32_bf16 v[244:247], v[44:47], a[68:71], v[244:247]
    ds_read_b128 v[80:83], v68 offset:4992
    v_accvgpr_write_b32 a243, v63
    v_mfma_f32_16x16x32_bf16 v[248:251], v[44:47], a[72:75], v[248:251]
    ds_read_b128 v[92:95], v69 offset:4992
    v_mfma_f32_16x16x32_bf16 v[252:255], v[44:47], a[76:79], v[252:255]
    ds_read_b128 v[24:27], v64 offset:0
    ds_read_b128 v[28:31], v65 offset:0
    ds_read_b128 v[32:35], v66 offset:0
    ds_read_b128 v[36:39], v67 offset:0
    v_exp_f32 v128, v128
    v_exp_f32 v129, v129
    s_add_u32 m0, s85, 0
    v_exp_f32 v130, v130
    v_exp_f32 v131, v131
    v_exp_f32 v132, v132
    s_waitcnt lgkmcnt(7)
    v_mfma_f32_32x32x4_2b_bf16 v[160:191], v[90:91], v[18:19], 0
    v_exp_f32 v133, v133
    v_exp_f32 v134, v134
    v_exp_f32 v135, v135
    v_exp_f32 v136, v136
    v_exp_f32 v137, v137
    v_exp_f32 v138, v138
    v_exp_f32 v139, v139
    v_exp_f32 v140, v140
    s_waitcnt lgkmcnt(3)
    v_smfmac_f32_32x32x32_bf16 v[96:111], v[24:27], v[128:135], v77
    s_add_u32 s68, s76, 49920
    s_addc_u32 s69, s77, 0
    v_exp_f32 v141, v141
    v_exp_f32 v142, v142
    v_exp_f32 v143, v143
    v_exp_f32 v144, v144
    v_exp_f32 v145, v145
    s_waitcnt lgkmcnt(2)
    v_smfmac_f32_32x32x32_bf16 v[96:111], v[28:31], v[136:143], v77
    buffer_load_dwordx4 v22, s[68:71], 0 offen offset:0 sc1 lds
    v_cvt_pk_bf16_f32 v48, v224, v225
    v_cvt_pk_bf16_f32 v49, v226, v227
    v_cvt_pk_bf16_f32 v50, v228, v229
    v_cvt_pk_bf16_f32 v51, v230, v231
    v_exp_f32 v146, v146
    v_exp_f32 v147, v147
    v_exp_f32 v148, v148
    v_mfma_f32_32x32x16_bf16 v[160:175], v[84:87], v[10:13], v[160:175]
    s_add_u32 s32, s40, 4489216
    s_addc_u32 s33, s41, 0
    ds_read_b128 v[40:43], v64 offset:4992
    v_exp_f32 v149, v149
    v_exp_f32 v150, v150
    v_exp_f32 v151, v151
    v_exp_f32 v152, v152
    v_exp_f32 v153, v153
    v_smfmac_f32_32x32x32_bf16 v[112:127], v[24:27], v[144:151], v77
    buffer_store_dwordx4 v[48:51], v20, s[32:35], 0 offen offset:0 sc1
    v_exp_f32 v154, v154
    v_exp_f32 v155, v155
    v_exp_f32 v156, v156
    v_mfma_f32_32x32x16_bf16 v[176:191], v[84:87], v[14:17], v[176:191]
    ds_read_b128 v[44:47], v65 offset:4992
    v_exp_f32 v157, v157
    v_exp_f32 v158, v158
    v_exp_f32 v159, v159
    v_exp_f32 v160, v160
    v_exp_f32 v161, v161
    v_smfmac_f32_32x32x32_bf16 v[112:127], v[28:31], v[152:159], v77
    ds_read_b128 v[84:87], v68 offset:6016
    v_exp_f32 v162, v162
    v_exp_f32 v163, v163
    v_exp_f32 v164, v164
    v_mfma_f32_32x32x4_2b_bf16 v[128:159], v[92:93], v[18:19], 0
    v_exp_f32 v165, v165
    v_exp_f32 v166, v166
    v_exp_f32 v167, v167
    v_exp_f32 v168, v168
    v_exp_f32 v169, v169
    v_exp_f32 v170, v170
    v_exp_f32 v171, v171
    v_exp_f32 v172, v172
    s_waitcnt lgkmcnt(4)
    v_smfmac_f32_32x32x32_bf16 v[96:111], v[32:35], v[160:167], v77
    buffer_load_dwordx4 v22, s[68:71], 0 offen offset:1024 sc1 lds
    v_exp_f32 v173, v173
    v_exp_f32 v174, v174
    v_exp_f32 v175, v175
    v_exp_f32 v176, v176
    v_exp_f32 v177, v177
    s_waitcnt lgkmcnt(3)
    v_smfmac_f32_32x32x32_bf16 v[96:111], v[36:39], v[168:175], v77
    buffer_load_dwordx4 v22, s[68:71], 0 offen offset:2048 sc1 lds
    v_exp_f32 v178, v178
    v_exp_f32 v179, v179
    v_exp_f32 v180, v180
    v_mfma_f32_32x32x16_bf16 v[128:143], v[80:83], v[10:13], v[128:143]
    buffer_load_dwordx4 v22, s[68:71], 0 offen offset:3072 sc1 lds
    ds_read_b128 v[24:27], v66 offset:4992
    v_cvt_pk_bf16_f32 v52, v232, v233
    v_cvt_pk_bf16_f32 v53, v234, v235
    v_cvt_pk_bf16_f32 v54, v236, v237
    v_cvt_pk_bf16_f32 v55, v238, v239
    v_exp_f32 v181, v181
    v_exp_f32 v182, v182
    v_exp_f32 v183, v183
    v_exp_f32 v184, v184
    v_exp_f32 v185, v185
    v_smfmac_f32_32x32x32_bf16 v[112:127], v[32:35], v[176:183], v77
    buffer_store_dwordx4 v[52:55], v21, s[32:35], 0 offen offset:0 sc1
    v_exp_f32 v186, v186
    v_exp_f32 v187, v187
    v_exp_f32 v188, v188
    v_mfma_f32_32x32x16_bf16 v[144:159], v[80:83], v[14:17], v[144:159]
    ds_read_b128 v[28:31], v67 offset:4992
    v_exp_f32 v189, v189
    v_exp_f32 v190, v190
    v_exp_f32 v191, v191
    v_exp_f32 v128, v128
    v_exp_f32 v129, v129
    v_smfmac_f32_32x32x32_bf16 v[112:127], v[36:39], v[184:191], v77
    s_waitcnt lgkmcnt(2)
    s_add_u32 m0, s85, 4096
    ds_read_b128 v[80:83], v68 offset:9984
    v_exp_f32 v130, v130
    v_exp_f32 v131, v131
    v_exp_f32 v132, v132
    v_mfma_f32_32x32x4_2b_bf16 v[160:191], v[94:95], v[18:19], 0
    v_exp_f32 v133, v133
    v_exp_f32 v134, v134
    v_exp_f32 v135, v135
    v_exp_f32 v136, v136
    v_exp_f32 v137, v137
    v_exp_f32 v138, v138
    v_exp_f32 v139, v139
    v_exp_f32 v140, v140
    v_smfmac_f32_32x32x32_bf16 v[96:111], v[40:43], v[128:135], v77
    s_add_u32 s68, s76, 54016
    s_addc_u32 s69, s77, 0
    ds_read_b128 v[88:91], v69 offset:9984
    v_exp_f32 v141, v141
    v_exp_f32 v142, v142
    v_exp_f32 v143, v143
    v_exp_f32 v144, v144
    v_exp_f32 v145, v145
    v_smfmac_f32_32x32x32_bf16 v[96:111], v[44:47], v[136:143], v77
    buffer_load_dwordx4 v22, s[68:71], 0 offen offset:0 sc1 lds
    v_cvt_pk_bf16_f32 v56, v240, v241
    v_cvt_pk_bf16_f32 v57, v242, v243
    v_cvt_pk_bf16_f32 v58, v244, v245
    v_cvt_pk_bf16_f32 v59, v246, v247
    v_exp_f32 v146, v146
    v_exp_f32 v147, v147
    v_exp_f32 v148, v148
    v_mfma_f32_32x32x16_bf16 v[160:175], v[84:87], v[10:13], v[160:175]
    ds_read_b128 v[32:35], v64 offset:9984
    v_exp_f32 v149, v149
    v_exp_f32 v150, v150
    v_exp_f32 v151, v151
    v_exp_f32 v152, v152
    v_exp_f32 v153, v153
    v_smfmac_f32_32x32x32_bf16 v[112:127], v[40:43], v[144:151], v77
    buffer_store_dwordx4 v[56:59], v20, s[32:35], 0 offen offset:1024 sc1
    v_exp_f32 v154, v154
    v_exp_f32 v155, v155
    v_exp_f32 v156, v156
    v_mfma_f32_32x32x16_bf16 v[176:191], v[84:87], v[14:17], v[176:191]
    ds_read_b128 v[36:39], v65 offset:9984
    v_exp_f32 v157, v157
    v_exp_f32 v158, v158
    v_exp_f32 v159, v159
    v_exp_f32 v160, v160
    v_exp_f32 v161, v161
    v_smfmac_f32_32x32x32_bf16 v[112:127], v[44:47], v[152:159], v77
    s_waitcnt lgkmcnt(2)
    ds_read_b128 v[84:87], v68 offset:11008
    v_exp_f32 v162, v162
    v_exp_f32 v163, v163
    v_exp_f32 v164, v164
    v_mfma_f32_32x32x4_2b_bf16 v[128:159], v[88:89], v[18:19], 0
    v_exp_f32 v165, v165
    v_exp_f32 v166, v166
    v_exp_f32 v167, v167
    v_exp_f32 v168, v168
    v_exp_f32 v169, v169
    v_exp_f32 v170, v170
    v_exp_f32 v171, v171
    v_exp_f32 v172, v172
    v_smfmac_f32_32x32x32_bf16 v[96:111], v[24:27], v[160:167], v77
L_pg1_2:
L_pgx10:
    s_cbranch_execz L_pgx14
    buffer_load_dwordx4 v22, s[68:71], 0 offen offset:1024 sc1 lds
    v_exp_f32 v173, v173
    v_exp_f32 v174, v174
    v_exp_f32 v175, v175
    v_exp_f32 v176, v176
    v_exp_f32 v177, v177
    v_smfmac_f32_32x32x32_bf16 v[96:111], v[28:31], v[168:175], v77
    buffer_load_dwordx4 v22, s[68:71], 0 offen offset:2048 sc1 lds
    v_exp_f32 v178, v178
    v_exp_f32 v179, v179
    v_exp_f32 v180, v180
    v_mfma_f32_32x32x16_bf16 v[128:143], v[80:83], v[10:13], v[128:143]
    buffer_load_dwordx4 v22, s[68:71], 0 offen offset:3072 sc1 lds
    ds_read_b128 v[40:43], v66 offset:9984
    v_cvt_pk_bf16_f32 v60, v248, v249
    v_cvt_pk_bf16_f32 v61, v250, v251
    v_cvt_pk_bf16_f32 v62, v252, v253
    v_cvt_pk_bf16_f32 v63, v254, v255
    v_exp_f32 v181, v181
    v_exp_f32 v182, v182
    v_exp_f32 v183, v183
    v_exp_f32 v184, v184
    v_exp_f32 v185, v185
    v_smfmac_f32_32x32x32_bf16 v[112:127], v[24:27], v[176:183], v77
    buffer_store_dwordx4 v[60:63], v21, s[32:35], 0 offen offset:1024 sc1
    v_exp_f32 v186, v186
    v_exp_f32 v187, v187
    v_exp_f32 v188, v188
    v_mfma_f32_32x32x16_bf16 v[144:159], v[80:83], v[14:17], v[144:159]
    ds_read_b128 v[44:47], v67 offset:9984
    v_exp_f32 v189, v189
    v_exp_f32 v190, v190
    v_exp_f32 v191, v191
    v_exp_f32 v128, v128
    v_exp_f32 v129, v129
    v_smfmac_f32_32x32x32_bf16 v[112:127], v[28:31], v[184:191], v77
    s_waitcnt lgkmcnt(2)
    s_add_u32 m0, s85, 8192
    ds_read_b128 v[80:83], v68 offset:14976
    v_exp_f32 v130, v130
    v_exp_f32 v131, v131
    v_exp_f32 v132, v132
    v_mfma_f32_32x32x4_2b_bf16 v[160:191], v[90:91], v[18:19], 0
    v_exp_f32 v133, v133
    v_exp_f32 v134, v134
    v_exp_f32 v135, v135
    v_exp_f32 v136, v136
    v_exp_f32 v137, v137
    v_exp_f32 v138, v138
    v_exp_f32 v139, v139
    v_exp_f32 v140, v140
    v_smfmac_f32_32x32x32_bf16 v[96:111], v[32:35], v[128:135], v77
    s_add_u32 s68, s76, 58112
    s_addc_u32 s69, s77, 0
    ds_read_b128 v[92:95], v69 offset:14976
    v_exp_f32 v141, v141
    v_exp_f32 v142, v142
    v_exp_f32 v143, v143
    v_exp_f32 v144, v144
    v_exp_f32 v145, v145
    v_smfmac_f32_32x32x32_bf16 v[96:111], v[36:39], v[136:143], v77
    s_add_u32 s32, s40, 4456448
    s_addc_u32 s33, s41, 0
    v_exp_f32 v146, v146
    v_exp_f32 v147, v147
    v_exp_f32 v148, v148
    v_mfma_f32_32x32x16_bf16 v[160:175], v[84:87], v[10:13], v[160:175]
    ds_read_b128 v[24:27], v64 offset:14976
    v_exp_f32 v149, v149
    v_exp_f32 v150, v150
    v_exp_f32 v151, v151
    v_exp_f32 v152, v152
    v_exp_f32 v153, v153
    v_smfmac_f32_32x32x32_bf16 v[112:127], v[32:35], v[144:151], v77
    buffer_store_dwordx4 a[164:167], v21, s[32:35], 0 offen offset:0 sc1
    v_exp_f32 v154, v154
    v_exp_f32 v155, v155
    v_exp_f32 v156, v156
    v_mfma_f32_32x32x16_bf16 v[176:191], v[84:87], v[14:17], v[176:191]
    ds_read_b128 v[28:31], v65 offset:14976
    v_exp_f32 v157, v157
    v_exp_f32 v158, v158
    v_exp_f32 v159, v159
    v_exp_f32 v160, v160
    v_exp_f32 v161, v161
    v_smfmac_f32_32x32x32_bf16 v[112:127], v[36:39], v[152:159], v77
    s_waitcnt lgkmcnt(2)
    ds_read_b128 v[84:87], v68 offset:16000
    v_exp_f32 v162, v162
    v_exp_f32 v163, v163
    v_exp_f32 v164, v164
    v_mfma_f32_32x32x4_2b_bf16 v[128:159], v[92:93], v[18:19], 0
    buffer_load_dwordx4 v22, s[68:71], 0 offen offset:0 sc1 lds
    v_exp_f32 v165, v165
    v_exp_f32 v166, v166
    v_exp_f32 v167, v167
    v_exp_f32 v168, v168
    v_exp_f32 v169, v169
    v_exp_f32 v170, v170
    v_exp_f32 v171, v171
    v_exp_f32 v172, v172
    v_smfmac_f32_32x32x32_bf16 v[96:111], v[40:43], v[160:167], v77
    s_add_u32 m0, s85, 36864
    v_exp_f32 v173, v173
    v_exp_f32 v174, v174
    v_exp_f32 v175, v175
    v_exp_f32 v176, v176
    v_exp_f32 v177, v177
    v_smfmac_f32_32x32x32_bf16 v[96:111], v[44:47], v[168:175], v77
    s_add_u32 s68, s76, 86784
    s_addc_u32 s69, s77, 0
    v_exp_f32 v178, v178
    v_exp_f32 v179, v179
    v_exp_f32 v180, v180
    v_mfma_f32_32x32x16_bf16 v[128:143], v[80:83], v[10:13], v[128:143]
    ds_read_b128 v[32:35], v66 offset:14976
    v_exp_f32 v181, v181
    v_exp_f32 v182, v182
    v_exp_f32 v183, v183
    v_exp_f32 v184, v184
    v_exp_f32 v185, v185
    v_smfmac_f32_32x32x32_bf16 v[112:127], v[40:43], v[176:183], v77
    buffer_store_dwordx4 a[168:171], v21, s[32:35], 0 offen offset:1024 sc1
    v_exp_f32 v186, v186
    v_exp_f32 v187, v187
    v_exp_f32 v188, v188
    v_mfma_f32_32x32x16_bf16 v[144:159], v[80:83], v[14:17], v[144:159]
    ds_read_b128 v[36:39], v67 offset:14976
    v_exp_f32 v189, v189
    v_exp_f32 v190, v190
    v_exp_f32 v191, v191
    v_exp_f32 v128, v128
    v_exp_f32 v129, v129
    v_smfmac_f32_32x32x32_bf16 v[112:127], v[44:47], v[184:191], v77
    s_waitcnt lgkmcnt(2)
    ds_read_b128 v[80:83], v68 offset:19968
    v_exp_f32 v130, v130
    v_exp_f32 v131, v131
    v_exp_f32 v132, v132
    v_mfma_f32_32x32x4_2b_bf16 v[160:191], v[94:95], v[18:19], 0
    v_exp_f32 v133, v133
    v_exp_f32 v134, v134
    v_exp_f32 v135, v135
    v_exp_f32 v136, v136
    v_exp_f32 v137, v137
    v_exp_f32 v138, v138
    v_exp_f32 v139, v139
    v_exp_f32 v140, v140
    v_smfmac_f32_32x32x32_bf16 v[96:111], v[24:27], v[128:135], v77
    buffer_load_dwordx4 v22, s[68:71], 0 offen offset:0 sc1 lds
    ds_read_b128 v[88:91], v69 offset:19968
    v_exp_f32 v141, v141
    v_exp_f32 v142, v142
    v_exp_f32 v143, v143
    v_exp_f32 v144, v144
    v_exp_f32 v145, v145
    v_smfmac_f32_32x32x32_bf16 v[96:111], v[28:31], v[136:143], v77
    buffer_load_dwordx4 v22, s[68:71], 0 offen offset:1024 sc1 lds
    buffer_load_dwordx4 v22, s[68:71], 0 offen offset:2048 sc1 lds
    v_exp_f32 v146, v146
    v_exp_f32 v147, v147
    v_exp_f32 v148, v148
    v_mfma_f32_32x32x16_bf16 v[160:175], v[84:87], v[10:13], v[160:175]
    s_add_u32 s32, s40, 4460544
    s_addc_u32 s33, s41, 0
    ds_read_b128 v[40:43], v64 offset:19968
    v_exp_f32 v149, v149
    v_exp_f32 v150, v150
    v_exp_f32 v151, v151
    v_exp_f32 v152, v152
    v_exp_f32 v153, v153
    v_smfmac_f32_32x32x32_bf16 v[112:127], v[24:27], v[144:151], v77
    buffer_store_dwordx4 a[172:175], v21, s[32:35], 0 offen offset:0 sc1
    v_exp_f32 v154, v154
    v_exp_f32 v155, v155
    v_exp_f32 v156, v156
    v_mfma_f32_32x32x16_bf16 v[176:191], v[84:87], v[14:17], v[176:191]
    ds_read_b128 v[44:47], v65 offset:19968
    v_exp_f32 v157, v157
    v_exp_f32 v158, v158
    v_exp_f32 v159, v159
    v_exp_f32 v160, v160
    v_exp_f32 v161, v161
    v_smfmac_f32_32x32x32_bf16 v[112:127], v[28:31], v[152:159], v77
    s_waitcnt lgkmcnt(2)
    ds_read_b128 v[84:87], v68 offset:20992
    v_exp_f32 v162, v162
    v_exp_f32 v163, v163
    v_exp_f32 v164, v164
    v_mfma_f32_32x32x4_2b_bf16 v[128:159], v[88:89], v[18:19], 0
    buffer_load_dwordx4 v22, s[68:71], 0 offen offset:3072 sc1 lds
    v_exp_f32 v165, v165
    v_exp_f32 v166, v166
    v_exp_f32 v167, v167
    v_exp_f32 v168, v168
    v_exp_f32 v169, v169
    v_exp_f32 v170, v170
    v_exp_f32 v171, v171
    v_exp_f32 v172, v172
    v_smfmac_f32_32x32x32_bf16 v[96:111], v[32:35], v[160:167], v77
    s_add_u32 m0, s85, 40960
    v_exp_f32 v173, v173
    v_exp_f32 v174, v174
    v_exp_f32 v175, v175
    v_exp_f32 v176, v176
    v_exp_f32 v177, v177
    v_smfmac_f32_32x32x32_bf16 v[96:111], v[36:39], v[168:175], v77
    s_add_u32 s68, s76, 90880
    s_addc_u32 s69, s77, 0
    v_exp_f32 v178, v178
    v_exp_f32 v179, v179
    v_exp_f32 v180, v180
    v_mfma_f32_32x32x16_bf16 v[128:143], v[80:83], v[10:13], v[128:143]
    ds_read_b128 v[24:27], v66 offset:19968
    v_exp_f32 v181, v181
    v_exp_f32 v182, v182
    v_exp_f32 v183, v183
    v_exp_f32 v184, v184
    v_exp_f32 v185, v185
    v_smfmac_f32_32x32x32_bf16 v[112:127], v[32:35], v[176:183], v77
    buffer_store_dwordx4 a[176:179], v20, s[32:35], 0 offen offset:1024 sc1
    v_exp_f32 v186, v186
    v_exp_f32 v187, v187
    v_exp_f32 v188, v188
    v_mfma_f32_32x32x16_bf16 v[144:159], v[80:83], v[14:17], v[144:159]
    ds_read_b128 v[28:31], v67 offset:19968
    v_exp_f32 v189, v189
    v_exp_f32 v190, v190
    v_exp_f32 v191, v191
    v_exp_f32 v128, v128
    v_exp_f32 v129, v129
    v_smfmac_f32_32x32x32_bf16 v[112:127], v[36:39], v[184:191], v77
    s_waitcnt lgkmcnt(2)
    ds_read_b128 v[80:83], v68 offset:24960
    v_exp_f32 v130, v130
    v_exp_f32 v131, v131
    v_exp_f32 v132, v132
    v_mfma_f32_32x32x4_2b_bf16 v[160:191], v[90:91], v[18:19], 0
    v_exp_f32 v133, v133
    v_exp_f32 v134, v134
    v_exp_f32 v135, v135
    v_exp_f32 v136, v136
    v_exp_f32 v137, v137
    v_exp_f32 v138, v138
    v_exp_f32 v139, v139
    v_exp_f32 v140, v140
    v_smfmac_f32_32x32x32_bf16 v[96:111], v[40:43], v[128:135], v77
    buffer_load_dwordx4 v22, s[68:71], 0 offen offset:0 sc1 lds
    ds_read_b128 v[92:95], v69 offset:24960
    v_exp_f32 v141, v141
    v_exp_f32 v142, v142
    v_exp_f32 v143, v143
    v_exp_f32 v144, v144
    v_exp_f32 v145, v145
    v_smfmac_f32_32x32x32_bf16 v[96:111], v[44:47], v[136:143], v77
    buffer_load_dwordx4 v22, s[68:71], 0 offen offset:1024 sc1 lds
    v_exp_f32 v146, v146
    v_exp_f32 v147, v147
    v_exp_f32 v148, v148
    v_mfma_f32_32x32x16_bf16 v[160:175], v[84:87], v[10:13], v[160:175]
    buffer_load_dwordx4 v22, s[68:71], 0 offen offset:2048 sc1 lds
    ds_read_b128 v[32:35], v64 offset:24960
    v_exp_f32 v149, v149
    v_exp_f32 v150, v150
    v_exp_f32 v151, v151
    v_exp_f32 v152, v152
    v_exp_f32 v153, v153
    v_smfmac_f32_32x32x32_bf16 v[112:127], v[40:43], v[144:151], v77
    buffer_store_dwordx4 a[180:183], v21, s[32:35], 0 offen offset:1024 sc1
    v_exp_f32 v154, v154
    v_exp_f32 v155, v155
    v_exp_f32 v156, v156
    v_mfma_f32_32x32x16_bf16 v[176:191], v[84:87], v[14:17], v[176:191]
    ds_read_b128 v[36:39], v65 offset:24960
    v_exp_f32 v157, v157
    v_exp_f32 v158, v158
    v_exp_f32 v159, v159
    v_exp_f32 v160, v160
    v_exp_f32 v161, v161
    v_smfmac_f32_32x32x32_bf16 v[112:127], v[44:47], v[152:159], v77
    s_waitcnt lgkmcnt(2)
    ds_read_b128 v[84:87], v68 offset:25984
    v_exp_f32 v162, v162
    v_exp_f32 v163, v163
    v_exp_f32 v164, v164
    v_mfma_f32_32x32x4_2b_bf16 v[128:159], v[92:93], v[18:19], 0
    buffer_load_dwordx4 v22, s[68:71], 0 offen offset:3072 sc1 lds
    v_exp_f32 v165, v165
    v_exp_f32 v166, v166
    v_exp_f32 v167, v167
    v_exp_f32 v168, v168
    v_exp_f32 v169, v169
    v_exp_f32 v170, v170
    v_exp_f32 v171, v171
    v_exp_f32 v172, v172
    v_smfmac_f32_32x32x32_bf16 v[96:111], v[24:27], v[160:167], v77
    s_add_u32 m0, s85, 45056
    v_exp_f32 v173, v173
    v_exp_f32 v174, v174
    v_exp_f32 v175, v175
    v_exp_f32 v176, v176
    v_exp_f32 v177, v177
    v_smfmac_f32_32x32x32_bf16 v[96:111], v[28:31], v[168:175], v77
    s_add_u32 s32, s40, 4464640
    s_addc_u32 s33, s41, 0
    v_exp_f32 v178, v178
    v_exp_f32 v179, v179
    v_exp_f32 v180, v180
    v_mfma_f32_32x32x16_bf16 v[128:143], v[80:83], v[10:13], v[128:143]
    ds_read_b128 v[40:43], v66 offset:24960
    v_exp_f32 v181, v181
    v_exp_f32 v182, v182
    v_exp_f32 v183, v183
    v_exp_f32 v184, v184
    v_exp_f32 v185, v185
    v_smfmac_f32_32x32x32_bf16 v[112:127], v[24:27], v[176:183], v77
    buffer_store_dwordx4 a[184:187], v21, s[32:35], 0 offen offset:0 sc1
    v_exp_f32 v186, v186
    v_exp_f32 v187, v187
    v_exp_f32 v188, v188
    v_mfma_f32_32x32x16_bf16 v[144:159], v[80:83], v[14:17], v[144:159]
    ds_read_b128 v[44:47], v67 offset:24960
    v_exp_f32 v189, v189
    v_exp_f32 v190, v190
    v_exp_f32 v191, v191
    v_exp_f32 v128, v128
    v_exp_f32 v129, v129
    v_smfmac_f32_32x32x32_bf16 v[112:127], v[28:31], v[184:191], v77
    s_waitcnt lgkmcnt(2)
    ds_read_b128 v[80:83], v68 offset:29952
    v_exp_f32 v130, v130
    v_exp_f32 v131, v131
    v_exp_f32 v132, v132
    v_mfma_f32_32x32x4_2b_bf16 v[160:191], v[94:95], v[18:19], 0
    v_exp_f32 v133, v133
    v_exp_f32 v134, v134
    v_exp_f32 v135, v135
    v_exp_f32 v136, v136
    v_exp_f32 v137, v137
    v_exp_f32 v138, v138
    v_exp_f32 v139, v139
    v_exp_f32 v140, v140
    v_smfmac_f32_32x32x32_bf16 v[96:111], v[32:35], v[128:135], v77
    s_add_u32 s68, s76, 94976
    s_addc_u32 s69, s77, 0
    ds_read_b128 v[88:91], v69 offset:29952
    v_exp_f32 v141, v141
    v_exp_f32 v142, v142
    v_exp_f32 v143, v143
    v_exp_f32 v144, v144
    v_exp_f32 v145, v145
    v_smfmac_f32_32x32x32_bf16 v[96:111], v[36:39], v[136:143], v77
    buffer_load_dwordx4 v22, s[68:71], 0 offen offset:0 sc1 lds
    v_exp_f32 v146, v146
    v_exp_f32 v147, v147
    v_exp_f32 v148, v148
    v_mfma_f32_32x32x16_bf16 v[160:175], v[84:87], v[10:13], v[160:175]
    s_add_u32 m0, s85, 73728
    ds_read_b128 v[24:27], v64 offset:29952
    v_exp_f32 v149, v149
    v_exp_f32 v150, v150
    v_exp_f32 v151, v151
    v_exp_f32 v152, v152
    v_exp_f32 v153, v153
    v_smfmac_f32_32x32x32_bf16 v[112:127], v[32:35], v[144:151], v77
    buffer_store_dwordx4 a[188:191], v20, s[32:35], 0 offen offset:1024 sc1
    v_exp_f32 v154, v154
    v_exp_f32 v155, v155
    v_exp_f32 v156, v156
    v_mfma_f32_32x32x16_bf16 v[176:191], v[84:87], v[14:17], v[176:191]
    ds_read_b128 v[28:31], v65 offset:29952
    v_exp_f32 v157, v157
    v_exp_f32 v158, v158
    v_exp_f32 v159, v159
    v_exp_f32 v160, v160
    v_exp_f32 v161, v161
    v_smfmac_f32_32x32x32_bf16 v[112:127], v[36:39], v[152:159], v77
    s_waitcnt lgkmcnt(2)
    ds_read_b128 v[84:87], v68 offset:30976
    v_exp_f32 v162, v162
    v_exp_f32 v163, v163
    v_exp_f32 v164, v164
    v_mfma_f32_32x32x4_2b_bf16 v[128:159], v[88:89], v[18:19], 0
    v_exp_f32 v165, v165
    v_exp_f32 v166, v166
    v_exp_f32 v167, v167
    v_exp_f32 v168, v168
    v_exp_f32 v169, v169
    v_exp_f32 v170, v170
    v_exp_f32 v171, v171
    v_exp_f32 v172, v172
    v_smfmac_f32_32x32x32_bf16 v[96:111], v[40:43], v[160:167], v77
    s_add_u32 s68, s76, 123648
    s_addc_u32 s69, s77, 0
    v_exp_f32 v173, v173
    v_exp_f32 v174, v174
    v_exp_f32 v175, v175
    v_exp_f32 v176, v176
    v_exp_f32 v177, v177
    v_smfmac_f32_32x32x32_bf16 v[96:111], v[44:47], v[168:175], v77
    buffer_load_dwordx4 v22, s[68:71], 0 offen offset:0 sc1 lds
    v_exp_f32 v178, v178
    v_exp_f32 v179, v179
    v_exp_f32 v180, v180
    v_mfma_f32_32x32x16_bf16 v[128:143], v[80:83], v[10:13], v[128:143]
    buffer_load_dwordx4 v22, s[68:71], 0 offen offset:1024 sc1 lds
    ds_read_b128 v[32:35], v66 offset:29952
    v_exp_f32 v181, v181
    v_exp_f32 v182, v182
    v_exp_f32 v183, v183
    v_exp_f32 v184, v184
    v_exp_f32 v185, v185
    v_smfmac_f32_32x32x32_bf16 v[112:127], v[40:43], v[176:183], v77
    buffer_store_dwordx4 a[192:195], v21, s[32:35], 0 offen offset:1024 sc1
    v_exp_f32 v186, v186
    v_exp_f32 v187, v187
    v_exp_f32 v188, v188
    v_mfma_f32_32x32x16_bf16 v[144:159], v[80:83], v[14:17], v[144:159]
    ds_read_b128 v[36:39], v67 offset:29952
    v_exp_f32 v189, v189
    v_exp_f32 v190, v190
    v_exp_f32 v191, v191
    v_exp_f32 v128, v128
    v_exp_f32 v129, v129
    v_smfmac_f32_32x32x32_bf16 v[112:127], v[44:47], v[184:191], v77
    s_waitcnt lgkmcnt(2)
    ds_read_b128 v[80:83], v68 offset:34944
    v_exp_f32 v130, v130
    v_exp_f32 v131, v131
    v_exp_f32 v132, v132
    v_mfma_f32_32x32x4_2b_bf16 v[160:191], v[90:91], v[18:19], 0
    buffer_load_dwordx4 v22, s[68:71], 0 offen offset:2048 sc1 lds
    v_exp_f32 v133, v133
    v_exp_f32 v134, v134
    v_exp_f32 v135, v135
    v_exp_f32 v136, v136
    v_exp_f32 v137, v137
    v_exp_f32 v138, v138
    v_exp_f32 v139, v139
    v_exp_f32 v140, v140
    v_smfmac_f32_32x32x32_bf16 v[96:111], v[24:27], v[128:135], v77
    buffer_load_dwordx4 v22, s[68:71], 0 offen offset:3072 sc1 lds
    ds_read_b128 v[92:95], v69 offset:34944
    v_exp_f32 v141, v141
    v_exp_f32 v142, v142
    v_exp_f32 v143, v143
    v_exp_f32 v144, v144
    v_exp_f32 v145, v145
    v_smfmac_f32_32x32x32_bf16 v[96:111], v[28:31], v[136:143], v77
    s_add_u32 m0, s85, 77824
    s_add_u32 s32, s40, 4468736
    s_addc_u32 s33, s41, 0
    v_exp_f32 v146, v146
    v_exp_f32 v147, v147
    v_exp_f32 v148, v148
    v_mfma_f32_32x32x16_bf16 v[160:175], v[84:87], v[10:13], v[160:175]
    ds_read_b128 v[40:43], v64 offset:34944
    v_exp_f32 v149, v149
    v_exp_f32 v150, v150
    v_exp_f32 v151, v151
    v_exp_f32 v152, v152
    v_exp_f32 v153, v153
    v_smfmac_f32_32x32x32_bf16 v[112:127], v[24:27], v[144:151], v77
    buffer_store_dwordx4 a[196:199], v21, s[32:35], 0 offen offset:0 sc1
    v_exp_f32 v154, v154
    v_exp_f32 v155, v155
    v_exp_f32 v156, v156
    v_mfma_f32_32x32x16_bf16 v[176:191], v[84:87], v[14:17], v[176:191]
    ds_read_b128 v[44:47], v65 offset:34944
    v_exp_f32 v157, v157
    v_exp_f32 v158, v158
    v_exp_f32 v159, v159
    v_exp_f32 v160, v160
    v_exp_f32 v161, v161
    v_smfmac_f32_32x32x32_bf16 v[112:127], v[28:31], v[152:159], v77
    s_waitcnt lgkmcnt(2)
    ds_read_b128 v[84:87], v68 offset:35968
    v_exp_f32 v162, v162
    v_exp_f32 v163, v163
    v_exp_f32 v164, v164
    v_mfma_f32_32x32x4_2b_bf16 v[128:159], v[92:93], v[18:19], 0
    v_exp_f32 v165, v165
    v_exp_f32 v166, v166
    v_exp_f32 v167, v167
    v_exp_f32 v168, v168
    v_exp_f32 v169, v169
    v_exp_f32 v170, v170
    v_exp_f32 v171, v171
    v_exp_f32 v172, v172
    v_smfmac_f32_32x32x32_bf16 v[96:111], v[32:35], v[160:167], v77
    s_add_u32 s68, s76, 127744
    s_addc_u32 s69, s77, 0
    v_exp_f32 v173, v173
    v_exp_f32 v174, v174
    v_exp_f32 v175, v175
    v_exp_f32 v176, v176
    v_exp_f32 v177, v177
    v_smfmac_f32_32x32x32_bf16 v[96:111], v[36:39], v[168:175], v77
    buffer_load_dwordx4 v22, s[68:71], 0 offen offset:0 sc1 lds
    v_exp_f32 v178, v178
    v_exp_f32 v179, v179
    v_exp_f32 v180, v180
    v_mfma_f32_32x32x16_bf16 v[128:143], v[80:83], v[10:13], v[128:143]
    buffer_load_dwordx4 v22, s[68:71], 0 offen offset:1024 sc1 lds
    ds_read_b128 v[24:27], v66 offset:34944
    v_exp_f32 v181, v181
    v_exp_f32 v182, v182
    v_exp_f32 v183, v183
    v_exp_f32 v184, v184
    v_exp_f32 v185, v185
    v_smfmac_f32_32x32x32_bf16 v[112:127], v[32:35], v[176:183], v77
    buffer_store_dwordx4 a[200:203], v20, s[32:35], 0 offen offset:1024 sc1
    v_exp_f32 v186, v186
    v_exp_f32 v187, v187
    v_exp_f32 v188, v188
    v_mfma_f32_32x32x16_bf16 v[144:159], v[80:83], v[14:17], v[144:159]
    ds_read_b128 v[28:31], v67 offset:34944
    v_exp_f32 v189, v189
    v_exp_f32 v190, v190
    v_exp_f32 v191, v191
    v_exp_f32 v128, v128
    v_exp_f32 v129, v129
    v_smfmac_f32_32x32x32_bf16 v[112:127], v[36:39], v[184:191], v77
    s_waitcnt lgkmcnt(2)
    ds_read_b128 v[80:83], v68 offset:39936
    v_exp_f32 v130, v130
    v_exp_f32 v131, v131
    v_exp_f32 v132, v132
    v_mfma_f32_32x32x4_2b_bf16 v[160:191], v[94:95], v[18:19], 0
    v_exp_f32 v133, v133
    v_exp_f32 v134, v134
    v_exp_f32 v135, v135
    v_exp_f32 v136, v136
    v_exp_f32 v137, v137
    v_exp_f32 v138, v138
    v_exp_f32 v139, v139
    v_exp_f32 v140, v140
    v_smfmac_f32_32x32x32_bf16 v[96:111], v[40:43], v[128:135], v77
    buffer_load_dwordx4 v22, s[68:71], 0 offen offset:2048 sc1 lds
    ds_read_b128 v[88:91], v69 offset:39936
    v_exp_f32 v141, v141
    v_exp_f32 v142, v142
    v_exp_f32 v143, v143
    v_exp_f32 v144, v144
    v_exp_f32 v145, v145
    v_smfmac_f32_32x32x32_bf16 v[96:111], v[44:47], v[136:143], v77
    buffer_load_dwordx4 v22, s[68:71], 0 offen offset:3072 sc1 lds
    v_exp_f32 v146, v146
    v_exp_f32 v147, v147
    v_exp_f32 v148, v148
    v_mfma_f32_32x32x16_bf16 v[160:175], v[84:87], v[10:13], v[160:175]
    ds_read_b128 v[32:35], v64 offset:39936
    v_exp_f32 v149, v149
    v_exp_f32 v150, v150
    v_exp_f32 v151, v151
    v_exp_f32 v152, v152
    v_exp_f32 v153, v153
    v_smfmac_f32_32x32x32_bf16 v[112:127], v[40:43], v[144:151], v77
    buffer_store_dwordx4 a[204:207], v21, s[32:35], 0 offen offset:1024 sc1
    v_exp_f32 v154, v154
    v_exp_f32 v155, v155
    v_exp_f32 v156, v156
    v_mfma_f32_32x32x16_bf16 v[176:191], v[84:87], v[14:17], v[176:191]
    ds_read_b128 v[36:39], v65 offset:39936
    v_exp_f32 v157, v157
    v_exp_f32 v158, v158
    v_exp_f32 v159, v159
    v_exp_f32 v160, v160
    v_exp_f32 v161, v161
    v_smfmac_f32_32x32x32_bf16 v[112:127], v[44:47], v[152:159], v77
    s_waitcnt lgkmcnt(2)
    s_add_u32 m0, s85, 81920
    ds_read_b128 v[84:87], v68 offset:40960
    v_exp_f32 v162, v162
    v_exp_f32 v163, v163
    v_exp_f32 v164, v164
    v_mfma_f32_32x32x4_2b_bf16 v[128:159], v[88:89], v[18:19], 0
    v_exp_f32 v165, v165
    v_exp_f32 v166, v166
    v_exp_f32 v167, v167
    v_exp_f32 v168, v168
    v_exp_f32 v169, v169
    v_exp_f32 v170, v170
    v_exp_f32 v171, v171
    v_exp_f32 v172, v172
    v_smfmac_f32_32x32x32_bf16 v[96:111], v[24:27], v[160:167], v77
    s_add_u32 s57, s85, 131840
    v_add_u32 v0, s57, v22
    v_min_u32 v0, 159728, v0
    buffer_load_dwordx4 v0, s[40:43], 0 offen sc1 lds
    v_exp_f32 v173, v173
    v_exp_f32 v174, v174
    v_exp_f32 v175, v175
    v_exp_f32 v176, v176
    v_exp_f32 v177, v177
    v_smfmac_f32_32x32x32_bf16 v[96:111], v[28:31], v[168:175], v77
    s_add_u32 s32, s40, 4472832
    s_addc_u32 s33, s41, 0
    v_exp_f32 v178, v178
    v_exp_f32 v179, v179
    v_exp_f32 v180, v180
    v_mfma_f32_32x32x16_bf16 v[128:143], v[80:83], v[10:13], v[128:143]
    ds_read_b128 v[40:43], v66 offset:39936
    v_exp_f32 v181, v181
    v_exp_f32 v182, v182
    v_exp_f32 v183, v183
    v_exp_f32 v184, v184
    v_exp_f32 v185, v185
    v_smfmac_f32_32x32x32_bf16 v[112:127], v[24:27], v[176:183], v77
    buffer_store_dwordx4 a[208:211], v21, s[32:35], 0 offen offset:0 sc1
    v_exp_f32 v186, v186
    v_exp_f32 v187, v187
    v_exp_f32 v188, v188
    v_mfma_f32_32x32x16_bf16 v[144:159], v[80:83], v[14:17], v[144:159]
    s_waitcnt vmcnt(29)
    s_barrier
    ds_read_b128 v[44:47], v67 offset:39936
    v_exp_f32 v189, v189
    v_exp_f32 v190, v190
    v_exp_f32 v191, v191
    v_exp_f32 v128, v128
    v_exp_f32 v129, v129
    v_smfmac_f32_32x32x32_bf16 v[112:127], v[28:31], v[184:191], v77
    s_waitcnt lgkmcnt(2)
    ds_read_b128 v[80:83], v68 offset:44928
    v_exp_f32 v130, v130
    v_exp_f32 v131, v131
    v_exp_f32 v132, v132
    v_mfma_f32_32x32x4_2b_bf16 v[160:191], v[90:91], v[18:19], 0
    v_exp_f32 v133, v133
    v_exp_f32 v134, v134
    v_exp_f32 v135, v135
    v_exp_f32 v136, v136
    v_exp_f32 v137, v137
    v_exp_f32 v138, v138
    v_exp_f32 v139, v139
    v_exp_f32 v140, v140
    v_smfmac_f32_32x32x32_bf16 v[96:111], v[32:35], v[128:135], v77
    s_add_u32 s36, s72, 0
    s_addc_u32 s37, s73, 0
    ds_read_b128 v[92:95], v69 offset:44928
    v_exp_f32 v141, v141
    v_exp_f32 v142, v142
    v_exp_f32 v143, v143
    v_exp_f32 v144, v144
    v_exp_f32 v145, v145
    v_smfmac_f32_32x32x32_bf16 v[96:111], v[36:39], v[136:143], v77
    buffer_load_dwordx4 a[0:3], v22, s[36:39], 0 offen offset:0 sc1
    v_exp_f32 v146, v146
    v_exp_f32 v147, v147
    v_exp_f32 v148, v148
    v_mfma_f32_32x32x16_bf16 v[160:175], v[84:87], v[10:13], v[160:175]
    buffer_load_dwordx4 a[16:19], v22, s[36:39], 0 offen offset:1024 sc1
    ds_read_b128 v[24:27], v64 offset:44928
    v_exp_f32 v149, v149
    v_exp_f32 v150, v150
    v_exp_f32 v151, v151
    v_exp_f32 v152, v152
    v_exp_f32 v153, v153
    v_smfmac_f32_32x32x32_bf16 v[112:127], v[32:35], v[144:151], v77
    buffer_store_dwordx4 a[212:215], v21, s[32:35], 0 offen offset:1024 sc1
    v_exp_f32 v154, v154
    v_exp_f32 v155, v155
    v_exp_f32 v156, v156
    v_mfma_f32_32x32x16_bf16 v[176:191], v[84:87], v[14:17], v[176:191]
    ds_read_b128 v[28:31], v65 offset:44928
    v_exp_f32 v157, v157
    v_exp_f32 v158, v158
    v_exp_f32 v159, v159
    v_exp_f32 v160, v160
    v_exp_f32 v161, v161
    v_smfmac_f32_32x32x32_bf16 v[112:127], v[36:39], v[152:159], v77
    s_waitcnt lgkmcnt(2)
    ds_read_b128 v[84:87], v68 offset:45952
    v_exp_f32 v162, v162
    v_exp_f32 v163, v163
    v_exp_f32 v164, v164
    v_mfma_f32_32x32x4_2b_bf16 v[128:159], v[92:93], v[18:19], 0
    v_exp_f32 v165, v165
    v_exp_f32 v166, v166
    v_exp_f32 v167, v167
    v_exp_f32 v168, v168
    v_exp_f32 v169, v169
    v_exp_f32 v170, v170
    v_exp_f32 v171, v171
    v_exp_f32 v172, v172
    v_smfmac_f32_32x32x32_bf16 v[96:111], v[40:43], v[160:167], v77
    buffer_load_dwordx4 a[32:35], v22, s[36:39], 0 offen offset:2048 sc1
    buffer_load_dwordx4 a[48:51], v22, s[36:39], 0 offen offset:3072 sc1
    v_exp_f32 v173, v173
    v_exp_f32 v174, v174
    v_exp_f32 v175, v175
    v_exp_f32 v176, v176
    v_exp_f32 v177, v177
    v_smfmac_f32_32x32x32_bf16 v[96:111], v[44:47], v[168:175], v77
    s_add_u32 s36, s72, 4096
    s_addc_u32 s37, s73, 0
    v_exp_f32 v178, v178
    v_exp_f32 v179, v179
    v_exp_f32 v180, v180
    v_mfma_f32_32x32x16_bf16 v[128:143], v[80:83], v[10:13], v[128:143]
    s_add_u32 s32, s40, 4476928
    s_addc_u32 s33, s41, 0
    ds_read_b128 v[32:35], v66 offset:44928
    v_exp_f32 v181, v181
    v_exp_f32 v182, v182
    v_exp_f32 v183, v183
    v_exp_f32 v184, v184
    v_exp_f32 v185, v185
    v_smfmac_f32_32x32x32_bf16 v[112:127], v[40:43], v[176:183], v77
    buffer_store_dwordx4 a[216:219], v21, s[32:35], 0 offen offset:0 sc1
    v_exp_f32 v186, v186
    v_exp_f32 v187, v187
    v_exp_f32 v188, v188
    v_mfma_f32_32x32x16_bf16 v[144:159], v[80:83], v[14:17], v[144:159]
    ds_read_b128 v[36:39], v67 offset:44928
    v_exp_f32 v189, v189
    v_exp_f32 v190, v190
    v_exp_f32 v191, v191
    v_add_u32 v68, 4294856704, v68
    v_add_u32 v69, 4294856704, v69
    v_add_u32 v64, v70, v64
    v_add_u32 v65, v70, v65
    v_exp_f32 v128, v128
    v_exp_f32 v129, v129
    v_smfmac_f32_32x32x32_bf16 v[112:127], v[44:47], v[184:191], v77
    s_waitcnt lgkmcnt(2)
    ds_read_b128 v[80:83], v68 offset:0
    v_exp_f32 v130, v130
    v_exp_f32 v131, v131
    v_exp_f32 v132, v132
    v_mfma_f32_32x32x4_2b_bf16 v[160:191], v[94:95], v[18:19], 0
    v_exp_f32 v133, v133
    v_exp_f32 v134, v134
    v_exp_f32 v135, v135
    v_exp_f32 v136, v136
    v_exp_f32 v137, v137
    v_exp_f32 v138, v138
    v_exp_f32 v139, v139
    v_exp_f32 v140, v140
    v_smfmac_f32_32x32x32_bf16 v[96:111], v[24:27], v[128:135], v77
    buffer_load_dwordx4 a[64:67], v22, s[36:39], 0 offen offset:0 sc1
    ds_read_b128 v[88:91], v69 offset:0
    v_exp_f32 v141, v141
    v_exp_f32 v142, v142
    v_exp_f32 v143, v143
    v_exp_f32 v144, v144
    v_exp_f32 v145, v145
    v_smfmac_f32_32x32x32_bf16 v[96:111], v[28:31], v[136:143], v77
    buffer_load_dwordx4 a[80:83], v22, s[36:39], 0 offen offset:1024 sc1
    v_exp_f32 v146, v146
    v_exp_f32 v147, v147
    v_exp_f32 v148, v148
    v_mfma_f32_32x32x16_bf16 v[160:175], v[84:87], v[10:13], v[160:175]
    buffer_load_dwordx4 a[96:99], v22, s[36:39], 0 offen offset:2048 sc1
    ds_read_b128 v[40:43], v64 offset:0
    v_exp_f32 v149, v149
    v_exp_f32 v150, v150
    v_exp_f32 v151, v151
    v_exp_f32 v152, v152
    v_exp_f32 v153, v153
    v_smfmac_f32_32x32x32_bf16 v[112:127], v[24:27], v[144:151], v77
    buffer_store_dwordx4 a[220:223], v20, s[32:35], 0 offen offset:1024 sc1
    v_exp_f32 v154, v154
    v_exp_f32 v155, v155
    v_exp_f32 v156, v156
    v_mfma_f32_32x32x16_bf16 v[176:191], v[84:87], v[14:17], v[176:191]
    ds_read_b128 v[44:47], v65 offset:0
    v_exp_f32 v157, v157
    v_exp_f32 v158, v158
    v_exp_f32 v159, v159
    v_add_u32 v66, v70, v66
    v_add_u32 v67, v70, v67
    v_exp_f32 v160, v160
    v_exp_f32 v161, v161
    v_smfmac_f32_32x32x32_bf16 v[112:127], v[28:31], v[152:159], v77
    s_waitcnt lgkmcnt(2)
    ds_read_b128 v[84:87], v68 offset:1024
    v_exp_f32 v162, v162
    v_exp_f32 v163, v163
    v_exp_f32 v164, v164
    v_mfma_f32_32x32x4_2b_bf16 v[128:159], v[88:89], v[18:19], 0
    v_exp_f32 v165, v165
L_pg1_3:
L_pgx11:
    s_cbranch_execz L_back1
    v_exp_f32 v166, v166
    v_exp_f32 v167, v167
    v_exp_f32 v168, v168
    v_exp_f32 v169, v169
    v_exp_f32 v170, v170
    v_exp_f32 v171, v171
    v_exp_f32 v172, v172
    v_smfmac_f32_32x32x32_bf16 v[96:111], v[32:35], v[160:167], v77
    buffer_load_dwordx4 a[112:115], v22, s[36:39], 0 offen offset:3072 sc1
    v_exp_f32 v173, v173
    v_exp_f32 v174, v174
    v_exp_f32 v175, v175
    v_exp_f32 v176, v176
    v_exp_f32 v177, v177
    v_smfmac_f32_32x32x32_bf16 v[96:111], v[36:39], v[168:175], v77
    s_add_u32 s36, s72, 8192
    s_addc_u32 s37, s73, 0
    v_exp_f32 v178, v178
    v_exp_f32 v179, v179
    v_exp_f32 v180, v180
    v_mfma_f32_32x32x16_bf16 v[128:143], v[80:83], v[10:13], v[128:143]
    ds_read_b128 v[24:27], v66 offset:0
    v_exp_f32 v181, v181
    v_exp_f32 v182, v182
    v_exp_f32 v183, v183
    v_exp_f32 v184, v184
    v_exp_f32 v185, v185
    v_smfmac_f32_32x32x32_bf16 v[112:127], v[32:35], v[176:183], v77
    buffer_store_dwordx4 a[224:227], v21, s[32:35], 0 offen offset:1024 sc1
    v_exp_f32 v186, v186
    v_exp_f32 v187, v187
    v_exp_f32 v188, v188
    v_mfma_f32_32x32x16_bf16 v[144:159], v[80:83], v[14:17], v[144:159]
    ds_read_b128 v[28:31], v67 offset:0
    v_exp_f32 v189, v189
    v_exp_f32 v190, v190
    v_exp_f32 v191, v191
    v_exp_f32 v128, v128
    v_exp_f32 v129, v129
    v_smfmac_f32_32x32x32_bf16 v[112:127], v[36:39], v[184:191], v77
    s_waitcnt lgkmcnt(2)
    ds_read_b128 v[80:83], v68 offset:4992
    v_exp_f32 v130, v130
    v_exp_f32 v131, v131
    v_exp_f32 v132, v132
    v_mfma_f32_32x32x4_2b_bf16 v[160:191], v[90:91], v[18:19], 0
    buffer_load_dwordx4 a[128:131], v22, s[36:39], 0 offen offset:0 sc1
    v_exp_f32 v133, v133
    v_exp_f32 v134, v134
    v_exp_f32 v135, v135
    v_exp_f32 v136, v136
    v_exp_f32 v137, v137
    v_exp_f32 v138, v138
    v_exp_f32 v139, v139
    v_exp_f32 v140, v140
    v_smfmac_f32_32x32x32_bf16 v[96:111], v[40:43], v[128:135], v77
    s_add_u32 s36, s72, 36864
    s_addc_u32 s37, s73, 0
    ds_read_b128 v[92:95], v69 offset:4992
    v_exp_f32 v141, v141
    v_exp_f32 v142, v142
    v_exp_f32 v143, v143
    v_exp_f32 v144, v144
    v_exp_f32 v145, v145
    v_smfmac_f32_32x32x32_bf16 v[96:111], v[44:47], v[136:143], v77
    buffer_load_dwordx4 a[4:7], v22, s[36:39], 0 offen offset:0 sc1
    v_exp_f32 v146, v146
    v_exp_f32 v147, v147
    v_exp_f32 v148, v148
    v_mfma_f32_32x32x16_bf16 v[160:175], v[84:87], v[10:13], v[160:175]
    s_add_u32 s32, s40, 4481024
    s_addc_u32 s33, s41, 0
    ds_read_b128 v[32:35], v64 offset:4992
    v_exp_f32 v149, v149
    v_exp_f32 v150, v150
    v_exp_f32 v151, v151
    v_exp_f32 v152, v152
    v_exp_f32 v153, v153
    v_smfmac_f32_32x32x32_bf16 v[112:127], v[40:43], v[144:151], v77
    buffer_store_dwordx4 a[228:231], v21, s[32:35], 0 offen offset:0 sc1
    v_exp_f32 v154, v154
    v_exp_f32 v155, v155
    v_exp_f32 v156, v156
    v_mfma_f32_32x32x16_bf16 v[176:191], v[84:87], v[14:17], v[176:191]
    ds_read_b128 v[36:39], v65 offset:4992
    v_exp_f32 v157, v157
    v_exp_f32 v158, v158
    v_exp_f32 v159, v159
    v_exp_f32 v160, v160
    v_exp_f32 v161, v161
    v_smfmac_f32_32x32x32_bf16 v[112:127], v[44:47], v[152:159], v77
    s_waitcnt lgkmcnt(2)
    ds_read_b128 v[84:87], v68 offset:6016
    v_exp_f32 v162, v162
    v_exp_f32 v163, v163
    v_exp_f32 v164, v164
    v_mfma_f32_32x32x4_2b_bf16 v[128:159], v[92:93], v[18:19], 0
    v_exp_f32 v165, v165
    v_exp_f32 v166, v166
    v_exp_f32 v167, v167
    v_exp_f32 v168, v168
    v_exp_f32 v169, v169
    v_exp_f32 v170, v170
    v_exp_f32 v171, v171
    v_exp_f32 v172, v172
    v_smfmac_f32_32x32x32_bf16 v[96:111], v[24:27], v[160:167], v77
    buffer_load_dwordx4 a[20:23], v22, s[36:39], 0 offen offset:1024 sc1
    v_exp_f32 v173, v173
    v_exp_f32 v174, v174
    v_exp_f32 v175, v175
    v_exp_f32 v176, v176
    v_exp_f32 v177, v177
    v_smfmac_f32_32x32x32_bf16 v[96:111], v[28:31], v[168:175], v77
    buffer_load_dwordx4 a[36:39], v22, s[36:39], 0 offen offset:2048 sc1
    v_exp_f32 v178, v178
    v_exp_f32 v179, v179
    v_exp_f32 v180, v180
    v_mfma_f32_32x32x16_bf16 v[128:143], v[80:83], v[10:13], v[128:143]
    buffer_load_dwordx4 a[52:55], v22, s[36:39], 0 offen offset:3072 sc1
    ds_read_b128 v[40:43], v66 offset:4992
    v_exp_f32 v181, v181
    v_exp_f32 v182, v182
    v_exp_f32 v183, v183
    v_exp_f32 v184, v184
    v_exp_f32 v185, v185
    v_smfmac_f32_32x32x32_bf16 v[112:127], v[24:27], v[176:183], v77
    buffer_store_dwordx4 a[232:235], v21, s[32:35], 0 offen offset:1024 sc1
    v_exp_f32 v186, v186
    v_exp_f32 v187, v187
    v_exp_f32 v188, v188
    v_mfma_f32_32x32x16_bf16 v[144:159], v[80:83], v[14:17], v[144:159]
    ds_read_b128 v[44:47], v67 offset:4992
    v_exp_f32 v189, v189
    v_exp_f32 v190, v190
    v_exp_f32 v191, v191
    v_exp_f32 v128, v128
    v_exp_f32 v129, v129
    v_smfmac_f32_32x32x32_bf16 v[112:127], v[28:31], v[184:191], v77
    s_waitcnt lgkmcnt(2)
    ds_read_b128 v[80:83], v68 offset:9984
    v_exp_f32 v130, v130
    v_exp_f32 v131, v131
    v_exp_f32 v132, v132
    v_mfma_f32_32x32x4_2b_bf16 v[160:191], v[94:95], v[18:19], 0
    v_exp_f32 v133, v133
    v_exp_f32 v134, v134
    v_exp_f32 v135, v135
    v_exp_f32 v136, v136
    v_exp_f32 v137, v137
    v_exp_f32 v138, v138
    v_exp_f32 v139, v139
    v_exp_f32 v140, v140
    v_smfmac_f32_32x32x32_bf16 v[96:111], v[32:35], v[128:135], v77
    s_add_u32 s36, s72, 40960
    s_addc_u32 s37, s73, 0
    ds_read_b128 v[88:91], v69 offset:9984
    v_exp_f32 v141, v141
    v_exp_f32 v142, v142
    v_exp_f32 v143, v143
    v_exp_f32 v144, v144
    v_exp_f32 v145, v145
    v_smfmac_f32_32x32x32_bf16 v[96:111], v[36:39], v[136:143], v77
    buffer_load_dwordx4 a[68:71], v22, s[36:39], 0 offen offset:0 sc1
    buffer_load_dwordx4 a[84:87], v22, s[36:39], 0 offen offset:1024 sc1
    v_exp_f32 v146, v146
    v_exp_f32 v147, v147
    v_exp_f32 v148, v148
    v_mfma_f32_32x32x16_bf16 v[160:175], v[84:87], v[10:13], v[160:175]
    s_add_u32 s32, s40, 4485120
    s_addc_u32 s33, s41, 0
    ds_read_b128 v[24:27], v64 offset:9984
    v_exp_f32 v149, v149
    v_exp_f32 v150, v150
    v_exp_f32 v151, v151
    v_exp_f32 v152, v152
    v_exp_f32 v153, v153
    v_smfmac_f32_32x32x32_bf16 v[112:127], v[32:35], v[144:151], v77
    buffer_store_dwordx4 a[236:239], v21, s[32:35], 0 offen offset:0 sc1
    v_exp_f32 v154, v154
    v_exp_f32 v155, v155
    v_exp_f32 v156, v156
    v_mfma_f32_32x32x16_bf16 v[176:191], v[84:87], v[14:17], v[176:191]
    ds_read_b128 v[28:31], v65 offset:9984
    v_exp_f32 v157, v157
    v_exp_f32 v158, v158
    v_exp_f32 v159, v159
    v_exp_f32 v160, v160
    v_exp_f32 v161, v161
    v_smfmac_f32_32x32x32_bf16 v[112:127], v[36:39], v[152:159], v77
    s_waitcnt lgkmcnt(2)
    ds_read_b128 v[84:87], v68 offset:11008
    v_exp_f32 v162, v162
    v_exp_f32 v163, v163
    v_exp_f32 v164, v164
    v_mfma_f32_32x32x4_2b_bf16 v[128:159], v[88:89], v[18:19], 0
    v_exp_f32 v165, v165
    v_exp_f32 v166, v166
    v_exp_f32 v167, v167
    v_exp_f32 v168, v168
    v_exp_f32 v169, v169
    v_exp_f32 v170, v170
    v_exp_f32 v171, v171
    v_exp_f32 v172, v172
    v_smfmac_f32_32x32x32_bf16 v[96:111], v[40:43], v[160:167], v77
    buffer_load_dwordx4 a[100:103], v22, s[36:39], 0 offen offset:2048 sc1
    v_exp_f32 v173, v173
    v_exp_f32 v174, v174
    v_exp_f32 v175, v175
    v_exp_f32 v176, v176
    v_exp_f32 v177, v177
    v_smfmac_f32_32x32x32_bf16 v[96:111], v[44:47], v[168:175], v77
    buffer_load_dwordx4 a[116:119], v22, s[36:39], 0 offen offset:3072 sc1
    v_exp_f32 v178, v178
    v_exp_f32 v179, v179
    v_exp_f32 v180, v180
    v_mfma_f32_32x32x16_bf16 v[128:143], v[80:83], v[10:13], v[128:143]
    ds_read_b128 v[32:35], v66 offset:9984
    v_exp_f32 v181, v181
    v_exp_f32 v182, v182
    v_exp_f32 v183, v183
    v_exp_f32 v184, v184
    v_exp_f32 v185, v185
    v_smfmac_f32_32x32x32_bf16 v[112:127], v[40:43], v[176:183], v77
    buffer_store_dwordx4 a[240:243], v21, s[32:35], 0 offen offset:1024 sc1
    v_exp_f32 v186, v186
    v_exp_f32 v187, v187
    v_exp_f32 v188, v188
    v_mfma_f32_32x32x16_bf16 v[144:159], v[80:83], v[14:17], v[144:159]
    ds_read_b128 v[36:39], v67 offset:9984
    v_exp_f32 v189, v189
    v_exp_f32 v190, v190
    v_exp_f32 v191, v191
    v_exp_f32 v128, v128
    v_exp_f32 v129, v129
    v_smfmac_f32_32x32x32_bf16 v[112:127], v[44:47], v[184:191], v77
    s_waitcnt lgkmcnt(2)
    ds_read_b128 v[80:83], v68 offset:14976
    v_exp_f32 v130, v130
    v_exp_f32 v131, v131
    v_exp_f32 v132, v132
    v_mfma_f32_32x32x4_2b_bf16 v[160:191], v[90:91], v[18:19], 0
    v_exp_f32 v133, v133
    v_exp_f32 v134, v134
    v_exp_f32 v135, v135
    v_exp_f32 v136, v136
    v_exp_f32 v137, v137
    v_exp_f32 v138, v138
    v_exp_f32 v139, v139
    v_exp_f32 v140, v140
    v_smfmac_f32_32x32x32_bf16 v[96:111], v[24:27], v[128:135], v77
    s_add_u32 s36, s72, 45056
    s_addc_u32 s37, s73, 0
    ds_read_b128 v[92:95], v69 offset:14976
    v_exp_f32 v141, v141
    v_exp_f32 v142, v142
    v_exp_f32 v143, v143
    v_exp_f32 v144, v144
    v_exp_f32 v145, v145
    v_smfmac_f32_32x32x32_bf16 v[96:111], v[28:31], v[136:143], v77
    buffer_load_dwordx4 a[132:135], v22, s[36:39], 0 offen offset:0 sc1
    v_exp_f32 v146, v146
    v_exp_f32 v147, v147
    v_exp_f32 v148, v148
    v_mfma_f32_32x32x16_bf16 v[160:175], v[84:87], v[10:13], v[160:175]
    ds_read_b128 v[40:43], v64 offset:14976
    v_exp_f32 v149, v149
    v_exp_f32 v150, v150
    v_exp_f32 v151, v151
    v_exp_f32 v152, v152
    v_exp_f32 v153, v153
    v_smfmac_f32_32x32x32_bf16 v[112:127], v[24:27], v[144:151], v77
    s_add_u32 s36, s72, 73728
    s_addc_u32 s37, s73, 0
    v_exp_f32 v154, v154
    v_exp_f32 v155, v155
    v_exp_f32 v156, v156
    v_mfma_f32_32x32x16_bf16 v[176:191], v[84:87], v[14:17], v[176:191]
    ds_read_b128 v[44:47], v65 offset:14976
    v_exp_f32 v157, v157
    v_exp_f32 v158, v158
    v_exp_f32 v159, v159
    v_exp_f32 v160, v160
    v_exp_f32 v161, v161
    v_smfmac_f32_32x32x32_bf16 v[112:127], v[28:31], v[152:159], v77
    s_waitcnt lgkmcnt(2)
    ds_read_b128 v[84:87], v68 offset:16000
    v_exp_f32 v162, v162
    v_exp_f32 v163, v163
    v_exp_f32 v164, v164
    v_mfma_f32_32x32x4_2b_bf16 v[128:159], v[92:93], v[18:19], 0
    v_exp_f32 v165, v165
    v_exp_f32 v166, v166
    v_exp_f32 v167, v167
    v_exp_f32 v168, v168
    v_exp_f32 v169, v169
    v_exp_f32 v170, v170
    v_exp_f32 v171, v171
    v_exp_f32 v172, v172
    v_smfmac_f32_32x32x32_bf16 v[96:111], v[32:35], v[160:167], v77
    buffer_load_dwordx4 a[8:11], v22, s[36:39], 0 offen offset:0 sc1
    v_exp_f32 v173, v173
    v_exp_f32 v174, v174
    v_exp_f32 v175, v175
    v_exp_f32 v176, v176
    v_exp_f32 v177, v177
    v_smfmac_f32_32x32x32_bf16 v[96:111], v[36:39], v[168:175], v77
    buffer_load_dwordx4 a[24:27], v22, s[36:39], 0 offen offset:1024 sc1
    v_exp_f32 v178, v178
    v_exp_f32 v179, v179
    v_exp_f32 v180, v180
    v_mfma_f32_32x32x16_bf16 v[128:143], v[80:83], v[10:13], v[128:143]
    ds_read_b128 v[24:27], v66 offset:14976
    v_exp_f32 v181, v181
    v_exp_f32 v182, v182
    v_exp_f32 v183, v183
    v_exp_f32 v184, v184
    v_exp_f32 v185, v185
    v_smfmac_f32_32x32x32_bf16 v[112:127], v[32:35], v[176:183], v77
    buffer_load_dwordx4 a[40:43], v22, s[36:39], 0 offen offset:2048 sc1
    v_exp_f32 v186, v186
    v_exp_f32 v187, v187
    v_exp_f32 v188, v188
    v_mfma_f32_32x32x16_bf16 v[144:159], v[80:83], v[14:17], v[144:159]
    ds_read_b128 v[28:31], v67 offset:14976
    v_exp_f32 v189, v189
    v_exp_f32 v190, v190
    v_exp_f32 v191, v191
    v_exp_f32 v128, v128
    v_exp_f32 v129, v129
    v_smfmac_f32_32x32x32_bf16 v[112:127], v[36:39], v[184:191], v77
    s_waitcnt lgkmcnt(2)
    ds_read_b128 v[80:83], v68 offset:19968
    v_exp_f32 v130, v130
    v_exp_f32 v131, v131
    v_exp_f32 v132, v132
    v_mfma_f32_32x32x4_2b_bf16 v[160:191], v[94:95], v[18:19], 0
    v_exp_f32 v133, v133
    v_exp_f32 v134, v134
    v_exp_f32 v135, v135
    v_exp_f32 v136, v136
    v_exp_f32 v137, v137
    v_exp_f32 v138, v138
    v_exp_f32 v139, v139
    v_exp_f32 v140, v140
    v_smfmac_f32_32x32x32_bf16 v[96:111], v[40:43], v[128:135], v77
    ds_read_b128 v[88:91], v69 offset:19968
    v_exp_f32 v141, v141
    v_exp_f32 v142, v142
    v_exp_f32 v143, v143
    v_exp_f32 v144, v144
    v_exp_f32 v145, v145
    v_smfmac_f32_32x32x32_bf16 v[96:111], v[44:47], v[136:143], v77
    buffer_load_dwordx4 a[56:59], v22, s[36:39], 0 offen offset:3072 sc1
    v_exp_f32 v146, v146
    v_exp_f32 v147, v147
    v_exp_f32 v148, v148
    v_mfma_f32_32x32x16_bf16 v[160:175], v[84:87], v[10:13], v[160:175]
    ds_read_b128 v[32:35], v64 offset:19968
    v_exp_f32 v149, v149
    v_exp_f32 v150, v150
    v_exp_f32 v151, v151
    v_exp_f32 v152, v152
    v_exp_f32 v153, v153
    v_smfmac_f32_32x32x32_bf16 v[112:127], v[40:43], v[144:151], v77
    s_add_u32 s36, s72, 77824
    s_addc_u32 s37, s73, 0
    v_exp_f32 v154, v154
    v_exp_f32 v155, v155
    v_exp_f32 v156, v156
    v_mfma_f32_32x32x16_bf16 v[176:191], v[84:87], v[14:17], v[176:191]
    ds_read_b128 v[36:39], v65 offset:19968
    v_exp_f32 v157, v157
    v_exp_f32 v158, v158
    v_exp_f32 v159, v159
    v_exp_f32 v160, v160
    v_exp_f32 v161, v161
    v_smfmac_f32_32x32x32_bf16 v[112:127], v[44:47], v[152:159], v77
    s_waitcnt lgkmcnt(2)
    ds_read_b128 v[84:87], v68 offset:20992
    v_exp_f32 v162, v162
    v_exp_f32 v163, v163
    v_exp_f32 v164, v164
    v_mfma_f32_32x32x4_2b_bf16 v[128:159], v[88:89], v[18:19], 0
    v_exp_f32 v165, v165
    v_exp_f32 v166, v166
    v_exp_f32 v167, v167
    v_exp_f32 v168, v168
    v_exp_f32 v169, v169
    v_exp_f32 v170, v170
    v_exp_f32 v171, v171
    v_exp_f32 v172, v172
    v_smfmac_f32_32x32x32_bf16 v[96:111], v[24:27], v[160:167], v77
    buffer_load_dwordx4 a[72:75], v22, s[36:39], 0 offen offset:0 sc1
    v_exp_f32 v173, v173
    v_exp_f32 v174, v174
    v_exp_f32 v175, v175
    v_exp_f32 v176, v176
    v_exp_f32 v177, v177
    v_smfmac_f32_32x32x32_bf16 v[96:111], v[28:31], v[168:175], v77
    buffer_load_dwordx4 a[88:91], v22, s[36:39], 0 offen offset:1024 sc1
    v_exp_f32 v178, v178
    v_exp_f32 v179, v179
    v_exp_f32 v180, v180
    v_mfma_f32_32x32x16_bf16 v[128:143], v[80:83], v[10:13], v[128:143]
    ds_read_b128 v[40:43], v66 offset:19968
    v_exp_f32 v181, v181
    v_exp_f32 v182, v182
    v_exp_f32 v183, v183
    v_exp_f32 v184, v184
    v_exp_f32 v185, v185
    v_smfmac_f32_32x32x32_bf16 v[112:127], v[24:27], v[176:183], v77
    s_waitcnt vmcnt(36)
    buffer_load_dwordx4 a[104:107], v22, s[36:39], 0 offen offset:2048 sc1
    v_exp_f32 v186, v186
    v_exp_f32 v187, v187
    v_exp_f32 v188, v188
    v_mfma_f32_32x32x16_bf16 v[144:159], v[80:83], v[14:17], v[144:159]
    ds_read_b128 v[44:47], v67 offset:19968
    v_exp_f32 v189, v189
    v_exp_f32 v190, v190
    v_exp_f32 v191, v191
    v_exp_f32 v128, v128
    v_exp_f32 v129, v129
    v_smfmac_f32_32x32x32_bf16 v[112:127], v[28:31], v[184:191], v77
    s_waitcnt lgkmcnt(2)
    ds_read_b128 v[80:83], v68 offset:24960
    v_exp_f32 v130, v130
    v_exp_f32 v131, v131
    v_exp_f32 v132, v132
    v_mfma_f32_32x32x4_2b_bf16 v[160:191], v[90:91], v[18:19], 0
    buffer_load_dwordx4 a[120:123], v22, s[36:39], 0 offen offset:3072 sc1
    v_exp_f32 v133, v133
    v_exp_f32 v134, v134
    v_exp_f32 v135, v135
    v_exp_f32 v136, v136
    v_exp_f32 v137, v137
    v_exp_f32 v138, v138
    v_exp_f32 v139, v139
    v_exp_f32 v140, v140
    v_smfmac_f32_32x32x32_bf16 v[96:111], v[32:35], v[128:135], v77
    s_add_u32 s36, s72, 81920
    s_addc_u32 s37, s73, 0
    ds_read_b128 v[92:95], v69 offset:24960
    v_exp_f32 v141, v141
    v_exp_f32 v142, v142
    v_exp_f32 v143, v143
    v_exp_f32 v144, v144
    v_exp_f32 v145, v145
    v_smfmac_f32_32x32x32_bf16 v[96:111], v[36:39], v[136:143], v77
    buffer_load_dwordx4 a[136:139], v22, s[36:39], 0 offen offset:0 sc1
    v_mov_b32 v2, s48
    v_mov_b32 v3, s49
    v_exp_f32 v146, v146
    v_exp_f32 v147, v147
    v_exp_f32 v148, v148
    v_mfma_f32_32x32x16_bf16 v[160:175], v[84:87], v[10:13], v[160:175]
    s_waitcnt vmcnt(10)
    s_barrier
    ds_read_b128 v[24:27], v64 offset:24960
    v_exp_f32 v149, v149
    v_exp_f32 v150, v150
    v_exp_f32 v151, v151
    v_exp_f32 v152, v152
    v_exp_f32 v153, v153
    v_smfmac_f32_32x32x32_bf16 v[112:127], v[32:35], v[144:151], v77
    buffer_store_dwordx2 v[2:3], v8, s[40:43], s98 offen offset:8 sc1
    v_exp_f32 v154, v154
    v_exp_f32 v155, v155
    v_exp_f32 v156, v156
    v_mfma_f32_32x32x16_bf16 v[176:191], v[84:87], v[14:17], v[176:191]
    ds_read_b128 v[28:31], v65 offset:24960
    v_exp_f32 v157, v157
    v_exp_f32 v158, v158
    v_exp_f32 v159, v159
    v_exp_f32 v160, v160
    v_exp_f32 v161, v161
    v_smfmac_f32_32x32x32_bf16 v[112:127], v[36:39], v[152:159], v77
    s_waitcnt lgkmcnt(2)
    ds_read_b128 v[84:87], v68 offset:25984
    v_exp_f32 v162, v162
    v_exp_f32 v163, v163
    v_exp_f32 v164, v164
    v_mfma_f32_32x32x4_2b_bf16 v[128:159], v[92:93], v[18:19], 0
    v_exp_f32 v165, v165
    v_exp_f32 v166, v166
    v_exp_f32 v167, v167
    v_exp_f32 v168, v168
    v_exp_f32 v169, v169
    v_exp_f32 v170, v170
    v_exp_f32 v171, v171
    v_exp_f32 v172, v172
    v_smfmac_f32_32x32x32_bf16 v[96:111], v[40:43], v[160:167], v77
    s_add_u32 s36, s72, 110592
    s_addc_u32 s37, s73, 0
    v_exp_f32 v173, v173
    v_exp_f32 v174, v174
    v_exp_f32 v175, v175
    v_exp_f32 v176, v176
    v_exp_f32 v177, v177
    v_smfmac_f32_32x32x32_bf16 v[96:111], v[44:47], v[168:175], v77
    buffer_load_dwordx4 a[12:15], v22, s[36:39], 0 offen offset:0 sc1
    v_exp_f32 v178, v178
    v_exp_f32 v179, v179
    v_exp_f32 v180, v180
    v_mfma_f32_32x32x16_bf16 v[128:143], v[80:83], v[10:13], v[128:143]
    ds_read_b128 v[32:35], v66 offset:24960
    v_exp_f32 v181, v181
    v_exp_f32 v182, v182
    v_exp_f32 v183, v183
    v_exp_f32 v184, v184
    v_exp_f32 v185, v185
    v_smfmac_f32_32x32x32_bf16 v[112:127], v[40:43], v[176:183], v77
    v_exp_f32 v186, v186
    v_exp_f32 v187, v187
    v_exp_f32 v188, v188
    v_mfma_f32_32x32x16_bf16 v[144:159], v[80:83], v[14:17], v[144:159]
    ds_read_b128 v[36:39], v67 offset:24960
    v_exp_f32 v189, v189
    v_exp_f32 v190, v190
    v_exp_f32 v191, v191
    v_exp_f32 v128, v128
    v_exp_f32 v129, v129
    v_smfmac_f32_32x32x32_bf16 v[112:127], v[44:47], v[184:191], v77
    s_waitcnt lgkmcnt(2)
    ds_read_b128 v[80:83], v68 offset:29952
    v_exp_f32 v130, v130
    v_exp_f32 v131, v131
    v_exp_f32 v132, v132
    v_mfma_f32_32x32x4_2b_bf16 v[160:191], v[94:95], v[18:19], 0
    v_exp_f32 v133, v133
    v_exp_f32 v134, v134
    v_exp_f32 v135, v135
    v_exp_f32 v136, v136
    v_exp_f32 v137, v137
    v_exp_f32 v138, v138
    v_exp_f32 v139, v139
    v_exp_f32 v140, v140
    v_smfmac_f32_32x32x32_bf16 v[96:111], v[24:27], v[128:135], v77
    buffer_load_dwordx4 a[28:31], v22, s[36:39], 0 offen offset:1024 sc1
    ds_read_b128 v[88:91], v69 offset:29952
    v_exp_f32 v141, v141
    v_exp_f32 v142, v142
    v_exp_f32 v143, v143
    v_exp_f32 v144, v144
    v_exp_f32 v145, v145
    v_smfmac_f32_32x32x32_bf16 v[96:111], v[28:31], v[136:143], v77
    buffer_load_dwordx4 a[44:47], v22, s[36:39], 0 offen offset:2048 sc1
    v_exp_f32 v146, v146
    v_exp_f32 v147, v147
    v_exp_f32 v148, v148
    v_mfma_f32_32x32x16_bf16 v[160:175], v[84:87], v[10:13], v[160:175]
    ds_read_b128 v[40:43], v64 offset:29952
    v_exp_f32 v149, v149
    v_exp_f32 v150, v150
    v_exp_f32 v151, v151
    v_exp_f32 v152, v152
    v_exp_f32 v153, v153
    v_smfmac_f32_32x32x32_bf16 v[112:127], v[24:27], v[144:151], v77
    buffer_load_dwordx4 a[60:63], v22, s[36:39], 0 offen offset:3072 sc1
    v_exp_f32 v154, v154
    v_exp_f32 v155, v155
    v_exp_f32 v156, v156
    v_mfma_f32_32x32x16_bf16 v[176:191], v[84:87], v[14:17], v[176:191]
    ds_read_b128 v[44:47], v65 offset:29952
    v_exp_f32 v157, v157
    v_exp_f32 v158, v158
    v_exp_f32 v159, v159
    v_exp_f32 v160, v160
    v_exp_f32 v161, v161
    v_smfmac_f32_32x32x32_bf16 v[112:127], v[28:31], v[152:159], v77
    s_waitcnt lgkmcnt(2)
    ds_read_b128 v[84:87], v68 offset:30976
    v_exp_f32 v162, v162
    v_exp_f32 v163, v163
    v_exp_f32 v164, v164
    v_mfma_f32_32x32x4_2b_bf16 v[128:159], v[88:89], v[18:19], 0
    v_exp_f32 v165, v165
    v_exp_f32 v166, v166
    v_exp_f32 v167, v167
    v_exp_f32 v168, v168
    v_exp_f32 v169, v169
    v_exp_f32 v170, v170
    v_exp_f32 v171, v171
    v_exp_f32 v172, v172
    v_smfmac_f32_32x32x32_bf16 v[96:111], v[32:35], v[160:167], v77
    s_add_u32 s36, s72, 114688
    s_addc_u32 s37, s73, 0
    v_exp_f32 v173, v173
    v_exp_f32 v174, v174
    v_exp_f32 v175, v175
    v_exp_f32 v176, v176
    v_exp_f32 v177, v177
    v_smfmac_f32_32x32x32_bf16 v[96:111], v[36:39], v[168:175], v77
    buffer_load_dwordx4 a[76:79], v22, s[36:39], 0 offen offset:0 sc1
    v_exp_f32 v178, v178
    v_exp_f32 v179, v179
    v_exp_f32 v180, v180
    v_mfma_f32_32x32x16_bf16 v[128:143], v[80:83], v[10:13], v[128:143]
    ds_read_b128 v[24:27], v66 offset:29952
    v_exp_f32 v181, v181
    v_exp_f32 v182, v182
    v_exp_f32 v183, v183
    v_exp_f32 v184, v184
    v_exp_f32 v185, v185
    v_smfmac_f32_32x32x32_bf16 v[112:127], v[32:35], v[176:183], v77
    buffer_load_dwordx4 a[92:95], v22, s[36:39], 0 offen offset:1024 sc1
    v_exp_f32 v186, v186
    v_exp_f32 v187, v187
    v_exp_f32 v188, v188
    v_mfma_f32_32x32x16_bf16 v[144:159], v[80:83], v[14:17], v[144:159]
    ds_read_b128 v[28:31], v67 offset:29952
    v_exp_f32 v189, v189
    v_exp_f32 v190, v190
    v_exp_f32 v191, v191
    v_exp_f32 v128, v128
    v_exp_f32 v129, v129
    v_smfmac_f32_32x32x32_bf16 v[112:127], v[36:39], v[184:191], v77
    s_waitcnt lgkmcnt(2)
    ds_read_b128 v[80:83], v68 offset:34944
    v_exp_f32 v130, v130
    v_exp_f32 v131, v131
    v_exp_f32 v132, v132
    v_mfma_f32_32x32x4_2b_bf16 v[160:191], v[90:91], v[18:19], 0
    v_exp_f32 v133, v133
    v_exp_f32 v134, v134
    v_exp_f32 v135, v135
    v_exp_f32 v136, v136
    v_exp_f32 v137, v137
    v_exp_f32 v138, v138
    v_exp_f32 v139, v139
    v_exp_f32 v140, v140
    v_smfmac_f32_32x32x32_bf16 v[96:111], v[40:43], v[128:135], v77
    buffer_load_dwordx4 a[108:111], v22, s[36:39], 0 offen offset:2048 sc1
    ds_read_b128 v[92:95], v69 offset:34944
    v_exp_f32 v141, v141
    v_exp_f32 v142, v142
    v_exp_f32 v143, v143
    v_exp_f32 v144, v144
    v_exp_f32 v145, v145
    v_smfmac_f32_32x32x32_bf16 v[96:111], v[44:47], v[136:143], v77
    buffer_load_dwordx4 a[124:127], v22, s[36:39], 0 offen offset:3072 sc1
    v_exp_f32 v146, v146
    v_exp_f32 v147, v147
    v_exp_f32 v148, v148
    v_mfma_f32_32x32x16_bf16 v[160:175], v[84:87], v[10:13], v[160:175]
    ds_read_b128 v[32:35], v64 offset:34944
    v_exp_f32 v149, v149
    v_exp_f32 v150, v150
    v_exp_f32 v151, v151
    v_exp_f32 v152, v152
    v_exp_f32 v153, v153
    v_smfmac_f32_32x32x32_bf16 v[112:127], v[40:43], v[144:151], v77
    buffer_load_dwordx2 v[2:3], v79, s[40:43], s9 offen sc1
    v_exp_f32 v154, v154
    v_exp_f32 v155, v155
    v_exp_f32 v156, v156
    v_mfma_f32_32x32x16_bf16 v[176:191], v[84:87], v[14:17], v[176:191]
    ds_read_b128 v[36:39], v65 offset:34944
    v_exp_f32 v157, v157
    v_exp_f32 v158, v158
    v_exp_f32 v159, v159
    v_exp_f32 v160, v160
    v_exp_f32 v161, v161
    v_smfmac_f32_32x32x32_bf16 v[112:127], v[44:47], v[152:159], v77
    s_waitcnt lgkmcnt(2)
    ds_read_b128 v[84:87], v68 offset:35968
    v_exp_f32 v162, v162
    v_exp_f32 v163, v163
    v_exp_f32 v164, v164
    v_mfma_f32_32x32x4_2b_bf16 v[128:159], v[92:93], v[18:19], 0
    v_exp_f32 v165, v165
    v_exp_f32 v166, v166
    v_exp_f32 v167, v167
    v_exp_f32 v168, v168
    v_exp_f32 v169, v169
    v_exp_f32 v170, v170
    v_exp_f32 v171, v171
    v_exp_f32 v172, v172
    v_smfmac_f32_32x32x32_bf16 v[96:111], v[24:27], v[160:167], v77
    s_add_u32 s36, s72, 118784
    s_addc_u32 s37, s73, 0
    v_exp_f32 v173, v173
    v_exp_f32 v174, v174
    v_exp_f32 v175, v175
    v_exp_f32 v176, v176
    v_exp_f32 v177, v177
    v_smfmac_f32_32x32x32_bf16 v[96:111], v[28:31], v[168:175], v77
    buffer_load_dwordx4 a[140:143], v22, s[36:39], 0 offen offset:0 sc1
    v_exp_f32 v178, v178
    v_exp_f32 v179, v179
    v_exp_f32 v180, v180
    v_mfma_f32_32x32x16_bf16 v[128:143], v[80:83], v[10:13], v[128:143]
    ds_read_b128 v[40:43], v66 offset:34944
    v_exp_f32 v181, v181
    v_exp_f32 v182, v182
    v_exp_f32 v183, v183
    v_exp_f32 v184, v184
    v_exp_f32 v185, v185
    v_smfmac_f32_32x32x32_bf16 v[112:127], v[24:27], v[176:183], v77
    buffer_load_dwordx4 a[144:147], v22, s[40:43], s13 offen offset:0 sc1
    v_exp_f32 v186, v186
    v_exp_f32 v187, v187
    v_exp_f32 v188, v188
    v_mfma_f32_32x32x16_bf16 v[144:159], v[80:83], v[14:17], v[144:159]
    ds_read_b128 v[44:47], v67 offset:34944
    v_exp_f32 v189, v189
    v_exp_f32 v190, v190
    v_exp_f32 v191, v191
    v_exp_f32 v128, v128
    v_exp_f32 v129, v129
    v_smfmac_f32_32x32x32_bf16 v[112:127], v[28:31], v[184:191], v77
    s_waitcnt lgkmcnt(2)
    ds_read_b128 v[80:83], v68 offset:39936
    v_exp_f32 v130, v130
    v_exp_f32 v131, v131
    v_exp_f32 v132, v132
    v_mfma_f32_32x32x4_2b_bf16 v[160:191], v[94:95], v[18:19], 0
    v_exp_f32 v133, v133
    v_exp_f32 v134, v134
    v_exp_f32 v135, v135
    v_exp_f32 v136, v136
    v_exp_f32 v137, v137
    v_exp_f32 v138, v138
    v_exp_f32 v139, v139
    v_exp_f32 v140, v140
    v_smfmac_f32_32x32x32_bf16 v[96:111], v[32:35], v[128:135], v77
    buffer_load_dwordx4 a[148:151], v22, s[40:43], s13 offen offset:1024 sc1
    ds_read_b128 v[88:91], v69 offset:39936
    v_exp_f32 v141, v141
    v_exp_f32 v142, v142
    v_exp_f32 v143, v143
    v_exp_f32 v144, v144
    v_exp_f32 v145, v145
    v_smfmac_f32_32x32x32_bf16 v[96:111], v[36:39], v[136:143], v77
    buffer_load_dwordx4 a[152:155], v22, s[40:43], s13 offen offset:2048 sc1
    v_exp_f32 v146, v146
    v_exp_f32 v147, v147
    v_exp_f32 v148, v148
    v_mfma_f32_32x32x16_bf16 v[160:175], v[84:87], v[10:13], v[160:175]
    ds_read_b128 v[24:27], v64 offset:39936
    v_exp_f32 v149, v149
    v_exp_f32 v150, v150
    v_exp_f32 v151, v151
    v_exp_f32 v152, v152
    v_exp_f32 v153, v153
    v_smfmac_f32_32x32x32_bf16 v[112:127], v[32:35], v[144:151], v77
    buffer_load_dwordx4 a[156:159], v22, s[40:43], s13 offen offset:3072 sc1
    v_exp_f32 v154, v154
    v_exp_f32 v155, v155
    v_exp_f32 v156, v156
    v_mfma_f32_32x32x16_bf16 v[176:191], v[84:87], v[14:17], v[176:191]
    ds_read_b128 v[28:31], v65 offset:39936
    v_exp_f32 v157, v157
    v_exp_f32 v158, v158
    v_exp_f32 v159, v159
    v_exp_f32 v160, v160
    v_exp_f32 v161, v161
    v_smfmac_f32_32x32x32_bf16 v[112:127], v[36:39], v[152:159], v77
    s_waitcnt lgkmcnt(2)
    s_add_u32 s13, s13, 4096
    ds_read_b128 v[84:87], v68 offset:40960
    v_exp_f32 v162, v162
    v_exp_f32 v163, v163
    v_exp_f32 v164, v164
    v_mfma_f32_32x32x4_2b_bf16 v[128:159], v[88:89], v[18:19], 0
    v_exp_f32 v165, v165
    v_exp_f32 v166, v166
    v_exp_f32 v167, v167
    v_exp_f32 v168, v168
    v_exp_f32 v169, v169
    v_exp_f32 v170, v170
    v_exp_f32 v171, v171
    v_exp_f32 v172, v172
    v_smfmac_f32_32x32x32_bf16 v[96:111], v[40:43], v[160:167], v77
    buffer_load_dwordx4 a[160:163], v22, s[40:43], s13 offen offset:0 sc1
    s_waitcnt vmcnt(6)
    v_cmp_ne_u64 vcc, s[48:49], v[2:3]
    v_exp_f32 v173, v173
    v_exp_f32 v174, v174
    v_exp_f32 v175, v175
    v_exp_f32 v176, v176
    v_exp_f32 v177, v177
    v_smfmac_f32_32x32x32_bf16 v[96:111], v[44:47], v[168:175], v77
    s_cmp_lg_u64 vcc, 0
    s_cbranch_scc1 L_pb_slow
L_pb_ok:
    v_exp_f32 v178, v178
    v_exp_f32 v179, v179
    v_exp_f32 v180, v180
    v_mfma_f32_32x32x16_bf16 v[128:143], v[80:83], v[10:13], v[128:143]
    ds_read_b128 v[32:35], v66 offset:39936
    v_exp_f32 v181, v181
    v_exp_f32 v182, v182
    v_exp_f32 v183, v183
    v_exp_f32 v184, v184
    v_exp_f32 v185, v185
    v_smfmac_f32_32x32x32_bf16 v[112:127], v[40:43], v[176:183], v77
L_pgx12:
    s_cbranch_execz L_back1
    v_exp_f32 v186, v186
    v_exp_f32 v187, v187
    v_exp_f32 v188, v188
    v_mfma_f32_32x32x16_bf16 v[144:159], v[80:83], v[14:17], v[144:159]
    ds_read_b128 v[36:39], v67 offset:39936
    v_exp_f32 v189, v189
    v_exp_f32 v190, v190
    v_exp_f32 v191, v191
    v_exp_f32 v128, v128
    v_exp_f32 v129, v129
    v_smfmac_f32_32x32x32_bf16 v[112:127], v[44:47], v[184:191], v77
    s_waitcnt lgkmcnt(2)
    ds_read_b128 v[80:83], v68 offset:44928
    v_exp_f32 v130, v130
    v_exp_f32 v131, v131
    v_exp_f32 v132, v132
    v_mfma_f32_32x32x4_2b_bf16 v[160:191], v[90:91], v[18:19], 0
    v_exp_f32 v133, v133
    v_exp_f32 v134, v134
    v_exp_f32 v135, v135
    v_exp_f32 v136, v136
    v_exp_f32 v137, v137
    v_exp_f32 v138, v138
    v_exp_f32 v139, v139
    v_exp_f32 v140, v140
    v_smfmac_f32_32x32x32_bf16 v[96:111], v[24:27], v[128:135], v77
    buffer_load_dwordx2 v[48:49], v72, s[28:31], s6 offen
    ds_read_b128 v[92:95], v69 offset:44928
    v_exp_f32 v141, v141
    v_exp_f32 v142, v142
    v_exp_f32 v143, v143
    v_exp_f32 v144, v144
    v_exp_f32 v145, v145
    v_smfmac_f32_32x32x32_bf16 v[96:111], v[28:31], v[136:143], v77
    s_add_u32 s68, s74, 0
    s_addc_u32 s69, s75, 0
    v_exp_f32 v146, v146
    v_exp_f32 v147, v147
    v_exp_f32 v148, v148
    v_mfma_f32_32x32x16_bf16 v[160:175], v[84:87], v[10:13], v[160:175]
    ds_read_b128 v[40:43], v64 offset:44928
    v_exp_f32 v149, v149
    v_exp_f32 v150, v150
    v_exp_f32 v151, v151
    v_exp_f32 v152, v152
    v_exp_f32 v153, v153
    v_smfmac_f32_32x32x32_bf16 v[112:127], v[24:27], v[144:151], v77
    buffer_load_dwordx4 a[164:167], v22, s[68:71], 0 offen offset:0 sc1
    v_exp_f32 v154, v154
    v_exp_f32 v155, v155
    v_exp_f32 v156, v156
    v_mfma_f32_32x32x16_bf16 v[176:191], v[84:87], v[14:17], v[176:191]
    ds_read_b128 v[44:47], v65 offset:44928
    v_exp_f32 v157, v157
    v_exp_f32 v158, v158
    v_exp_f32 v159, v159
    v_exp_f32 v160, v160
    v_exp_f32 v161, v161
    v_smfmac_f32_32x32x32_bf16 v[112:127], v[28:31], v[152:159], v77
    s_waitcnt lgkmcnt(2)
    ds_read_b128 v[84:87], v68 offset:45952
    v_exp_f32 v162, v162
    v_exp_f32 v163, v163
    v_exp_f32 v164, v164
    v_mfma_f32_32x32x4_2b_bf16 v[128:159], v[92:93], v[18:19], 0
    v_exp_f32 v165, v165
    v_exp_f32 v166, v166
    v_exp_f32 v167, v167
    v_exp_f32 v168, v168
    v_exp_f32 v169, v169
    v_exp_f32 v170, v170
    v_exp_f32 v171, v171
    v_exp_f32 v172, v172
    v_smfmac_f32_32x32x32_bf16 v[96:111], v[32:35], v[160:167], v77
    buffer_load_dwordx2 v[50:51], v73, s[28:31], s6 offen
    v_exp_f32 v173, v173
    v_exp_f32 v174, v174
    v_exp_f32 v175, v175
    v_exp_f32 v176, v176
    v_exp_f32 v177, v177
    v_smfmac_f32_32x32x32_bf16 v[96:111], v[36:39], v[168:175], v77
    buffer_load_dwordx4 a[168:171], v22, s[68:71], 0 offen offset:1024 sc1
    v_exp_f32 v178, v178
    v_exp_f32 v179, v179
    v_exp_f32 v180, v180
    v_mfma_f32_32x32x16_bf16 v[128:143], v[80:83], v[10:13], v[128:143]
    ds_read_b128 v[24:27], v66 offset:44928
    v_exp_f32 v181, v181
    v_exp_f32 v182, v182
    v_exp_f32 v183, v183
    v_exp_f32 v184, v184
    v_exp_f32 v185, v185
    v_smfmac_f32_32x32x32_bf16 v[112:127], v[32:35], v[176:183], v77
    buffer_load_dwordx4 a[172:175], v22, s[68:71], 0 offen offset:2048 sc1
    v_exp_f32 v186, v186
    v_exp_f32 v187, v187
    v_exp_f32 v188, v188
    v_mfma_f32_32x32x16_bf16 v[144:159], v[80:83], v[14:17], v[144:159]
    ds_read_b128 v[28:31], v67 offset:44928
    v_exp_f32 v189, v189
    v_exp_f32 v190, v190
    v_exp_f32 v191, v191
    v_exp_f32 v128, v128
    v_exp_f32 v129, v129
    v_smfmac_f32_32x32x32_bf16 v[112:127], v[36:39], v[184:191], v77
    s_waitcnt lgkmcnt(2)
    ds_read_b128 v[80:83], v68 offset:49920
    v_exp_f32 v130, v130
    v_exp_f32 v131, v131
    v_exp_f32 v132, v132
    v_mfma_f32_32x32x4_2b_bf16 v[160:191], v[94:95], v[18:19], 0
    v_exp_f32 v133, v133
    v_exp_f32 v134, v134
    v_exp_f32 v135, v135
    v_exp_f32 v136, v136
    v_exp_f32 v137, v137
    v_exp_f32 v138, v138
    v_exp_f32 v139, v139
    v_exp_f32 v140, v140
    v_smfmac_f32_32x32x32_bf16 v[96:111], v[40:43], v[128:135], v77
    ds_read_b128 v[88:91], v69 offset:49920
    v_exp_f32 v141, v141
    v_exp_f32 v142, v142
    v_exp_f32 v143, v143
    v_exp_f32 v144, v144
    v_exp_f32 v145, v145
    v_smfmac_f32_32x32x32_bf16 v[96:111], v[44:47], v[136:143], v77
    buffer_load_dwordx4 a[176:179], v22, s[68:71], 0 offen offset:3072 sc1
    v_exp_f32 v146, v146
    v_exp_f32 v147, v147
    v_exp_f32 v148, v148
    v_mfma_f32_32x32x16_bf16 v[160:175], v[84:87], v[10:13], v[160:175]
    ds_read_b128 v[32:35], v64 offset:49920
    v_exp_f32 v149, v149
    v_exp_f32 v150, v150
    v_exp_f32 v151, v151
    v_exp_f32 v152, v152
    v_exp_f32 v153, v153
    v_smfmac_f32_32x32x32_bf16 v[112:127], v[40:43], v[144:151], v77
    s_add_u32 s68, s74, 4096
    s_addc_u32 s69, s75, 0
    v_exp_f32 v154, v154
    v_exp_f32 v155, v155
    v_exp_f32 v156, v156
    v_mfma_f32_32x32x16_bf16 v[176:191], v[84:87], v[14:17], v[176:191]
    ds_read_b128 v[36:39], v65 offset:49920
    v_exp_f32 v157, v157
    v_exp_f32 v158, v158
    v_exp_f32 v159, v159
    v_exp_f32 v160, v160
    v_exp_f32 v161, v161
    v_smfmac_f32_32x32x32_bf16 v[112:127], v[44:47], v[152:159], v77
    s_waitcnt lgkmcnt(2)
    ds_read_b128 v[84:87], v68 offset:50944
    v_exp_f32 v162, v162
    v_exp_f32 v163, v163
    v_exp_f32 v164, v164
    v_mfma_f32_32x32x4_2b_bf16 v[128:159], v[88:89], v[18:19], 0
    v_exp_f32 v165, v165
    v_exp_f32 v166, v166
    v_exp_f32 v167, v167
    v_exp_f32 v168, v168
    v_exp_f32 v169, v169
    v_exp_f32 v170, v170
    v_exp_f32 v171, v171
    v_exp_f32 v172, v172
    v_smfmac_f32_32x32x32_bf16 v[96:111], v[24:27], v[160:167], v77
    buffer_load_dwordx2 v[52:53], v74, s[28:31], s6 offen
    v_exp_f32 v173, v173
    v_exp_f32 v174, v174
    v_exp_f32 v175, v175
    v_exp_f32 v176, v176
    v_exp_f32 v177, v177
    v_smfmac_f32_32x32x32_bf16 v[96:111], v[28:31], v[168:175], v77
    buffer_load_dwordx4 a[180:183], v22, s[68:71], 0 offen offset:0 sc1
    v_exp_f32 v178, v178
    v_exp_f32 v179, v179
    v_exp_f32 v180, v180
    v_mfma_f32_32x32x16_bf16 v[128:143], v[80:83], v[10:13], v[128:143]
    ds_read_b128 v[40:43], v66 offset:49920
    v_exp_f32 v181, v181
    v_exp_f32 v182, v182
    v_exp_f32 v183, v183
    v_exp_f32 v184, v184
    v_exp_f32 v185, v185
    v_smfmac_f32_32x32x32_bf16 v[112:127], v[24:27], v[176:183], v77
    buffer_load_dwordx4 a[184:187], v22, s[68:71], 0 offen offset:1024 sc1
    v_exp_f32 v186, v186
    v_exp_f32 v187, v187
    v_exp_f32 v188, v188
    v_mfma_f32_32x32x16_bf16 v[144:159], v[80:83], v[14:17], v[144:159]
    ds_read_b128 v[44:47], v67 offset:49920
    v_exp_f32 v189, v189
    v_exp_f32 v190, v190
    v_exp_f32 v191, v191
    v_exp_f32 v128, v128
    v_exp_f32 v129, v129
    v_smfmac_f32_32x32x32_bf16 v[112:127], v[28:31], v[184:191], v77
    s_waitcnt lgkmcnt(2)
    ds_read_b128 v[80:83], v68 offset:54912
    v_exp_f32 v130, v130
    v_exp_f32 v131, v131
    v_exp_f32 v132, v132
    v_mfma_f32_32x32x4_2b_bf16 v[160:191], v[90:91], v[18:19], 0
    v_exp_f32 v133, v133
    v_exp_f32 v134, v134
    v_exp_f32 v135, v135
    v_exp_f32 v136, v136
    v_exp_f32 v137, v137
    v_exp_f32 v138, v138
    v_exp_f32 v139, v139
    v_exp_f32 v140, v140
    v_smfmac_f32_32x32x32_bf16 v[96:111], v[32:35], v[128:135], v77
    ds_read_b128 v[92:95], v69 offset:54912
    v_exp_f32 v141, v141
    v_exp_f32 v142, v142
    v_exp_f32 v143, v143
    v_exp_f32 v144, v144
    v_exp_f32 v145, v145
    v_smfmac_f32_32x32x32_bf16 v[96:111], v[36:39], v[136:143], v77
    buffer_load_dwordx4 a[188:191], v22, s[68:71], 0 offen offset:2048 sc1
    v_exp_f32 v146, v146
    v_exp_f32 v147, v147
    v_exp_f32 v148, v148
    v_mfma_f32_32x32x16_bf16 v[160:175], v[84:87], v[10:13], v[160:175]
    ds_read_b128 v[24:27], v64 offset:54912
    v_exp_f32 v149, v149
    v_exp_f32 v150, v150
    v_exp_f32 v151, v151
    v_exp_f32 v152, v152
    v_exp_f32 v153, v153
    v_smfmac_f32_32x32x32_bf16 v[112:127], v[32:35], v[144:151], v77
    buffer_load_dwordx4 a[192:195], v22, s[68:71], 0 offen offset:3072 sc1
    v_exp_f32 v154, v154
    v_exp_f32 v155, v155
    v_exp_f32 v156, v156
    v_mfma_f32_32x32x16_bf16 v[176:191], v[84:87], v[14:17], v[176:191]
    ds_read_b128 v[28:31], v65 offset:54912
    v_exp_f32 v157, v157
    v_exp_f32 v158, v158
    v_exp_f32 v159, v159
    v_exp_f32 v160, v160
    v_exp_f32 v161, v161
    v_smfmac_f32_32x32x32_bf16 v[112:127], v[36:39], v[152:159], v77
    s_waitcnt lgkmcnt(2)
    ds_read_b128 v[84:87], v68 offset:55936
    v_exp_f32 v162, v162
    v_exp_f32 v163, v163
    v_exp_f32 v164, v164
    v_mfma_f32_32x32x4_2b_bf16 v[128:159], v[92:93], v[18:19], 0
    v_exp_f32 v165, v165
    v_exp_f32 v166, v166
    v_exp_f32 v167, v167
    v_exp_f32 v168, v168
    v_exp_f32 v169, v169
    v_exp_f32 v170, v170
    v_exp_f32 v171, v171
    v_exp_f32 v172, v172
    v_smfmac_f32_32x32x32_bf16 v[96:111], v[40:43], v[160:167], v77
    buffer_load_dwordx2 v[54:55], v75, s[28:31], s6 offen
    v_exp_f32 v173, v173
    v_exp_f32 v174, v174
    v_exp_f32 v175, v175
    v_exp_f32 v176, v176
    v_exp_f32 v177, v177
    v_smfmac_f32_32x32x32_bf16 v[96:111], v[44:47], v[168:175], v77
    s_add_u32 s68, s74, 8192
    s_addc_u32 s69, s75, 0
    v_exp_f32 v178, v178
    v_exp_f32 v179, v179
    v_exp_f32 v180, v180
    v_mfma_f32_32x32x16_bf16 v[128:143], v[80:83], v[10:13], v[128:143]
    ds_read_b128 v[32:35], v66 offset:54912
    v_exp_f32 v181, v181
    v_exp_f32 v182, v182
    v_exp_f32 v183, v183
    v_exp_f32 v184, v184
    v_exp_f32 v185, v185
    v_smfmac_f32_32x32x32_bf16 v[112:127], v[40:43], v[176:183], v77
    buffer_load_dwordx4 a[196:199], v22, s[68:71], 0 offen offset:0 sc1
    v_exp_f32 v186, v186
    v_exp_f32 v187, v187
    v_exp_f32 v188, v188
    v_mfma_f32_32x32x16_bf16 v[144:159], v[80:83], v[14:17], v[144:159]
    ds_read_b128 v[36:39], v67 offset:54912
    v_exp_f32 v189, v189
    v_exp_f32 v190, v190
    v_exp_f32 v191, v191
    v_exp_f32 v128, v128
    v_exp_f32 v129, v129
    v_smfmac_f32_32x32x32_bf16 v[112:127], v[44:47], v[184:191], v77
    s_waitcnt lgkmcnt(2)
    ds_read_b128 v[80:83], v68 offset:59904
    v_exp_f32 v130, v130
    v_exp_f32 v131, v131
    v_exp_f32 v132, v132
    v_mfma_f32_32x32x4_2b_bf16 v[160:191], v[94:95], v[18:19], 0
    v_exp_f32 v133, v133
    v_exp_f32 v134, v134
    v_exp_f32 v135, v135
    v_exp_f32 v136, v136
    v_exp_f32 v137, v137
    v_exp_f32 v138, v138
    v_exp_f32 v139, v139
    v_exp_f32 v140, v140
    v_smfmac_f32_32x32x32_bf16 v[96:111], v[24:27], v[128:135], v77
    buffer_load_dwordx2 v[56:57], v76, s[28:31], s6 offen
    ds_read_b128 v[88:91], v69 offset:59904
    v_exp_f32 v141, v141
    v_exp_f32 v142, v142
    v_exp_f32 v143, v143
    v_exp_f32 v144, v144
    v_exp_f32 v145, v145
    v_smfmac_f32_32x32x32_bf16 v[96:111], v[28:31], v[136:143], v77
    s_add_u32 s68, s74, 36864
    s_addc_u32 s69, s75, 0
    v_exp_f32 v146, v146
    v_exp_f32 v147, v147
    v_exp_f32 v148, v148
    v_mfma_f32_32x32x16_bf16 v[160:175], v[84:87], v[10:13], v[160:175]
    ds_read_b128 v[40:43], v64 offset:59904
    v_exp_f32 v149, v149
    v_exp_f32 v150, v150
    v_exp_f32 v151, v151
    v_exp_f32 v152, v152
    v_exp_f32 v153, v153
    v_smfmac_f32_32x32x32_bf16 v[112:127], v[24:27], v[144:151], v77
    buffer_load_dwordx4 a[200:203], v22, s[68:71], 0 offen offset:0 sc1
    v_exp_f32 v154, v154
    v_exp_f32 v155, v155
    v_exp_f32 v156, v156
    v_mfma_f32_32x32x16_bf16 v[176:191], v[84:87], v[14:17], v[176:191]
    ds_read_b128 v[44:47], v65 offset:59904
    v_exp_f32 v157, v157
    v_exp_f32 v158, v158
    v_exp_f32 v159, v159
    v_exp_f32 v160, v160
    v_exp_f32 v161, v161
    v_smfmac_f32_32x32x32_bf16 v[112:127], v[28:31], v[152:159], v77
    s_waitcnt lgkmcnt(2)
    ds_read_b128 v[84:87], v68 offset:60928
    v_exp_f32 v162, v162
    v_exp_f32 v163, v163
    v_exp_f32 v164, v164
    v_mfma_f32_32x32x4_2b_bf16 v[128:159], v[88:89], v[18:19], 0
    v_exp_f32 v165, v165
    v_exp_f32 v166, v166
    v_exp_f32 v167, v167
    v_exp_f32 v168, v168
    v_exp_f32 v169, v169
    v_exp_f32 v170, v170
    v_exp_f32 v171, v171
    v_exp_f32 v172, v172
    v_smfmac_f32_32x32x32_bf16 v[96:111], v[32:35], v[160:167], v77
    buffer_load_dwordx4 a[204:207], v22, s[68:71], 0 offen offset:1024 sc1
    v_exp_f32 v173, v173
    v_exp_f32 v174, v174
    v_exp_f32 v175, v175
    v_exp_f32 v176, v176
    v_exp_f32 v177, v177
    v_smfmac_f32_32x32x32_bf16 v[96:111], v[36:39], v[168:175], v77
    buffer_load_dwordx4 a[208:211], v22, s[68:71], 0 offen offset:2048 sc1
    v_exp_f32 v178, v178
    v_exp_f32 v179, v179
    v_exp_f32 v180, v180
    v_mfma_f32_32x32x16_bf16 v[128:143], v[80:83], v[10:13], v[128:143]
    ds_read_b128 v[24:27], v66 offset:59904
    v_exp_f32 v181, v181
    v_exp_f32 v182, v182
    v_exp_f32 v183, v183
    v_exp_f32 v184, v184
    v_exp_f32 v185, v185
    v_smfmac_f32_32x32x32_bf16 v[112:127], v[32:35], v[176:183], v77
    v_exp_f32 v186, v186
    v_exp_f32 v187, v187
    v_exp_f32 v188, v188
    v_mfma_f32_32x32x16_bf16 v[144:159], v[80:83], v[14:17], v[144:159]
    ds_read_b128 v[28:31], v67 offset:59904
    v_exp_f32 v189, v189
    v_exp_f32 v190, v190
    v_exp_f32 v191, v191
    v_add_u32 v68, 64896, v68
    v_add_u32 v69, 64896, v69
    v_add_u32 v64, v71, v64
    v_add_u32 v65, v71, v65
    v_exp_f32 v128, v128
    v_exp_f32 v129, v129
    v_smfmac_f32_32x32x32_bf16 v[112:127], v[36:39], v[184:191], v77
    s_waitcnt lgkmcnt(2)
    ds_read_b128 v[80:83], v68 offset:0
    v_exp_f32 v130, v130
    v_exp_f32 v131, v131
    v_exp_f32 v132, v132
    v_mfma_f32_32x32x4_2b_bf16 v[160:191], v[90:91], v[18:19], 0
    v_exp_f32 v133, v133
    v_exp_f32 v134, v134
    v_exp_f32 v135, v135
    v_exp_f32 v136, v136
    v_exp_f32 v137, v137
    v_exp_f32 v138, v138
    v_exp_f32 v139, v139
    v_exp_f32 v140, v140
    v_smfmac_f32_32x32x32_bf16 v[96:111], v[40:43], v[128:135], v77
    global_load_dwordx4 v[244:247], v22, s[0:1] offset:-3072
    ds_read_b128 v[92:95], v69 offset:0
    v_exp_f32 v141, v141
    v_exp_f32 v142, v142
    v_exp_f32 v143, v143
    v_exp_f32 v144, v144
    v_exp_f32 v145, v145
    v_smfmac_f32_32x32x32_bf16 v[96:111], v[44:47], v[136:143], v77
    buffer_load_dwordx4 a[212:215], v22, s[68:71], 0 offen offset:3072 sc1
    v_exp_f32 v146, v146
    v_exp_f32 v147, v147
    v_exp_f32 v148, v148
    v_mfma_f32_32x32x16_bf16 v[160:175], v[84:87], v[10:13], v[160:175]
    ds_read_b128 v[32:35], v64 offset:0
    v_exp_f32 v149, v149
    v_exp_f32 v150, v150
    v_exp_f32 v151, v151
    v_exp_f32 v152, v152
    v_exp_f32 v153, v153
    v_smfmac_f32_32x32x32_bf16 v[112:127], v[40:43], v[144:151], v77
    s_add_u32 s68, s74, 40960
    s_addc_u32 s69, s75, 0
    v_exp_f32 v154, v154
    v_exp_f32 v155, v155
    v_exp_f32 v156, v156
    v_mfma_f32_32x32x16_bf16 v[176:191], v[84:87], v[14:17], v[176:191]
    ds_read_b128 v[36:39], v65 offset:0
    v_exp_f32 v157, v157
    v_exp_f32 v158, v158
    v_exp_f32 v159, v159
    v_add_u32 v66, v71, v66
    v_add_u32 v67, v71, v67
    v_exp_f32 v160, v160
    v_exp_f32 v161, v161
    v_smfmac_f32_32x32x32_bf16 v[112:127], v[44:47], v[152:159], v77
    s_waitcnt lgkmcnt(2)
    ds_read_b128 v[84:87], v68 offset:1024
    v_exp_f32 v162, v162
    v_exp_f32 v163, v163
    v_exp_f32 v164, v164
    v_mfma_f32_32x32x4_2b_bf16 v[128:159], v[92:93], v[18:19], 0
    v_exp_f32 v165, v165
    v_exp_f32 v166, v166
    v_exp_f32 v167, v167
    v_exp_f32 v168, v168
    v_exp_f32 v169, v169
    v_exp_f32 v170, v170
    v_exp_f32 v171, v171
    v_exp_f32 v172, v172
    v_smfmac_f32_32x32x32_bf16 v[96:111], v[24:27], v[160:167], v77
    buffer_load_dwordx4 a[216:219], v22, s[68:71], 0 offen offset:0 sc1
    v_exp_f32 v173, v173
    v_exp_f32 v174, v174
    v_exp_f32 v175, v175
    v_exp_f32 v176, v176
    v_exp_f32 v177, v177
    v_smfmac_f32_32x32x32_bf16 v[96:111], v[28:31], v[168:175], v77
    buffer_load_dwordx4 a[220:223], v22, s[68:71], 0 offen offset:1024 sc1
    v_exp_f32 v178, v178
    v_exp_f32 v179, v179
    v_exp_f32 v180, v180
    v_mfma_f32_32x32x16_bf16 v[128:143], v[80:83], v[10:13], v[128:143]
    ds_read_b128 v[40:43], v66 offset:0
    v_exp_f32 v181, v181
    v_exp_f32 v182, v182
    v_exp_f32 v183, v183
    v_exp_f32 v184, v184
    v_exp_f32 v185, v185
    v_smfmac_f32_32x32x32_bf16 v[112:127], v[24:27], v[176:183], v77
    v_exp_f32 v186, v186
    v_exp_f32 v187, v187
    v_exp_f32 v188, v188
    v_mfma_f32_32x32x16_bf16 v[144:159], v[80:83], v[14:17], v[144:159]
    ds_read_b128 v[44:47], v67 offset:0
    v_exp_f32 v189, v189
    v_exp_f32 v190, v190
    v_exp_f32 v191, v191
    v_exp_f32 v128, v128
    v_exp_f32 v129, v129
    v_smfmac_f32_32x32x32_bf16 v[112:127], v[28:31], v[184:191], v77
    s_waitcnt lgkmcnt(2)
    ds_read_b128 v[80:83], v68 offset:4992
    v_exp_f32 v130, v130
    v_exp_f32 v131, v131
    v_exp_f32 v132, v132
    v_mfma_f32_32x32x4_2b_bf16 v[160:191], v[94:95], v[18:19], 0
    v_exp_f32 v133, v133
    v_exp_f32 v134, v134
    v_exp_f32 v135, v135
    v_exp_f32 v136, v136
    v_exp_f32 v137, v137
    v_exp_f32 v138, v138
    v_exp_f32 v139, v139
    v_exp_f32 v140, v140
    v_smfmac_f32_32x32x32_bf16 v[96:111], v[32:35], v[128:135], v77
    global_load_dwordx4 v[248:251], v22, s[0:1] offset:-2048
    ds_read_b128 v[88:91], v69 offset:4992
    v_exp_f32 v141, v141
    v_exp_f32 v142, v142
    v_exp_f32 v143, v143
    v_exp_f32 v144, v144
    v_exp_f32 v145, v145
    v_smfmac_f32_32x32x32_bf16 v[96:111], v[36:39], v[136:143], v77
    buffer_load_dwordx4 a[224:227], v22, s[68:71], 0 offen offset:2048 sc1
    v_exp_f32 v146, v146
    v_exp_f32 v147, v147
    v_exp_f32 v148, v148
    v_mfma_f32_32x32x16_bf16 v[160:175], v[84:87], v[10:13], v[160:175]
    ds_read_b128 v[24:27], v64 offset:4992
    v_exp_f32 v149, v149
    v_exp_f32 v150, v150
    v_exp_f32 v151, v151
    v_exp_f32 v152, v152
    v_exp_f32 v153, v153
    v_smfmac_f32_32x32x32_bf16 v[112:127], v[32:35], v[144:151], v77
    buffer_load_dwordx4 a[228:231], v22, s[68:71], 0 offen offset:3072 sc1
    v_exp_f32 v154, v154
    v_exp_f32 v155, v155
    v_exp_f32 v156, v156
    v_mfma_f32_32x32x16_bf16 v[176:191], v[84:87], v[14:17], v[176:191]
    ds_read_b128 v[28:31], v65 offset:4992
    v_exp_f32 v157, v157
    v_exp_f32 v158, v158
    v_exp_f32 v159, v159
    v_exp_f32 v160, v160
    v_exp_f32 v161, v161
    v_smfmac_f32_32x32x32_bf16 v[112:127], v[36:39], v[152:159], v77
    s_waitcnt lgkmcnt(2)
    ds_read_b128 v[84:87], v68 offset:6016
    v_exp_f32 v162, v162
    v_exp_f32 v163, v163
    v_exp_f32 v164, v164
    v_mfma_f32_32x32x4_2b_bf16 v[128:159], v[88:89], v[18:19], 0
    v_exp_f32 v165, v165
    v_exp_f32 v166, v166
    v_exp_f32 v167, v167
    v_exp_f32 v168, v168
    v_exp_f32 v169, v169
    v_exp_f32 v170, v170
    v_exp_f32 v171, v171
    v_exp_f32 v172, v172
    v_smfmac_f32_32x32x32_bf16 v[96:111], v[40:43], v[160:167], v77
    global_load_dwordx3 v[252:254], v22, s[0:1] offset:-1024
    v_exp_f32 v173, v173
    v_exp_f32 v174, v174
    v_exp_f32 v175, v175
    v_exp_f32 v176, v176
    v_exp_f32 v177, v177
    v_smfmac_f32_32x32x32_bf16 v[96:111], v[44:47], v[168:175], v77
    s_add_u32 s68, s74, 45056
    s_addc_u32 s69, s75, 0
    v_exp_f32 v178, v178
    v_exp_f32 v179, v179
    v_exp_f32 v180, v180
    v_mfma_f32_32x32x16_bf16 v[128:143], v[80:83], v[10:13], v[128:143]
    ds_read_b128 v[32:35], v66 offset:4992
    v_exp_f32 v181, v181
    v_exp_f32 v182, v182
    v_exp_f32 v183, v183
    v_exp_f32 v184, v184
    v_exp_f32 v185, v185
    v_smfmac_f32_32x32x32_bf16 v[112:127], v[40:43], v[176:183], v77
    buffer_load_dwordx4 a[232:235], v22, s[68:71], 0 offen offset:0 sc1
    v_exp_f32 v186, v186
    v_exp_f32 v187, v187
    v_exp_f32 v188, v188
    v_mfma_f32_32x32x16_bf16 v[144:159], v[80:83], v[14:17], v[144:159]
    ds_read_b128 v[36:39], v67 offset:4992
    v_exp_f32 v189, v189
    v_exp_f32 v190, v190
    v_exp_f32 v191, v191
    v_exp_f32 v128, v128
    v_exp_f32 v129, v129
    v_smfmac_f32_32x32x32_bf16 v[112:127], v[44:47], v[184:191], v77
    s_waitcnt lgkmcnt(2)
    ds_read_b128 v[80:83], v68 offset:9984
    v_exp_f32 v130, v130
    v_exp_f32 v131, v131
    v_exp_f32 v132, v132
    v_mfma_f32_32x32x4_2b_bf16 v[160:191], v[90:91], v[18:19], 0
    v_exp_f32 v133, v133
    v_exp_f32 v134, v134
    v_exp_f32 v135, v135
    v_exp_f32 v136, v136
    v_exp_f32 v137, v137
    v_exp_f32 v138, v138
    v_exp_f32 v139, v139
    v_exp_f32 v140, v140
    v_smfmac_f32_32x32x32_bf16 v[96:111], v[24:27], v[128:135], v77
    s_add_u32 s68, s74, 73728
    s_addc_u32 s69, s75, 0
    ds_read_b128 v[92:95], v69 offset:9984
    v_exp_f32 v141, v141
    v_exp_f32 v142, v142
    v_exp_f32 v143, v143
    v_exp_f32 v144, v144
    v_exp_f32 v145, v145
    v_smfmac_f32_32x32x32_bf16 v[96:111], v[28:31], v[136:143], v77
    v_exp_f32 v146, v146
    v_exp_f32 v147, v147
    v_exp_f32 v148, v148
    v_mfma_f32_32x32x16_bf16 v[160:175], v[84:87], v[10:13], v[160:175]
    ds_read_b128 v[40:43], v64 offset:9984
    v_exp_f32 v149, v149
    v_exp_f32 v150, v150
    v_exp_f32 v151, v151
    v_exp_f32 v152, v152
    v_exp_f32 v153, v153
    v_smfmac_f32_32x32x32_bf16 v[112:127], v[24:27], v[144:151], v77
    v_exp_f32 v154, v154
    v_exp_f32 v155, v155
    v_exp_f32 v156, v156
    v_mfma_f32_32x32x16_bf16 v[176:191], v[84:87], v[14:17], v[176:191]
    ds_read_b128 v[44:47], v65 offset:9984
    v_exp_f32 v157, v157
    v_exp_f32 v158, v158
    v_exp_f32 v159, v159
    v_exp_f32 v160, v160
    v_exp_f32 v161, v161
    v_smfmac_f32_32x32x32_bf16 v[112:127], v[28:31], v[152:159], v77
    s_waitcnt lgkmcnt(2)
    ds_read_b128 v[84:87], v68 offset:11008
    v_exp_f32 v162, v162
    v_exp_f32 v163, v163
    v_exp_f32 v164, v164
    v_mfma_f32_32x32x4_2b_bf16 v[128:159], v[92:93], v[18:19], 0
    v_exp_f32 v165, v165
    v_exp_f32 v166, v166
    v_exp_f32 v167, v167
    v_exp_f32 v168, v168
    v_exp_f32 v169, v169
    v_exp_f32 v170, v170
    v_exp_f32 v171, v171
    v_exp_f32 v172, v172
    v_smfmac_f32_32x32x32_bf16 v[96:111], v[32:35], v[160:167], v77
    global_load_dwordx2 v[58:59], v22, s[0:1] offset:0
    v_exp_f32 v173, v173
    v_exp_f32 v174, v174
    v_exp_f32 v175, v175
    v_exp_f32 v176, v176
    v_exp_f32 v177, v177
    v_smfmac_f32_32x32x32_bf16 v[96:111], v[36:39], v[168:175], v77
    buffer_load_dwordx4 a[236:239], v22, s[68:71], 0 offen offset:0 sc1
    v_exp_f32 v178, v178
    v_exp_f32 v179, v179
    v_exp_f32 v180, v180
    v_mfma_f32_32x32x16_bf16 v[128:143], v[80:83], v[10:13], v[128:143]
    ds_read_b128 v[24:27], v66 offset:9984
    v_exp_f32 v181, v181
    v_exp_f32 v182, v182
    v_exp_f32 v183, v183
    v_exp_f32 v184, v184
    v_exp_f32 v185, v185
    v_smfmac_f32_32x32x32_bf16 v[112:127], v[32:35], v[176:183], v77
    buffer_load_dwordx4 a[240:243], v22, s[68:71], 0 offen offset:1024 sc1
    v_exp_f32 v186, v186
    v_exp_f32 v187, v187
    v_exp_f32 v188, v188
    v_mfma_f32_32x32x16_bf16 v[144:159], v[80:83], v[14:17], v[144:159]
    ds_read_b128 v[28:31], v67 offset:9984
    v_exp_f32 v189, v189
    v_exp_f32 v190, v190
    v_exp_f32 v191, v191
    v_exp_f32 v128, v128
    v_exp_f32 v129, v129
    v_smfmac_f32_32x32x32_bf16 v[112:127], v[36:39], v[184:191], v77
    s_waitcnt lgkmcnt(2)
    ds_read_b128 v[80:83], v68 offset:14976
    v_exp_f32 v130, v130
    v_exp_f32 v131, v131
    v_exp_f32 v132, v132
    v_mfma_f32_32x32x4_2b_bf16 v[160:191], v[94:95], v[18:19], 0
    v_exp_f32 v133, v133
    v_exp_f32 v134, v134
    v_exp_f32 v135, v135
    v_exp_f32 v136, v136
    v_exp_f32 v137, v137
    v_exp_f32 v138, v138
    v_exp_f32 v139, v139
    v_exp_f32 v140, v140
    v_smfmac_f32_32x32x32_bf16 v[96:111], v[40:43], v[128:135], v77
    ds_read_b128 v[88:91], v69 offset:14976
    v_exp_f32 v141, v141
    v_exp_f32 v142, v142
    v_exp_f32 v143, v143
    v_exp_f32 v144, v144
    v_exp_f32 v145, v145
    v_smfmac_f32_32x32x32_bf16 v[96:111], v[44:47], v[136:143], v77
    buffer_load_dwordx4 a[244:247], v22, s[68:71], 0 offen offset:2048 sc1
    v_exp_f32 v146, v146
    v_exp_f32 v147, v147
    v_exp_f32 v148, v148
    v_mfma_f32_32x32x16_bf16 v[160:175], v[84:87], v[10:13], v[160:175]
    ds_read_b128 v[32:35], v64 offset:14976
    v_exp_f32 v149, v149
    v_exp_f32 v150, v150
    v_exp_f32 v151, v151
    v_exp_f32 v152, v152
    v_exp_f32 v153, v153
    v_smfmac_f32_32x32x32_bf16 v[112:127], v[40:43], v[144:151], v77
    buffer_load_dwordx4 a[248:251], v22, s[68:71], 0 offen offset:3072 sc1
    v_exp_f32 v154, v154
    v_exp_f32 v155, v155
    v_exp_f32 v156, v156
    v_mfma_f32_32x32x16_bf16 v[176:191], v[84:87], v[14:17], v[176:191]
    ds_read_b128 v[36:39], v65 offset:14976
    v_exp_f32 v157, v157
    v_exp_f32 v158, v158
    v_exp_f32 v159, v159
    v_exp_f32 v160, v160
    v_exp_f32 v161, v161
    v_smfmac_f32_32x32x32_bf16 v[112:127], v[44:47], v[152:159], v77
    s_waitcnt lgkmcnt(2)
    ds_read_b128 v[84:87], v68 offset:16000
    v_exp_f32 v162, v162
    v_exp_f32 v163, v163
    v_exp_f32 v164, v164
    v_mfma_f32_32x32x4_2b_bf16 v[128:159], v[88:89], v[18:19], 0
    v_exp_f32 v165, v165
    v_exp_f32 v166, v166
    v_exp_f32 v167, v167
    v_exp_f32 v168, v168
    v_exp_f32 v169, v169
    v_exp_f32 v170, v170
    v_exp_f32 v171, v171
    v_exp_f32 v172, v172
    v_smfmac_f32_32x32x32_bf16 v[96:111], v[24:27], v[160:167], v77
    global_load_dwordx4 v[60:63], v22, s[0:1] offset:1024
    v_exp_f32 v173, v173
    v_exp_f32 v174, v174
    v_exp_f32 v175, v175
    v_exp_f32 v176, v176
    v_exp_f32 v177, v177
    v_smfmac_f32_32x32x32_bf16 v[96:111], v[28:31], v[168:175], v77
    s_add_u32 s68, s74, 77824
    s_addc_u32 s69, s75, 0
    v_exp_f32 v178, v178
    v_exp_f32 v179, v179
    v_exp_f32 v180, v180
    v_mfma_f32_32x32x16_bf16 v[128:143], v[80:83], v[10:13], v[128:143]
    ds_read_b128 v[40:43], v66 offset:14976
    v_exp_f32 v181, v181
    v_exp_f32 v182, v182
    v_exp_f32 v183, v183
    v_exp_f32 v184, v184
    v_exp_f32 v185, v185
    v_smfmac_f32_32x32x32_bf16 v[112:127], v[24:27], v[176:183], v77
    buffer_load_dwordx4 a[252:255], v22, s[68:71], 0 offen offset:0 sc1
    v_exp_f32 v186, v186
    v_exp_f32 v187, v187
    v_exp_f32 v188, v188
    v_mfma_f32_32x32x16_bf16 v[144:159], v[80:83], v[14:17], v[144:159]
    ds_read_b128 v[44:47], v67 offset:14976
    v_exp_f32 v189, v189
    v_exp_f32 v190, v190
    v_exp_f32 v191, v191
    v_exp_f32 v128, v128
    v_exp_f32 v129, v129
    v_smfmac_f32_32x32x32_bf16 v[112:127], v[28:31], v[184:191], v77
    s_waitcnt lgkmcnt(2)
    ds_read_b128 v[80:83], v68 offset:19968
    v_exp_f32 v130, v130
    v_exp_f32 v131, v131
    v_exp_f32 v132, v132
    v_mfma_f32_32x32x4_2b_bf16 v[160:191], v[90:91], v[18:19], 0
    v_exp_f32 v133, v133
    v_exp_f32 v134, v134
    v_exp_f32 v135, v135
    v_exp_f32 v136, v136
    v_exp_f32 v137, v137
    v_exp_f32 v138, v138
    v_exp_f32 v139, v139
    v_exp_f32 v140, v140
    v_smfmac_f32_32x32x32_bf16 v[96:111], v[32:35], v[128:135], v77
    ds_read_b128 v[92:95], v69 offset:19968
    v_exp_f32 v141, v141
    v_exp_f32 v142, v142
    v_exp_f32 v143, v143
    v_exp_f32 v144, v144
    v_exp_f32 v145, v145
    v_smfmac_f32_32x32x32_bf16 v[96:111], v[36:39], v[136:143], v77
    buffer_load_dwordx4 v[192:195], v22, s[68:71], 0 offen offset:1024 sc1
    v_exp_f32 v146, v146
    v_exp_f32 v147, v147
    v_exp_f32 v148, v148
    v_mfma_f32_32x32x16_bf16 v[160:175], v[84:87], v[10:13], v[160:175]
    ds_read_b128 v[24:27], v64 offset:19968
    v_exp_f32 v149, v149
    v_exp_f32 v150, v150
    v_exp_f32 v151, v151
    v_exp_f32 v152, v152
    v_exp_f32 v153, v153
    v_smfmac_f32_32x32x32_bf16 v[112:127], v[32:35], v[144:151], v77
    buffer_load_dwordx4 v[196:199], v22, s[68:71], 0 offen offset:2048 sc1
    v_exp_f32 v154, v154
    v_exp_f32 v155, v155
    v_exp_f32 v156, v156
L_pgx13:
    s_cbranch_execz L_back1
    v_mfma_f32_32x32x16_bf16 v[176:191], v[84:87], v[14:17], v[176:191]
    ds_read_b128 v[28:31], v65 offset:19968
    v_exp_f32 v157, v157
    v_exp_f32 v158, v158
    v_exp_f32 v159, v159
    v_exp_f32 v160, v160
    v_exp_f32 v161, v161
    v_smfmac_f32_32x32x32_bf16 v[112:127], v[36:39], v[152:159], v77
    s_waitcnt lgkmcnt(2)
    ds_read_b128 v[84:87], v68 offset:20992
    v_exp_f32 v162, v162
    v_exp_f32 v163, v163
    v_exp_f32 v164, v164
    v_mfma_f32_32x32x4_2b_bf16 v[128:159], v[92:93], v[18:19], 0
    v_exp_f32 v165, v165
    v_exp_f32 v166, v166
    v_exp_f32 v167, v167
    v_exp_f32 v168, v168
    v_exp_f32 v169, v169
    v_exp_f32 v170, v170
    v_exp_f32 v171, v171
    v_exp_f32 v172, v172
    v_smfmac_f32_32x32x32_bf16 v[96:111], v[40:43], v[160:167], v77
    buffer_load_dwordx4 v[200:203], v22, s[68:71], 0 offen offset:3072 sc1
    v_exp_f32 v173, v173
    v_exp_f32 v174, v174
    v_exp_f32 v175, v175
    v_exp_f32 v176, v176
    v_exp_f32 v177, v177
    v_smfmac_f32_32x32x32_bf16 v[96:111], v[44:47], v[168:175], v77
    s_add_u32 s68, s74, 81920
    s_addc_u32 s69, s75, 0
    v_exp_f32 v178, v178
    v_exp_f32 v179, v179
    v_exp_f32 v180, v180
    v_mfma_f32_32x32x16_bf16 v[128:143], v[80:83], v[10:13], v[128:143]
    ds_read_b128 v[32:35], v66 offset:19968
    v_exp_f32 v181, v181
    v_exp_f32 v182, v182
    v_exp_f32 v183, v183
    v_exp_f32 v184, v184
    v_exp_f32 v185, v185
    v_smfmac_f32_32x32x32_bf16 v[112:127], v[40:43], v[176:183], v77
    v_exp_f32 v186, v186
    v_exp_f32 v187, v187
    v_exp_f32 v188, v188
    v_mfma_f32_32x32x16_bf16 v[144:159], v[80:83], v[14:17], v[144:159]
    ds_read_b128 v[36:39], v67 offset:19968
    v_exp_f32 v189, v189
    v_exp_f32 v190, v190
    v_exp_f32 v191, v191
    v_exp_f32 v128, v128
    v_exp_f32 v129, v129
    v_smfmac_f32_32x32x32_bf16 v[112:127], v[44:47], v[184:191], v77
    s_waitcnt lgkmcnt(2)
    ds_read_b128 v[80:83], v68 offset:24960
    v_exp_f32 v130, v130
    v_exp_f32 v131, v131
    v_exp_f32 v132, v132
    v_mfma_f32_32x32x4_2b_bf16 v[160:191], v[94:95], v[18:19], 0
    v_exp_f32 v133, v133
    v_exp_f32 v134, v134
    v_exp_f32 v135, v135
    v_exp_f32 v136, v136
    v_exp_f32 v137, v137
    v_exp_f32 v138, v138
    v_exp_f32 v139, v139
    v_exp_f32 v140, v140
    v_smfmac_f32_32x32x32_bf16 v[96:111], v[24:27], v[128:135], v77
    ds_read_b128 v[88:91], v69 offset:24960
    v_exp_f32 v141, v141
    v_exp_f32 v142, v142
    v_exp_f32 v143, v143
    v_exp_f32 v144, v144
    v_exp_f32 v145, v145
    v_smfmac_f32_32x32x32_bf16 v[96:111], v[28:31], v[136:143], v77
    buffer_load_dwordx4 v[204:207], v22, s[68:71], 0 offen offset:0 sc1
    v_exp_f32 v146, v146
    v_exp_f32 v147, v147
    v_exp_f32 v148, v148
    v_mfma_f32_32x32x16_bf16 v[160:175], v[84:87], v[10:13], v[160:175]
    ds_read_b128 v[40:43], v64 offset:24960
    v_exp_f32 v149, v149
    v_exp_f32 v150, v150
    v_exp_f32 v151, v151
    v_exp_f32 v152, v152
    v_exp_f32 v153, v153
    v_smfmac_f32_32x32x32_bf16 v[112:127], v[24:27], v[144:151], v77
    s_add_u32 s68, s74, 110592
    s_addc_u32 s69, s75, 0
    v_exp_f32 v154, v154
    v_exp_f32 v155, v155
    v_exp_f32 v156, v156
    v_mfma_f32_32x32x16_bf16 v[176:191], v[84:87], v[14:17], v[176:191]
    ds_read_b128 v[44:47], v65 offset:24960
    v_exp_f32 v157, v157
    v_exp_f32 v158, v158
    v_exp_f32 v159, v159
    v_exp_f32 v160, v160
    v_exp_f32 v161, v161
    v_smfmac_f32_32x32x32_bf16 v[112:127], v[28:31], v[152:159], v77
    s_waitcnt lgkmcnt(2)
    ds_read_b128 v[84:87], v68 offset:25984
    v_exp_f32 v162, v162
    v_exp_f32 v163, v163
    v_exp_f32 v164, v164
    v_mfma_f32_32x32x4_2b_bf16 v[128:159], v[88:89], v[18:19], 0
    v_exp_f32 v165, v165
    v_exp_f32 v166, v166
    v_exp_f32 v167, v167
    v_exp_f32 v168, v168
    v_exp_f32 v169, v169
    v_exp_f32 v170, v170
    v_exp_f32 v171, v171
    v_exp_f32 v172, v172
    v_smfmac_f32_32x32x32_bf16 v[96:111], v[32:35], v[160:167], v77
    buffer_load_dwordx4 v[208:211], v22, s[68:71], 0 offen offset:0 sc1
    v_exp_f32 v173, v173
    v_exp_f32 v174, v174
    v_exp_f32 v175, v175
    v_exp_f32 v176, v176
    v_exp_f32 v177, v177
    v_smfmac_f32_32x32x32_bf16 v[96:111], v[36:39], v[168:175], v77
    buffer_load_dwordx4 v[212:215], v22, s[68:71], 0 offen offset:1024 sc1
    v_exp_f32 v178, v178
    v_exp_f32 v179, v179
    v_exp_f32 v180, v180
    v_mfma_f32_32x32x16_bf16 v[128:143], v[80:83], v[10:13], v[128:143]
    ds_read_b128 v[24:27], v66 offset:24960
    v_exp_f32 v181, v181
    v_exp_f32 v182, v182
    v_exp_f32 v183, v183
    v_exp_f32 v184, v184
    v_exp_f32 v185, v185
    v_smfmac_f32_32x32x32_bf16 v[112:127], v[32:35], v[176:183], v77
    v_exp_f32 v186, v186
    v_exp_f32 v187, v187
    v_exp_f32 v188, v188
    v_mfma_f32_32x32x16_bf16 v[144:159], v[80:83], v[14:17], v[144:159]
    ds_read_b128 v[28:31], v67 offset:24960
    v_exp_f32 v189, v189
    v_exp_f32 v190, v190
    v_exp_f32 v191, v191
    v_exp_f32 v128, v128
    v_exp_f32 v129, v129
    v_smfmac_f32_32x32x32_bf16 v[112:127], v[36:39], v[184:191], v77
    s_waitcnt lgkmcnt(2)
    ds_read_b128 v[80:83], v68 offset:29952
    v_exp_f32 v130, v130
    v_exp_f32 v131, v131
    v_exp_f32 v132, v132
    v_mfma_f32_32x32x4_2b_bf16 v[160:191], v[90:91], v[18:19], 0
    v_exp_f32 v133, v133
    v_exp_f32 v134, v134
    v_exp_f32 v135, v135
    v_exp_f32 v136, v136
    v_exp_f32 v137, v137
    v_exp_f32 v138, v138
    v_exp_f32 v139, v139
    v_exp_f32 v140, v140
    v_smfmac_f32_32x32x32_bf16 v[96:111], v[40:43], v[128:135], v77
    ds_read_b128 v[92:95], v69 offset:29952
    v_exp_f32 v141, v141
    v_exp_f32 v142, v142
    v_exp_f32 v143, v143
    v_exp_f32 v144, v144
    v_exp_f32 v145, v145
    v_smfmac_f32_32x32x32_bf16 v[96:111], v[44:47], v[136:143], v77
    buffer_load_dwordx4 v[216:219], v22, s[68:71], 0 offen offset:2048 sc1
    v_exp_f32 v146, v146
    v_exp_f32 v147, v147
    v_exp_f32 v148, v148
    v_mfma_f32_32x32x16_bf16 v[160:175], v[84:87], v[10:13], v[160:175]
    ds_read_b128 v[32:35], v64 offset:29952
    v_exp_f32 v149, v149
    v_exp_f32 v150, v150
    v_exp_f32 v151, v151
    v_exp_f32 v152, v152
    v_exp_f32 v153, v153
    v_smfmac_f32_32x32x32_bf16 v[112:127], v[40:43], v[144:151], v77
    buffer_load_dwordx4 v[220:223], v22, s[68:71], 0 offen offset:3072 sc1
    v_exp_f32 v154, v154
    v_exp_f32 v155, v155
    v_exp_f32 v156, v156
    v_mfma_f32_32x32x16_bf16 v[176:191], v[84:87], v[14:17], v[176:191]
    ds_read_b128 v[36:39], v65 offset:29952
    v_exp_f32 v157, v157
    v_exp_f32 v158, v158
    v_exp_f32 v159, v159
    v_exp_f32 v160, v160
    v_exp_f32 v161, v161
    v_smfmac_f32_32x32x32_bf16 v[112:127], v[44:47], v[152:159], v77
    s_waitcnt lgkmcnt(2)
    ds_read_b128 v[84:87], v68 offset:30976
    v_exp_f32 v162, v162
    v_exp_f32 v163, v163
    v_exp_f32 v164, v164
    v_mfma_f32_32x32x4_2b_bf16 v[128:159], v[92:93], v[18:19], 0
    v_exp_f32 v165, v165
    v_exp_f32 v166, v166
    v_exp_f32 v167, v167
    v_exp_f32 v168, v168
    v_exp_f32 v169, v169
    v_exp_f32 v170, v170
    v_exp_f32 v171, v171
    v_exp_f32 v172, v172
    v_smfmac_f32_32x32x32_bf16 v[96:111], v[24:27], v[160:167], v77
    s_add_u32 s68, s74, 114688
    s_addc_u32 s69, s75, 0
    v_exp_f32 v173, v173
    v_exp_f32 v174, v174
    v_exp_f32 v175, v175
    v_exp_f32 v176, v176
    v_exp_f32 v177, v177
    v_smfmac_f32_32x32x32_bf16 v[96:111], v[28:31], v[168:175], v77
    buffer_load_dwordx4 v[224:227], v22, s[68:71], 0 offen offset:0 sc1
    v_exp_f32 v178, v178
    v_exp_f32 v179, v179
    v_exp_f32 v180, v180
    v_mfma_f32_32x32x16_bf16 v[128:143], v[80:83], v[10:13], v[128:143]
    ds_read_b128 v[40:43], v66 offset:29952
    v_exp_f32 v181, v181
    v_exp_f32 v182, v182
    v_exp_f32 v183, v183
    v_exp_f32 v184, v184
    v_exp_f32 v185, v185
    v_smfmac_f32_32x32x32_bf16 v[112:127], v[24:27], v[176:183], v77
    v_exp_f32 v186, v186
    v_exp_f32 v187, v187
    v_exp_f32 v188, v188
    v_mfma_f32_32x32x16_bf16 v[144:159], v[80:83], v[14:17], v[144:159]
    ds_read_b128 v[44:47], v67 offset:29952
    v_exp_f32 v189, v189
    v_exp_f32 v190, v190
    v_exp_f32 v191, v191
    v_exp_f32 v128, v128
    v_exp_f32 v129, v129
    v_smfmac_f32_32x32x32_bf16 v[112:127], v[28:31], v[184:191], v77
    s_waitcnt lgkmcnt(2)
    ds_read_b128 v[80:83], v68 offset:34944
    v_exp_f32 v130, v130
    v_exp_f32 v131, v131
    v_exp_f32 v132, v132
    v_mfma_f32_32x32x4_2b_bf16 v[160:191], v[94:95], v[18:19], 0
    v_exp_f32 v133, v133
    v_exp_f32 v134, v134
    v_exp_f32 v135, v135
    v_exp_f32 v136, v136
    v_exp_f32 v137, v137
    v_exp_f32 v138, v138
    v_exp_f32 v139, v139
    v_exp_f32 v140, v140
    v_smfmac_f32_32x32x32_bf16 v[96:111], v[32:35], v[128:135], v77
    ds_read_b128 v[88:91], v69 offset:34944
    v_exp_f32 v141, v141
    v_exp_f32 v142, v142
    v_exp_f32 v143, v143
    v_exp_f32 v144, v144
    v_exp_f32 v145, v145
    v_smfmac_f32_32x32x32_bf16 v[96:111], v[36:39], v[136:143], v77
    buffer_load_dwordx4 v[228:231], v22, s[68:71], 0 offen offset:1024 sc1
    v_exp_f32 v146, v146
    v_exp_f32 v147, v147
    v_exp_f32 v148, v148
    v_mfma_f32_32x32x16_bf16 v[160:175], v[84:87], v[10:13], v[160:175]
    ds_read_b128 v[24:27], v64 offset:34944
    v_exp_f32 v149, v149
    v_exp_f32 v150, v150
    v_exp_f32 v151, v151
    v_exp_f32 v152, v152
    v_exp_f32 v153, v153
    v_smfmac_f32_32x32x32_bf16 v[112:127], v[32:35], v[144:151], v77
    buffer_load_dwordx4 v[232:235], v22, s[68:71], 0 offen offset:2048 sc1
    v_exp_f32 v154, v154
    v_exp_f32 v155, v155
    v_exp_f32 v156, v156
    v_mfma_f32_32x32x16_bf16 v[176:191], v[84:87], v[14:17], v[176:191]
    ds_read_b128 v[28:31], v65 offset:34944
    v_exp_f32 v157, v157
    v_exp_f32 v158, v158
    v_exp_f32 v159, v159
    v_exp_f32 v160, v160
    v_exp_f32 v161, v161
    v_smfmac_f32_32x32x32_bf16 v[112:127], v[36:39], v[152:159], v77
    s_waitcnt lgkmcnt(2)
    ds_read_b128 v[84:87], v68 offset:35968
    v_exp_f32 v162, v162
    v_exp_f32 v163, v163
    v_exp_f32 v164, v164
    v_mfma_f32_32x32x4_2b_bf16 v[128:159], v[88:89], v[18:19], 0
    v_exp_f32 v165, v165
    v_exp_f32 v166, v166
    v_exp_f32 v167, v167
    v_exp_f32 v168, v168
    v_exp_f32 v169, v169
    v_exp_f32 v170, v170
    v_exp_f32 v171, v171
    v_exp_f32 v172, v172
    v_smfmac_f32_32x32x32_bf16 v[96:111], v[40:43], v[160:167], v77
    buffer_load_dwordx4 v[236:239], v22, s[68:71], 0 offen offset:3072 sc1
    v_exp_f32 v173, v173
    v_exp_f32 v174, v174
    v_exp_f32 v175, v175
    v_exp_f32 v176, v176
    v_exp_f32 v177, v177
    v_smfmac_f32_32x32x32_bf16 v[96:111], v[44:47], v[168:175], v77
    s_add_u32 s68, s74, 118784
    s_addc_u32 s69, s75, 0
    v_exp_f32 v178, v178
    v_exp_f32 v179, v179
    v_exp_f32 v180, v180
    v_mfma_f32_32x32x16_bf16 v[128:143], v[80:83], v[10:13], v[128:143]
    ds_read_b128 v[32:35], v66 offset:34944
    v_exp_f32 v181, v181
    v_exp_f32 v182, v182
    v_exp_f32 v183, v183
    v_exp_f32 v184, v184
    v_exp_f32 v185, v185
    v_smfmac_f32_32x32x32_bf16 v[112:127], v[40:43], v[176:183], v77
    v_exp_f32 v186, v186
    v_exp_f32 v187, v187
    v_exp_f32 v188, v188
    v_mfma_f32_32x32x16_bf16 v[144:159], v[80:83], v[14:17], v[144:159]
    ds_read_b128 v[36:39], v67 offset:34944
    v_exp_f32 v189, v189
    v_exp_f32 v190, v190
    v_exp_f32 v191, v191
    v_exp_f32 v128, v128
    v_exp_f32 v129, v129
    v_smfmac_f32_32x32x32_bf16 v[112:127], v[44:47], v[184:191], v77
    s_waitcnt lgkmcnt(2)
    ds_read_b128 v[80:83], v68 offset:39936
    v_exp_f32 v130, v130
    v_exp_f32 v131, v131
    v_exp_f32 v132, v132
    v_mfma_f32_32x32x4_2b_bf16 v[160:191], v[90:91], v[18:19], 0
    v_exp_f32 v133, v133
    v_exp_f32 v134, v134
    v_exp_f32 v135, v135
    v_exp_f32 v136, v136
    v_exp_f32 v137, v137
    v_exp_f32 v138, v138
    v_exp_f32 v139, v139
    v_exp_f32 v140, v140
    v_smfmac_f32_32x32x32_bf16 v[96:111], v[24:27], v[128:135], v77
    ds_read_b128 v[92:95], v69 offset:39936
    v_exp_f32 v141, v141
    v_exp_f32 v142, v142
    v_exp_f32 v143, v143
    v_exp_f32 v144, v144
    v_exp_f32 v145, v145
    v_smfmac_f32_32x32x32_bf16 v[96:111], v[28:31], v[136:143], v77
    buffer_load_dwordx4 v[240:243], v22, s[68:71], 0 offen offset:0 sc1
    v_exp_f32 v146, v146
    v_exp_f32 v147, v147
    v_exp_f32 v148, v148
    v_mfma_f32_32x32x16_bf16 v[160:175], v[84:87], v[10:13], v[160:175]
    ds_read_b128 v[40:43], v64 offset:39936
    v_exp_f32 v149, v149
    v_exp_f32 v150, v150
    v_exp_f32 v151, v151
    v_exp_f32 v152, v152
    v_exp_f32 v153, v153
    v_smfmac_f32_32x32x32_bf16 v[112:127], v[24:27], v[144:151], v77
    v_exp_f32 v154, v154
    v_exp_f32 v155, v155
    v_exp_f32 v156, v156
    v_mfma_f32_32x32x16_bf16 v[176:191], v[84:87], v[14:17], v[176:191]
    ds_read_b128 v[44:47], v65 offset:39936
    v_exp_f32 v157, v157
    v_exp_f32 v158, v158
    v_exp_f32 v159, v159
    v_exp_f32 v160, v160
    v_exp_f32 v161, v161
    v_smfmac_f32_32x32x32_bf16 v[112:127], v[28:31], v[152:159], v77
    s_waitcnt lgkmcnt(2)
    ds_read_b128 v[84:87], v68 offset:40960
    v_exp_f32 v162, v162
    v_exp_f32 v163, v163
    v_exp_f32 v164, v164
    v_mfma_f32_32x32x4_2b_bf16 v[128:159], v[92:93], v[18:19], 0
    v_exp_f32 v165, v165
    v_exp_f32 v166, v166
    v_exp_f32 v167, v167
    v_exp_f32 v168, v168
    v_exp_f32 v169, v169
    v_exp_f32 v170, v170
    v_exp_f32 v171, v171
    v_exp_f32 v172, v172
    v_smfmac_f32_32x32x32_bf16 v[96:111], v[32:35], v[160:167], v77
    s_waitcnt vmcnt(24)
    buffer_load_dword v255, v251, s[40:43], s14 offen offset:2304 sc1
    v_exp_f32 v173, v173
    v_exp_f32 v174, v174
    v_exp_f32 v175, v175
    v_exp_f32 v176, v176
    v_exp_f32 v177, v177
    v_smfmac_f32_32x32x32_bf16 v[96:111], v[36:39], v[168:175], v77
    v_exp_f32 v178, v178
    v_exp_f32 v179, v179
    v_exp_f32 v180, v180
    v_mfma_f32_32x32x16_bf16 v[128:143], v[80:83], v[10:13], v[128:143]
    ds_read_b128 v[24:27], v66 offset:39936
    v_exp_f32 v181, v181
    v_exp_f32 v182, v182
    v_exp_f32 v183, v183
    v_exp_f32 v184, v184
    v_exp_f32 v185, v185
    v_smfmac_f32_32x32x32_bf16 v[112:127], v[32:35], v[176:183], v77
    v_exp_f32 v186, v186
    v_exp_f32 v187, v187
    v_exp_f32 v188, v188
    v_mfma_f32_32x32x16_bf16 v[144:159], v[80:83], v[14:17], v[144:159]
    ds_read_b128 v[28:31], v67 offset:39936
    v_exp_f32 v189, v189
    v_exp_f32 v190, v190
    v_exp_f32 v191, v191
    v_exp_f32 v128, v128
    v_exp_f32 v129, v129
    v_smfmac_f32_32x32x32_bf16 v[112:127], v[36:39], v[184:191], v77
    s_waitcnt lgkmcnt(2)
    v_exp_f32 v130, v130
    v_exp_f32 v131, v131
    v_exp_f32 v132, v132
    v_mfma_f32_32x32x4_2b_bf16 v[160:191], v[94:95], v[18:19], 0
    v_exp_f32 v133, v133
    v_exp_f32 v134, v134
    v_exp_f32 v135, v135
    v_exp_f32 v136, v136
    v_exp_f32 v137, v137
    v_exp_f32 v138, v138
    v_exp_f32 v139, v139
    v_exp_f32 v140, v140
    v_smfmac_f32_32x32x32_bf16 v[96:111], v[40:43], v[128:135], v77
    v_exp_f32 v141, v141
    v_exp_f32 v142, v142
    v_exp_f32 v143, v143
    v_exp_f32 v144, v144
    v_exp_f32 v145, v145
    v_smfmac_f32_32x32x32_bf16 v[96:111], v[44:47], v[136:143], v77
    v_exp_f32 v146, v146
    v_exp_f32 v147, v147
    v_exp_f32 v148, v148
    v_mfma_f32_32x32x16_bf16 v[160:175], v[84:87], v[10:13], v[160:175]
    v_exp_f32 v149, v149
    v_exp_f32 v150, v150
    v_exp_f32 v151, v151
    v_exp_f32 v152, v152
    v_exp_f32 v153, v153
    v_smfmac_f32_32x32x32_bf16 v[112:127], v[40:43], v[144:151], v77
    v_exp_f32 v154, v154
    v_exp_f32 v155, v155
    v_exp_f32 v156, v156
    v_mfma_f32_32x32x16_bf16 v[176:191], v[84:87], v[14:17], v[176:191]
    v_exp_f32 v157, v157
    v_exp_f32 v158, v158
    v_exp_f32 v159, v159
    v_exp_f32 v160, v160
    v_exp_f32 v161, v161
    v_smfmac_f32_32x32x32_bf16 v[112:127], v[44:47], v[152:159], v77
    v_exp_f32 v162, v162
    v_exp_f32 v163, v163
    v_exp_f32 v164, v164
    v_exp_f32 v165, v165
    v_exp_f32 v166, v166
    v_exp_f32 v167, v167
    v_exp_f32 v168, v168
    v_exp_f32 v169, v169
    v_exp_f32 v170, v170
    v_exp_f32 v171, v171
    v_exp_f32 v172, v172
    s_waitcnt lgkmcnt(1)
    v_smfmac_f32_32x32x32_bf16 v[96:111], v[24:27], v[160:167], v77
    s_waitcnt vmcnt(22)
    buffer_store_dwordx2 v[252:253], v254, s[64:67], 0 offen offset:2304 sc1
    v_exp_f32 v173, v173
    v_exp_f32 v174, v174
    v_exp_f32 v175, v175
    v_exp_f32 v176, v176
    v_exp_f32 v177, v177
    s_waitcnt lgkmcnt(0)
    v_smfmac_f32_32x32x32_bf16 v[96:111], v[28:31], v[168:175], v77
    v_exp_f32 v178, v178
    v_exp_f32 v179, v179
    v_exp_f32 v180, v180
    v_exp_f32 v181, v181
    v_exp_f32 v182, v182
    v_exp_f32 v183, v183
    v_exp_f32 v184, v184
    v_exp_f32 v185, v185
    v_smfmac_f32_32x32x32_bf16 v[112:127], v[24:27], v[176:183], v77
    v_exp_f32 v186, v186
    v_exp_f32 v187, v187
    v_exp_f32 v188, v188
    v_exp_f32 v189, v189
    v_exp_f32 v190, v190
    v_exp_f32 v191, v191
    s_nop 1
    v_smfmac_f32_32x32x32_bf16 v[112:127], v[28:31], v[184:191], v77
    v_add_f32 v0, abs(v96), abs(v97)
    v_add_f32 v0, v0, abs(v98)
    v_add_f32 v0, v0, abs(v99)
    v_add_f32 v0, v0, abs(v100)
    v_add_f32 v0, v0, abs(v101)
    v_add_f32 v0, v0, abs(v102)
    v_add_f32 v0, v0, abs(v103)
    v_add_f32 v0, v0, abs(v104)
    v_add_f32 v0, v0, abs(v105)
    s_nop 2
    v_add_f32 v1, abs(v112), abs(v113)
    v_add_f32 v1, v1, abs(v114)
    v_add_f32 v1, v1, abs(v115)
    v_add_f32 v1, v1, abs(v116)
    v_add_f32 v1, v1, abs(v117)
    v_add_f32 v1, v1, abs(v118)
    v_add_f32 v1, v1, abs(v119)
    v_add_f32 v1, v1, abs(v120)
    v_add_f32 v1, v1, abs(v121)
    v_add_f32 v2, v106, v122
    v_add_f32 v3, v0, v1
    v_fma_f32 v2, v2, 4.0, v3
    v_min_f32 v3, v106, v122
    v_mul_f32 v3, 0x37800000, v3
    v_min3_f32 v0, v0, v1, v3
    v_cmp_nlt_f32 vcc, 0x06800000, v0
    s_nop 1
    s_mov_b64 s[12:13], vcc
    v_cmp_ngt_f32 vcc, 0x7c800000, v2
    s_nop 1
    s_or_b64 vcc, vcc, s[12:13]
    s_cbranch_scc1 L_fb
L_norm:
    v_rcp_f32 v0, v106
    v_rcp_f32 v2, v122
    v_pk_mul_f32 v[96:97], v[96:97], v[0:1] op_sel_hi:[1,0]
    v_pk_mul_f32 v[98:99], v[98:99], v[0:1] op_sel_hi:[1,0]
    v_pk_mul_f32 v[100:101], v[100:101], v[0:1] op_sel_hi:[1,0]
    v_pk_mul_f32 v[102:103], v[102:103], v[0:1] op_sel_hi:[1,0]
    v_pk_mul_f32 v[104:105], v[104:105], v[0:1] op_sel_hi:[1,0]
    v_cvt_pk_bf16_f32 v4, v96, v97
    v_cvt_pk_bf16_f32 v5, v98, v99
    v_cvt_pk_bf16_f32 v6, v100, v101
    v_cvt_pk_bf16_f32 v7, v102, v103
    v_cvt_pk_bf16_f32 v12, v104, v105
    buffer_store_dwordx4 v[4:7], v22, s[64:67], 0 offen offset:0 sc1
    v_pk_mul_f32 v[112:113], v[112:113], v[2:3] op_sel_hi:[1,0]
    v_pk_mul_f32 v[114:115], v[114:115], v[2:3] op_sel_hi:[1,0]
    v_pk_mul_f32 v[116:117], v[116:117], v[2:3] op_sel_hi:[1,0]
    v_pk_mul_f32 v[118:119], v[118:119], v[2:3] op_sel_hi:[1,0]
    v_pk_mul_f32 v[120:121], v[120:121], v[2:3] op_sel_hi:[1,0]
    v_cvt_pk_bf16_f32 v8, v112, v113
    v_cvt_pk_bf16_f32 v9, v114, v115
    v_cvt_pk_bf16_f32 v10, v116, v117
    v_cvt_pk_bf16_f32 v11, v118, v119
    v_cvt_pk_bf16_f32 v13, v120, v121
    buffer_store_dwordx4 v[8:11], v22, s[64:67], 0 offen offset:1024 sc1
    buffer_store_dwordx2 v[12:13], v78, s[64:67], 0 offen offset:2048 sc1
    s_waitcnt vmcnt(4)
    v_cmp_eq_u32 s[10:11], -1, v255
    s_add_u32 s4, s40, s14
    s_addc_u32 s5, s41, 0
    s_barrier
    v_mfma_f32_16x16x32_bf16 v[80:83], v[244:247], a[164:167], 0
    s_cmp_lg_u64 s[10:11], 0
    s_cbranch_scc1 L_oe
    buffer_load_dwordx2 v[168:169], v251, s[40:43], s14 offen offset:2048 sc1
    buffer_load_dwordx4 v[152:155], v250, s[40:43], s14 offen offset:0 sc1
    buffer_load_dwordx4 v[156:159], v250, s[40:43], s14 offen offset:2432 sc1
    buffer_load_dwordx4 v[160:163], v250, s[40:43], s15 offen offset:0 sc1
    buffer_load_dwordx4 v[164:167], v250, s[40:43], s15 offen offset:2432 sc1
    buffer_load_dwordx2 v[186:187], v251, s[40:43], s14 offen offset:2176 sc1
    buffer_load_dwordx4 v[170:173], v250, s[40:43], s14 offen offset:256 sc1
    buffer_load_dwordx4 v[174:177], v250, s[40:43], s14 offen offset:2688 sc1
    buffer_load_dwordx4 v[178:181], v250, s[40:43], s15 offen offset:256 sc1
    buffer_load_dwordx4 v[182:185], v250, s[40:43], s15 offen offset:2688 sc1
L_oe:
    v_mfma_f32_16x16x32_bf16 v[84:87], v[246:249], a[164:167], 0
    v_mfma_f32_16x16x32_bf16 v[88:91], v[244:247], a[168:171], 0
    v_mfma_f32_16x16x32_bf16 v[92:95], v[246:249], a[168:171], 0
    v_mfma_f32_16x16x32_bf16 v[96:99], v[244:247], a[172:175], 0
    s_load_dword s16, s[4:5], 2304 glc
    v_mfma_f32_16x16x32_bf16 v[100:103], v[246:249], a[172:175], 0
    s_load_dword s17, s[4:5], 4736 glc
    v_mfma_f32_16x16x32_bf16 v[104:107], v[244:247], a[176:179], 0
    s_load_dword s18, s[4:5], 7168 glc
    v_mfma_f32_16x16x32_bf16 v[108:111], v[246:249], a[176:179], 0
    s_load_dword s19, s[4:5], 9600 glc
    v_mfma_f32_16x16x32_bf16 v[112:115], v[244:247], a[180:183], 0
    v_mfma_f32_16x16x32_bf16 v[116:119], v[246:249], a[180:183], 0
    v_mfma_f32_16x16x32_bf16 v[120:123], v[244:247], a[184:187], 0
    v_mfma_f32_16x16x32_bf16 v[124:127], v[246:249], a[184:187], 0
    v_mfma_f32_16x16x32_bf16 v[128:131], v[244:247], a[188:191], 0
    v_mfma_f32_16x16x32_bf16 v[132:135], v[246:249], a[188:191], 0
    v_mfma_f32_16x16x32_bf16 v[136:139], v[244:247], a[192:195], 0
    v_mfma_f32_16x16x32_bf16 v[140:143], v[246:249], a[192:195], 0
    v_mfma_f32_16x16x32_bf16 v[144:147], v[244:247], a[196:199], 0
    v_mfma_f32_16x16x32_bf16 v[148:151], v[246:249], a[196:199], 0
    v_mfma_f32_16x16x32_bf16 v[80:83], v[244:247], a[200:203], v[80:83]
    v_mfma_f32_16x16x32_bf16 v[84:87], v[246:249], a[200:203], v[84:87]
    v_mfma_f32_16x16x32_bf16 v[88:91], v[244:247], a[204:207], v[88:91]
    v_mfma_f32_16x16x32_bf16 v[92:95], v[246:249], a[204:207], v[92:95]
    v_mfma_f32_16x16x32_bf16 v[96:99], v[244:247], a[208:211], v[96:99]
    v_mfma_f32_16x16x32_bf16 v[100:103], v[246:249], a[208:211], v[100:103]
    v_mfma_f32_16x16x32_bf16 v[104:107], v[244:247], a[212:215], v[104:107]
    v_mfma_f32_16x16x32_bf16 v[108:111], v[246:249], a[212:215], v[108:111]
    v_mfma_f32_16x16x32_bf16 v[112:115], v[244:247], a[216:219], v[112:115]
    v_mfma_f32_16x16x32_bf16 v[116:119], v[246:249], a[216:219], v[116:119]
    v_mfma_f32_16x16x32_bf16 v[120:123], v[244:247], a[220:223], v[120:123]
    v_mfma_f32_16x16x32_bf16 v[124:127], v[246:249], a[220:223], v[124:127]
    v_mfma_f32_16x16x32_bf16 v[128:131], v[244:247], a[224:227], v[128:131]
    v_mfma_f32_16x16x32_bf16 v[132:135], v[246:249], a[224:227], v[132:135]
    v_mfma_f32_16x16x32_bf16 v[136:139], v[244:247], a[228:231], v[136:139]
    v_mfma_f32_16x16x32_bf16 v[140:143], v[246:249], a[228:231], v[140:143]
    v_mfma_f32_16x16x32_bf16 v[144:147], v[244:247], a[232:235], v[144:147]
    v_mfma_f32_16x16x32_bf16 v[148:151], v[246:249], a[232:235], v[148:151]
    v_mfma_f32_16x16x32_bf16 v[80:83], v[244:247], a[236:239], v[80:83]
    v_mfma_f32_16x16x32_bf16 v[84:87], v[246:249], a[236:239], v[84:87]
    v_mfma_f32_16x16x32_bf16 v[88:91], v[244:247], a[240:243], v[88:91]
    v_mfma_f32_16x16x32_bf16 v[92:95], v[246:249], a[240:243], v[92:95]
    v_mfma_f32_16x16x32_bf16 v[96:99], v[244:247], a[244:247], v[96:99]
    v_mfma_f32_16x16x32_bf16 v[100:103], v[246:249], a[244:247], v[100:103]
    v_mfma_f32_16x16x32_bf16 v[104:107], v[244:247], a[248:251], v[104:107]
    v_mfma_f32_16x16x32_bf16 v[108:111], v[246:249], a[248:251], v[108:111]
    v_mfma_f32_16x16x32_bf16 v[112:115], v[244:247], a[252:255], v[112:115]
    s_cmp_eq_u64 s[10:11], 0
    s_cbranch_scc1 L_ol_ok
    s_mov_b32 s61, 0
    s_branch L_ol_in
L_ol_loop:
    s_load_dword s16, s[4:5], 2304 glc
    s_load_dword s17, s[4:5], 4736 glc
    s_load_dword s18, s[4:5], 7168 glc
    s_load_dword s19, s[4:5], 9600 glc
L_ol_in:
    s_add_u32 s61, s61, 1
    s_cmp_ge_u32 s61, 0x20000
    s_cbranch_scc1 L_ol_go
    s_waitcnt lgkmcnt(0)
    s_or_b64 s[16:17], s[16:17], s[18:19]
    s_cbranch_scc1 L_ol_loop
L_ol_go:
    buffer_load_dwordx2 v[168:169], v251, s[40:43], s14 offen offset:2048 sc1
    buffer_load_dwordx4 v[152:155], v250, s[40:43], s14 offen offset:0 sc1
    buffer_load_dwordx4 v[156:159], v250, s[40:43], s14 offen offset:2432 sc1
    buffer_load_dwordx4 v[160:163], v250, s[40:43], s15 offen offset:0 sc1
    buffer_load_dwordx4 v[164:167], v250, s[40:43], s15 offen offset:2432 sc1
    buffer_load_dwordx2 v[186:187], v251, s[40:43], s14 offen offset:2176 sc1
    buffer_load_dwordx4 v[170:173], v250, s[40:43], s14 offen offset:256 sc1
    buffer_load_dwordx4 v[174:177], v250, s[40:43], s14 offen offset:2688 sc1
    buffer_load_dwordx4 v[178:181], v250, s[40:43], s15 offen offset:256 sc1
    buffer_load_dwordx4 v[182:185], v250, s[40:43], s15 offen offset:2688 sc1
L_ol_ok:
    v_mfma_f32_16x16x32_bf16 v[116:119], v[246:249], a[252:255], v[116:119]
    v_mfma_f32_16x16x32_bf16 v[120:123], v[244:247], v[192:195], v[120:123]
    v_mfma_f32_16x16x32_bf16 v[124:127], v[246:249], v[192:195], v[124:127]
    v_mfma_f32_16x16x32_bf16 v[128:131], v[244:247], v[196:199], v[128:131]
    v_mfma_f32_16x16x32_bf16 v[132:135], v[246:249], v[196:199], v[132:135]
    v_mfma_f32_16x16x32_bf16 v[136:139], v[244:247], v[200:203], v[136:139]
    v_mfma_f32_16x16x32_bf16 v[140:143], v[246:249], v[200:203], v[140:143]
    v_mfma_f32_16x16x32_bf16 v[144:147], v[244:247], v[204:207], v[144:147]
    v_mfma_f32_16x16x32_bf16 v[148:151], v[246:249], v[204:207], v[148:151]
    v_mfma_f32_16x16x32_bf16 v[80:83], v[244:247], v[208:211], v[80:83]
    v_mfma_f32_16x16x32_bf16 v[84:87], v[246:249], v[208:211], v[84:87]
    v_mfma_f32_16x16x32_bf16 v[88:91], v[244:247], v[212:215], v[88:91]
    v_mfma_f32_16x16x32_bf16 v[92:95], v[246:249], v[212:215], v[92:95]
    v_mfma_f32_16x16x32_bf16 v[96:99], v[244:247], v[216:219], v[96:99]
    v_mfma_f32_16x16x32_bf16 v[100:103], v[246:249], v[216:219], v[100:103]
    v_mfma_f32_16x16x32_bf16 v[104:107], v[244:247], v[220:223], v[104:107]
    v_mfma_f32_16x16x32_bf16 v[108:111], v[246:249], v[220:223], v[108:111]
    v_mfma_f32_16x16x32_bf16 v[112:115], v[244:247], v[224:227], v[112:115]
    v_mfma_f32_16x16x32_bf16 v[116:119], v[246:249], v[224:227], v[116:119]
    v_mfma_f32_16x16x32_bf16 v[120:123], v[244:247], v[228:231], v[120:123]
    v_mfma_f32_16x16x32_bf16 v[124:127], v[246:249], v[228:231], v[124:127]
    v_mfma_f32_16x16x32_bf16 v[128:131], v[244:247], v[232:235], v[128:131]
    v_mfma_f32_16x16x32_bf16 v[132:135], v[246:249], v[232:235], v[132:135]
    v_mfma_f32_16x16x32_bf16 v[136:139], v[244:247], v[236:239], v[136:139]
    v_mfma_f32_16x16x32_bf16 v[140:143], v[246:249], v[236:239], v[140:143]
    v_mfma_f32_16x16x32_bf16 v[144:147], v[244:247], v[240:243], v[144:147]
    v_mfma_f32_16x16x32_bf16 v[148:151], v[246:249], v[240:243], v[148:151]
    s_waitcnt vmcnt(5)
    v_max3_u32 v0, v152, v153, v154
    v_max3_u32 v0, v0, v155, v156
    v_max3_u32 v0, v0, v157, v158
    v_max3_u32 v0, v0, v159, v160
    v_max3_u32 v0, v0, v161, v162
    v_max3_u32 v0, v0, v163, v164
    v_max3_u32 v0, v0, v165, v166
    v_max3_u32 v0, v0, v167, v168
    v_max_u32 v0, v0, v169
    v_cmp_eq_u32 vcc, -1, v0
    s_nop 1
    s_cmp_eq_u64 vcc, 0
    s_cbranch_scc0 L_pc0_slow
L_pc0_ok:
    v_mfma_f32_16x16x16_bf16 v[80:83], a[144:145], v[168:169], v[80:83]
    v_lshlrev_b32 v24, 16, v48
    v_and_b32 v25, 0xffff0000, v48
    v_mfma_f32_16x16x16_bf16 v[88:91], a[146:147], v[168:169], v[88:91]
    v_lshlrev_b32 v26, 16, v49
    v_and_b32 v27, 0xffff0000, v49
    v_mfma_f32_16x16x16_bf16 v[96:99], a[148:149], v[168:169], v[96:99]
    v_lshlrev_b32 v28, 16, v50
    v_and_b32 v29, 0xffff0000, v50
    v_mfma_f32_16x16x16_bf16 v[104:107], a[150:151], v[168:169], v[104:107]
    v_lshlrev_b32 v30, 16, v51
    v_mfma_f32_16x16x16_bf16 v[112:115], a[152:153], v[168:169], v[112:115]
    v_and_b32 v31, 0xffff0000, v51
    v_lshlrev_b32 v32, 16, v52
    v_mfma_f32_16x16x16_bf16 v[120:123], a[154:155], v[168:169], v[120:123]
    v_and_b32 v33, 0xffff0000, v52
    v_lshlrev_b32 v34, 16, v53
    v_mfma_f32_16x16x16_bf16 v[128:131], a[156:157], v[168:169], v[128:131]
    v_and_b32 v35, 0xffff0000, v53
    v_mfma_f32_16x16x32_bf16 v[80:83], a[0:3], v[152:155], v[80:83]
    v_lshlrev_b32 v36, 16, v54
    v_and_b32 v37, 0xffff0000, v54
    v_mfma_f32_16x16x32_bf16 v[80:83], a[4:7], v[156:159], v[80:83]
    v_mfma_f32_16x16x32_bf16 v[80:83], a[8:11], v[160:163], v[80:83]
    v_lshlrev_b32 v38, 16, v55
    v_and_b32 v39, 0xffff0000, v55
    v_mfma_f32_16x16x32_bf16 v[80:83], a[12:15], v[164:167], v[80:83]
    v_mfma_f32_16x16x16_bf16 v[136:139], a[158:159], v[168:169], v[136:139]
    v_mfma_f32_16x16x32_bf16 v[88:91], a[16:19], v[152:155], v[88:91]
    v_lshlrev_b32 v40, 16, v56
    v_and_b32 v41, 0xffff0000, v56
    v_mfma_f32_16x16x32_bf16 v[88:91], a[20:23], v[156:159], v[88:91]
L_pgx14:
    s_cbranch_execz L_back1
    v_mfma_f32_16x16x32_bf16 v[88:91], a[24:27], v[160:163], v[88:91]
    v_lshlrev_b32 v42, 16, v57
    v_and_b32 v43, 0xffff0000, v57
    v_mfma_f32_16x16x32_bf16 v[88:91], a[28:31], v[164:167], v[88:91]
    v_mfma_f32_16x16x16_bf16 v[144:147], a[160:161], v[168:169], v[144:147]
    v_mfma_f32_16x16x32_bf16 v[96:99], a[32:35], v[152:155], v[96:99]
    s_waitcnt vmcnt(0)
    v_max3_u32 v0, v170, v171, v172
    v_mfma_f32_16x16x32_bf16 v[96:99], a[36:39], v[156:159], v[96:99]
    ds_write_b64 v58, v[80:81] offset:0
    v_mfma_f32_16x16x32_bf16 v[96:99], a[40:43], v[160:163], v[96:99]
    v_max3_u32 v0, v0, v173, v174
    v_max3_u32 v0, v0, v175, v176
    v_mfma_f32_16x16x32_bf16 v[96:99], a[44:47], v[164:167], v[96:99]
    ds_write_b64 v58, v[82:83] offset:8
    v_mfma_f32_16x16x32_bf16 v[104:107], a[48:51], v[152:155], v[104:107]
    v_max3_u32 v0, v0, v177, v178
    v_max3_u32 v0, v0, v179, v180
    v_mfma_f32_16x16x32_bf16 v[104:107], a[52:55], v[156:159], v[104:107]
    ds_write_b64 v58, v[88:89] offset:64
    v_mfma_f32_16x16x32_bf16 v[104:107], a[56:59], v[160:163], v[104:107]
    v_max3_u32 v0, v0, v181, v182
    v_max3_u32 v0, v0, v183, v184
    v_mfma_f32_16x16x32_bf16 v[104:107], a[60:63], v[164:167], v[104:107]
    ds_write_b64 v58, v[90:91] offset:72
    v_mfma_f32_16x16x32_bf16 v[112:115], a[64:67], v[152:155], v[112:115]
    v_max3_u32 v0, v0, v185, v186
    v_max_u32 v0, v0, v187
    v_mfma_f32_16x16x32_bf16 v[112:115], a[68:71], v[156:159], v[112:115]
    ds_write_b64 v58, v[96:97] offset:128
    v_mfma_f32_16x16x32_bf16 v[112:115], a[72:75], v[160:163], v[112:115]
    v_cmp_eq_u32 vcc, -1, v0
    s_nop 1
    s_cmp_eq_u64 vcc, 0
    s_cbranch_scc0 L_pc1_slow
L_pc1_ok:
    v_mfma_f32_16x16x32_bf16 v[112:115], a[76:79], v[164:167], v[112:115]
    ds_write_b64 v58, v[98:99] offset:136
    v_mfma_f32_16x16x32_bf16 v[120:123], a[80:83], v[152:155], v[120:123]
    v_mfma_f32_16x16x32_bf16 v[120:123], a[84:87], v[156:159], v[120:123]
    ds_write_b64 v58, v[104:105] offset:192
    v_mfma_f32_16x16x32_bf16 v[120:123], a[88:91], v[160:163], v[120:123]
    v_mfma_f32_16x16x32_bf16 v[120:123], a[92:95], v[164:167], v[120:123]
    ds_write_b64 v58, v[106:107] offset:200
    v_mfma_f32_16x16x16_bf16 v[84:87], a[144:145], v[186:187], v[84:87]
    v_mfma_f32_16x16x16_bf16 v[92:95], a[146:147], v[186:187], v[92:95]
    v_mfma_f32_16x16x32_bf16 v[128:131], a[96:99], v[152:155], v[128:131]
    v_mfma_f32_16x16x32_bf16 v[128:131], a[100:103], v[156:159], v[128:131]
    ds_write_b64 v58, v[112:113] offset:256
    v_mfma_f32_16x16x32_bf16 v[128:131], a[104:107], v[160:163], v[128:131]
    v_mfma_f32_16x16x32_bf16 v[128:131], a[108:111], v[164:167], v[128:131]
    ds_write_b64 v58, v[114:115] offset:264
    v_mfma_f32_16x16x16_bf16 v[100:103], a[148:149], v[186:187], v[100:103]
    v_mfma_f32_16x16x16_bf16 v[108:111], a[150:151], v[186:187], v[108:111]
    v_mfma_f32_16x16x32_bf16 v[136:139], a[112:115], v[152:155], v[136:139]
    v_mfma_f32_16x16x32_bf16 v[136:139], a[116:119], v[156:159], v[136:139]
    ds_write_b64 v58, v[120:121] offset:320
    v_mfma_f32_16x16x32_bf16 v[136:139], a[120:123], v[160:163], v[136:139]
    v_mfma_f32_16x16x32_bf16 v[136:139], a[124:127], v[164:167], v[136:139]
    ds_write_b64 v58, v[122:123] offset:328
    v_mfma_f32_16x16x16_bf16 v[116:119], a[152:153], v[186:187], v[116:119]
    v_mfma_f32_16x16x16_bf16 v[124:127], a[154:155], v[186:187], v[124:127]
    v_mfma_f32_16x16x32_bf16 v[144:147], a[128:131], v[152:155], v[144:147]
    v_mfma_f32_16x16x32_bf16 v[144:147], a[132:135], v[156:159], v[144:147]
    ds_write_b64 v58, v[128:129] offset:384
    v_mfma_f32_16x16x32_bf16 v[144:147], a[136:139], v[160:163], v[144:147]
    v_mfma_f32_16x16x32_bf16 v[144:147], a[140:143], v[164:167], v[144:147]
    ds_write_b64 v58, v[130:131] offset:392
    v_mfma_f32_16x16x16_bf16 v[132:135], a[156:157], v[186:187], v[132:135]
    v_mfma_f32_16x16x16_bf16 v[140:143], a[158:159], v[186:187], v[140:143]
    v_mfma_f32_16x16x32_bf16 v[84:87], a[0:3], v[170:173], v[84:87]
    v_mfma_f32_16x16x32_bf16 v[84:87], a[4:7], v[174:177], v[84:87]
    ds_write_b64 v58, v[136:137] offset:448
    v_mfma_f32_16x16x32_bf16 v[84:87], a[8:11], v[178:181], v[84:87]
    v_mfma_f32_16x16x32_bf16 v[84:87], a[12:15], v[182:185], v[84:87]
    ds_write_b64 v58, v[138:139] offset:456
    v_mfma_f32_16x16x16_bf16 v[148:151], a[160:161], v[186:187], v[148:151]
    v_mfma_f32_16x16x32_bf16 v[92:95], a[16:19], v[170:173], v[92:95]
    v_mfma_f32_16x16x32_bf16 v[92:95], a[20:23], v[174:177], v[92:95]
    ds_write_b64 v58, v[144:145] offset:512
    v_mfma_f32_16x16x32_bf16 v[92:95], a[24:27], v[178:181], v[92:95]
    v_mfma_f32_16x16x32_bf16 v[92:95], a[28:31], v[182:185], v[92:95]
    ds_write_b64 v58, v[146:147] offset:520
    v_mfma_f32_16x16x32_bf16 v[100:103], a[32:35], v[170:173], v[100:103]
    v_mfma_f32_16x16x32_bf16 v[100:103], a[36:39], v[174:177], v[100:103]
    ds_write_b64 v58, v[84:85] offset:9472
    v_mfma_f32_16x16x32_bf16 v[100:103], a[40:43], v[178:181], v[100:103]
    v_mfma_f32_16x16x32_bf16 v[100:103], a[44:47], v[182:185], v[100:103]
    ds_write_b64 v58, v[86:87] offset:9480
    v_mfma_f32_16x16x32_bf16 v[108:111], a[48:51], v[170:173], v[108:111]
    v_mfma_f32_16x16x32_bf16 v[108:111], a[52:55], v[174:177], v[108:111]
    ds_write_b64 v58, v[92:93] offset:9536
    v_mfma_f32_16x16x32_bf16 v[108:111], a[56:59], v[178:181], v[108:111]
    v_mfma_f32_16x16x32_bf16 v[108:111], a[60:63], v[182:185], v[108:111]
    ds_write_b64 v58, v[94:95] offset:9544
    v_mfma_f32_16x16x32_bf16 v[116:119], a[64:67], v[170:173], v[116:119]
    v_mfma_f32_16x16x32_bf16 v[116:119], a[68:71], v[174:177], v[116:119]
    ds_write_b64 v58, v[100:101] offset:9600
    v_mfma_f32_16x16x32_bf16 v[116:119], a[72:75], v[178:181], v[116:119]
    v_mfma_f32_16x16x32_bf16 v[116:119], a[76:79], v[182:185], v[116:119]
    ds_write_b64 v58, v[102:103] offset:9608
    v_mfma_f32_16x16x32_bf16 v[124:127], a[80:83], v[170:173], v[124:127]
    v_mfma_f32_16x16x32_bf16 v[124:127], a[84:87], v[174:177], v[124:127]
    ds_write_b64 v58, v[108:109] offset:9664
    v_mfma_f32_16x16x32_bf16 v[124:127], a[88:91], v[178:181], v[124:127]
    v_mfma_f32_16x16x32_bf16 v[124:127], a[92:95], v[182:185], v[124:127]
    ds_write_b64 v58, v[110:111] offset:9672
    v_mfma_f32_16x16x32_bf16 v[132:135], a[96:99], v[170:173], v[132:135]
    v_mfma_f32_16x16x32_bf16 v[132:135], a[100:103], v[174:177], v[132:135]
    ds_write_b64 v58, v[116:117] offset:9728
    v_mfma_f32_16x16x32_bf16 v[132:135], a[104:107], v[178:181], v[132:135]
    v_mfma_f32_16x16x32_bf16 v[132:135], a[108:111], v[182:185], v[132:135]
    ds_write_b64 v58, v[118:119] offset:9736
    v_mfma_f32_16x16x32_bf16 v[140:143], a[112:115], v[170:173], v[140:143]
    v_mfma_f32_16x16x32_bf16 v[140:143], a[116:119], v[174:177], v[140:143]
    ds_write_b64 v58, v[124:125] offset:9792
    v_mfma_f32_16x16x32_bf16 v[140:143], a[120:123], v[178:181], v[140:143]
    v_mfma_f32_16x16x32_bf16 v[140:143], a[124:127], v[182:185], v[140:143]
    ds_write_b64 v58, v[126:127] offset:9800
    v_mfma_f32_16x16x32_bf16 v[148:151], a[128:131], v[170:173], v[148:151]
    v_mfma_f32_16x16x32_bf16 v[148:151], a[132:135], v[174:177], v[148:151]
    ds_write_b64 v58, v[132:133] offset:9856
    v_mfma_f32_16x16x32_bf16 v[148:151], a[136:139], v[178:181], v[148:151]
    v_mfma_f32_16x16x32_bf16 v[148:151], a[140:143], v[182:185], v[148:151]
    ds_write_b64 v58, v[134:135] offset:9864
    s_nop 0
    ds_write_b64 v58, v[140:141] offset:9920
    ds_write_b64 v58, v[142:143] offset:9928
    s_nop 3
    ds_write_b64 v58, v[148:149] offset:9984
    ds_write_b64 v58, v[150:151] offset:9992
    s_waitcnt lgkmcnt(0)
    s_barrier
    ds_read_b128 v[192:195], v59 offset:0
    ds_read_b128 v[196:199], v59 offset:18944
    ds_read_b128 v[200:203], v59 offset:37888
    ds_read_b128 v[204:207], v59 offset:56832
    ds_read_b128 v[208:211], v60 offset:0
    ds_read_b128 v[212:215], v60 offset:18944
    ds_read_b128 v[216:219], v60 offset:37888
    ds_read_b128 v[220:223], v60 offset:56832
    s_waitcnt lgkmcnt(4)
    v_pk_add_f32 v[24:25], v[24:25], v[192:193]
    ds_read_b128 v[224:227], v61 offset:0
    v_pk_add_f32 v[26:27], v[26:27], v[194:195]
    v_pk_add_f32 v[24:25], v[24:25], v[196:197]
    ds_read_b128 v[228:231], v61 offset:18944
    v_pk_add_f32 v[26:27], v[26:27], v[198:199]
    v_pk_add_f32 v[24:25], v[24:25], v[200:201]
    v_pk_add_f32 v[26:27], v[26:27], v[202:203]
    ds_read_b128 v[232:235], v61 offset:37888
    v_pk_add_f32 v[24:25], v[24:25], v[204:205]
    v_pk_add_f32 v[26:27], v[26:27], v[206:207]
    v_cvt_pk_bf16_f32 v192, v24, v25
    ds_read_b128 v[236:239], v61 offset:56832
    v_cvt_pk_bf16_f32 v193, v26, v27
    buffer_store_dwordx2 v[192:193], v72, s[44:47], 0 offen
    s_waitcnt lgkmcnt(4)
    v_pk_add_f32 v[28:29], v[28:29], v[208:209]
    ds_read_b128 v[152:155], v62 offset:0
    v_pk_add_f32 v[30:31], v[30:31], v[210:211]
    v_pk_add_f32 v[28:29], v[28:29], v[212:213]
    ds_read_b128 v[156:159], v62 offset:18944
    v_pk_add_f32 v[30:31], v[30:31], v[214:215]
    v_pk_add_f32 v[28:29], v[28:29], v[216:217]
    v_pk_add_f32 v[30:31], v[30:31], v[218:219]
    ds_read_b128 v[160:163], v62 offset:37888
    v_pk_add_f32 v[28:29], v[28:29], v[220:221]
    v_pk_add_f32 v[30:31], v[30:31], v[222:223]
    v_cvt_pk_bf16_f32 v208, v28, v29
    ds_read_b128 v[164:167], v62 offset:56832
    v_cvt_pk_bf16_f32 v209, v30, v31
    buffer_store_dwordx2 v[208:209], v73, s[44:47], 0 offen
    s_waitcnt lgkmcnt(4)
    v_pk_add_f32 v[32:33], v[32:33], v[224:225]
    ds_read_b128 v[168:171], v63 offset:0
    v_pk_add_f32 v[34:35], v[34:35], v[226:227]
    v_pk_add_f32 v[32:33], v[32:33], v[228:229]
    ds_read_b128 v[172:175], v63 offset:18944
    v_pk_add_f32 v[34:35], v[34:35], v[230:231]
    v_pk_add_f32 v[32:33], v[32:33], v[232:233]
    v_pk_add_f32 v[34:35], v[34:35], v[234:235]
    ds_read_b128 v[176:179], v63 offset:37888
    v_pk_add_f32 v[32:33], v[32:33], v[236:237]
    v_pk_add_f32 v[34:35], v[34:35], v[238:239]
    v_cvt_pk_bf16_f32 v224, v32, v33
    ds_read_b128 v[180:183], v63 offset:56832
    v_cvt_pk_bf16_f32 v225, v34, v35
    buffer_store_dwordx2 v[224:225], v74, s[44:47], 0 offen
    s_waitcnt lgkmcnt(4)
    v_pk_add_f32 v[36:37], v[36:37], v[152:153]
    v_pk_add_f32 v[38:39], v[38:39], v[154:155]
    v_pk_add_f32 v[36:37], v[36:37], v[156:157]
    v_pk_add_f32 v[38:39], v[38:39], v[158:159]
    v_pk_add_f32 v[36:37], v[36:37], v[160:161]
    v_pk_add_f32 v[38:39], v[38:39], v[162:163]
    v_pk_add_f32 v[36:37], v[36:37], v[164:165]
    v_pk_add_f32 v[38:39], v[38:39], v[166:167]
    v_cvt_pk_bf16_f32 v152, v36, v37
    v_cvt_pk_bf16_f32 v153, v38, v39
    buffer_store_dwordx2 v[152:153], v75, s[44:47], 0 offen
    s_waitcnt lgkmcnt(0)
    v_pk_add_f32 v[40:41], v[40:41], v[168:169]
    v_pk_add_f32 v[42:43], v[42:43], v[170:171]
    v_pk_add_f32 v[40:41], v[40:41], v[172:173]
    v_pk_add_f32 v[42:43], v[42:43], v[174:175]
    v_pk_add_f32 v[40:41], v[40:41], v[176:177]
    v_pk_add_f32 v[42:43], v[42:43], v[178:179]
    v_pk_add_f32 v[40:41], v[40:41], v[180:181]
    v_pk_add_f32 v[42:43], v[42:43], v[182:183]
    v_cvt_pk_bf16_f32 v168, v40, v41
    v_cvt_pk_bf16_f32 v169, v42, v43
    buffer_store_dwordx2 v[168:169], v76, s[44:47], 0 offen
    s_endpgm
L_p0_slow:
    s_mov_b32 s61, 0
L_p0_loop:
    s_sleep 4
    buffer_load_dwordx2 v[2:3], v22, s[40:43], s51 offen sc1
    s_waitcnt vmcnt(0)
    v_cmp_ne_u64 vcc, s[48:49], v[2:3]
    s_add_u32 s61, s61, 1
    s_nop 4
    s_cmp_lg_u64 vcc, 0
    s_cbranch_scc0 L_p0_ok
    s_cmp_lt_u32 s61, 0x20000
    s_cbranch_scc1 L_p0_loop
    s_branch L_p0_ok
L_pa_slow:
    s_mov_b32 s61, 0
L_pa_loop:
    s_sleep 4
    buffer_load_dwordx2 v[2:3], v22, s[40:43], s51 offen sc1
    s_waitcnt vmcnt(0)
    v_cmp_ne_u64 vcc, s[48:49], v[2:3]
    s_add_u32 s61, s61, 1
    s_nop 4
    s_cmp_lg_u64 vcc, 0
    s_cbranch_scc0 L_pa_ok
    s_cmp_lt_u32 s61, 0x20000
    s_cbranch_scc1 L_pa_loop
    s_branch L_pa_ok
L_pb_slow:
    s_mov_b32 s61, 0
L_pb_loop:
    s_sleep 4
    buffer_load_dwordx2 v[2:3], v79, s[40:43], s9 offen sc1
    s_waitcnt vmcnt(0)
    v_cmp_ne_u64 vcc, s[48:49], v[2:3]
    s_add_u32 s61, s61, 1
    s_nop 4
    s_cmp_lg_u64 vcc, 0
    s_cbranch_scc0 L_pb_ok
    s_cmp_lt_u32 s61, 0x20000
    s_cbranch_scc1 L_pb_loop
    s_branch L_pb_ok
L_pc0_slow:
    s_mov_b32 s61, 0
L_pc0_loop:
    buffer_load_dwordx2 v[168:169], v251, s[40:43], s14 offen offset:2048 sc1
    buffer_load_dwordx4 v[152:155], v250, s[40:43], s14 offen offset:0 sc1
    buffer_load_dwordx4 v[156:159], v250, s[40:43], s14 offen offset:2432 sc1
    buffer_load_dwordx4 v[160:163], v250, s[40:43], s15 offen offset:0 sc1
    buffer_load_dwordx4 v[164:167], v250, s[40:43], s15 offen offset:2432 sc1
    buffer_load_dwordx2 v[186:187], v251, s[40:43], s14 offen offset:2176 sc1
    buffer_load_dwordx4 v[170:173], v250, s[40:43], s14 offen offset:256 sc1
    buffer_load_dwordx4 v[174:177], v250, s[40:43], s14 offen offset:2688 sc1
    buffer_load_dwordx4 v[178:181], v250, s[40:43], s15 offen offset:256 sc1
    buffer_load_dwordx4 v[182:185], v250, s[40:43], s15 offen offset:2688 sc1
    s_waitcnt vmcnt(0)
    v_max3_u32 v0, v152, v153, v154
    v_max3_u32 v0, v0, v155, v156
    v_max3_u32 v0, v0, v157, v158
    v_max3_u32 v0, v0, v159, v160
    v_max3_u32 v0, v0, v161, v162
    v_max3_u32 v0, v0, v163, v164
    v_max3_u32 v0, v0, v165, v166
    v_max3_u32 v0, v0, v167, v168
    v_max_u32 v0, v0, v169
    v_cmp_eq_u32 vcc, -1, v0
    s_add_u32 s61, s61, 1
    s_nop 4
    s_cmp_eq_u64 vcc, 0
    s_cbranch_scc1 L_pc0_ok
    s_cmp_lt_u32 s61, 0x20000
    s_cbranch_scc1 L_pc0_loop
    s_branch L_pc0_ok
L_pc1_slow:
    s_mov_b32 s61, 0
L_pc1_loop:
    buffer_load_dwordx2 v[186:187], v251, s[40:43], s14 offen offset:2176 sc1
    buffer_load_dwordx4 v[170:173], v250, s[40:43], s14 offen offset:256 sc1
    buffer_load_dwordx4 v[174:177], v250, s[40:43], s14 offen offset:2688 sc1
    buffer_load_dwordx4 v[178:181], v250, s[40:43], s15 offen offset:256 sc1
    buffer_load_dwordx4 v[182:185], v250, s[40:43], s15 offen offset:2688 sc1
    s_waitcnt vmcnt(0)
    v_max3_u32 v0, v170, v171, v172
    v_max3_u32 v0, v0, v173, v174
    v_max3_u32 v0, v0, v175, v176
    v_max3_u32 v0, v0, v177, v178
    v_max3_u32 v0, v0, v179, v180
    v_max3_u32 v0, v0, v181, v182
    v_max3_u32 v0, v0, v183, v184
    v_max3_u32 v0, v0, v185, v186
    v_max_u32 v0, v0, v187
    v_cmp_eq_u32 vcc, -1, v0
    s_add_u32 s61, s61, 1
    s_nop 4
    s_cmp_eq_u64 vcc, 0
    s_cbranch_scc1 L_pc1_ok
    s_cmp_lt_u32 s61, 0x20000
    s_cbranch_scc1 L_pc1_loop
    s_branch L_pc1_ok

L_fb:
    s_nop 15
    v_min_u32 v38, 1, v71
    v_mov_b32 v19, 0
    v_mov_b32 v0, 0xff800000
    v_mov_b32 v1, 0xff800000
    v_add_u32 v32, 45696, v68
    v_add_u32 v33, 45696, v69
    v_add_u32 v2, v70, v71
    v_sub_u32 v34, v64, v2
    v_sub_u32 v35, v65, v2
    v_sub_u32 v36, v66, v2
    v_sub_u32 v37, v67, v2
    s_mov_b32 s61, 0
L_fb1:
    ds_read_b128 v[80:83], v32 offset:0
    ds_read_b128 v[88:91], v33
    s_waitcnt lgkmcnt(0)
    v_mfma_f32_32x32x4_2b_bf16 v[128:159], v[88:89], v[18:19], 0
    s_nop 15
    s_nop 1
    v_mfma_f32_32x32x16_bf16 v[128:143], v[80:83], v[10:13], v[128:143]
    v_mfma_f32_32x32x16_bf16 v[144:159], v[80:83], v[14:17], v[144:159]
    s_nop 10
    v_max3_f32 v0, v0, v128, v129
    v_max3_f32 v0, v0, v130, v131
    v_max3_f32 v0, v0, v132, v133
    v_max3_f32 v0, v0, v134, v135
    v_max3_f32 v0, v0, v136, v137
    v_max3_f32 v0, v0, v138, v139
    v_max3_f32 v0, v0, v140, v141
    v_max3_f32 v0, v0, v142, v143
    v_max3_f32 v1, v1, v144, v145
    v_max3_f32 v1, v1, v146, v147
    v_max3_f32 v1, v1, v148, v149
    v_max3_f32 v1, v1, v150, v151
    v_max3_f32 v1, v1, v152, v153
    v_max3_f32 v1, v1, v154, v155
    v_max3_f32 v1, v1, v156, v157
    v_max3_f32 v1, v1, v158, v159
    ds_read_b128 v[80:83], v32 offset:1024
    ds_read_b128 v[88:91], v33
    s_waitcnt lgkmcnt(0)
    v_mfma_f32_32x32x4_2b_bf16 v[128:159], v[90:91], v[18:19], 0
    s_nop 15
    s_nop 1
    v_mfma_f32_32x32x16_bf16 v[128:143], v[80:83], v[10:13], v[128:143]
    v_mfma_f32_32x32x16_bf16 v[144:159], v[80:83], v[14:17], v[144:159]
    s_nop 10
    v_max3_f32 v0, v0, v128, v129
    v_max3_f32 v0, v0, v130, v131
    v_max3_f32 v0, v0, v132, v133
    v_max3_f32 v0, v0, v134, v135
    v_max3_f32 v0, v0, v136, v137
    v_max3_f32 v0, v0, v138, v139
    v_max3_f32 v0, v0, v140, v141
    v_max3_f32 v0, v0, v142, v143
    v_max3_f32 v1, v1, v144, v145
    v_max3_f32 v1, v1, v146, v147
    v_max3_f32 v1, v1, v148, v149
    v_max3_f32 v1, v1, v150, v151
    v_max3_f32 v1, v1, v152, v153
    v_max3_f32 v1, v1, v154, v155
    v_max3_f32 v1, v1, v156, v157
    v_max3_f32 v1, v1, v158, v159
    s_add_u32 s61, s61, 1
    s_cmp_eq_u32 s61, 10
    s_mov_b32 s12, 4992
    s_cmov_b32 s12, 4294811776
    v_add_u32 v32, s12, v32
    v_add_u32 v33, s12, v33
    v_mul_lo_u32 v2, v38, s12
    v_add_u32 v34, v2, v34
    v_add_u32 v35, v2, v35
    v_add_u32 v36, v2, v36
    v_add_u32 v37, v2, v37
    s_cmp_lt_u32 s61, 32
    s_nop 15
    s_cbranch_scc1 L_fb1
    v_mov_b32 v3, v0
    s_nop 1
    v_permlane32_swap_b32 v3, v0
    v_max_f32 v0, v0, v3
    v_mov_b32 v3, v1
    s_nop 1
    v_permlane32_swap_b32 v3, v1
    v_max_f32 v1, v1, v3
    v_mov_b32 v96, 0
    v_mov_b32 v97, 0
    v_mov_b32 v98, 0
    v_mov_b32 v99, 0
    v_mov_b32 v100, 0
    v_mov_b32 v101, 0
    v_mov_b32 v102, 0
    v_mov_b32 v103, 0
    v_mov_b32 v104, 0
    v_mov_b32 v105, 0
    v_mov_b32 v106, 0
    v_mov_b32 v107, 0
    v_mov_b32 v108, 0
    v_mov_b32 v109, 0
    v_mov_b32 v110, 0
    v_mov_b32 v111, 0
    v_mov_b32 v112, 0
    v_mov_b32 v113, 0
    v_mov_b32 v114, 0
    v_mov_b32 v115, 0
    v_mov_b32 v116, 0
    v_mov_b32 v117, 0
    v_mov_b32 v118, 0
    v_mov_b32 v119, 0
    v_mov_b32 v120, 0
    v_mov_b32 v121, 0
    v_mov_b32 v122, 0
    v_mov_b32 v123, 0
    v_mov_b32 v124, 0
    v_mov_b32 v125, 0
    v_mov_b32 v126, 0
    v_mov_b32 v127, 0
    v_add_u32 v32, 45696, v68
    v_add_u32 v33, 45696, v69
    v_add_u32 v2, v70, v71
    v_sub_u32 v34, v64, v2
    v_sub_u32 v35, v65, v2
    v_sub_u32 v36, v66, v2
    v_sub_u32 v37, v67, v2
    s_mov_b32 s61, 0
L_fb2:
    ds_read_b128 v[80:83], v32 offset:0
    ds_read_b128 v[88:91], v33
    s_waitcnt lgkmcnt(0)
    v_mfma_f32_32x32x4_2b_bf16 v[128:159], v[88:89], v[18:19], 0
    s_nop 15
    s_nop 1
    v_mfma_f32_32x32x16_bf16 v[128:143], v[80:83], v[10:13], v[128:143]
    v_mfma_f32_32x32x16_bf16 v[144:159], v[80:83], v[14:17], v[144:159]
    ds_read_b128 v[24:27], v34
    ds_read_b128 v[28:31], v35
    s_nop 8
    v_sub_f32 v128, v128, v0
    v_sub_f32 v129, v129, v0
    v_sub_f32 v130, v130, v0
    v_sub_f32 v131, v131, v0
    v_sub_f32 v132, v132, v0
    v_sub_f32 v133, v133, v0
    v_sub_f32 v134, v134, v0
    v_sub_f32 v135, v135, v0
    v_sub_f32 v136, v136, v0
    v_sub_f32 v137, v137, v0
    v_sub_f32 v138, v138, v0
    v_sub_f32 v139, v139, v0
    v_sub_f32 v140, v140, v0
    v_sub_f32 v141, v141, v0
    v_sub_f32 v142, v142, v0
    v_sub_f32 v143, v143, v0
    v_sub_f32 v144, v144, v1
    v_sub_f32 v145, v145, v1
    v_sub_f32 v146, v146, v1
    v_sub_f32 v147, v147, v1
    v_sub_f32 v148, v148, v1
    v_sub_f32 v149, v149, v1
    v_sub_f32 v150, v150, v1
    v_sub_f32 v151, v151, v1
    v_sub_f32 v152, v152, v1
    v_sub_f32 v153, v153, v1
    v_sub_f32 v154, v154, v1
    v_sub_f32 v155, v155, v1
    v_sub_f32 v156, v156, v1
    v_sub_f32 v157, v157, v1
    v_sub_f32 v158, v158, v1
    v_sub_f32 v159, v159, v1
    v_exp_f32 v128, v128
    v_exp_f32 v129, v129
    v_exp_f32 v130, v130
    v_exp_f32 v131, v131
    v_exp_f32 v132, v132
    v_exp_f32 v133, v133
    v_exp_f32 v134, v134
    v_exp_f32 v135, v135
    v_exp_f32 v136, v136
    v_exp_f32 v137, v137
    v_exp_f32 v138, v138
    v_exp_f32 v139, v139
    v_exp_f32 v140, v140
    v_exp_f32 v141, v141
    v_exp_f32 v142, v142
    v_exp_f32 v143, v143
    v_exp_f32 v144, v144
    v_exp_f32 v145, v145
    v_exp_f32 v146, v146
    v_exp_f32 v147, v147
    v_exp_f32 v148, v148
    v_exp_f32 v149, v149
    v_exp_f32 v150, v150
    v_exp_f32 v151, v151
    v_exp_f32 v152, v152
    v_exp_f32 v153, v153
    v_exp_f32 v154, v154
    v_exp_f32 v155, v155
    v_exp_f32 v156, v156
    v_exp_f32 v157, v157
    v_exp_f32 v158, v158
    v_exp_f32 v159, v159
    s_waitcnt lgkmcnt(1)
    v_smfmac_f32_32x32x32_bf16 v[96:111], v[24:27], v[128:135], v77
    s_waitcnt lgkmcnt(0)
    v_smfmac_f32_32x32x32_bf16 v[96:111], v[28:31], v[136:143], v77
    v_smfmac_f32_32x32x32_bf16 v[112:127], v[24:27], v[144:151], v77
    v_smfmac_f32_32x32x32_bf16 v[112:127], v[28:31], v[152:159], v77
    ds_read_b128 v[80:83], v32 offset:1024
    ds_read_b128 v[88:91], v33
    s_waitcnt lgkmcnt(0)
    v_mfma_f32_32x32x4_2b_bf16 v[128:159], v[90:91], v[18:19], 0
    s_nop 15
    s_nop 1
    v_mfma_f32_32x32x16_bf16 v[128:143], v[80:83], v[10:13], v[128:143]
    v_mfma_f32_32x32x16_bf16 v[144:159], v[80:83], v[14:17], v[144:159]
    ds_read_b128 v[24:27], v36
    ds_read_b128 v[28:31], v37
    s_nop 8
    v_sub_f32 v128, v128, v0
    v_sub_f32 v129, v129, v0
    v_sub_f32 v130, v130, v0
    v_sub_f32 v131, v131, v0
    v_sub_f32 v132, v132, v0
    v_sub_f32 v133, v133, v0
    v_sub_f32 v134, v134, v0
    v_sub_f32 v135, v135, v0
    v_sub_f32 v136, v136, v0
    v_sub_f32 v137, v137, v0
    v_sub_f32 v138, v138, v0
    v_sub_f32 v139, v139, v0
    v_sub_f32 v140, v140, v0
    v_sub_f32 v141, v141, v0
    v_sub_f32 v142, v142, v0
    v_sub_f32 v143, v143, v0
    v_sub_f32 v144, v144, v1
    v_sub_f32 v145, v145, v1
    v_sub_f32 v146, v146, v1
    v_sub_f32 v147, v147, v1
    v_sub_f32 v148, v148, v1
    v_sub_f32 v149, v149, v1
    v_sub_f32 v150, v150, v1
    v_sub_f32 v151, v151, v1
    v_sub_f32 v152, v152, v1
    v_sub_f32 v153, v153, v1
    v_sub_f32 v154, v154, v1
    v_sub_f32 v155, v155, v1
    v_sub_f32 v156, v156, v1
    v_sub_f32 v157, v157, v1
    v_sub_f32 v158, v158, v1
    v_sub_f32 v159, v159, v1
    v_exp_f32 v128, v128
    v_exp_f32 v129, v129
    v_exp_f32 v130, v130
    v_exp_f32 v131, v131
    v_exp_f32 v132, v132
    v_exp_f32 v133, v133
    v_exp_f32 v134, v134
    v_exp_f32 v135, v135
    v_exp_f32 v136, v136
    v_exp_f32 v137, v137
    v_exp_f32 v138, v138
    v_exp_f32 v139, v139
    v_exp_f32 v140, v140
    v_exp_f32 v141, v141
    v_exp_f32 v142, v142
    v_exp_f32 v143, v143
    v_exp_f32 v144, v144
    v_exp_f32 v145, v145
    v_exp_f32 v146, v146
    v_exp_f32 v147, v147
    v_exp_f32 v148, v148
    v_exp_f32 v149, v149
    v_exp_f32 v150, v150
    v_exp_f32 v151, v151
    v_exp_f32 v152, v152
    v_exp_f32 v153, v153
    v_exp_f32 v154, v154
    v_exp_f32 v155, v155
    v_exp_f32 v156, v156
    v_exp_f32 v157, v157
    v_exp_f32 v158, v158
    v_exp_f32 v159, v159
    s_waitcnt lgkmcnt(1)
    v_smfmac_f32_32x32x32_bf16 v[96:111], v[24:27], v[128:135], v77
    s_waitcnt lgkmcnt(0)
    v_smfmac_f32_32x32x32_bf16 v[96:111], v[28:31], v[136:143], v77
    v_smfmac_f32_32x32x32_bf16 v[112:127], v[24:27], v[144:151], v77
    v_smfmac_f32_32x32x32_bf16 v[112:127], v[28:31], v[152:159], v77
    s_add_u32 s61, s61, 1
    s_cmp_eq_u32 s61, 10
    s_mov_b32 s12, 4992
    s_cmov_b32 s12, 4294811776
    v_add_u32 v32, s12, v32
    v_add_u32 v33, s12, v33
    v_mul_lo_u32 v2, v38, s12
    v_add_u32 v34, v2, v34
    v_add_u32 v35, v2, v35
    v_add_u32 v36, v2, v36
    v_add_u32 v37, v2, v37
    s_cmp_lt_u32 s61, 32
    s_nop 15
    s_cbranch_scc1 L_fb2
    s_nop 15
    s_branch L_norm
L_end:
    s_endpgm
.p2align 7
.type L_tab,@object
L_tab:
.long 0,0,147456,0,16,16,147464,16,1152,1152,147472,32,1168,1168,147480,48
.long 2304,20736,147488,9216,2320,20752,147496,9232,3456,21888,147504,9248,3472,21904,147512,9264
.long 9216,32,147520,18432,9232,48,147528,18448,10368,1184,147536,18464,10384,1200,147544,18480
.long 11520,20768,147552,27648,11536,20784,147560,27664,12672,21920,147568,27680,12688,21936,147576,27696
.long 4608,41472,147712,36864,4624,41488,147720,36880,5760,42624,147728,36896,5776,42640,147736,36912
.long 6912,62208,147744,46080,6928,62224,147752,46096,8064,63360,147760,46112,8080,63376,147768,46128
.long 13824,41504,147776,55296,13840,41520,147784,55312,14976,42656,147792,55328,14992,42672,147800,55344
.long 16128,62240,147808,64512,16144,62256,147816,64528,17280,63392,147824,64544,17296,63408,147832,64560
.long 20736,82944,147968,73760,20752,82960,147976,73776,21888,84096,147984,73728,21904,84112,147992,73744
.long 23040,103680,148000,82976,23056,103696,148008,82992,24192,104832,148016,82944,24208,104848,148024,82960
.long 29952,82976,148032,92192,29968,82992,148040,92208,31104,84128,148048,92160,31120,84144,148056,92176
.long 32256,103712,148064,101408,32272,103728,148072,101424,33408,104864,148080,101376,33424,104880,148088,101392
.long 25344,124416,148224,110624,25360,124432,148232,110640,26496,125568,148240,110592,26512,125584,148248,110608
.long 27648,145152,148256,119840,27664,145168,148264,119856,28800,146304,148272,119808,28816,146320,148280,119824
.long 34560,124448,148288,129056,34576,124464,148296,129072,35712,125600,148304,129024,35728,125616,148312,129040
.long 36864,145184,148320,138272,36880,145200,148328,138288,38016,146336,148336,138240,38032,146352,148344,138256
.long 0,0,0,6144,16,8,8,6152,32,16,16,6160,48,24,24,6168
.long 64,64,32,6176,80,72,40,6184,96,80,48,6192,112,88,56,6200
.long 1152,128,64,6208,1168,136,72,6216,1184,144,80,6224,1200,152,88,6232
.long 1216,192,96,6240,1232,200,104,6248,1248,208,112,6256,1264,216,120,6264
.long 2336,544,128,6272,2352,552,136,6280,2304,560,144,6288,2320,568,152,6296
.long 2400,608,160,6304,2416,616,168,6312,2368,624,176,6320,2384,632,184,6328
.long 3488,672,192,6336,3504,680,200,6344,3456,688,208,6352,3472,696,216,6360
.long 3552,736,224,6368,3568,744,232,6376,3520,752,240,6384,3536,760,248,6392
.long 4672,1024,256,6400,4688,1032,264,6408,4704,1040,272,6416,4720,1048,280,6424
.long 4608,1088,288,6432,4624,1096,296,6440,4640,1104,304,6448,4656,1112,312,6456
.long 5824,1152,320,6464,5840,1160,328,6472,5856,1168,336,6480,5872,1176,344,6488
.long 5760,1216,352,6496,5776,1224,360,6504,5792,1232,368,6512,5808,1240,376,6520
.long 7008,1568,384,6528,7024,1576,392,6536,6976,1584,400,6544,6992,1592,408,6552
.long 6944,1632,416,6560,6960,1640,424,6568,6912,1648,432,6576,6928,1656,440,6584
.long 8160,1696,448,6592,8176,1704,456,6600,8128,1712,464,6608,8144,1720,472,6616
.long 8096,1760,480,6624,8112,1768,488,6632,8064,1776,496,6640,8080,1784,504,6648
.long 147456,147456,153600,153632,147464,147464,153672,153704,147472,147520,153744,153776,147480,147528,153816,153848
.long 147488,147472,153888,153920,147496,147480,153960,153992,147504,147536,154032,154064,147512,147544,154104,154136
.long 147520,147488,154176,154208,147528,147496,154248,154280,147536,147552,154320,154352,147544,147560,154392,154424
.long 147552,147504,154464,154496,147560,147512,154536,154568,147568,147568,154608,154640,147576,147576,154680,154712
.long 147584,147584,153608,153640,147592,147592,153680,153712,147600,147648,153752,153784,147608,147656,153824,153856
.long 147616,147600,153896,153928,147624,147608,153968,154000,147632,147664,154040,154072,147640,147672,154112,154144
.long 147648,147616,154184,154216,147656,147624,154256,154288,147664,147680,154328,154360,147672,147688,154400,154432
.long 147680,147632,154472,154504,147688,147640,154544,154576,147696,147696,154616,154648,147704,147704,154688,154720
.long 148608,148608,153616,147456,148616,148616,153688,147472,148624,148672,153760,147488,148632,148680,153832,147504
.long 148640,148624,153904,147520,148648,148632,153976,147536,148656,148688,154048,147552,148664,148696,154120,147568
.long 148672,148640,154192,147584,148680,148648,154264,147600,148688,148704,154336,147616,148696,148712,154408,147632
.long 148704,148656,154480,147648,148712,148664,154552,147664,148720,148720,154624,147680,148728,148728,154696,147696
.long 148736,148736,153624,147464,148744,148744,153696,147480,148752,148800,153768,147496,148760,148808,153840,147512
.long 148768,148752,153912,147528,148776,148760,153984,147544,148784,148816,154056,147560,148792,148824,154128,147576
.long 148800,148768,154200,147592,148808,148776,154272,147608,148816,148832,154344,147624,148824,148840,154416,147640
.long 148832,148784,154488,147656,148840,148792,154560,147672,148848,148848,154632,147688,148856,148856,154704,147704
.long 0xbf39be31,0,0,0,0xbf39be31,0,0,0,0xbf39be31,0,0,0,0xbf39be31,0,0,0
.long 0xbf39be31,0,0,0,0xbf39be31,0,0,0,0xbf39be31,0,0,0,0xbf39be31,0,0,0
.long 0xbf39be31,0,0,0,0xbf39be31,0,0,0,0xbf39be31,0,0,0,0xbf39be31,0,0,0
.long 0xbf39be31,0,0,0,0xbf39be31,0,0,0,0xbf39be31,0,0,0,0xbf39be31,0,0,0
.long 0xbf39be31,0,0,0,0xbf39be31,0,0,0,0xbf39be31,0,0,0,0xbf39be31,0,0,0
.long 0xbf39be31,0,0,0,0xbf39be31,0,0,0,0xbf39be31,0,0,0,0xbf39be31,0,0,0
.long 0xbf39be31,0,0,0,0xbf39be31,0,0,0,0xbf39be31,0,0,0,0xbf39be31,0,0,0
.long 0xbf39be31,0,0,0,0xbf39be31,0,0,0,0xbf39be31,0,0,0,0xbf39be31,0,0,0
.long 0xc0088e99,0,0,0,0xc0088e99,0,0,0,0xc0088e99,0,0,0,0xc0088e99,0,0,0
.long 0xc0088e99,0,0,0,0xc0088e99,0,0,0,0xc0088e99,0,0,0,0xc0088e99,0,0,0
.long 0xc0088e99,0,0,0,0xc0088e99,0,0,0,0xc0088e99,0,0,0,0xc0088e99,0,0,0
.long 0xc0088e99,0,0,0,0xc0088e99,0,0,0,0xc0088e99,0,0,0,0xc0088e99,0,0,0
.long 0xc0088e99,0,0,0,0xc0088e99,0,0,0,0xc0088e99,0,0,0,0xc0088e99,0,0,0
.long 0xc0088e99,0,0,0,0xc0088e99,0,0,0,0xc0088e99,0,0,0,0xc0088e99,0,0,0
.long 0xc0088e99,0,0,0,0xc0088e99,0,0,0,0xc0088e99,0,0,0,0xc0088e99,0,0,0
.long 0xc0088e99,0,0,0,0xc0088e99,0,0,0,0xc0088e99,0,0,0,0xc0088e99,0,0,0
.long 0,8,16,24,32,40,48,56,64,72,80,88,96,104,112,120
.long 128,136,144,152,160,168,176,184,192,200,208,216,224,232,240,248
.long 256,264,272,280,288,296,304,312,320,328,336,344,352,360,368,376
.long 384,392,400,408,416,424,432,440,448,456,464,472,480,488,496,504
.long 512,520,528,536,544,552,560,568,576,584,592,600,608,616,624,632
.long 640,648,656,664,672,680,688,696,704,712,720,728,736,744,752,760
.long 768,776,784,792,800,808,816,824,832,840,848,856,864,872,880,888
.long 896,904,912,920,928,936,944,952,960,968,976,984,992,1000,1008,1016
.long 2560,2688,2832,2960,3104,3232,3376,3504,2568,2696,2840,2968,3112,3240,3384,3512
.long 2576,2704,2816,2944,3120,3248,3360,3488,2584,2712,2824,2952,3128,3256,3368,3496
.long 2592,2720,2864,2992,3072,3200,3344,3472,2600,2728,2872,3000,3080,3208,3352,3480
.long 2608,2736,2848,2976,3088,3216,3328,3456,2616,2744,2856,2984,3096,3224,3336,3464
.long 3648,3776,3920,4048,4192,4320,4464,4592,3656,3784,3928,4056,4200,4328,4472,4600
.long 3664,3792,3904,4032,4208,4336,4448,4576,3672,3800,3912,4040,4216,4344,4456,4584
.long 3680,3808,3952,4080,4160,4288,4432,4560,3688,3816,3960,4088,4168,4296,4440,4568
.long 3696,3824,3936,4064,4176,4304,4416,4544,3704,3832,3944,4072,4184,4312,4424,4552
.long 0x40000000,2048,0x40000000,2064,0x40000000,2080,0x40000000,2096,0x40000000,2112,0x40000000,2128,0x40000000,2144,0x40000000,2160
.long 0x40000000,2176,0x40000000,2192,0x40000000,2208,0x40000000,2224,0x40000000,2240,0x40000000,2256,0x40000000,2272,0x40000000,2288
.long 0x40000000,2304,0x40000000,2320,0x40000000,2336,0x40000000,2352,0x40000000,2368,0x40000000,2384,0x40000000,2400,0x40000000,2416
.long 0x40000000,2432,0x40000000,2448,0x40000000,2464,0x40000000,2480,0x40000000,2496,0x40000000,2512,0x40000000,2528,0x40000000,2544
.long 4880,0x40000000,0x40000000,0x40000000,0x40000000,0x40000000,4608,4736,4888,0x40000000,0x40000000,0x40000000,0x40000000,0x40000000,4616,4744
.long 4864,0x40000000,0x40000000,0x40000000,0x40000000,0x40000000,4624,4752,4872,0x40000000,0x40000000,0x40000000,0x40000000,0x40000000,4632,4760
.long 4912,0x40000000,0x40000000,0x40000000,0x40000000,0x40000000,4640,4768,4920,0x40000000,0x40000000,0x40000000,0x40000000,0x40000000,4648,4776
.long 4896,0x40000000,0x40000000,0x40000000,0x40000000,0x40000000,4656,4784,4904,0x40000000,0x40000000,0x40000000,0x40000000,0x40000000,4664,4792
.long 0x40000000,0x40000000,0x40000000,0x40000000,0x40000000,0x40000000,0x40000000,0x40000000,0x40000000,0x40000000,0x40000000,0x40000000,0x40000000,0x40000000,0x40000000,0x40000000
.long 0x40000000,0x40000000,0x40000000,0x40000000,0x40000000,0x40000000,0x40000000,0x40000000,0x40000000,0x40000000,0x40000000,0x40000000,0x40000000,0x40000000,0x40000000,0x40000000
.long 0x40000000,0x40000000,0x40000000,0x40000000,0x40000000,0x40000000,0x40000000,0x40000000,0x40000000,0x40000000,0x40000000,0x40000000,0x40000000,0x40000000,0x40000000,0x40000000
.long 0x40000000,0x40000000,0x40000000,0x40000000,0x40000000,0x40000000,0x40000000,0x40000000,0x40000000,0x40000000,0x40000000,0x40000000,0x40000000,0x40000000,0x40000000,0x40000000
.long 0x40000000,0x40000000,0x40000000,0x40000000,0x40000000,0x40000000,0x40000000,0x40000000,0x40000000,0x40000000,0x40000000,0x40000000,0x40000000,0x40000000,0x40000000,0x40000000
.long 0x40000000,0x40000000,0x40000000,0x40000000,0x40000000,0x40000000,0x40000000,0x40000000,0x40000000,0x40000000,0x40000000,0x40000000,0x40000000,0x40000000,0x40000000,0x40000000
.long 0x40000000,0x40000000,0x40000000,0x40000000,0x40000000,0x40000000,0x40000000,0x40000000,0x40000000,0x40000000,0x40000000,0x40000000,0x40000000,0x40000000,0x40000000,0x40000000
.long 0x40000000,0x40000000,0x40000000,0x40000000,0x40000000,0x40000000,0x40000000,0x40000000,0x40000000,0x40000000,0x40000000,0x40000000,0x40000000,0x40000000,0x40000000,0x40000000
.long 73728,73760,74752,74784,73736,73768,74760,74792,73744,73776,74768,74800,73752,73784,74776,74808
.long 73856,73888,74880,74912,73864,73896,74888,74920,73872,73904,74896,74928,73880,73912,74904,74936
.long 74016,73984,75040,75008,74024,73992,75048,75016,74032,74000,75056,75024,74040,74008,75064,75032
.long 74144,74112,75168,75136,74152,74120,75176,75144,74160,74128,75184,75152,74168,74136,75192,75160
.long 74304,74336,75328,75360,74312,74344,75336,75368,74320,74352,75344,75376,74328,74360,75352,75384
.long 74432,74464,75456,75488,74440,74472,75464,75496,74448,74480,75472,75504,74456,74488,75480,75512
.long 74592,74560,75616,75584,74600,74568,75624,75592,74608,74576,75632,75600,74616,74584,75640,75608
.long 74720,74688,75744,75712,74728,74696,75752,75720,74736,74704,75760,75728,74744,74712,75768,75736
.long 82944,82976,83968,84000,82952,82984,83976,84008,82960,82992,83984,84016,82968,83000,83992,84024
.long 83072,83104,84096,84128,83080,83112,84104,84136,83088,83120,84112,84144,83096,83128,84120,84152
.long 83232,83200,84256,84224,83240,83208,84264,84232,83248,83216,84272,84240,83256,83224,84280,84248
.long 83360,83328,84384,84352,83368,83336,84392,84360,83376,83344,84400,84368,83384,83352,84408,84376
.long 83520,83552,84544,84576,83528,83560,84552,84584,83536,83568,84560,84592,83544,83576,84568,84600
.long 83648,83680,84672,84704,83656,83688,84680,84712,83664,83696,84688,84720,83672,83704,84696,84728
.long 83808,83776,84832,84800,83816,83784,84840,84808,83824,83792,84848,84816,83832,83800,84856,84824
.long 83936,83904,84960,84928,83944,83912,84968,84936,83952,83920,84976,84944,83960,83928,84984,84952
.long 81920,81952,0,6144,81928,81960,8,6152,81936,81968,16,6160,81944,81976,24,6168
.long 82048,82080,32,6176,82056,82088,40,6184,82064,82096,48,6192,82072,82104,56,6200
.long 82208,82176,64,6208,82216,82184,72,6216,82224,82192,80,6224,82232,82200,88,6232
.long 82336,82304,96,6240,82344,82312,104,6248,82352,82320,112,6256,82360,82328,120,6264
.long 82496,82528,128,6272,82504,82536,136,6280,82512,82544,144,6288,82520,82552,152,6296
.long 82624,82656,160,6304,82632,82664,168,6312,82640,82672,176,6320,82648,82680,184,6328
.long 82784,82752,192,6336,82792,82760,200,6344,82800,82768,208,6352,82808,82776,216,6360
.long 82912,82880,224,6368,82920,82888,232,6376,82928,82896,240,6384,82936,82904,248,6392
.long 91136,91168,256,6400,91144,91176,264,6408,91152,91184,272,6416,91160,91192,280,6424
.long 91264,91296,288,6432,91272,91304,296,6440,91280,91312,304,6448,91288,91320,312,6456
.long 91424,91392,320,6464,91432,91400,328,6472,91440,91408,336,6480,91448,91416,344,6488
.long 91552,91520,352,6496,91560,91528,360,6504,91568,91536,368,6512,91576,91544,376,6520
.long 91712,91744,384,6528,91720,91752,392,6536,91728,91760,400,6544,91736,91768,408,6552
.long 91840,91872,416,6560,91848,91880,424,6568,91856,91888,432,6576,91864,91896,440,6584
.long 92000,91968,448,6592,92008,91976,456,6600,92016,91984,464,6608,92024,91992,472,6616
.long 92128,92096,480,6624,92136,92104,488,6632,92144,92112,496,6640,92152,92120,504,6648
.long 153600,153600,0,0,153672,153672,8,0,153744,153744,16,0,153816,153816,24,0
.long 153888,153888,32,0,153960,153960,40,0,154032,154032,48,0,154104,154104,56,0
.long 154176,154176,64,0,154248,154248,72,0,154320,154320,80,0,154392,154392,88,0
.long 154464,154464,96,0,154536,154536,104,0,154608,154608,112,0,154680,154680,120,0
.long 154752,154752,128,0,154824,154824,136,0,154896,154896,144,0,154968,154968,152,0
.long 155040,155040,160,0,155112,155112,168,0,155184,155184,176,0,155256,155256,184,0
.long 155328,155328,192,0,155400,155400,200,0,155472,155472,208,0,155544,155544,216,0
.long 155616,155616,224,0,155688,155688,232,0,155760,155760,240,0,155832,155832,248,0
.long 153616,153636,256,0,153688,153708,264,0,153760,153780,272,0,153832,153852,280,0
.long 153904,153924,288,0,153976,153996,296,0,154048,154068,304,0,154120,154140,312,0
.long 154192,154212,320,0,154264,154284,328,0,154336,154356,336,0,154408,154428,344,0
.long 154480,154500,352,0,154552,154572,360,0,154624,154644,368,0,154696,154716,376,0
.long 154768,154788,0x40000000,0,154840,154860,0x40000000,0,154912,154932,0x40000000,0,154984,155004,0x40000000,0
.long 155056,155076,0x40000000,0,155128,155148,0x40000000,0,155200,155220,0x40000000,0,155272,155292,0x40000000,0
.long 155344,155364,0x40000000,0,155416,155436,0x40000000,0,155488,155508,0x40000000,0,155560,155580,0x40000000,0
.long 155632,155652,0x40000000,0,155704,155724,0x40000000,0,155776,155796,0x40000000,0,155848,155868,0x40000000,0
.long 113152,113184,113216,113248,113280,113312,113344,113376,113424,113456,113488,113520,113552,113584,113616,113648
.long 113696,113664,113760,113728,113824,113792,113888,113856,113968,113936,114032,114000,114096,114064,114160,114128
.long 114240,114272,114176,114208,114368,114400,114304,114336,114512,114544,114448,114480,114640,114672,114576,114608
.long 114784,114752,114720,114688,114912,114880,114848,114816,115056,115024,114992,114960,115184,115152,115120,115088
.long 115200,115232,115264,115296,115328,115360,115392,115424,115472,115504,115536,115568,163840,163840,163840,163840
.long 163840,163840,163840,163840,163840,163840,163840,163840,115472,115504,115536,115568,163840,163840,163840,163840
.long 163840,163840,163840,163840,163840,163840,163840,163840,163840,163840,163840,163840,163840,163840,163840,163840
.long 163840,163840,163840,163840,163840,163840,163840,163840,163840,163840,163840,163840,163840,163840,163840,163840
.long 113168,113200,113232,113264,113296,113328,113360,113392,113408,113440,113472,113504,113536,113568,113600,113632
.long 113712,113680,113776,113744,113840,113808,113904,113872,113952,113920,114016,113984,114080,114048,114144,114112
.long 114256,114288,114192,114224,114384,114416,114320,114352,114496,114528,114432,114464,114624,114656,114560,114592
.long 114800,114768,114736,114704,114928,114896,114864,114832,115040,115008,114976,114944,115168,115136,115104,115072
.long 115216,115248,115280,115312,115344,115376,115408,115440,115456,115488,115520,115552,163840,163840,163840,163840
.long 163840,163840,163840,163840,163840,163840,163840,163840,115456,115488,115520,115552,163840,163840,163840,163840
.long 163840,163840,163840,163840,163840,163840,163840,163840,163840,163840,163840,163840,163840,163840,163840,163840
.long 163840,163840,163840,163840,163840,163840,163840,163840,163840,163840,163840,163840,163840,163840,163840,163840
.long 110592,112640,0xfffe5000,64896,110608,112656,0xfffe5000,64896,110624,112672,0xfffe5000,64896,110640,112688,0xfffe5000,64896
.long 110656,112704,0xfffe5000,64896,110672,112720,0xfffe5000,64896,110688,112736,0xfffe5000,64896,110704,112752,0xfffe5000,64896
.long 110720,112768,0xfffe5000,64896,110736,112784,0xfffe5000,64896,110752,112800,0xfffe5000,64896,110768,112816,0xfffe5000,64896
.long 110784,112832,0xfffe5000,64896,110800,112848,0xfffe5000,64896,110816,112864,0xfffe5000,64896,110832,112880,0xfffe5000,64896
.long 110848,112896,0xfffe5000,64896,110864,112912,0xfffe5000,64896,110880,112928,0xfffe5000,64896,110896,112944,0,0
.long 110912,112960,0,0,110928,112976,0,0,110944,112992,0xfffe5000,64896,110960,113008,0,0
.long 110976,113024,0,0,110992,113040,0,0,111008,113056,0,0,111024,113072,0,0
.long 111040,113088,0,0,111056,113104,0,0,111072,113120,0,0,111088,113136,0,0
.long 111104,112640,0xfffe5000,64896,111120,112656,0xfffe5000,64896,111136,112672,0xfffe5000,64896,111152,112688,0xfffe5000,64896
.long 111168,112704,0xfffe5000,64896,111184,112720,0xfffe5000,64896,111200,112736,0xfffe5000,64896,111216,112752,0xfffe5000,64896
.long 111232,112768,0xfffe5000,64896,111248,112784,0xfffe5000,64896,111264,112800,0xfffe5000,64896,111280,112816,0xfffe5000,64896
.long 111296,112832,0xfffe5000,64896,111312,112848,0xfffe5000,64896,111328,112864,0xfffe5000,64896,111344,112880,0xfffe5000,64896
.long 111360,112896,0xfffe5000,64896,111376,112912,0xfffe5000,64896,111392,112928,0xfffe5000,64896,111408,112944,0,0
.long 111424,112960,0,0,111440,112976,0,0,111456,112992,0xfffe5000,64896,111472,113008,0,0
.long 111488,113024,0,0,111504,113040,0,0,111520,113056,0,0,111536,113072,0,0
.long 111552,113088,0,0,111568,113104,0,0,111584,113120,0,0,111600,113136,0,0
.long 0,8096,596800,1185504,8,8104,596808,1185512,16,8112,596816,1185520,24,8120,596824,1185528
.long 32,8128,596832,1185536,40,8136,596840,1185544,48,8144,596848,1185552,56,8152,596856,1185560
.long 64,8160,596864,1185568,72,8168,596872,1185576,80,8176,596880,1185584,88,8184,596888,1185592
.long 96,8192,596896,1185600,104,8200,596904,1185608,112,8208,596912,1185616,120,8216,596920,1185624
.long 128,8224,596928,1185632,136,8232,596936,1185640,144,8240,596944,1185648,152,8248,596952,1185656
.long 160,8256,596960,1185664,168,8264,596968,1185672,176,8272,596976,1185680,184,8280,596984,1185688
.long 192,8288,596992,1186560,200,8296,597000,1186568,208,8304,597008,1186576,216,8312,597016,1186584
.long 224,8320,597888,1186592,232,8328,597896,1186600,240,8336,597904,1186608,248,8344,597912,1186616
.long 256,589824,597920,1186624,264,589832,597928,1186632,272,589840,597936,1186640,280,589848,597944,1186648
.long 1152,589856,597952,1186656,1160,589864,597960,1186664,1168,589872,597968,1186672,1176,589880,597976,1186680
.long 1184,589888,597984,1186688,1192,589896,597992,1186696,1200,589904,598000,1186704,1208,589912,598008,1186712
.long 1216,589920,598016,1186720,1224,589928,598024,1186728,1232,589936,598032,1186736,1240,589944,598040,1186744
.long 1248,589952,598048,1186752,1256,589960,598056,1186760,1264,589968,598064,1186768,1272,589976,598072,1186776
.long 1280,589984,598080,1186784,1288,589992,598088,1186792,1296,590000,598096,1186800,1304,590008,598104,1186808
.long 1312,590016,598112,1186816,1320,590024,598120,1186824,1328,590032,598128,1186832,1336,590040,598136,1186840
.long 1344,590048,598144,1187712,1352,590056,598152,1187720,1360,590064,598160,1187728,1368,590072,598168,1187736
.long 1774208,0xdddddddd,0,0,1774216,0xdddddddd,8,16,1774224,0xdddddddd,16,32,1774232,0xdddddddd,24,48
.long 1774240,0xdddddddd,32,0,1774248,0xdddddddd,40,16,1774256,0xdddddddd,48,32,1774264,0xdddddddd,56,48
.long 1774272,0xdddddddd,64,0,1774280,0xdddddddd,72,16,1774288,0xdddddddd,80,32,1774296,0xdddddddd,88,48
.long 1774304,0xdddddddd,96,0,1774312,0xdddddddd,104,16,1774320,0xdddddddd,112,32,1774328,0xdddddddd,120,48
.long 1774336,0xdddddddd,128,0,1774344,0xdddddddd,136,16,1774352,0xdddddddd,144,32,1774360,0xdddddddd,152,48
.long 1775232,0xdddddddd,160,0,1775240,0xdddddddd,168,16,1775248,0xdddddddd,176,32,1775256,0xdddddddd,184,48
.long 1775264,0xdddddddd,192,0,1775272,0xdddddddd,200,16,1775280,0xdddddddd,208,32,1775288,0xdddddddd,216,48
.long 1775296,0xdddddddd,224,0,1775304,0xdddddddd,232,16,1775312,0xdddddddd,240,32,1775320,0xdddddddd,248,48
.long 1775328,0xdddddddd,0x40000000,0,1775336,0xdddddddd,0x40000000,16,1775344,0xdddddddd,0x40000000,32,1775352,0xdddddddd,0x40000000,48
.long 1775360,0xdddddddd,0x40000000,0,1775368,0xdddddddd,0x40000000,16,1775376,0xdddddddd,0x40000000,32,1775384,0xdddddddd,0x40000000,48
.long 1775392,0xdddddddd,0x40000000,0,1775400,0xdddddddd,0x40000000,16,1775408,0xdddddddd,0x40000000,32,1775416,0xdddddddd,0x40000000,48
.long 1775424,0xdddddddd,0x40000000,0,1775432,0xdddddddd,0x40000000,16,1775440,0xdddddddd,0x40000000,32,1775448,0xdddddddd,0x40000000,48
.long 1775456,0xdddddddd,0x40000000,0,1775464,0xdddddddd,0x40000000,16,1775472,0xdddddddd,0x40000000,32,1775480,0xdddddddd,0x40000000,48
.long 1775488,0xdddddddd,0x40000000,0,1775496,0xdddddddd,0x40000000,16,1775504,0xdddddddd,0x40000000,32,1775512,0xdddddddd,0x40000000,48
.long 1776384,0xdddddddd,0x40000000,0,1776392,0xdddddddd,0x40000000,16,1776400,0xdddddddd,0x40000000,32,1776408,0xdddddddd,0x40000000,48
.long 1776416,0xdddddddd,0x40000000,0,1776424,0xdddddddd,0x40000000,16,1776432,0xdddddddd,0x40000000,32,1776440,0xdddddddd,0x40000000,48
.long 16256,0,0,0,0x3f800000,0,0,0,0,16256,0,0,0,0x3f800000,0,0
.long 0,0,0,0,0,0,0,0,0,0,0,0,0,0,0,0
.long 0,0,0,0,0,0,0,0,0,0,0,0,0,0,0,0
.long 0,0,0,0,0,0,0,0,0,0,0,0,0,0,0,0
.long 0,0,0,0,0,0,0,0,0,0,0,0,0,0,0,0
.long 16256,0,0,0,0x3f800000,0,0,0,0,16256,0,0,0,0x3f800000,0,0
.long 0,0,0,0,0,0,0,0,0,0,0,0,0,0,0,0
.long 0,0,0,0,0,0,0,0,0,0,0,0,0,0,0,0
.long 0,0,0,0,0,0,0,0,0,0,0,0,0,0,0,0
.long 0,0,0,0,0,0,0,0,0,0,0,0,0,0,0,0
.long 16256,0,0,0,0x3f800000,0,0,0,0,16256,0,0,0,0x3f800000,0,0
.long 0,0,0,0,0,0,0,0,0,0,0,0,0,0,0,0
.long 0,0,0,0,0,0,0,0,0,0,0,0,0,0,0,0
.long 0,0,0,0,0,0,0,0,0,0,0,0,0,0,0,0
.long 0,0,0,0,0,0,0,0,0,0,0,0,0,0,0,0
.long 16256,0,0,0,0x3f800000,0,0,0,0,16256,0,0,0,0x3f800000,0,0
.long 16256,0,0,0,0x3f800000,0,16,8,0,16256,32,16,0,0x3f800000,48,24
.long 0,0,64,32,0,0,80,40,0,0,96,48,0,0,112,56
.long 0,0,128,64,0,0,144,72,0,0,160,80,0,0,176,88
.long 0,0,192,96,0,0,208,104,0,0,224,112,0,0,240,120
.long 0,0,512,2432,0,0,528,2440,0,0,544,2448,0,0,560,2456
.long 16256,0,576,2464,0x3f800000,0,592,2472,0,16256,608,2480,0,0x3f800000,624,2488
.long 0,0,640,2496,0,0,656,2504,0,0,672,2512,0,0,688,2520
.long 0,0,704,2528,0,0,720,2536,0,0,736,2544,0,0,752,2552
.long 0,0,1024,4864,0,0,1040,4872,0,0,1056,4880,0,0,1072,4888
.long 0,0,1088,4896,0,0,1104,4904,0,0,1120,4912,0,0,1136,4920
.long 16256,0,1152,4928,0x3f800000,0,1168,4936,0,16256,1184,4944,0,0x3f800000,1200,4952
.long 0,0,1216,4960,0,0,1232,4968,0,0,1248,4976,0,0,1264,4984
.long 0,0,1536,7296,0,0,1552,7304,0,0,1568,7312,0,0,1584,7320
.long 0,0,1600,7328,0,0,1616,7336,0,0,1632,7344,0,0,1648,7352
.long 0,0,1664,7360,0,0,1680,7368,0,0,1696,7376,0,0,1712,7384
.long 16256,0,1728,7392,0x3f800000,0,1744,7400,0,16256,1760,7408,0,0x3f800000,1776,7416
.long 0,0,0,0,0,0,8,0,0,0,16,0,0,0,24,0
.long 0,0,32,0,0,0,40,0,0,0,48,0,0,0,56,0
.long 0,0,64,0,0,0,72,0,0,0,80,0,0,0,88,0
.long 0,0,96,0,0,0,104,0,0,0,112,0,0,0,120,0
.long 0,0,0x40000000,0,0,0,0x40000000,0,0,0,0x40000000,0,0,0,0x40000000,0
.long 0,0,0x40000000,0,0,0,0x40000000,0,0,0,0x40000000,0,0,0,0x40000000,0
.long 0,0,0x40000000,0,0,0,0x40000000,0,0,0,0x40000000,0,0,0,0x40000000,0
.long 0,0,0x40000000,0,0,0,0x40000000,0,0,0,0x40000000,0,0,0,0x40000000,0
.long 0,0,0x40000000,0,0,0,0x40000000,0,0,0,0x40000000,0,0,0,0x40000000,0
.long 0,0,0x40000000,0,0,0,0x40000000,0,0,0,0x40000000,0,0,0,0x40000000,0
.long 0,0,0x40000000,0,0,0,0x40000000,0,0,0,0x40000000,0,0,0,0x40000000,0
.long 0,0,0x40000000,0,0,0,0x40000000,0,0,0,0x40000000,0,0,0,0x40000000,0
.long 0,0,0x40000000,0,0,0,0x40000000,0,0,0,0x40000000,0,0,0,0x40000000,0
.long 0,0,0x40000000,0,0,0,0x40000000,0,0,0,0x40000000,0,0,0,0x40000000,0
.long 0,0,0x40000000,0,0,0,0x40000000,0,0,0,0x40000000,0,0,0,0x40000000,0
.long 0,0,0x40000000,0,0,0,0x40000000,0,0,0,0x40000000,0,0,0,0x40000000,0
.long 0,0,0,0,592,16,0,0,1184,32,0,0,1776,48,0,0
.long 2368,64,0,0,2960,80,0,0,3552,96,0,0,4144,112,0,0
.long 4736,128,0,0,5328,144,0,0,5920,160,0,0,6512,176,0,0
.long 7104,192,0,0,7696,208,0,0,8288,224,0,0,8880,240,0,0
.long 16,256,0,0,608,272,0,0,1200,288,0,0,1792,304,0,0
.long 2384,320,0,0,2976,336,0,0,3568,352,0,0,4160,368,0,0
.long 4752,384,0,0,5344,400,0,0,5936,416,0,0,6528,432,0,0
.long 7120,448,0,0,7712,464,0,0,8304,480,0,0,8896,496,0,0
.long 32,512,0,0,624,528,0,0,1216,544,0,0,1808,560,0,0
.long 2400,592,0,0,2992,608,0,0,3584,624,0,0,4176,640,0,0
.long 4768,656,0,0,5360,672,0,0,5952,688,0,0,6544,704,0,0
.long 7136,720,0,0,7728,736,0,0,8320,752,0,0,8912,768,0,0
.long 48,784,0,0,640,800,0,0,1232,816,0,0,1824,832,0,0
.long 2416,848,0,0,3008,864,0,0,3600,880,0,0,4192,896,0,0
.long 4784,912,0,0,5376,928,0,0,5968,944,0,0,6560,960,0,0
.long 7152,976,0,0,7744,992,0,0,8336,1008,0,0,8928,1024,0,0
.long 4208,8416,12624,16832,4224,8432,12640,16848,4240,8448,12656,16864,4256,8464,12672,16880
.long 4272,8480,12688,16896,4288,8496,12704,16912,4304,8512,12720,16928,4320,8528,12736,16944
.long 4336,8544,12752,16960,4352,8560,12768,16976,4368,8576,12784,16992,4384,8592,12800,17008
.long 4400,8608,12816,17024,4416,8624,12832,17040,4432,8640,12848,17056,4448,8656,12864,17072
.long 4464,8672,12880,17088,4480,8688,12896,17104,4496,8704,12912,17120,4512,8720,12928,17136
.long 4528,8736,12944,17168,4544,8752,12960,17184,4560,8768,12976,17200,4576,8784,12992,17216
.long 4592,8800,13024,17232,4608,8816,13040,17248,4624,8832,13056,17264,4640,8848,13072,17280
.long 4656,8880,13088,17296,4672,8896,13104,17312,4688,8912,13120,17328,4704,8928,13136,17344
.long 4736,8944,13152,17360,4752,8960,13168,17376,4768,8976,13184,17392,4784,8992,13200,17408
.long 4800,9008,13216,17424,4816,9024,13232,17440,4832,9040,13248,17456,4848,9056,13264,17472
.long 4864,9072,13280,17488,4880,9088,13296,17504,4896,9104,13312,17520,4912,9120,13328,17536
.long 4928,9136,13344,17552,4944,9152,13360,17568,4960,9168,13376,17584,4976,9184,13392,17600
.long 4992,9200,13408,17616,5008,9216,13424,17632,5024,9232,13440,17648,5040,9248,13456,17664
.long 5056,9264,13472,17680,5072,9280,13488,17696,5088,9296,13504,17712,5104,9312,13520,17728
.long 5120,9328,13536,17760,5136,9344,13552,17776,5152,9360,13568,17792,5168,9376,13584,17808
.long 5184,9392,13616,17824,5200,9408,13632,17840,5216,9424,13648,17856,5232,9440,13664,17872
.long 0,0,149504,147456,16,16,149512,147472,1152,1152,149520,147488,1168,1168,149528,147504
.long 2304,20736,149536,156672,2320,20752,149544,156688,3456,21888,149552,156704,3472,21904,149560,156720
.long 9216,32,149568,165888,9232,48,149576,165904,10368,1184,149584,165920,10384,1200,149592,165936
.long 11520,20768,149600,175104,11536,20784,149608,175120,12672,21920,149616,175136,12688,21936,149624,175152
.long 4608,41472,149760,184320,4624,41488,149768,184336,5760,42624,149776,184352,5776,42640,149784,184368
.long 6912,62208,149792,193536,6928,62224,149800,193552,8064,63360,149808,193568,8080,63376,149816,193584
.long 13824,41504,149824,202752,13840,41520,149832,202768,14976,42656,149840,202784,14992,42672,149848,202800
.long 16128,62240,149856,211968,16144,62256,149864,211984,17280,63392,149872,212000,17296,63408,149880,212016
.long 20736,82944,150016,221216,20752,82960,150024,221232,21888,84096,150032,221184,21904,84112,150040,221200
.long 23040,103680,150048,230432,23056,103696,150056,230448,24192,104832,150064,230400,24208,104848,150072,230416
.long 29952,82976,150080,239648,29968,82992,150088,239664,31104,84128,150096,239616,31120,84144,150104,239632
.long 32256,103712,150112,248864,32272,103728,150120,248880,33408,104864,150128,248832,33424,104880,150136,248848
.long 25344,124416,150272,258080,25360,124432,150280,258096,26496,125568,150288,258048,26512,125584,150296,258064
.long 27648,145152,150304,267296,27664,145168,150312,267312,28800,146304,150320,267264,28816,146320,150328,267280
.long 34560,124448,150336,276512,34576,124464,150344,276528,35712,125600,150352,276480,35728,125616,150360,276496
.long 36864,145184,150368,285728,36880,145200,150376,285744,38016,146336,150384,285696,38032,146352,150392,285712
.long 9216,32,6144,0,9232,40,6152,8,9248,48,6160,16,9264,56,6168,24
.long 9280,96,6176,32,9296,104,6184,40,9312,112,6192,48,9328,120,6200,56
.long 10368,160,6208,64,10384,168,6216,72,10400,176,6224,80,10416,184,6232,88
.long 10432,224,6240,96,10448,232,6248,104,10464,240,6256,112,10480,248,6264,120
.long 11552,512,6272,128,11568,520,6280,136,11520,528,6288,144,11536,536,6296,152
.long 11616,576,6304,160,11632,584,6312,168,11584,592,6320,176,11600,600,6328,184
.long 12704,640,6336,192,12720,648,6344,200,12672,656,6352,208,12688,664,6360,216
.long 12768,704,6368,224,12784,712,6376,232,12736,720,6384,240,12752,728,6392,248
.long 13888,1056,6400,256,13904,1064,6408,264,13920,1072,6416,272,13936,1080,6424,280
.long 13824,1120,6432,288,13840,1128,6440,296,13856,1136,6448,304,13872,1144,6456,312
.long 15040,1184,6464,320,15056,1192,6472,328,15072,1200,6480,336,15088,1208,6488,344
.long 14976,1248,6496,352,14992,1256,6504,360,15008,1264,6512,368,15024,1272,6520,376
.long 16224,1536,6528,384,16240,1544,6536,392,16192,1552,6544,400,16208,1560,6552,408
.long 16160,1600,6560,416,16176,1608,6568,424,16128,1616,6576,432,16144,1624,6584,440
.long 17376,1664,6592,448,17392,1672,6600,456,17344,1680,6608,464,17360,1688,6616,472
.long 17312,1728,6624,480,17328,1736,6632,488,17280,1744,6640,496,17296,1752,6648,504
.long 147712,147712,155904,155936,147720,147720,155976,156008,147728,147776,156048,156080,147736,147784,156120,156152
.long 147744,147728,156192,156224,147752,147736,156264,156296,147760,147792,156336,156368,147768,147800,156408,156440
.long 147776,147744,156480,156512,147784,147752,156552,156584,147792,147808,156624,156656,147800,147816,156696,156728
.long 147808,147760,156768,156800,147816,147768,156840,156872,147824,147824,156912,156944,147832,147832,156984,157016
.long 147840,147840,155912,155944,147848,147848,155984,156016,147856,147904,156056,156088,147864,147912,156128,156160
.long 147872,147856,156200,156232,147880,147864,156272,156304,147888,147920,156344,156376,147896,147928,156416,156448
.long 147904,147872,156488,156520,147912,147880,156560,156592,147920,147936,156632,156664,147928,147944,156704,156736
.long 147936,147888,156776,156808,147944,147896,156848,156880,147952,147952,156920,156952,147960,147960,156992,157024
.long 148864,148864,155920,147712,148872,148872,155992,147728,148880,148928,156064,147744,148888,148936,156136,147760
.long 148896,148880,156208,147776,148904,148888,156280,147792,148912,148944,156352,147808,148920,148952,156424,147824
.long 148928,148896,156496,147840,148936,148904,156568,147856,148944,148960,156640,147872,148952,148968,156712,147888
.long 148960,148912,156784,147904,148968,148920,156856,147920,148976,148976,156928,147936,148984,148984,157000,147952
.long 148992,148992,155928,147720,149000,149000,156000,147736,149008,149056,156072,147752,149016,149064,156144,147768
.long 149024,149008,156216,147784,149032,149016,156288,147800,149040,149072,156360,147816,149048,149080,156432,147832
.long 149056,149024,156504,147848,149064,149032,156576,147864,149072,149088,156648,147880,149080,149096,156720,147896
.long 149088,149040,156792,147912,149096,149048,156864,147928,149104,149104,156936,147944,149112,149112,157008,147960
.long 0xbf39be31,0,0,0,0xbf39be31,0,0,0,0xbf39be31,0,0,0,0xbf39be31,0,0,0
.long 0xbf39be31,0,0,0,0xbf39be31,0,0,0,0xbf39be31,0,0,0,0xbf39be31,0,0,0
.long 0xbf39be31,0,0,0,0xbf39be31,0,0,0,0xbf39be31,0,0,0,0xbf39be31,0,0,0
.long 0xbf39be31,0,0,0,0xbf39be31,0,0,0,0xbf39be31,0,0,0,0xbf39be31,0,0,0
.long 0xbf39be31,0,0,0,0xbf39be31,0,0,0,0xbf39be31,0,0,0,0xbf39be31,0,0,0
.long 0xbf39be31,0,0,0,0xbf39be31,0,0,0,0xbf39be31,0,0,0,0xbf39be31,0,0,0
.long 0xbf39be31,0,0,0,0xbf39be31,0,0,0,0xbf39be31,0,0,0,0xbf39be31,0,0,0
.long 0xbf39be31,0,0,0,0xbf39be31,0,0,0,0xbf39be31,0,0,0,0xbf39be31,0,0,0
.long 0xc0088e99,0,0,0,0xc0088e99,0,0,0,0xc0088e99,0,0,0,0xc0088e99,0,0,0
.long 0xc0088e99,0,0,0,0xc0088e99,0,0,0,0xc0088e99,0,0,0,0xc0088e99,0,0,0
.long 0xc0088e99,0,0,0,0xc0088e99,0,0,0,0xc0088e99,0,0,0,0xc0088e99,0,0,0
.long 0xc0088e99,0,0,0,0xc0088e99,0,0,0,0xc0088e99,0,0,0,0xc0088e99,0,0,0
.long 0xc0088e99,0,0,0,0xc0088e99,0,0,0,0xc0088e99,0,0,0,0xc0088e99,0,0,0
.long 0xc0088e99,0,0,0,0xc0088e99,0,0,0,0xc0088e99,0,0,0,0xc0088e99,0,0,0
.long 0xc0088e99,0,0,0,0xc0088e99,0,0,0,0xc0088e99,0,0,0,0xc0088e99,0,0,0
.long 0xc0088e99,0,0,0,0xc0088e99,0,0,0,0xc0088e99,0,0,0,0xc0088e99,0,0,0
.long 1024,1032,1040,1048,1056,1064,1072,1080,1088,1096,1104,1112,1120,1128,1136,1144
.long 1152,1160,1168,1176,1184,1192,1200,1208,1216,1224,1232,1240,1248,1256,1264,1272
.long 1280,1288,1296,1304,1312,1320,1328,1336,1344,1352,1360,1368,1376,1384,1392,1400
.long 1408,1416,1424,1432,1440,1448,1456,1464,1472,1480,1488,1496,1504,1512,1520,1528
.long 1536,1544,1552,1560,1568,1576,1584,1592,1600,1608,1616,1624,1632,1640,1648,1656
.long 1664,1672,1680,1688,1696,1704,1712,1720,1728,1736,1744,1752,1760,1768,1776,1784
.long 1792,1800,1808,1816,1824,1832,1840,1848,1856,1864,1872,1880,1888,1896,1904,1912
.long 1920,1928,1936,1944,1952,1960,1968,1976,1984,1992,2000,2008,2016,2024,2032,2040
.long 2624,2752,2896,3024,3168,3296,3440,3568,2632,2760,2904,3032,3176,3304,3448,3576
.long 2640,2768,2880,3008,3184,3312,3424,3552,2648,2776,2888,3016,3192,3320,3432,3560
.long 2656,2784,2928,3056,3136,3264,3408,3536,2664,2792,2936,3064,3144,3272,3416,3544
.long 2672,2800,2912,3040,3152,3280,3392,3520,2680,2808,2920,3048,3160,3288,3400,3528
.long 3584,3712,3856,3984,4128,4256,4400,4528,3592,3720,3864,3992,4136,4264,4408,4536
.long 3600,3728,3840,3968,4144,4272,4384,4512,3608,3736,3848,3976,4152,4280,4392,4520
.long 3616,3744,3888,4016,4096,4224,4368,4496,3624,3752,3896,4024,4104,4232,4376,4504
.long 3632,3760,3872,4000,4112,4240,4352,4480,3640,3768,3880,4008,4120,4248,4360,4488
.long 0x40000000,2056,0x40000000,2072,0x40000000,2088,0x40000000,2104,0x40000000,2120,0x40000000,2136,0x40000000,2152,0x40000000,2168
.long 0x40000000,2184,0x40000000,2200,0x40000000,2216,0x40000000,2232,0x40000000,2248,0x40000000,2264,0x40000000,2280,0x40000000,2296
.long 0x40000000,2312,0x40000000,2328,0x40000000,2344,0x40000000,2360,0x40000000,2376,0x40000000,2392,0x40000000,2408,0x40000000,2424
.long 0x40000000,2440,0x40000000,2456,0x40000000,2472,0x40000000,2488,0x40000000,2504,0x40000000,2520,0x40000000,2536,0x40000000,2552
.long 4944,0x40000000,0x40000000,0x40000000,0x40000000,0x40000000,4672,4800,4952,0x40000000,0x40000000,0x40000000,0x40000000,0x40000000,4680,4808
.long 4928,0x40000000,0x40000000,0x40000000,0x40000000,0x40000000,4688,4816,4936,0x40000000,0x40000000,0x40000000,0x40000000,0x40000000,4696,4824
.long 4976,0x40000000,0x40000000,0x40000000,0x40000000,0x40000000,4704,4832,4984,0x40000000,0x40000000,0x40000000,0x40000000,0x40000000,4712,4840
.long 4960,0x40000000,0x40000000,0x40000000,0x40000000,0x40000000,4720,4848,4968,0x40000000,0x40000000,0x40000000,0x40000000,0x40000000,4728,4856
.long 0x40000000,0x40000000,0x40000000,0x40000000,0x40000000,0x40000000,0x40000000,0x40000000,0x40000000,0x40000000,0x40000000,0x40000000,0x40000000,0x40000000,0x40000000,0x40000000
.long 0x40000000,0x40000000,0x40000000,0x40000000,0x40000000,0x40000000,0x40000000,0x40000000,0x40000000,0x40000000,0x40000000,0x40000000,0x40000000,0x40000000,0x40000000,0x40000000
.long 0x40000000,0x40000000,0x40000000,0x40000000,0x40000000,0x40000000,0x40000000,0x40000000,0x40000000,0x40000000,0x40000000,0x40000000,0x40000000,0x40000000,0x40000000,0x40000000
.long 0x40000000,0x40000000,0x40000000,0x40000000,0x40000000,0x40000000,0x40000000,0x40000000,0x40000000,0x40000000,0x40000000,0x40000000,0x40000000,0x40000000,0x40000000,0x40000000
.long 0x40000000,0x40000000,0x40000000,0x40000000,0x40000000,0x40000000,0x40000000,0x40000000,0x40000000,0x40000000,0x40000000,0x40000000,0x40000000,0x40000000,0x40000000,0x40000000
.long 0x40000000,0x40000000,0x40000000,0x40000000,0x40000000,0x40000000,0x40000000,0x40000000,0x40000000,0x40000000,0x40000000,0x40000000,0x40000000,0x40000000,0x40000000,0x40000000
.long 0x40000000,0x40000000,0x40000000,0x40000000,0x40000000,0x40000000,0x40000000,0x40000000,0x40000000,0x40000000,0x40000000,0x40000000,0x40000000,0x40000000,0x40000000,0x40000000
.long 0x40000000,0x40000000,0x40000000,0x40000000,0x40000000,0x40000000,0x40000000,0x40000000,0x40000000,0x40000000,0x40000000,0x40000000,0x40000000,0x40000000,0x40000000,0x40000000
.long 74816,74848,73792,73824,74824,74856,73800,73832,74832,74864,73808,73840,74840,74872,73816,73848
.long 74944,74976,73920,73952,74952,74984,73928,73960,74960,74992,73936,73968,74968,75000,73944,73976
.long 75104,75072,74080,74048,75112,75080,74088,74056,75120,75088,74096,74064,75128,75096,74104,74072
.long 75232,75200,74208,74176,75240,75208,74216,74184,75248,75216,74224,74192,75256,75224,74232,74200
.long 75264,75296,74240,74272,75272,75304,74248,74280,75280,75312,74256,74288,75288,75320,74264,74296
.long 75392,75424,74368,74400,75400,75432,74376,74408,75408,75440,74384,74416,75416,75448,74392,74424
.long 75552,75520,74528,74496,75560,75528,74536,74504,75568,75536,74544,74512,75576,75544,74552,74520
.long 75680,75648,74656,74624,75688,75656,74664,74632,75696,75664,74672,74640,75704,75672,74680,74648
.long 84032,84064,83008,83040,84040,84072,83016,83048,84048,84080,83024,83056,84056,84088,83032,83064
.long 84160,84192,83136,83168,84168,84200,83144,83176,84176,84208,83152,83184,84184,84216,83160,83192
.long 84320,84288,83296,83264,84328,84296,83304,83272,84336,84304,83312,83280,84344,84312,83320,83288
.long 84448,84416,83424,83392,84456,84424,83432,83400,84464,84432,83440,83408,84472,84440,83448,83416
.long 84480,84512,83456,83488,84488,84520,83464,83496,84496,84528,83472,83504,84504,84536,83480,83512
.long 84608,84640,83584,83616,84616,84648,83592,83624,84624,84656,83600,83632,84632,84664,83608,83640
.long 84768,84736,83744,83712,84776,84744,83752,83720,84784,84752,83760,83728,84792,84760,83768,83736
.long 84896,84864,83872,83840,84904,84872,83880,83848,84912,84880,83888,83856,84920,84888,83896,83864
.long 81984,82016,6656,512,81992,82024,6664,520,82000,82032,6672,528,82008,82040,6680,536
.long 82112,82144,6688,544,82120,82152,6696,552,82128,82160,6704,560,82136,82168,6712,568
.long 82272,82240,6720,576,82280,82248,6728,584,82288,82256,6736,592,82296,82264,6744,600
.long 82400,82368,6752,608,82408,82376,6760,616,82416,82384,6768,624,82424,82392,6776,632
.long 82432,82464,6784,640,82440,82472,6792,648,82448,82480,6800,656,82456,82488,6808,664
.long 82560,82592,6816,672,82568,82600,6824,680,82576,82608,6832,688,82584,82616,6840,696
.long 82720,82688,6848,704,82728,82696,6856,712,82736,82704,6864,720,82744,82712,6872,728
.long 82848,82816,6880,736,82856,82824,6888,744,82864,82832,6896,752,82872,82840,6904,760
.long 91200,91232,6912,768,91208,91240,6920,776,91216,91248,6928,784,91224,91256,6936,792
.long 91328,91360,6944,800,91336,91368,6952,808,91344,91376,6960,816,91352,91384,6968,824
.long 91488,91456,6976,832,91496,91464,6984,840,91504,91472,6992,848,91512,91480,7000,856
.long 91616,91584,7008,864,91624,91592,7016,872,91632,91600,7024,880,91640,91608,7032,888
.long 91648,91680,7040,896,91656,91688,7048,904,91664,91696,7056,912,91672,91704,7064,920
.long 91776,91808,7072,928,91784,91816,7080,936,91792,91824,7088,944,91800,91832,7096,952
.long 91936,91904,7104,960,91944,91912,7112,968,91952,91920,7120,976,91960,91928,7128,984
.long 92064,92032,7136,992,92072,92040,7144,1000,92080,92048,7152,1008,92088,92056,7160,1016
.long 155904,155904,0,0,155976,155976,8,0,156048,156048,16,0,156120,156120,24,0
.long 156192,156192,32,0,156264,156264,40,0,156336,156336,48,0,156408,156408,56,0
.long 156480,156480,64,0,156552,156552,72,0,156624,156624,80,0,156696,156696,88,0
.long 156768,156768,96,0,156840,156840,104,0,156912,156912,112,0,156984,156984,120,0
.long 157056,157056,128,0,157128,157128,136,0,157200,157200,144,0,157272,157272,152,0
.long 157344,157344,160,0,157416,157416,168,0,157488,157488,176,0,157560,157560,184,0
.long 157632,157632,192,0,157704,157704,200,0,157776,157776,208,0,157848,157848,216,0
.long 157920,157920,224,0,157992,157992,232,0,158064,158064,240,0,158136,158136,248,0
.long 155920,155940,256,0,155992,156012,264,0,156064,156084,272,0,156136,156156,280,0
.long 156208,156228,288,0,156280,156300,296,0,156352,156372,304,0,156424,156444,312,0
.long 156496,156516,320,0,156568,156588,328,0,156640,156660,336,0,156712,156732,344,0
.long 156784,156804,352,0,156856,156876,360,0,156928,156948,368,0,157000,157020,376,0
.long 157072,157092,0x40000000,0,157144,157164,0x40000000,0,157216,157236,0x40000000,0,157288,157308,0x40000000,0
.long 157360,157380,0x40000000,0,157432,157452,0x40000000,0,157504,157524,0x40000000,0,157576,157596,0x40000000,0
.long 157648,157668,0x40000000,0,157720,157740,0x40000000,0,157792,157812,0x40000000,0,157864,157884,0x40000000,0
.long 157936,157956,0x40000000,0,158008,158028,0x40000000,0,158080,158100,0x40000000,0,158152,158172,0x40000000,0
.long 113152,113184,113216,113248,113280,113312,113344,113376,113424,113456,113488,113520,113552,113584,113616,113648
.long 113696,113664,113760,113728,113824,113792,113888,113856,113968,113936,114032,114000,114096,114064,114160,114128
.long 114240,114272,114176,114208,114368,114400,114304,114336,114512,114544,114448,114480,114640,114672,114576,114608
.long 114784,114752,114720,114688,114912,114880,114848,114816,115056,115024,114992,114960,115184,115152,115120,115088
.long 115200,115232,115264,115296,115328,115360,115392,115424,115472,115504,115536,115568,163840,163840,163840,163840
.long 163840,163840,163840,163840,163840,163840,163840,163840,115472,115504,115536,115568,163840,163840,163840,163840
.long 163840,163840,163840,163840,163840,163840,163840,163840,163840,163840,163840,163840,163840,163840,163840,163840
.long 163840,163840,163840,163840,163840,163840,163840,163840,163840,163840,163840,163840,163840,163840,163840,163840
.long 113168,113200,113232,113264,113296,113328,113360,113392,113408,113440,113472,113504,113536,113568,113600,113632
.long 113712,113680,113776,113744,113840,113808,113904,113872,113952,113920,114016,113984,114080,114048,114144,114112
.long 114256,114288,114192,114224,114384,114416,114320,114352,114496,114528,114432,114464,114624,114656,114560,114592
.long 114800,114768,114736,114704,114928,114896,114864,114832,115040,115008,114976,114944,115168,115136,115104,115072
.long 115216,115248,115280,115312,115344,115376,115408,115440,115456,115488,115520,115552,163840,163840,163840,163840
.long 163840,163840,163840,163840,163840,163840,163840,163840,115456,115488,115520,115552,163840,163840,163840,163840
.long 163840,163840,163840,163840,163840,163840,163840,163840,163840,163840,163840,163840,163840,163840,163840,163840
.long 163840,163840,163840,163840,163840,163840,163840,163840,163840,163840,163840,163840,163840,163840,163840,163840
.long 110592,112640,0xfffe5000,64896,110608,112656,0xfffe5000,64896,110624,112672,0xfffe5000,64896,110640,112688,0xfffe5000,64896
.long 110656,112704,0xfffe5000,64896,110672,112720,0xfffe5000,64896,110688,112736,0xfffe5000,64896,110704,112752,0xfffe5000,64896
.long 110720,112768,0xfffe5000,64896,110736,112784,0xfffe5000,64896,110752,112800,0xfffe5000,64896,110768,112816,0xfffe5000,64896
.long 110784,112832,0xfffe5000,64896,110800,112848,0xfffe5000,64896,110816,112864,0xfffe5000,64896,110832,112880,0xfffe5000,64896
.long 110848,112896,0xfffe5000,64896,110864,112912,0xfffe5000,64896,110880,112928,0xfffe5000,64896,110896,112944,0,0
.long 110912,112960,0,0,110928,112976,0,0,110944,112992,0xfffe5000,64896,110960,113008,0,0
.long 110976,113024,0,0,110992,113040,0,0,111008,113056,0,0,111024,113072,0,0
.long 111040,113088,0,0,111056,113104,0,0,111072,113120,0,0,111088,113136,0,0
.long 111104,112640,0xfffe5000,64896,111120,112656,0xfffe5000,64896,111136,112672,0xfffe5000,64896,111152,112688,0xfffe5000,64896
.long 111168,112704,0xfffe5000,64896,111184,112720,0xfffe5000,64896,111200,112736,0xfffe5000,64896,111216,112752,0xfffe5000,64896
.long 111232,112768,0xfffe5000,64896,111248,112784,0xfffe5000,64896,111264,112800,0xfffe5000,64896,111280,112816,0xfffe5000,64896
.long 111296,112832,0xfffe5000,64896,111312,112848,0xfffe5000,64896,111328,112864,0xfffe5000,64896,111344,112880,0xfffe5000,64896
.long 111360,112896,0xfffe5000,64896,111376,112912,0xfffe5000,64896,111392,112928,0xfffe5000,64896,111408,112944,0,0
.long 111424,112960,0,0,111440,112976,0,0,111456,112992,0xfffe5000,64896,111472,113008,0,0
.long 111488,113024,0,0,111504,113040,0,0,111520,113056,0,0,111536,113072,0,0
.long 111552,113088,0,0,111568,113104,0,0,111584,113120,0,0,111600,113136,0,0
.long 1376,590080,1179648,1187744,1384,590088,1179656,1187752,1392,590096,1179664,1187760,1400,590104,1179672,1187768
.long 1408,590976,1179680,1187776,1416,590984,1179688,1187784,1424,590992,1179696,1187792,1432,591000,1179704,1187800
.long 2304,591008,1179712,1187808,2312,591016,1179720,1187816,2320,591024,1179728,1187824,2328,591032,1179736,1187832
.long 2336,591040,1179744,1187840,2344,591048,1179752,1187848,2352,591056,1179760,1187856,2360,591064,1179768,1187864
.long 2368,591072,1179776,1187872,2376,591080,1179784,1187880,2384,591088,1179792,1187888,2392,591096,1179800,1187896
.long 2400,591104,1179808,1187904,2408,591112,1179816,1187912,2416,591120,1179824,1187920,2424,591128,1179832,1187928
.long 2432,591136,1179840,1187936,2440,591144,1179848,1187944,2448,591152,1179856,1187952,2456,591160,1179864,1187960
.long 2464,591168,1179872,1187968,2472,591176,1179880,1187976,2480,591184,1179888,1187984,2488,591192,1179896,1187992
.long 2496,591200,1179904,1769472,2504,591208,1179912,1769480,2512,591216,1179920,1769488,2520,591224,1179928,1769496
.long 2528,591232,1180800,1769504,2536,591240,1180808,1769512,2544,591248,1180816,1769520,2552,591256,1180824,1769528
.long 2560,592128,1180832,1769536,2568,592136,1180840,1769544,2576,592144,1180848,1769552,2584,592152,1180856,1769560
.long 3456,592160,1180864,1769568,3464,592168,1180872,1769576,3472,592176,1180880,1769584,3480,592184,1180888,1769592
.long 3488,592192,1180896,1769600,3496,592200,1180904,1769608,3504,592208,1180912,1769616,3512,592216,1180920,1769624
.long 3520,592224,1180928,1769632,3528,592232,1180936,1769640,3536,592240,1180944,1769648,3544,592248,1180952,1769656
.long 3552,592256,1180960,1769664,3560,592264,1180968,1769672,3568,592272,1180976,1769680,3576,592280,1180984,1769688
.long 3584,592288,1180992,1769696,3592,592296,1181000,1769704,3600,592304,1181008,1769712,3608,592312,1181016,1769720
.long 1776448,0xdddddddd,0,0,1776456,0xdddddddd,8,16,1776464,0xdddddddd,16,32,1776472,0xdddddddd,24,48
.long 1776480,0xdddddddd,32,0,1776488,0xdddddddd,40,16,1776496,0xdddddddd,48,32,1776504,0xdddddddd,56,48
.long 1776512,0xdddddddd,64,0,1776520,0xdddddddd,72,16,1776528,0xdddddddd,80,32,1776536,0xdddddddd,88,48
.long 1776544,0xdddddddd,96,0,1776552,0xdddddddd,104,16,1776560,0xdddddddd,112,32,1776568,0xdddddddd,120,48
.long 1776576,0xdddddddd,128,0,1776584,0xdddddddd,136,16,1776592,0xdddddddd,144,32,1776600,0xdddddddd,152,48
.long 1776608,0xdddddddd,160,0,1776616,0xdddddddd,168,16,1776624,0xdddddddd,176,32,1776632,0xdddddddd,184,48
.long 1776640,0xdddddddd,192,0,1776648,0xdddddddd,200,16,1776656,0xdddddddd,208,32,1776664,0xdddddddd,216,48
.long 1777536,0xdddddddd,224,0,1777544,0xdddddddd,232,16,1777552,0xdddddddd,240,32,1777560,0xdddddddd,248,48
.long 1777568,0xdddddddd,0x40000000,0,1777576,0xdddddddd,0x40000000,16,1777584,0xdddddddd,0x40000000,32,1777592,0xdddddddd,0x40000000,48
.long 1777600,0xdddddddd,0x40000000,0,1777608,0xdddddddd,0x40000000,16,1777616,0xdddddddd,0x40000000,32,1777624,0xdddddddd,0x40000000,48
.long 1777632,0xdddddddd,0x40000000,0,1777640,0xdddddddd,0x40000000,16,1777648,0xdddddddd,0x40000000,32,1777656,0xdddddddd,0x40000000,48
.long 1777664,0xdddddddd,0x40000000,0,1777672,0xdddddddd,0x40000000,16,1777680,0xdddddddd,0x40000000,32,1777688,0xdddddddd,0x40000000,48
.long 1777696,0xdddddddd,0x40000000,0,1777704,0xdddddddd,0x40000000,16,1777712,0xdddddddd,0x40000000,32,1777720,0xdddddddd,0x40000000,48
.long 1777728,0xdddddddd,0x40000000,0,1777736,0xdddddddd,0x40000000,16,1777744,0xdddddddd,0x40000000,32,1777752,0xdddddddd,0x40000000,48
.long 1777760,0xdddddddd,0x40000000,0,1777768,0xdddddddd,0x40000000,16,1777776,0xdddddddd,0x40000000,32,1777784,0xdddddddd,0x40000000,48
.long 1777792,0xdddddddd,0x40000000,0,1777800,0xdddddddd,0x40000000,16,1777808,0xdddddddd,0x40000000,32,1777816,0xdddddddd,0x40000000,48
.long 16256,0,0,0,0x3f800000,0,0,0,0,16256,0,0,0,0x3f800000,0,0
.long 0,0,0,0,0,0,0,0,0,0,0,0,0,0,0,0
.long 0,0,0,0,0,0,0,0,0,0,0,0,0,0,0,0
.long 0,0,0,0,0,0,0,0,0,0,0,0,0,0,0,0
.long 0,0,0,0,0,0,0,0,0,0,0,0,0,0,0,0
.long 16256,0,0,0,0x3f800000,0,0,0,0,16256,0,0,0,0x3f800000,0,0
.long 0,0,0,0,0,0,0,0,0,0,0,0,0,0,0,0
.long 0,0,0,0,0,0,0,0,0,0,0,0,0,0,0,0
.long 0,0,0,0,0,0,0,0,0,0,0,0,0,0,0,0
.long 0,0,0,0,0,0,0,0,0,0,0,0,0,0,0,0
.long 16256,0,0,0,0x3f800000,0,0,0,0,16256,0,0,0,0x3f800000,0,0
.long 0,0,0,0,0,0,0,0,0,0,0,0,0,0,0,0
.long 0,0,0,0,0,0,0,0,0,0,0,0,0,0,0,0
.long 0,0,0,0,0,0,0,0,0,0,0,0,0,0,0,0
.long 0,0,0,0,0,0,0,0,0,0,0,0,0,0,0,0
.long 16256,0,0,0,0x3f800000,0,0,0,0,16256,0,0,0,0x3f800000,0,0
.long 16256,0,0,0,0x3f800000,0,16,8,0,16256,32,16,0,0x3f800000,48,24
.long 0,0,64,32,0,0,80,40,0,0,96,48,0,0,112,56
.long 0,0,128,64,0,0,144,72,0,0,160,80,0,0,176,88
.long 0,0,192,96,0,0,208,104,0,0,224,112,0,0,240,120
.long 0,0,512,2432,0,0,528,2440,0,0,544,2448,0,0,560,2456
.long 16256,0,576,2464,0x3f800000,0,592,2472,0,16256,608,2480,0,0x3f800000,624,2488
.long 0,0,640,2496,0,0,656,2504,0,0,672,2512,0,0,688,2520
.long 0,0,704,2528,0,0,720,2536,0,0,736,2544,0,0,752,2552
.long 0,0,1024,4864,0,0,1040,4872,0,0,1056,4880,0,0,1072,4888
.long 0,0,1088,4896,0,0,1104,4904,0,0,1120,4912,0,0,1136,4920
.long 16256,0,1152,4928,0x3f800000,0,1168,4936,0,16256,1184,4944,0,0x3f800000,1200,4952
.long 0,0,1216,4960,0,0,1232,4968,0,0,1248,4976,0,0,1264,4984
.long 0,0,1536,7296,0,0,1552,7304,0,0,1568,7312,0,0,1584,7320
.long 0,0,1600,7328,0,0,1616,7336,0,0,1632,7344,0,0,1648,7352
.long 0,0,1664,7360,0,0,1680,7368,0,0,1696,7376,0,0,1712,7384
.long 16256,0,1728,7392,0x3f800000,0,1744,7400,0,16256,1760,7408,0,0x3f800000,1776,7416
.long 0,0,0,0,0,0,8,0,0,0,16,0,0,0,24,0
.long 0,0,32,0,0,0,40,0,0,0,48,0,0,0,56,0
.long 0,0,64,0,0,0,72,0,0,0,80,0,0,0,88,0
.long 0,0,96,0,0,0,104,0,0,0,112,0,0,0,120,0
.long 0,0,0x40000000,0,0,0,0x40000000,0,0,0,0x40000000,0,0,0,0x40000000,0
.long 0,0,0x40000000,0,0,0,0x40000000,0,0,0,0x40000000,0,0,0,0x40000000,0
.long 0,0,0x40000000,0,0,0,0x40000000,0,0,0,0x40000000,0,0,0,0x40000000,0
.long 0,0,0x40000000,0,0,0,0x40000000,0,0,0,0x40000000,0,0,0,0x40000000,0
.long 0,0,0x40000000,0,0,0,0x40000000,0,0,0,0x40000000,0,0,0,0x40000000,0
.long 0,0,0x40000000,0,0,0,0x40000000,0,0,0,0x40000000,0,0,0,0x40000000,0
.long 0,0,0x40000000,0,0,0,0x40000000,0,0,0,0x40000000,0,0,0,0x40000000,0
.long 0,0,0x40000000,0,0,0,0x40000000,0,0,0,0x40000000,0,0,0,0x40000000,0
.long 0,0,0x40000000,0,0,0,0x40000000,0,0,0,0x40000000,0,0,0,0x40000000,0
.long 0,0,0x40000000,0,0,0,0x40000000,0,0,0,0x40000000,0,0,0,0x40000000,0
.long 0,0,0x40000000,0,0,0,0x40000000,0,0,0,0x40000000,0,0,0,0x40000000,0
.long 0,0,0x40000000,0,0,0,0x40000000,0,0,0,0x40000000,0,0,0,0x40000000,0
.long 18944,1040,0,0,19536,1056,0,0,20128,1072,0,0,20720,1088,0,0
.long 21312,1104,0,0,21904,1120,0,0,22496,1136,0,0,23088,1152,0,0
.long 23680,1184,0,0,24272,1200,0,0,24864,1216,0,0,25456,1232,0,0
.long 26048,1248,0,0,26640,1264,0,0,27232,1280,0,0,27824,1296,0,0
.long 18960,1312,0,0,19552,1328,0,0,20144,1344,0,0,20736,1360,0,0
.long 21328,1376,0,0,21920,1392,0,0,22512,1408,0,0,23104,1424,0,0
.long 23696,1440,0,0,24288,1456,0,0,24880,1472,0,0,25472,1488,0,0
.long 26064,1504,0,0,26656,1520,0,0,27248,1536,0,0,27840,1552,0,0
.long 18976,1568,0,0,19568,1584,0,0,20160,1600,0,0,20752,1616,0,0
.long 21344,1632,0,0,21936,1648,0,0,22528,1664,0,0,23120,1680,0,0
.long 23712,1696,0,0,24304,1712,0,0,24896,1728,0,0,25488,1744,0,0
.long 26080,1776,0,0,26672,1792,0,0,27264,1808,0,0,27856,1824,0,0
.long 18992,1840,0,0,19584,1856,0,0,20176,1872,0,0,20768,1888,0,0
.long 21360,1904,0,0,21952,1920,0,0,22544,1936,0,0,23136,1952,0,0
.long 23728,1968,0,0,24320,1984,0,0,24912,2000,0,0,25504,2016,0,0
.long 26096,2032,0,0,26688,2048,0,0,27280,2064,0,0,27872,2080,0,0
.long 5248,9472,13680,17888,5264,9488,13696,17904,5280,9504,13712,17920,5296,9520,13728,17936
.long 5328,9536,13744,17952,5344,9552,13760,17968,5360,9568,13776,17984,5376,9584,13792,18000
.long 5392,9600,13808,18016,5408,9616,13824,18032,5424,9632,13840,18048,5440,9648,13856,18064
.long 5456,9664,13872,18080,5472,9680,13888,18096,5488,9696,13904,18112,5504,9712,13920,18128
.long 5520,9728,13936,18144,5536,9744,13952,18160,5552,9760,13968,18176,5568,9776,13984,18192
.long 5584,9792,14000,18208,5600,9808,14016,18224,5616,9824,14032,18240,5632,9840,14048,18256
.long 5648,9856,14064,18272,5664,9872,14080,18288,5680,9888,14096,18304,5696,9904,14112,18320
.long 5712,9920,14128,18352,5728,9936,14144,18368,5744,9952,14160,18384,5760,9968,14176,18400
.long 5776,9984,14208,18416,5792,10000,14224,18432,5808,10016,14240,18448,5824,10032,14256,18464
.long 5840,10064,14272,18480,5856,10080,14288,18496,5872,10096,14304,18512,5888,10112,14320,18528
.long 5920,10128,14336,18544,5936,10144,14352,18560,5952,10160,14368,18576,5968,10176,14384,18592
.long 5984,10192,14400,18608,6000,10208,14416,18624,6016,10224,14432,18640,6032,10240,14448,18656
.long 6048,10256,14464,18672,6064,10272,14480,18688,6080,10288,14496,18704,6096,10304,14512,18720
.long 6112,10320,14528,18736,6128,10336,14544,18752,6144,10352,14560,18768,6160,10368,14576,18784
.long 6176,10384,14592,18800,6192,10400,14608,18816,6208,10416,14624,18832,6224,10432,14640,18848
.long 6240,10448,14656,18864,6256,10464,14672,18880,6272,10480,14688,18896,6288,10496,14704,18912
.long 0,0,151552,0,16,16,151560,16,1152,1152,151568,32,1168,1168,151576,48
.long 2304,20736,151584,9216,2320,20752,151592,9232,3456,21888,151600,9248,3472,21904,151608,9264
.long 9216,32,151616,18432,9232,48,151624,18448,10368,1184,151632,18464,10384,1200,151640,18480
.long 11520,20768,151648,27648,11536,20784,151656,27664,12672,21920,151664,27680,12688,21936,151672,27696
.long 4608,41472,151808,36864,4624,41488,151816,36880,5760,42624,151824,36896,5776,42640,151832,36912
.long 6912,62208,151840,46080,6928,62224,151848,46096,8064,63360,151856,46112,8080,63376,151864,46128
.long 13824,41504,151872,55296,13840,41520,151880,55312,14976,42656,151888,55328,14992,42672,151896,55344
.long 16128,62240,151904,64512,16144,62256,151912,64528,17280,63392,151920,64544,17296,63408,151928,64560
.long 20736,82944,152064,73760,20752,82960,152072,73776,21888,84096,152080,73728,21904,84112,152088,73744
.long 23040,103680,152096,82976,23056,103696,152104,82992,24192,104832,152112,82944,24208,104848,152120,82960
.long 29952,82976,152128,92192,29968,82992,152136,92208,31104,84128,152144,92160,31120,84144,152152,92176
.long 32256,103712,152160,101408,32272,103728,152168,101424,33408,104864,152176,101376,33424,104880,152184,101392
.long 25344,124416,152320,110624,25360,124432,152328,110640,26496,125568,152336,110592,26512,125584,152344,110608
.long 27648,145152,152352,119840,27664,145168,152360,119856,28800,146304,152368,119808,28816,146320,152376,119824
.long 34560,124448,152384,129056,34576,124464,152392,129072,35712,125600,152400,129024,35728,125616,152408,129040
.long 36864,145184,152416,138272,36880,145200,152424,138288,38016,146336,152432,138240,38032,146352,152440,138256
.long 18432,0,12288,18432,18448,8,12296,18440,18464,16,12304,18448,18480,24,12312,18456
.long 18496,64,12320,18464,18512,72,12328,18472,18528,80,12336,18480,18544,88,12344,18488
.long 19584,128,12352,18496,19600,136,12360,18504,19616,144,12368,18512,19632,152,12376,18520
.long 19648,192,12384,18528,19664,200,12392,18536,19680,208,12400,18544,19696,216,12408,18552
.long 20768,544,12416,18560,20784,552,12424,18568,20736,560,12432,18576,20752,568,12440,18584
.long 20832,608,12448,18592,20848,616,12456,18600,20800,624,12464,18608,20816,632,12472,18616
.long 21920,672,12480,18624,21936,680,12488,18632,21888,688,12496,18640,21904,696,12504,18648
.long 21984,736,12512,18656,22000,744,12520,18664,21952,752,12528,18672,21968,760,12536,18680
.long 23104,1024,12544,18688,23120,1032,12552,18696,23136,1040,12560,18704,23152,1048,12568,18712
.long 23040,1088,12576,18720,23056,1096,12584,18728,23072,1104,12592,18736,23088,1112,12600,18744
.long 24256,1152,12608,18752,24272,1160,12616,18760,24288,1168,12624,18768,24304,1176,12632,18776
.long 24192,1216,12640,18784,24208,1224,12648,18792,24224,1232,12656,18800,24240,1240,12664,18808
.long 25440,1568,12672,18816,25456,1576,12680,18824,25408,1584,12688,18832,25424,1592,12696,18840
.long 25376,1632,12704,18848,25392,1640,12712,18856,25344,1648,12720,18864,25360,1656,12728,18872
.long 26592,1696,12736,18880,26608,1704,12744,18888,26560,1712,12752,18896,26576,1720,12760,18904
.long 26528,1760,12768,18912,26544,1768,12776,18920,26496,1776,12784,18928,26512,1784,12792,18936
.long 147968,147968,158208,158240,147976,147976,158280,158312,147984,148032,158352,158384,147992,148040,158424,158456
.long 148000,147984,158496,158528,148008,147992,158568,158600,148016,148048,158640,158672,148024,148056,158712,158744
.long 148032,148000,158784,158816,148040,148008,158856,158888,148048,148064,158928,158960,148056,148072,159000,159032
.long 148064,148016,159072,159104,148072,148024,159144,159176,148080,148080,159216,159248,148088,148088,159288,159320
.long 148096,148096,158216,158248,148104,148104,158288,158320,148112,148160,158360,158392,148120,148168,158432,158464
.long 148128,148112,158504,158536,148136,148120,158576,158608,148144,148176,158648,158680,148152,148184,158720,158752
.long 148160,148128,158792,158824,148168,148136,158864,158896,148176,148192,158936,158968,148184,148200,159008,159040
.long 148192,148144,159080,159112,148200,148152,159152,159184,148208,148208,159224,159256,148216,148216,159296,159328
.long 149120,149120,158224,147968,149128,149128,158296,147984,149136,149184,158368,148000,149144,149192,158440,148016
.long 149152,149136,158512,148032,149160,149144,158584,148048,149168,149200,158656,148064,149176,149208,158728,148080
.long 149184,149152,158800,148096,149192,149160,158872,148112,149200,149216,158944,148128,149208,149224,159016,148144
.long 149216,149168,159088,148160,149224,149176,159160,148176,149232,149232,159232,148192,149240,149240,159304,148208
.long 149248,149248,158232,147976,149256,149256,158304,147992,149264,149312,158376,148008,149272,149320,158448,148024
.long 149280,149264,158520,148040,149288,149272,158592,148056,149296,149328,158664,148072,149304,149336,158736,148088
.long 149312,149280,158808,148104,149320,149288,158880,148120,149328,149344,158952,148136,149336,149352,159024,148152
.long 149344,149296,159096,148168,149352,149304,159168,148184,149360,149360,159240,148200,149368,149368,159312,148216
.long 0xbf39be31,0,0,0,0xbf39be31,0,0,0,0xbf39be31,0,0,0,0xbf39be31,0,0,0
.long 0xbf39be31,0,0,0,0xbf39be31,0,0,0,0xbf39be31,0,0,0,0xbf39be31,0,0,0
.long 0xbf39be31,0,0,0,0xbf39be31,0,0,0,0xbf39be31,0,0,0,0xbf39be31,0,0,0
.long 0xbf39be31,0,0,0,0xbf39be31,0,0,0,0xbf39be31,0,0,0,0xbf39be31,0,0,0
.long 0xbf39be31,0,0,0,0xbf39be31,0,0,0,0xbf39be31,0,0,0,0xbf39be31,0,0,0
.long 0xbf39be31,0,0,0,0xbf39be31,0,0,0,0xbf39be31,0,0,0,0xbf39be31,0,0,0
.long 0xbf39be31,0,0,0,0xbf39be31,0,0,0,0xbf39be31,0,0,0,0xbf39be31,0,0,0
.long 0xbf39be31,0,0,0,0xbf39be31,0,0,0,0xbf39be31,0,0,0,0xbf39be31,0,0,0
.long 0xc0088e99,0,0,0,0xc0088e99,0,0,0,0xc0088e99,0,0,0,0xc0088e99,0,0,0
.long 0xc0088e99,0,0,0,0xc0088e99,0,0,0,0xc0088e99,0,0,0,0xc0088e99,0,0,0
.long 0xc0088e99,0,0,0,0xc0088e99,0,0,0,0xc0088e99,0,0,0,0xc0088e99,0,0,0
.long 0xc0088e99,0,0,0,0xc0088e99,0,0,0,0xc0088e99,0,0,0,0xc0088e99,0,0,0
.long 0xc0088e99,0,0,0,0xc0088e99,0,0,0,0xc0088e99,0,0,0,0xc0088e99,0,0,0
.long 0xc0088e99,0,0,0,0xc0088e99,0,0,0,0xc0088e99,0,0,0,0xc0088e99,0,0,0
.long 0xc0088e99,0,0,0,0xc0088e99,0,0,0,0xc0088e99,0,0,0,0xc0088e99,0,0,0
.long 0xc0088e99,0,0,0,0xc0088e99,0,0,0,0xc0088e99,0,0,0,0xc0088e99,0,0,0
.long 0,8,16,24,32,40,48,56,64,72,80,88,96,104,112,120
.long 128,136,144,152,160,168,176,184,192,200,208,216,224,232,240,248
.long 256,264,272,280,288,296,304,312,320,328,336,344,352,360,368,376
.long 384,392,400,408,416,424,432,440,448,456,464,472,480,488,496,504
.long 512,520,528,536,544,552,560,568,576,584,592,600,608,616,624,632
.long 640,648,656,664,672,680,688,696,704,712,720,728,736,744,752,760
.long 768,776,784,792,800,808,816,824,832,840,848,856,864,872,880,888
.long 896,904,912,920,928,936,944,952,960,968,976,984,992,1000,1008,1016
.long 2560,2688,2832,2960,3104,3232,3376,3504,2568,2696,2840,2968,3112,3240,3384,3512
.long 2576,2704,2816,2944,3120,3248,3360,3488,2584,2712,2824,2952,3128,3256,3368,3496
.long 2592,2720,2864,2992,3072,3200,3344,3472,2600,2728,2872,3000,3080,3208,3352,3480
.long 2608,2736,2848,2976,3088,3216,3328,3456,2616,2744,2856,2984,3096,3224,3336,3464
.long 3648,3776,3920,4048,4192,4320,4464,4592,3656,3784,3928,4056,4200,4328,4472,4600
.long 3664,3792,3904,4032,4208,4336,4448,4576,3672,3800,3912,4040,4216,4344,4456,4584
.long 3680,3808,3952,4080,4160,4288,4432,4560,3688,3816,3960,4088,4168,4296,4440,4568
.long 3696,3824,3936,4064,4176,4304,4416,4544,3704,3832,3944,4072,4184,4312,4424,4552
.long 0x40000000,2048,0x40000000,2064,0x40000000,2080,0x40000000,2096,0x40000000,2112,0x40000000,2128,0x40000000,2144,0x40000000,2160
.long 0x40000000,2176,0x40000000,2192,0x40000000,2208,0x40000000,2224,0x40000000,2240,0x40000000,2256,0x40000000,2272,0x40000000,2288
.long 0x40000000,2304,0x40000000,2320,0x40000000,2336,0x40000000,2352,0x40000000,2368,0x40000000,2384,0x40000000,2400,0x40000000,2416
.long 0x40000000,2432,0x40000000,2448,0x40000000,2464,0x40000000,2480,0x40000000,2496,0x40000000,2512,0x40000000,2528,0x40000000,2544
.long 4880,0x40000000,0x40000000,0x40000000,0x40000000,0x40000000,4608,4736,4888,0x40000000,0x40000000,0x40000000,0x40000000,0x40000000,4616,4744
.long 4864,0x40000000,0x40000000,0x40000000,0x40000000,0x40000000,4624,4752,4872,0x40000000,0x40000000,0x40000000,0x40000000,0x40000000,4632,4760
.long 4912,0x40000000,0x40000000,0x40000000,0x40000000,0x40000000,4640,4768,4920,0x40000000,0x40000000,0x40000000,0x40000000,0x40000000,4648,4776
.long 4896,0x40000000,0x40000000,0x40000000,0x40000000,0x40000000,4656,4784,4904,0x40000000,0x40000000,0x40000000,0x40000000,0x40000000,4664,4792
.long 0x40000000,0x40000000,0x40000000,0x40000000,0x40000000,0x40000000,0x40000000,0x40000000,0x40000000,0x40000000,0x40000000,0x40000000,0x40000000,0x40000000,0x40000000,0x40000000
.long 0x40000000,0x40000000,0x40000000,0x40000000,0x40000000,0x40000000,0x40000000,0x40000000,0x40000000,0x40000000,0x40000000,0x40000000,0x40000000,0x40000000,0x40000000,0x40000000
.long 0x40000000,0x40000000,0x40000000,0x40000000,0x40000000,0x40000000,0x40000000,0x40000000,0x40000000,0x40000000,0x40000000,0x40000000,0x40000000,0x40000000,0x40000000,0x40000000
.long 0x40000000,0x40000000,0x40000000,0x40000000,0x40000000,0x40000000,0x40000000,0x40000000,0x40000000,0x40000000,0x40000000,0x40000000,0x40000000,0x40000000,0x40000000,0x40000000
.long 0x40000000,0x40000000,0x40000000,0x40000000,0x40000000,0x40000000,0x40000000,0x40000000,0x40000000,0x40000000,0x40000000,0x40000000,0x40000000,0x40000000,0x40000000,0x40000000
.long 0x40000000,0x40000000,0x40000000,0x40000000,0x40000000,0x40000000,0x40000000,0x40000000,0x40000000,0x40000000,0x40000000,0x40000000,0x40000000,0x40000000,0x40000000,0x40000000
.long 0x40000000,0x40000000,0x40000000,0x40000000,0x40000000,0x40000000,0x40000000,0x40000000,0x40000000,0x40000000,0x40000000,0x40000000,0x40000000,0x40000000,0x40000000,0x40000000
.long 0x40000000,0x40000000,0x40000000,0x40000000,0x40000000,0x40000000,0x40000000,0x40000000,0x40000000,0x40000000,0x40000000,0x40000000,0x40000000,0x40000000,0x40000000,0x40000000
.long 73728,73760,74752,74784,73736,73768,74760,74792,73744,73776,74768,74800,73752,73784,74776,74808
.long 73856,73888,74880,74912,73864,73896,74888,74920,73872,73904,74896,74928,73880,73912,74904,74936
.long 74016,73984,75040,75008,74024,73992,75048,75016,74032,74000,75056,75024,74040,74008,75064,75032
.long 74144,74112,75168,75136,74152,74120,75176,75144,74160,74128,75184,75152,74168,74136,75192,75160
.long 74304,74336,75328,75360,74312,74344,75336,75368,74320,74352,75344,75376,74328,74360,75352,75384
.long 74432,74464,75456,75488,74440,74472,75464,75496,74448,74480,75472,75504,74456,74488,75480,75512
.long 74592,74560,75616,75584,74600,74568,75624,75592,74608,74576,75632,75600,74616,74584,75640,75608
.long 74720,74688,75744,75712,74728,74696,75752,75720,74736,74704,75760,75728,74744,74712,75768,75736
.long 82944,82976,83968,84000,82952,82984,83976,84008,82960,82992,83984,84016,82968,83000,83992,84024
.long 83072,83104,84096,84128,83080,83112,84104,84136,83088,83120,84112,84144,83096,83128,84120,84152
.long 83232,83200,84256,84224,83240,83208,84264,84232,83248,83216,84272,84240,83256,83224,84280,84248
.long 83360,83328,84384,84352,83368,83336,84392,84360,83376,83344,84400,84368,83384,83352,84408,84376
.long 83520,83552,84544,84576,83528,83560,84552,84584,83536,83568,84560,84592,83544,83576,84568,84600
.long 83648,83680,84672,84704,83656,83688,84680,84712,83664,83696,84688,84720,83672,83704,84696,84728
.long 83808,83776,84832,84800,83816,83784,84840,84808,83824,83792,84848,84816,83832,83800,84856,84824
.long 83936,83904,84960,84928,83944,83912,84968,84936,83952,83920,84976,84944,83960,83928,84984,84952
.long 81920,81952,12288,18432,81928,81960,12296,18440,81936,81968,12304,18448,81944,81976,12312,18456
.long 82048,82080,12320,18464,82056,82088,12328,18472,82064,82096,12336,18480,82072,82104,12344,18488
.long 82208,82176,12352,18496,82216,82184,12360,18504,82224,82192,12368,18512,82232,82200,12376,18520
.long 82336,82304,12384,18528,82344,82312,12392,18536,82352,82320,12400,18544,82360,82328,12408,18552
.long 82496,82528,12416,18560,82504,82536,12424,18568,82512,82544,12432,18576,82520,82552,12440,18584
.long 82624,82656,12448,18592,82632,82664,12456,18600,82640,82672,12464,18608,82648,82680,12472,18616
.long 82784,82752,12480,18624,82792,82760,12488,18632,82800,82768,12496,18640,82808,82776,12504,18648
.long 82912,82880,12512,18656,82920,82888,12520,18664,82928,82896,12528,18672,82936,82904,12536,18680
.long 91136,91168,12544,18688,91144,91176,12552,18696,91152,91184,12560,18704,91160,91192,12568,18712
.long 91264,91296,12576,18720,91272,91304,12584,18728,91280,91312,12592,18736,91288,91320,12600,18744
.long 91424,91392,12608,18752,91432,91400,12616,18760,91440,91408,12624,18768,91448,91416,12632,18776
.long 91552,91520,12640,18784,91560,91528,12648,18792,91568,91536,12656,18800,91576,91544,12664,18808
.long 91712,91744,12672,18816,91720,91752,12680,18824,91728,91760,12688,18832,91736,91768,12696,18840
.long 91840,91872,12704,18848,91848,91880,12712,18856,91856,91888,12720,18864,91864,91896,12728,18872
.long 92000,91968,12736,18880,92008,91976,12744,18888,92016,91984,12752,18896,92024,91992,12760,18904
.long 92128,92096,12768,18912,92136,92104,12776,18920,92144,92112,12784,18928,92152,92120,12792,18936
.long 158208,158208,0,0,158280,158280,8,0,158352,158352,16,0,158424,158424,24,0
.long 158496,158496,32,0,158568,158568,40,0,158640,158640,48,0,158712,158712,56,0
.long 158784,158784,64,0,158856,158856,72,0,158928,158928,80,0,159000,159000,88,0
.long 159072,159072,96,0,159144,159144,104,0,159216,159216,112,0,159288,159288,120,0
.long 159360,159360,128,0,159432,159432,136,0,159504,159504,144,0,159576,159576,152,0
.long 159648,159648,160,0,159720,159720,168,0,159792,159792,176,0,159864,159864,184,0
.long 159936,159936,192,0,160008,160008,200,0,160080,160080,208,0,160152,160152,216,0
.long 160224,160224,224,0,160296,160296,232,0,160368,160368,240,0,160440,160440,248,0
.long 158224,158244,256,0,158296,158316,264,0,158368,158388,272,0,158440,158460,280,0
.long 158512,158532,288,0,158584,158604,296,0,158656,158676,304,0,158728,158748,312,0
.long 158800,158820,320,0,158872,158892,328,0,158944,158964,336,0,159016,159036,344,0
.long 159088,159108,352,0,159160,159180,360,0,159232,159252,368,0,159304,159324,376,0
.long 159376,159396,0x40000000,0,159448,159468,0x40000000,0,159520,159540,0x40000000,0,159592,159612,0x40000000,0
.long 159664,159684,0x40000000,0,159736,159756,0x40000000,0,159808,159828,0x40000000,0,159880,159900,0x40000000,0
.long 159952,159972,0x40000000,0,160024,160044,0x40000000,0,160096,160116,0x40000000,0,160168,160188,0x40000000,0
.long 160240,160260,0x40000000,0,160312,160332,0x40000000,0,160384,160404,0x40000000,0,160456,160476,0x40000000,0
.long 113152,113184,113216,113248,113280,113312,113344,113376,113424,113456,113488,113520,113552,113584,113616,113648
.long 113696,113664,113760,113728,113824,113792,113888,113856,113968,113936,114032,114000,114096,114064,114160,114128
.long 114240,114272,114176,114208,114368,114400,114304,114336,114512,114544,114448,114480,114640,114672,114576,114608
.long 114784,114752,114720,114688,114912,114880,114848,114816,115056,115024,114992,114960,115184,115152,115120,115088
.long 115200,115232,115264,115296,115328,115360,115392,115424,115472,115504,115536,115568,163840,163840,163840,163840
.long 163840,163840,163840,163840,163840,163840,163840,163840,115472,115504,115536,115568,163840,163840,163840,163840
.long 163840,163840,163840,163840,163840,163840,163840,163840,163840,163840,163840,163840,163840,163840,163840,163840
.long 163840,163840,163840,163840,163840,163840,163840,163840,163840,163840,163840,163840,163840,163840,163840,163840
.long 113168,113200,113232,113264,113296,113328,113360,113392,113408,113440,113472,113504,113536,113568,113600,113632
.long 113712,113680,113776,113744,113840,113808,113904,113872,113952,113920,114016,113984,114080,114048,114144,114112
.long 114256,114288,114192,114224,114384,114416,114320,114352,114496,114528,114432,114464,114624,114656,114560,114592
.long 114800,114768,114736,114704,114928,114896,114864,114832,115040,115008,114976,114944,115168,115136,115104,115072
.long 115216,115248,115280,115312,115344,115376,115408,115440,115456,115488,115520,115552,163840,163840,163840,163840
.long 163840,163840,163840,163840,163840,163840,163840,163840,115456,115488,115520,115552,163840,163840,163840,163840
.long 163840,163840,163840,163840,163840,163840,163840,163840,163840,163840,163840,163840,163840,163840,163840,163840
.long 163840,163840,163840,163840,163840,163840,163840,163840,163840,163840,163840,163840,163840,163840,163840,163840
.long 110592,112640,0xfffe5000,64896,110608,112656,0xfffe5000,64896,110624,112672,0xfffe5000,64896,110640,112688,0xfffe5000,64896
.long 110656,112704,0xfffe5000,64896,110672,112720,0xfffe5000,64896,110688,112736,0xfffe5000,64896,110704,112752,0xfffe5000,64896
.long 110720,112768,0xfffe5000,64896,110736,112784,0xfffe5000,64896,110752,112800,0xfffe5000,64896,110768,112816,0xfffe5000,64896
.long 110784,112832,0xfffe5000,64896,110800,112848,0xfffe5000,64896,110816,112864,0xfffe5000,64896,110832,112880,0xfffe5000,64896
.long 110848,112896,0xfffe5000,64896,110864,112912,0xfffe5000,64896,110880,112928,0xfffe5000,64896,110896,112944,0,0
.long 110912,112960,0,0,110928,112976,0,0,110944,112992,0xfffe5000,64896,110960,113008,0,0
.long 110976,113024,0,0,110992,113040,0,0,111008,113056,0,0,111024,113072,0,0
.long 111040,113088,0,0,111056,113104,0,0,111072,113120,0,0,111088,113136,0,0
.long 111104,112640,0xfffe5000,64896,111120,112656,0xfffe5000,64896,111136,112672,0xfffe5000,64896,111152,112688,0xfffe5000,64896
.long 111168,112704,0xfffe5000,64896,111184,112720,0xfffe5000,64896,111200,112736,0xfffe5000,64896,111216,112752,0xfffe5000,64896
.long 111232,112768,0xfffe5000,64896,111248,112784,0xfffe5000,64896,111264,112800,0xfffe5000,64896,111280,112816,0xfffe5000,64896
.long 111296,112832,0xfffe5000,64896,111312,112848,0xfffe5000,64896,111328,112864,0xfffe5000,64896,111344,112880,0xfffe5000,64896
.long 111360,112896,0xfffe5000,64896,111376,112912,0xfffe5000,64896,111392,112928,0xfffe5000,64896,111408,112944,0,0
.long 111424,112960,0,0,111440,112976,0,0,111456,112992,0xfffe5000,64896,111472,113008,0,0
.long 111488,113024,0,0,111504,113040,0,0,111520,113056,0,0,111536,113072,0,0
.long 111552,113088,0,0,111568,113104,0,0,111584,113120,0,0,111600,113136,0,0
.long 3616,592320,1181024,1769728,3624,592328,1181032,1769736,3632,592336,1181040,1769744,3640,592344,1181048,1769752
.long 3648,592352,1181056,1770624,3656,592360,1181064,1770632,3664,592368,1181072,1770640,3672,592376,1181080,1770648
.long 3680,592384,1181952,1770656,3688,592392,1181960,1770664,3696,592400,1181968,1770672,3704,592408,1181976,1770680
.long 3712,593280,1181984,1770688,3720,593288,1181992,1770696,3728,593296,1182000,1770704,3736,593304,1182008,1770712
.long 4608,593312,1182016,1770720,4616,593320,1182024,1770728,4624,593328,1182032,1770736,4632,593336,1182040,1770744
.long 4640,593344,1182048,1770752,4648,593352,1182056,1770760,4656,593360,1182064,1770768,4664,593368,1182072,1770776
.long 4672,593376,1182080,1770784,4680,593384,1182088,1770792,4688,593392,1182096,1770800,4696,593400,1182104,1770808
.long 4704,593408,1182112,1770816,4712,593416,1182120,1770824,4720,593424,1182128,1770832,4728,593432,1182136,1770840
.long 4736,593440,1182144,1770848,4744,593448,1182152,1770856,4752,593456,1182160,1770864,4760,593464,1182168,1770872
.long 4768,593472,1182176,1770880,4776,593480,1182184,1770888,4784,593488,1182192,1770896,4792,593496,1182200,1770904
.long 4800,593504,1182208,1771776,4808,593512,1182216,1771784,4816,593520,1182224,1771792,4824,593528,1182232,1771800
.long 4832,593536,1183104,1771808,4840,593544,1183112,1771816,4848,593552,1183120,1771824,4856,593560,1183128,1771832
.long 4864,594432,1183136,1771840,4872,594440,1183144,1771848,4880,594448,1183152,1771856,4888,594456,1183160,1771864
.long 5760,594464,1183168,1771872,5768,594472,1183176,1771880,5776,594480,1183184,1771888,5784,594488,1183192,1771896
.long 5792,594496,1183200,1771904,5800,594504,1183208,1771912,5808,594512,1183216,1771920,5816,594520,1183224,1771928
.long 5824,594528,1183232,1771936,5832,594536,1183240,1771944,5840,594544,1183248,1771952,5848,594552,1183256,1771960
.long 0x40000000,0xdddddddd,0,0,0x40000000,0xdddddddd,8,16,0x40000000,0xdddddddd,16,32,0x40000000,0xdddddddd,24,48
.long 0x40000000,0xdddddddd,32,0,0x40000000,0xdddddddd,40,16,0x40000000,0xdddddddd,48,32,0x40000000,0xdddddddd,56,48
.long 0x40000000,0xdddddddd,64,0,0x40000000,0xdddddddd,72,16,0x40000000,0xdddddddd,80,32,0x40000000,0xdddddddd,88,48
.long 0x40000000,0xdddddddd,96,0,0x40000000,0xdddddddd,104,16,0x40000000,0xdddddddd,112,32,0x40000000,0xdddddddd,120,48
.long 0x40000000,0xdddddddd,128,0,0x40000000,0xdddddddd,136,16,0x40000000,0xdddddddd,144,32,0x40000000,0xdddddddd,152,48
.long 0x40000000,0xdddddddd,160,0,0x40000000,0xdddddddd,168,16,0x40000000,0xdddddddd,176,32,0x40000000,0xdddddddd,184,48
.long 0x40000000,0xdddddddd,192,0,0x40000000,0xdddddddd,200,16,0x40000000,0xdddddddd,208,32,0x40000000,0xdddddddd,216,48
.long 0x40000000,0xdddddddd,224,0,0x40000000,0xdddddddd,232,16,0x40000000,0xdddddddd,240,32,0x40000000,0xdddddddd,248,48
.long 0x40000000,0xdddddddd,0x40000000,0,0x40000000,0xdddddddd,0x40000000,16,0x40000000,0xdddddddd,0x40000000,32,0x40000000,0xdddddddd,0x40000000,48
.long 0x40000000,0xdddddddd,0x40000000,0,0x40000000,0xdddddddd,0x40000000,16,0x40000000,0xdddddddd,0x40000000,32,0x40000000,0xdddddddd,0x40000000,48
.long 0x40000000,0xdddddddd,0x40000000,0,0x40000000,0xdddddddd,0x40000000,16,0x40000000,0xdddddddd,0x40000000,32,0x40000000,0xdddddddd,0x40000000,48
.long 0x40000000,0xdddddddd,0x40000000,0,0x40000000,0xdddddddd,0x40000000,16,0x40000000,0xdddddddd,0x40000000,32,0x40000000,0xdddddddd,0x40000000,48
.long 0x40000000,0xdddddddd,0x40000000,0,0x40000000,0xdddddddd,0x40000000,16,0x40000000,0xdddddddd,0x40000000,32,0x40000000,0xdddddddd,0x40000000,48
.long 0x40000000,0xdddddddd,0x40000000,0,0x40000000,0xdddddddd,0x40000000,16,0x40000000,0xdddddddd,0x40000000,32,0x40000000,0xdddddddd,0x40000000,48
.long 0x40000000,0xdddddddd,0x40000000,0,0x40000000,0xdddddddd,0x40000000,16,0x40000000,0xdddddddd,0x40000000,32,0x40000000,0xdddddddd,0x40000000,48
.long 0x40000000,0xdddddddd,0x40000000,0,0x40000000,0xdddddddd,0x40000000,16,0x40000000,0xdddddddd,0x40000000,32,0x40000000,0xdddddddd,0x40000000,48
.long 16256,0,0,0,0x3f800000,0,0,0,0,16256,0,0,0,0x3f800000,0,0
.long 0,0,0,0,0,0,0,0,0,0,0,0,0,0,0,0
.long 0,0,0,0,0,0,0,0,0,0,0,0,0,0,0,0
.long 0,0,0,0,0,0,0,0,0,0,0,0,0,0,0,0
.long 0,0,0,0,0,0,0,0,0,0,0,0,0,0,0,0
.long 16256,0,0,0,0x3f800000,0,0,0,0,16256,0,0,0,0x3f800000,0,0
.long 0,0,0,0,0,0,0,0,0,0,0,0,0,0,0,0
.long 0,0,0,0,0,0,0,0,0,0,0,0,0,0,0,0
.long 0,0,0,0,0,0,0,0,0,0,0,0,0,0,0,0
.long 0,0,0,0,0,0,0,0,0,0,0,0,0,0,0,0
.long 16256,0,0,0,0x3f800000,0,0,0,0,16256,0,0,0,0x3f800000,0,0
.long 0,0,0,0,0,0,0,0,0,0,0,0,0,0,0,0
.long 0,0,0,0,0,0,0,0,0,0,0,0,0,0,0,0
.long 0,0,0,0,0,0,0,0,0,0,0,0,0,0,0,0
.long 0,0,0,0,0,0,0,0,0,0,0,0,0,0,0,0
.long 16256,0,0,0,0x3f800000,0,0,0,0,16256,0,0,0,0x3f800000,0,0
.long 16256,0,0,0,0x3f800000,0,16,8,0,16256,32,16,0,0x3f800000,48,24
.long 0,0,64,32,0,0,80,40,0,0,96,48,0,0,112,56
.long 0,0,128,64,0,0,144,72,0,0,160,80,0,0,176,88
.long 0,0,192,96,0,0,208,104,0,0,224,112,0,0,240,120
.long 0,0,512,2432,0,0,528,2440,0,0,544,2448,0,0,560,2456
.long 16256,0,576,2464,0x3f800000,0,592,2472,0,16256,608,2480,0,0x3f800000,624,2488
.long 0,0,640,2496,0,0,656,2504,0,0,672,2512,0,0,688,2520
.long 0,0,704,2528,0,0,720,2536,0,0,736,2544,0,0,752,2552
.long 0,0,1024,4864,0,0,1040,4872,0,0,1056,4880,0,0,1072,4888
.long 0,0,1088,4896,0,0,1104,4904,0,0,1120,4912,0,0,1136,4920
.long 16256,0,1152,4928,0x3f800000,0,1168,4936,0,16256,1184,4944,0,0x3f800000,1200,4952
.long 0,0,1216,4960,0,0,1232,4968,0,0,1248,4976,0,0,1264,4984
.long 0,0,1536,7296,0,0,1552,7304,0,0,1568,7312,0,0,1584,7320
.long 0,0,1600,7328,0,0,1616,7336,0,0,1632,7344,0,0,1648,7352
.long 0,0,1664,7360,0,0,1680,7368,0,0,1696,7376,0,0,1712,7384
.long 16256,0,1728,7392,0x3f800000,0,1744,7400,0,16256,1760,7408,0,0x3f800000,1776,7416
.long 0,0,0,0,0,0,8,0,0,0,16,0,0,0,24,0
.long 0,0,32,0,0,0,40,0,0,0,48,0,0,0,56,0
.long 0,0,64,0,0,0,72,0,0,0,80,0,0,0,88,0
.long 0,0,96,0,0,0,104,0,0,0,112,0,0,0,120,0
.long 0,0,0x40000000,0,0,0,0x40000000,0,0,0,0x40000000,0,0,0,0x40000000,0
.long 0,0,0x40000000,0,0,0,0x40000000,0,0,0,0x40000000,0,0,0,0x40000000,0
.long 0,0,0x40000000,0,0,0,0x40000000,0,0,0,0x40000000,0,0,0,0x40000000,0
.long 0,0,0x40000000,0,0,0,0x40000000,0,0,0,0x40000000,0,0,0,0x40000000,0
.long 0,0,0x40000000,0,0,0,0x40000000,0,0,0,0x40000000,0,0,0,0x40000000,0
.long 0,0,0x40000000,0,0,0,0x40000000,0,0,0,0x40000000,0,0,0,0x40000000,0
.long 0,0,0x40000000,0,0,0,0x40000000,0,0,0,0x40000000,0,0,0,0x40000000,0
.long 0,0,0x40000000,0,0,0,0x40000000,0,0,0,0x40000000,0,0,0,0x40000000,0
.long 0,0,0x40000000,0,0,0,0x40000000,0,0,0,0x40000000,0,0,0,0x40000000,0
.long 0,0,0x40000000,0,0,0,0x40000000,0,0,0,0x40000000,0,0,0,0x40000000,0
.long 0,0,0x40000000,0,0,0,0x40000000,0,0,0,0x40000000,0,0,0,0x40000000,0
.long 0,0,0x40000000,0,0,0,0x40000000,0,0,0,0x40000000,0,0,0,0x40000000,0
.long 37888,2096,0,0,38480,2112,0,0,39072,2128,0,0,39664,2144,0,0
.long 40256,2160,0,0,40848,2176,0,0,41440,2192,0,0,42032,2208,0,0
.long 42624,2224,0,0,43216,2240,0,0,43808,2256,0,0,44400,2272,0,0
.long 44992,2288,0,0,45584,2304,0,0,46176,2320,0,0,46768,2336,0,0
.long 37904,2368,0,0,38496,2384,0,0,39088,2400,0,0,39680,2416,0,0
.long 40272,2432,0,0,40864,2448,0,0,41456,2464,0,0,42048,2480,0,0
.long 42640,2496,0,0,43232,2512,0,0,43824,2528,0,0,44416,2544,0,0
.long 45008,2560,0,0,45600,2576,0,0,46192,2592,0,0,46784,2608,0,0
.long 37920,2624,0,0,38512,2640,0,0,39104,2656,0,0,39696,2672,0,0
.long 40288,2688,0,0,40880,2704,0,0,41472,2720,0,0,42064,2736,0,0
.long 42656,2752,0,0,43248,2768,0,0,43840,2784,0,0,44432,2800,0,0
.long 45024,2816,0,0,45616,2832,0,0,46208,2848,0,0,46800,2864,0,0
.long 37936,2880,0,0,38528,2896,0,0,39120,2912,0,0,39712,2928,0,0
.long 40304,2960,0,0,40896,2976,0,0,41488,2992,0,0,42080,3008,0,0
.long 42672,3024,0,0,43264,3040,0,0,43856,3056,0,0,44448,3072,0,0
.long 45040,3088,0,0,45632,3104,0,0,46224,3120,0,0,46816,3136,0,0
.long 6304,10512,14720,18944,6320,10528,14736,18960,6336,10544,14752,18976,6352,10560,14768,18992
.long 6368,10576,14800,19008,6384,10592,14816,19024,6400,10608,14832,19040,6416,10624,14848,19056
.long 6432,10656,14864,19072,6448,10672,14880,19088,6464,10688,14896,19104,6480,10704,14912,19120
.long 6512,10720,14928,19136,6528,10736,14944,19152,6544,10752,14960,19168,6560,10768,14976,19184
.long 6576,10784,14992,19200,6592,10800,15008,19216,6608,10816,15024,19232,6624,10832,15040,19248
.long 6640,10848,15056,19264,6656,10864,15072,19280,6672,10880,15088,19296,6688,10896,15104,19312
.long 6704,10912,15120,19328,6720,10928,15136,19344,6736,10944,15152,19360,6752,10960,15168,19376
.long 6768,10976,15184,19392,6784,10992,15200,19408,6800,11008,15216,19424,6816,11024,15232,19440
.long 6832,11040,15248,19456,6848,11056,15264,19472,6864,11072,15280,19488,6880,11088,15296,19504
.long 6896,11104,15312,19536,6912,11120,15328,19552,6928,11136,15344,19568,6944,11152,15360,19584
.long 6960,11168,15392,19600,6976,11184,15408,19616,6992,11200,15424,19632,7008,11216,15440,19648
.long 7024,11248,15456,19664,7040,11264,15472,19680,7056,11280,15488,19696,7072,11296,15504,19712
.long 7104,11312,15520,19728,7120,11328,15536,19744,7136,11344,15552,19760,7152,11360,15568,19776
.long 7168,11376,15584,19792,7184,11392,15600,19808,7200,11408,15616,19824,7216,11424,15632,19840
.long 7232,11440,15648,19856,7248,11456,15664,19872,7264,11472,15680,19888,7280,11488,15696,19904
.long 7296,11504,15712,19920,7312,11520,15728,19936,7328,11536,15744,19952,7344,11552,15760,19968
.long 0,0,153600,147456,16,16,153608,147472,1152,1152,153616,147488,1168,1168,153624,147504
.long 2304,20736,153632,156672,2320,20752,153640,156688,3456,21888,153648,156704,3472,21904,153656,156720
.long 9216,32,153664,165888,9232,48,153672,165904,10368,1184,153680,165920,10384,1200,153688,165936
.long 11520,20768,153696,175104,11536,20784,153704,175120,12672,21920,153712,175136,12688,21936,153720,175152
.long 4608,41472,153856,184320,4624,41488,153864,184336,5760,42624,153872,184352,5776,42640,153880,184368
.long 6912,62208,153888,193536,6928,62224,153896,193552,8064,63360,153904,193568,8080,63376,153912,193584
.long 13824,41504,153920,202752,13840,41520,153928,202768,14976,42656,153936,202784,14992,42672,153944,202800
.long 16128,62240,153952,211968,16144,62256,153960,211984,17280,63392,153968,212000,17296,63408,153976,212016
.long 20736,82944,154112,221216,20752,82960,154120,221232,21888,84096,154128,221184,21904,84112,154136,221200
.long 23040,103680,154144,230432,23056,103696,154152,230448,24192,104832,154160,230400,24208,104848,154168,230416
.long 29952,82976,154176,239648,29968,82992,154184,239664,31104,84128,154192,239616,31120,84144,154200,239632
.long 32256,103712,154208,248864,32272,103728,154216,248880,33408,104864,154224,248832,33424,104880,154232,248848
.long 25344,124416,154368,258080,25360,124432,154376,258096,26496,125568,154384,258048,26512,125584,154392,258064
.long 27648,145152,154400,267296,27664,145168,154408,267312,28800,146304,154416,267264,28816,146320,154424,267280
.long 34560,124448,154432,276512,34576,124464,154440,276528,35712,125600,154448,276480,35728,125616,154456,276496
.long 36864,145184,154464,285728,36880,145200,154472,285744,38016,146336,154480,285696,38032,146352,154488,285712
.long 27648,32,18432,12288,27664,40,18440,12296,27680,48,18448,12304,27696,56,18456,12312
.long 27712,96,18464,12320,27728,104,18472,12328,27744,112,18480,12336,27760,120,18488,12344
.long 28800,160,18496,12352,28816,168,18504,12360,28832,176,18512,12368,28848,184,18520,12376
.long 28864,224,18528,12384,28880,232,18536,12392,28896,240,18544,12400,28912,248,18552,12408
.long 29984,512,18560,12416,30000,520,18568,12424,29952,528,18576,12432,29968,536,18584,12440
.long 30048,576,18592,12448,30064,584,18600,12456,30016,592,18608,12464,30032,600,18616,12472
.long 31136,640,18624,12480,31152,648,18632,12488,31104,656,18640,12496,31120,664,18648,12504
.long 31200,704,18656,12512,31216,712,18664,12520,31168,720,18672,12528,31184,728,18680,12536
.long 32320,1056,18688,12544,32336,1064,18696,12552,32352,1072,18704,12560,32368,1080,18712,12568
.long 32256,1120,18720,12576,32272,1128,18728,12584,32288,1136,18736,12592,32304,1144,18744,12600
.long 33472,1184,18752,12608,33488,1192,18760,12616,33504,1200,18768,12624,33520,1208,18776,12632
.long 33408,1248,18784,12640,33424,1256,18792,12648,33440,1264,18800,12656,33456,1272,18808,12664
.long 34656,1536,18816,12672,34672,1544,18824,12680,34624,1552,18832,12688,34640,1560,18840,12696
.long 34592,1600,18848,12704,34608,1608,18856,12712,34560,1616,18864,12720,34576,1624,18872,12728
.long 35808,1664,18880,12736,35824,1672,18888,12744,35776,1680,18896,12752,35792,1688,18904,12760
.long 35744,1728,18912,12768,35760,1736,18920,12776,35712,1744,18928,12784,35728,1752,18936,12792
.long 148224,148224,160512,160544,148232,148232,160584,160616,148240,148288,160656,160688,148248,148296,160728,160760
.long 148256,148240,160800,160832,148264,148248,160872,160904,148272,148304,160944,160976,148280,148312,161016,161048
.long 148288,148256,161088,161120,148296,148264,161160,161192,148304,148320,161232,161264,148312,148328,161304,161336
.long 148320,148272,161376,161408,148328,148280,161448,161480,148336,148336,161520,161552,148344,148344,161592,161624
.long 148352,148352,160520,160552,148360,148360,160592,160624,148368,148416,160664,160696,148376,148424,160736,160768
.long 148384,148368,160808,160840,148392,148376,160880,160912,148400,148432,160952,160984,148408,148440,161024,161056
.long 148416,148384,161096,161128,148424,148392,161168,161200,148432,148448,161240,161272,148440,148456,161312,161344
.long 148448,148400,161384,161416,148456,148408,161456,161488,148464,148464,161528,161560,148472,148472,161600,161632
.long 149376,149376,160528,148224,149384,149384,160600,148240,149392,149440,160672,148256,149400,149448,160744,148272
.long 149408,149392,160816,148288,149416,149400,160888,148304,149424,149456,160960,148320,149432,149464,161032,148336
.long 149440,149408,161104,148352,149448,149416,161176,148368,149456,149472,161248,148384,149464,149480,161320,148400
.long 149472,149424,161392,148416,149480,149432,161464,148432,149488,149488,161536,148448,149496,149496,161608,148464
.long 149504,149504,160536,148232,149512,149512,160608,148248,149520,149568,160680,148264,149528,149576,160752,148280
.long 149536,149520,160824,148296,149544,149528,160896,148312,149552,149584,160968,148328,149560,149592,161040,148344
.long 149568,149536,161112,148360,149576,149544,161184,148376,149584,149600,161256,148392,149592,149608,161328,148408
.long 149600,149552,161400,148424,149608,149560,161472,148440,149616,149616,161544,148456,149624,149624,161616,148472
.long 0xbf39be31,0,0,0,0xbf39be31,0,0,0,0xbf39be31,0,0,0,0xbf39be31,0,0,0
.long 0xbf39be31,0,0,0,0xbf39be31,0,0,0,0xbf39be31,0,0,0,0xbf39be31,0,0,0
.long 0xbf39be31,0,0,0,0xbf39be31,0,0,0,0xbf39be31,0,0,0,0xbf39be31,0,0,0
.long 0xbf39be31,0,0,0,0xbf39be31,0,0,0,0xbf39be31,0,0,0,0xbf39be31,0,0,0
.long 0xbf39be31,0,0,0,0xbf39be31,0,0,0,0xbf39be31,0,0,0,0xbf39be31,0,0,0
.long 0xbf39be31,0,0,0,0xbf39be31,0,0,0,0xbf39be31,0,0,0,0xbf39be31,0,0,0
.long 0xbf39be31,0,0,0,0xbf39be31,0,0,0,0xbf39be31,0,0,0,0xbf39be31,0,0,0
.long 0xbf39be31,0,0,0,0xbf39be31,0,0,0,0xbf39be31,0,0,0,0xbf39be31,0,0,0
.long 0xc0088e99,0,0,0,0xc0088e99,0,0,0,0xc0088e99,0,0,0,0xc0088e99,0,0,0
.long 0xc0088e99,0,0,0,0xc0088e99,0,0,0,0xc0088e99,0,0,0,0xc0088e99,0,0,0
.long 0xc0088e99,0,0,0,0xc0088e99,0,0,0,0xc0088e99,0,0,0,0xc0088e99,0,0,0
.long 0xc0088e99,0,0,0,0xc0088e99,0,0,0,0xc0088e99,0,0,0,0xc0088e99,0,0,0
.long 0xc0088e99,0,0,0,0xc0088e99,0,0,0,0xc0088e99,0,0,0,0xc0088e99,0,0,0
.long 0xc0088e99,0,0,0,0xc0088e99,0,0,0,0xc0088e99,0,0,0,0xc0088e99,0,0,0
.long 0xc0088e99,0,0,0,0xc0088e99,0,0,0,0xc0088e99,0,0,0,0xc0088e99,0,0,0
.long 0xc0088e99,0,0,0,0xc0088e99,0,0,0,0xc0088e99,0,0,0,0xc0088e99,0,0,0
.long 1024,1032,1040,1048,1056,1064,1072,1080,1088,1096,1104,1112,1120,1128,1136,1144
.long 1152,1160,1168,1176,1184,1192,1200,1208,1216,1224,1232,1240,1248,1256,1264,1272
.long 1280,1288,1296,1304,1312,1320,1328,1336,1344,1352,1360,1368,1376,1384,1392,1400
.long 1408,1416,1424,1432,1440,1448,1456,1464,1472,1480,1488,1496,1504,1512,1520,1528
.long 1536,1544,1552,1560,1568,1576,1584,1592,1600,1608,1616,1624,1632,1640,1648,1656
.long 1664,1672,1680,1688,1696,1704,1712,1720,1728,1736,1744,1752,1760,1768,1776,1784
.long 1792,1800,1808,1816,1824,1832,1840,1848,1856,1864,1872,1880,1888,1896,1904,1912
.long 1920,1928,1936,1944,1952,1960,1968,1976,1984,1992,2000,2008,2016,2024,2032,2040
.long 2624,2752,2896,3024,3168,3296,3440,3568,2632,2760,2904,3032,3176,3304,3448,3576
.long 2640,2768,2880,3008,3184,3312,3424,3552,2648,2776,2888,3016,3192,3320,3432,3560
.long 2656,2784,2928,3056,3136,3264,3408,3536,2664,2792,2936,3064,3144,3272,3416,3544
.long 2672,2800,2912,3040,3152,3280,3392,3520,2680,2808,2920,3048,3160,3288,3400,3528
.long 3584,3712,3856,3984,4128,4256,4400,4528,3592,3720,3864,3992,4136,4264,4408,4536
.long 3600,3728,3840,3968,4144,4272,4384,4512,3608,3736,3848,3976,4152,4280,4392,4520
.long 3616,3744,3888,4016,4096,4224,4368,4496,3624,3752,3896,4024,4104,4232,4376,4504
.long 3632,3760,3872,4000,4112,4240,4352,4480,3640,3768,3880,4008,4120,4248,4360,4488
.long 0x40000000,2056,0x40000000,2072,0x40000000,2088,0x40000000,2104,0x40000000,2120,0x40000000,2136,0x40000000,2152,0x40000000,2168
.long 0x40000000,2184,0x40000000,2200,0x40000000,2216,0x40000000,2232,0x40000000,2248,0x40000000,2264,0x40000000,2280,0x40000000,2296
.long 0x40000000,2312,0x40000000,2328,0x40000000,2344,0x40000000,2360,0x40000000,2376,0x40000000,2392,0x40000000,2408,0x40000000,2424
.long 0x40000000,2440,0x40000000,2456,0x40000000,2472,0x40000000,2488,0x40000000,2504,0x40000000,2520,0x40000000,2536,0x40000000,2552
.long 4944,0x40000000,0x40000000,0x40000000,0x40000000,0x40000000,4672,4800,4952,0x40000000,0x40000000,0x40000000,0x40000000,0x40000000,4680,4808
.long 4928,0x40000000,0x40000000,0x40000000,0x40000000,0x40000000,4688,4816,4936,0x40000000,0x40000000,0x40000000,0x40000000,0x40000000,4696,4824
.long 4976,0x40000000,0x40000000,0x40000000,0x40000000,0x40000000,4704,4832,4984,0x40000000,0x40000000,0x40000000,0x40000000,0x40000000,4712,4840
.long 4960,0x40000000,0x40000000,0x40000000,0x40000000,0x40000000,4720,4848,4968,0x40000000,0x40000000,0x40000000,0x40000000,0x40000000,4728,4856
.long 0x40000000,0x40000000,0x40000000,0x40000000,0x40000000,0x40000000,0x40000000,0x40000000,0x40000000,0x40000000,0x40000000,0x40000000,0x40000000,0x40000000,0x40000000,0x40000000
.long 0x40000000,0x40000000,0x40000000,0x40000000,0x40000000,0x40000000,0x40000000,0x40000000,0x40000000,0x40000000,0x40000000,0x40000000,0x40000000,0x40000000,0x40000000,0x40000000
.long 0x40000000,0x40000000,0x40000000,0x40000000,0x40000000,0x40000000,0x40000000,0x40000000,0x40000000,0x40000000,0x40000000,0x40000000,0x40000000,0x40000000,0x40000000,0x40000000
.long 0x40000000,0x40000000,0x40000000,0x40000000,0x40000000,0x40000000,0x40000000,0x40000000,0x40000000,0x40000000,0x40000000,0x40000000,0x40000000,0x40000000,0x40000000,0x40000000
.long 0x40000000,0x40000000,0x40000000,0x40000000,0x40000000,0x40000000,0x40000000,0x40000000,0x40000000,0x40000000,0x40000000,0x40000000,0x40000000,0x40000000,0x40000000,0x40000000
.long 0x40000000,0x40000000,0x40000000,0x40000000,0x40000000,0x40000000,0x40000000,0x40000000,0x40000000,0x40000000,0x40000000,0x40000000,0x40000000,0x40000000,0x40000000,0x40000000
.long 0x40000000,0x40000000,0x40000000,0x40000000,0x40000000,0x40000000,0x40000000,0x40000000,0x40000000,0x40000000,0x40000000,0x40000000,0x40000000,0x40000000,0x40000000,0x40000000
.long 0x40000000,0x40000000,0x40000000,0x40000000,0x40000000,0x40000000,0x40000000,0x40000000,0x40000000,0x40000000,0x40000000,0x40000000,0x40000000,0x40000000,0x40000000,0x40000000
.long 74816,74848,73792,73824,74824,74856,73800,73832,74832,74864,73808,73840,74840,74872,73816,73848
.long 74944,74976,73920,73952,74952,74984,73928,73960,74960,74992,73936,73968,74968,75000,73944,73976
.long 75104,75072,74080,74048,75112,75080,74088,74056,75120,75088,74096,74064,75128,75096,74104,74072
.long 75232,75200,74208,74176,75240,75208,74216,74184,75248,75216,74224,74192,75256,75224,74232,74200
.long 75264,75296,74240,74272,75272,75304,74248,74280,75280,75312,74256,74288,75288,75320,74264,74296
.long 75392,75424,74368,74400,75400,75432,74376,74408,75408,75440,74384,74416,75416,75448,74392,74424
.long 75552,75520,74528,74496,75560,75528,74536,74504,75568,75536,74544,74512,75576,75544,74552,74520
.long 75680,75648,74656,74624,75688,75656,74664,74632,75696,75664,74672,74640,75704,75672,74680,74648
.long 84032,84064,83008,83040,84040,84072,83016,83048,84048,84080,83024,83056,84056,84088,83032,83064
.long 84160,84192,83136,83168,84168,84200,83144,83176,84176,84208,83152,83184,84184,84216,83160,83192
.long 84320,84288,83296,83264,84328,84296,83304,83272,84336,84304,83312,83280,84344,84312,83320,83288
.long 84448,84416,83424,83392,84456,84424,83432,83400,84464,84432,83440,83408,84472,84440,83448,83416
.long 84480,84512,83456,83488,84488,84520,83464,83496,84496,84528,83472,83504,84504,84536,83480,83512
.long 84608,84640,83584,83616,84616,84648,83592,83624,84624,84656,83600,83632,84632,84664,83608,83640
.long 84768,84736,83744,83712,84776,84744,83752,83720,84784,84752,83760,83728,84792,84760,83768,83736
.long 84896,84864,83872,83840,84904,84872,83880,83848,84912,84880,83888,83856,84920,84888,83896,83864
.long 81984,82016,18944,12800,81992,82024,18952,12808,82000,82032,18960,12816,82008,82040,18968,12824
.long 82112,82144,18976,12832,82120,82152,18984,12840,82128,82160,18992,12848,82136,82168,19000,12856
.long 82272,82240,19008,12864,82280,82248,19016,12872,82288,82256,19024,12880,82296,82264,19032,12888
.long 82400,82368,19040,12896,82408,82376,19048,12904,82416,82384,19056,12912,82424,82392,19064,12920
.long 82432,82464,19072,12928,82440,82472,19080,12936,82448,82480,19088,12944,82456,82488,19096,12952
.long 82560,82592,19104,12960,82568,82600,19112,12968,82576,82608,19120,12976,82584,82616,19128,12984
.long 82720,82688,19136,12992,82728,82696,19144,13000,82736,82704,19152,13008,82744,82712,19160,13016
.long 82848,82816,19168,13024,82856,82824,19176,13032,82864,82832,19184,13040,82872,82840,19192,13048
.long 91200,91232,19200,13056,91208,91240,19208,13064,91216,91248,19216,13072,91224,91256,19224,13080
.long 91328,91360,19232,13088,91336,91368,19240,13096,91344,91376,19248,13104,91352,91384,19256,13112
.long 91488,91456,19264,13120,91496,91464,19272,13128,91504,91472,19280,13136,91512,91480,19288,13144
.long 91616,91584,19296,13152,91624,91592,19304,13160,91632,91600,19312,13168,91640,91608,19320,13176
.long 91648,91680,19328,13184,91656,91688,19336,13192,91664,91696,19344,13200,91672,91704,19352,13208
.long 91776,91808,19360,13216,91784,91816,19368,13224,91792,91824,19376,13232,91800,91832,19384,13240
.long 91936,91904,19392,13248,91944,91912,19400,13256,91952,91920,19408,13264,91960,91928,19416,13272
.long 92064,92032,19424,13280,92072,92040,19432,13288,92080,92048,19440,13296,92088,92056,19448,13304
.long 160512,160512,0,0,160584,160584,8,0,160656,160656,16,0,160728,160728,24,0
.long 160800,160800,32,0,160872,160872,40,0,160944,160944,48,0,161016,161016,56,0
.long 161088,161088,64,0,161160,161160,72,0,161232,161232,80,0,161304,161304,88,0
.long 161376,161376,96,0,161448,161448,104,0,161520,161520,112,0,161592,161592,120,0
.long 161664,161664,128,0,161736,161736,136,0,161808,161808,144,0,161880,161880,152,0
.long 161952,161952,160,0,162024,162024,168,0,162096,162096,176,0,162168,162168,184,0
.long 162240,162240,192,0,162312,162312,200,0,162384,162384,208,0,162456,162456,216,0
.long 162528,162528,224,0,162600,162600,232,0,162672,162672,240,0,162744,162744,248,0
.long 160528,160548,256,0,160600,160620,264,0,160672,160692,272,0,160744,160764,280,0
.long 160816,160836,288,0,160888,160908,296,0,160960,160980,304,0,161032,161052,312,0
.long 161104,161124,320,0,161176,161196,328,0,161248,161268,336,0,161320,161340,344,0
.long 161392,161412,352,0,161464,161484,360,0,161536,161556,368,0,161608,161628,376,0
.long 161680,161700,0x40000000,0,161752,161772,0x40000000,0,161824,161844,0x40000000,0,161896,161916,0x40000000,0
.long 161968,161988,0x40000000,0,162040,162060,0x40000000,0,162112,162132,0x40000000,0,162184,162204,0x40000000,0
.long 162256,162276,0x40000000,0,162328,162348,0x40000000,0,162400,162420,0x40000000,0,162472,162492,0x40000000,0
.long 162544,162564,0x40000000,0,162616,162636,0x40000000,0,162688,162708,0x40000000,0,162760,162780,0x40000000,0
.long 113152,113184,113216,113248,113280,113312,113344,113376,113424,113456,113488,113520,113552,113584,113616,113648
.long 113696,113664,113760,113728,113824,113792,113888,113856,113968,113936,114032,114000,114096,114064,114160,114128
.long 114240,114272,114176,114208,114368,114400,114304,114336,114512,114544,114448,114480,114640,114672,114576,114608
.long 114784,114752,114720,114688,114912,114880,114848,114816,115056,115024,114992,114960,115184,115152,115120,115088
.long 115200,115232,115264,115296,115328,115360,115392,115424,115472,115504,115536,115568,163840,163840,163840,163840
.long 163840,163840,163840,163840,163840,163840,163840,163840,115472,115504,115536,115568,163840,163840,163840,163840
.long 163840,163840,163840,163840,163840,163840,163840,163840,163840,163840,163840,163840,163840,163840,163840,163840
.long 163840,163840,163840,163840,163840,163840,163840,163840,163840,163840,163840,163840,163840,163840,163840,163840
.long 113168,113200,113232,113264,113296,113328,113360,113392,113408,113440,113472,113504,113536,113568,113600,113632
.long 113712,113680,113776,113744,113840,113808,113904,113872,113952,113920,114016,113984,114080,114048,114144,114112
.long 114256,114288,114192,114224,114384,114416,114320,114352,114496,114528,114432,114464,114624,114656,114560,114592
.long 114800,114768,114736,114704,114928,114896,114864,114832,115040,115008,114976,114944,115168,115136,115104,115072
.long 115216,115248,115280,115312,115344,115376,115408,115440,115456,115488,115520,115552,163840,163840,163840,163840
.long 163840,163840,163840,163840,163840,163840,163840,163840,115456,115488,115520,115552,163840,163840,163840,163840
.long 163840,163840,163840,163840,163840,163840,163840,163840,163840,163840,163840,163840,163840,163840,163840,163840
.long 163840,163840,163840,163840,163840,163840,163840,163840,163840,163840,163840,163840,163840,163840,163840,163840
.long 110592,112640,0xfffe5000,64896,110608,112656,0xfffe5000,64896,110624,112672,0xfffe5000,64896,110640,112688,0xfffe5000,64896
.long 110656,112704,0xfffe5000,64896,110672,112720,0xfffe5000,64896,110688,112736,0xfffe5000,64896,110704,112752,0xfffe5000,64896
.long 110720,112768,0xfffe5000,64896,110736,112784,0xfffe5000,64896,110752,112800,0xfffe5000,64896,110768,112816,0xfffe5000,64896
.long 110784,112832,0xfffe5000,64896,110800,112848,0xfffe5000,64896,110816,112864,0xfffe5000,64896,110832,112880,0xfffe5000,64896
.long 110848,112896,0xfffe5000,64896,110864,112912,0xfffe5000,64896,110880,112928,0xfffe5000,64896,110896,112944,0,0
.long 110912,112960,0,0,110928,112976,0,0,110944,112992,0xfffe5000,64896,110960,113008,0,0
.long 110976,113024,0,0,110992,113040,0,0,111008,113056,0,0,111024,113072,0,0
.long 111040,113088,0,0,111056,113104,0,0,111072,113120,0,0,111088,113136,0,0
.long 111104,112640,0xfffe5000,64896,111120,112656,0xfffe5000,64896,111136,112672,0xfffe5000,64896,111152,112688,0xfffe5000,64896
.long 111168,112704,0xfffe5000,64896,111184,112720,0xfffe5000,64896,111200,112736,0xfffe5000,64896,111216,112752,0xfffe5000,64896
.long 111232,112768,0xfffe5000,64896,111248,112784,0xfffe5000,64896,111264,112800,0xfffe5000,64896,111280,112816,0xfffe5000,64896
.long 111296,112832,0xfffe5000,64896,111312,112848,0xfffe5000,64896,111328,112864,0xfffe5000,64896,111344,112880,0xfffe5000,64896
.long 111360,112896,0xfffe5000,64896,111376,112912,0xfffe5000,64896,111392,112928,0xfffe5000,64896,111408,112944,0,0
.long 111424,112960,0,0,111440,112976,0,0,111456,112992,0xfffe5000,64896,111472,113008,0,0
.long 111488,113024,0,0,111504,113040,0,0,111520,113056,0,0,111536,113072,0,0
.long 111552,113088,0,0,111568,113104,0,0,111584,113120,0,0,111600,113136,0,0
.long 5856,594560,1183264,1771968,5864,594568,1183272,1771976,5872,594576,1183280,1771984,5880,594584,1183288,1771992
.long 5888,594592,1183296,1772000,5896,594600,1183304,1772008,5904,594608,1183312,1772016,5912,594616,1183320,1772024
.long 5920,594624,1183328,1772032,5928,594632,1183336,1772040,5936,594640,1183344,1772048,5944,594648,1183352,1772056
.long 5952,594656,1183360,1772928,5960,594664,1183368,1772936,5968,594672,1183376,1772944,5976,594680,1183384,1772952
.long 5984,594688,1184256,1772960,5992,594696,1184264,1772968,6000,594704,1184272,1772976,6008,594712,1184280,1772984
.long 6016,595584,1184288,1772992,6024,595592,1184296,1773000,6032,595600,1184304,1773008,6040,595608,1184312,1773016
.long 6912,595616,1184320,1773024,6920,595624,1184328,1773032,6928,595632,1184336,1773040,6936,595640,1184344,1773048
.long 6944,595648,1184352,1773056,6952,595656,1184360,1773064,6960,595664,1184368,1773072,6968,595672,1184376,1773080
.long 6976,595680,1184384,1773088,6984,595688,1184392,1773096,6992,595696,1184400,1773104,7000,595704,1184408,1773112
.long 7008,595712,1184416,1773120,7016,595720,1184424,1773128,7024,595728,1184432,1773136,7032,595736,1184440,1773144
.long 7040,595744,1184448,1773152,7048,595752,1184456,1773160,7056,595760,1184464,1773168,7064,595768,1184472,1773176
.long 7072,595776,1184480,1773184,7080,595784,1184488,1773192,7088,595792,1184496,1773200,7096,595800,1184504,1773208
.long 7104,595808,1184512,1774080,7112,595816,1184520,1774088,7120,595824,1184528,1774096,7128,595832,1184536,1774104
.long 7136,595840,1185408,1774112,7144,595848,1185416,1774120,7152,595856,1185424,1774128,7160,595864,1185432,1774136
.long 7168,596736,1185440,1774144,7176,596744,1185448,1774152,7184,596752,1185456,1774160,7192,596760,1185464,1774168
.long 8064,596768,1185472,1774176,8072,596776,1185480,1774184,8080,596784,1185488,1774192,8088,596792,1185496,1774200
.long 0x40000000,0xdddddddd,0,0,0x40000000,0xdddddddd,8,16,0x40000000,0xdddddddd,16,32,0x40000000,0xdddddddd,24,48
.long 0x40000000,0xdddddddd,32,0,0x40000000,0xdddddddd,40,16,0x40000000,0xdddddddd,48,32,0x40000000,0xdddddddd,56,48
.long 0x40000000,0xdddddddd,64,0,0x40000000,0xdddddddd,72,16,0x40000000,0xdddddddd,80,32,0x40000000,0xdddddddd,88,48
.long 0x40000000,0xdddddddd,96,0,0x40000000,0xdddddddd,104,16,0x40000000,0xdddddddd,112,32,0x40000000,0xdddddddd,120,48
.long 0x40000000,0xdddddddd,128,0,0x40000000,0xdddddddd,136,16,0x40000000,0xdddddddd,144,32,0x40000000,0xdddddddd,152,48
.long 0x40000000,0xdddddddd,160,0,0x40000000,0xdddddddd,168,16,0x40000000,0xdddddddd,176,32,0x40000000,0xdddddddd,184,48
.long 0x40000000,0xdddddddd,192,0,0x40000000,0xdddddddd,200,16,0x40000000,0xdddddddd,208,32,0x40000000,0xdddddddd,216,48
.long 0x40000000,0xdddddddd,224,0,0x40000000,0xdddddddd,232,16,0x40000000,0xdddddddd,240,32,0x40000000,0xdddddddd,248,48
.long 0x40000000,0xdddddddd,0x40000000,0,0x40000000,0xdddddddd,0x40000000,16,0x40000000,0xdddddddd,0x40000000,32,0x40000000,0xdddddddd,0x40000000,48
.long 0x40000000,0xdddddddd,0x40000000,0,0x40000000,0xdddddddd,0x40000000,16,0x40000000,0xdddddddd,0x40000000,32,0x40000000,0xdddddddd,0x40000000,48
.long 0x40000000,0xdddddddd,0x40000000,0,0x40000000,0xdddddddd,0x40000000,16,0x40000000,0xdddddddd,0x40000000,32,0x40000000,0xdddddddd,0x40000000,48
.long 0x40000000,0xdddddddd,0x40000000,0,0x40000000,0xdddddddd,0x40000000,16,0x40000000,0xdddddddd,0x40000000,32,0x40000000,0xdddddddd,0x40000000,48
.long 0x40000000,0xdddddddd,0x40000000,0,0x40000000,0xdddddddd,0x40000000,16,0x40000000,0xdddddddd,0x40000000,32,0x40000000,0xdddddddd,0x40000000,48
.long 0x40000000,0xdddddddd,0x40000000,0,0x40000000,0xdddddddd,0x40000000,16,0x40000000,0xdddddddd,0x40000000,32,0x40000000,0xdddddddd,0x40000000,48
.long 0x40000000,0xdddddddd,0x40000000,0,0x40000000,0xdddddddd,0x40000000,16,0x40000000,0xdddddddd,0x40000000,32,0x40000000,0xdddddddd,0x40000000,48
.long 0x40000000,0xdddddddd,0x40000000,0,0x40000000,0xdddddddd,0x40000000,16,0x40000000,0xdddddddd,0x40000000,32,0x40000000,0xdddddddd,0x40000000,48
.long 16256,0,0,0,0x3f800000,0,0,0,0,16256,0,0,0,0x3f800000,0,0
.long 0,0,0,0,0,0,0,0,0,0,0,0,0,0,0,0
.long 0,0,0,0,0,0,0,0,0,0,0,0,0,0,0,0
.long 0,0,0,0,0,0,0,0,0,0,0,0,0,0,0,0
.long 0,0,0,0,0,0,0,0,0,0,0,0,0,0,0,0
.long 16256,0,0,0,0x3f800000,0,0,0,0,16256,0,0,0,0x3f800000,0,0
.long 0,0,0,0,0,0,0,0,0,0,0,0,0,0,0,0
.long 0,0,0,0,0,0,0,0,0,0,0,0,0,0,0,0
.long 0,0,0,0,0,0,0,0,0,0,0,0,0,0,0,0
.long 0,0,0,0,0,0,0,0,0,0,0,0,0,0,0,0
.long 16256,0,0,0,0x3f800000,0,0,0,0,16256,0,0,0,0x3f800000,0,0
.long 0,0,0,0,0,0,0,0,0,0,0,0,0,0,0,0
.long 0,0,0,0,0,0,0,0,0,0,0,0,0,0,0,0
.long 0,0,0,0,0,0,0,0,0,0,0,0,0,0,0,0
.long 0,0,0,0,0,0,0,0,0,0,0,0,0,0,0,0
.long 16256,0,0,0,0x3f800000,0,0,0,0,16256,0,0,0,0x3f800000,0,0
.long 16256,0,0,0,0x3f800000,0,16,8,0,16256,32,16,0,0x3f800000,48,24
.long 0,0,64,32,0,0,80,40,0,0,96,48,0,0,112,56
.long 0,0,128,64,0,0,144,72,0,0,160,80,0,0,176,88
.long 0,0,192,96,0,0,208,104,0,0,224,112,0,0,240,120
.long 0,0,512,2432,0,0,528,2440,0,0,544,2448,0,0,560,2456
.long 16256,0,576,2464,0x3f800000,0,592,2472,0,16256,608,2480,0,0x3f800000,624,2488
.long 0,0,640,2496,0,0,656,2504,0,0,672,2512,0,0,688,2520
.long 0,0,704,2528,0,0,720,2536,0,0,736,2544,0,0,752,2552
.long 0,0,1024,4864,0,0,1040,4872,0,0,1056,4880,0,0,1072,4888
.long 0,0,1088,4896,0,0,1104,4904,0,0,1120,4912,0,0,1136,4920
.long 16256,0,1152,4928,0x3f800000,0,1168,4936,0,16256,1184,4944,0,0x3f800000,1200,4952
.long 0,0,1216,4960,0,0,1232,4968,0,0,1248,4976,0,0,1264,4984
.long 0,0,1536,7296,0,0,1552,7304,0,0,1568,7312,0,0,1584,7320
.long 0,0,1600,7328,0,0,1616,7336,0,0,1632,7344,0,0,1648,7352
.long 0,0,1664,7360,0,0,1680,7368,0,0,1696,7376,0,0,1712,7384
.long 16256,0,1728,7392,0x3f800000,0,1744,7400,0,16256,1760,7408,0,0x3f800000,1776,7416
.long 0,0,0,0,0,0,8,0,0,0,16,0,0,0,24,0
.long 0,0,32,0,0,0,40,0,0,0,48,0,0,0,56,0
.long 0,0,64,0,0,0,72,0,0,0,80,0,0,0,88,0
.long 0,0,96,0,0,0,104,0,0,0,112,0,0,0,120,0
.long 0,0,0x40000000,0,0,0,0x40000000,0,0,0,0x40000000,0,0,0,0x40000000,0
.long 0,0,0x40000000,0,0,0,0x40000000,0,0,0,0x40000000,0,0,0,0x40000000,0
.long 0,0,0x40000000,0,0,0,0x40000000,0,0,0,0x40000000,0,0,0,0x40000000,0
.long 0,0,0x40000000,0,0,0,0x40000000,0,0,0,0x40000000,0,0,0,0x40000000,0
.long 0,0,0x40000000,0,0,0,0x40000000,0,0,0,0x40000000,0,0,0,0x40000000,0
.long 0,0,0x40000000,0,0,0,0x40000000,0,0,0,0x40000000,0,0,0,0x40000000,0
.long 0,0,0x40000000,0,0,0,0x40000000,0,0,0,0x40000000,0,0,0,0x40000000,0
.long 0,0,0x40000000,0,0,0,0x40000000,0,0,0,0x40000000,0,0,0,0x40000000,0
.long 0,0,0x40000000,0,0,0,0x40000000,0,0,0,0x40000000,0,0,0,0x40000000,0
.long 0,0,0x40000000,0,0,0,0x40000000,0,0,0,0x40000000,0,0,0,0x40000000,0
.long 0,0,0x40000000,0,0,0,0x40000000,0,0,0,0x40000000,0,0,0,0x40000000,0
.long 0,0,0x40000000,0,0,0,0x40000000,0,0,0,0x40000000,0,0,0,0x40000000,0
.long 56832,3152,0,0,57424,3168,0,0,58016,3184,0,0,58608,3200,0,0
.long 59200,3216,0,0,59792,3232,0,0,60384,3248,0,0,60976,3264,0,0
.long 61568,3280,0,0,62160,3296,0,0,62752,3312,0,0,63344,3328,0,0
.long 63936,3344,0,0,64528,3360,0,0,65120,3376,0,0,65712,3392,0,0
.long 56848,3408,0,0,57440,3424,0,0,58032,3440,0,0,58624,3456,0,0
.long 59216,3472,0,0,59808,3488,0,0,60400,3504,0,0,60992,3520,0,0
.long 61584,3552,0,0,62176,3568,0,0,62768,3584,0,0,63360,3600,0,0
.long 63952,3616,0,0,64544,3632,0,0,65136,3648,0,0,65728,3664,0,0
.long 56864,3680,0,0,57456,3696,0,0,58048,3712,0,0,58640,3728,0,0
.long 59232,3744,0,0,59824,3760,0,0,60416,3776,0,0,61008,3792,0,0
.long 61600,3808,0,0,62192,3824,0,0,62784,3840,0,0,63376,3856,0,0
.long 63968,3872,0,0,64560,3888,0,0,65152,3904,0,0,65744,3920,0,0
.long 56880,3936,0,0,57472,3952,0,0,58064,3968,0,0,58656,3984,0,0
.long 59248,4000,0,0,59840,4016,0,0,60432,4032,0,0,61024,4048,0,0
.long 61616,4064,0,0,62208,4080,0,0,62800,4096,0,0,63392,4112,0,0
.long 63984,4144,0,0,64576,4160,0,0,65168,4176,0,0,65760,4192,0,0
.long 7360,11568,15776,19984,7376,11584,15792,20000,7392,11600,15808,20016,7408,11616,15824,20032
.long 7424,11632,15840,20048,7440,11648,15856,20064,7456,11664,15872,20080,7472,11680,15888,20096
.long 7488,11696,15904,20128,7504,11712,15920,20144,7520,11728,15936,20160,7536,11744,15952,20176
.long 7552,11760,15984,20192,7568,11776,16000,20208,7584,11792,16016,20224,7600,11808,16032,20240
.long 7616,11840,16048,20256,7632,11856,16064,20272,7648,11872,16080,20288,7664,11888,16096,20304
.long 7696,11904,16112,20320,7712,11920,16128,20336,7728,11936,16144,20352,7744,11952,16160,20368
.long 7760,11968,16176,20384,7776,11984,16192,20400,7792,12000,16208,20416,7808,12016,16224,20432
.long 7824,12032,16240,20448,7840,12048,16256,20464,7856,12064,16272,20480,7872,12080,16288,20496
.long 7888,12096,16304,20512,7904,12112,16320,20528,7920,12128,16336,20544,7936,12144,16352,20560
.long 7952,12160,16368,20576,7968,12176,16384,20592,7984,12192,16400,20608,8000,12208,16416,20624
.long 8016,12224,16432,20640,8032,12240,16448,20656,8048,12256,16464,20672,8064,12272,16480,20688
.long 8080,12288,16496,20720,8096,12304,16512,20736,8112,12320,16528,20752,8128,12336,16544,20768
.long 8144,12352,16576,20784,8160,12368,16592,20800,8176,12384,16608,20816,8192,12400,16624,20832
.long 8208,12432,16640,20848,8224,12448,16656,20864,8240,12464,16672,20880,8256,12480,16688,20896
.long 8288,12496,16704,20912,8304,12512,16720,20928,8320,12528,16736,20944,8336,12544,16752,20960
.long 8352,12560,16768,20976,8368,12576,16784,20992,8384,12592,16800,21008,8400,12608,16816,21024
L_tab_end:
.size L_tab, L_tab_end-L_tab
.section .rodata,"a"
.p2align 6
.amdhsa_kernel parallel_sum__grouped_kv_mqa__geglu_ffn__prompt_kernel
  .amdhsa_next_free_vgpr 512
  .amdhsa_next_free_sgpr 102
  .amdhsa_accum_offset 256
  .amdhsa_group_segment_fixed_size 0
  .amdhsa_kernarg_size 96
  .amdhsa_user_sgpr_count 2
  .amdhsa_user_sgpr_kernarg_segment_ptr 1
  .amdhsa_system_sgpr_workgroup_id_x 1
.end_amdhsa_kernel
```
